```python
import torch

def _softmax(x, axis=-1):
    return torch.softmax(x, dim=axis)
def _gelu(x):
    return torch.nn.functional.gelu(x, approximate="tanh")
def _silu(x):
    return torch.nn.functional.silu(x)
def _sigmoid(x):
    return torch.sigmoid(x)
def _layernorm(x, axis=-1, eps=1e-5):
    m = x.mean(dim=axis, keepdim=True)
    v = x.var(dim=axis, keepdim=True, unbiased=False)
    return (x - m) / torch.sqrt(v + eps)
def _scatter_add(tgt, idx, src, axis=0):
    return tgt.clone().index_add_(axis, idx, src)
def _segment_sum(src, seg, n):
    out = torch.zeros((n,) + src.shape[1:], dtype=src.dtype)
    return out.index_add_(0, seg, src)
def _pad(x, pw):
    flat = tuple(v for pair in reversed(pw) for v in pair)
    return torch.nn.functional.pad(x, flat)

kernel_name = 'parallel_sum__linear_attn_block__dense_activation_squared_relu__prompt'

def setup_inputs():

    _w = (lambda a: (lambda t: t.to(torch.bfloat16) if t.is_floating_point() else t)(torch.as_tensor(a)))
    def _A_setup():
        B, S, D = 1, 2048, 448
        return {
            "x": _w((lambda *s: torch.randn(*s, dtype=torch.bfloat16) * 0.05)(B, S, D)),
            "wqkv": _w((lambda *s: torch.randn(*s, dtype=torch.bfloat16) * 0.4)(D, 3 * D)),
            "wo": _w((lambda *s: torch.randn(*s, dtype=torch.bfloat16) * 0.4)(D, D)),
        }
    _A_in = _A_setup()

    def _B_setup():
        B, S, D, F = 1, 2048, 448, 1792
        return {
            "x": _w((lambda *s: torch.randn(*s, dtype=torch.bfloat16) * 0.05)(B, S, D)),
            "w1": _w((lambda *s: torch.randn(*s, dtype=torch.bfloat16) * 0.05)(D, F)),
            "b1": _w((lambda *s: torch.randn(*s, dtype=torch.bfloat16) * 0.4)(F)),
            "w2": _w((lambda *s: torch.randn(*s, dtype=torch.bfloat16) * 0.05)(F, D)),
            "b2": _w((lambda *s: torch.randn(*s, dtype=torch.bfloat16) * 1.6)(D)),
        }
    _B_in = _B_setup()

    return {
        "A_x": _A_in["x"],
        "A_wqkv": _A_in["wqkv"],
        "A_wo": _A_in["wo"],
        "B_x": _B_in["x"],
        "B_w1": _B_in["w1"],
        "B_b1": _B_in["b1"],
        "B_w2": _B_in["w2"],
        "B_b2": _B_in["b2"],
    }

def reference(A_x, A_wqkv, A_wo, B_x, B_w1, B_b1, B_w2, B_b2):
    def _A_ref(x, wqkv, wo):
        B, S, D = x.shape
        H = 16; Dh = D // H
        qkv = (lambda x, *d: x.permute(*d))((x @ wqkv).reshape(B, S, 3, H, Dh), 2, 0, 3, 1, 4)
        q, k, v = qkv[0], qkv[1], qkv[2]
        phi = lambda t: torch.where(t > 0, t + 1, torch.exp(t)) + 1e-6
        pq, pk = phi(q), phi(k)
        kv = torch.einsum("bhsd,bhse->bhde", pk, v)
        z = torch.einsum("bhsd->bhd", pk)
        num = torch.einsum("bhqd,bhde->bhqe", pq, kv)
        den = torch.einsum("bhqd,bhd->bhq", pq, z)[..., None] + 1e-6
        o = num / den
        return (lambda x, *d: x.permute(*d))(o, 0, 2, 1, 3).reshape(B, S, D) @ wo

    def _B_ref(x, w1, b1, w2, b2):
        h = torch.einsum("bsd,df->bsf", x, w1) + b1
        zero = torch.zeros_like(h)
        r = torch.where(h > zero, h, zero)
        h = r * r
        out = torch.einsum("bsf,fd->bsd", h, w2) + b2
        return out

    x = A_x
    xn = _layernorm(x, axis=-1)
    return x + _A_ref(xn, A_wqkv, A_wo) + _B_ref(xn, B_w1, B_b1, B_w2, B_b2)
```

```asm
; @launch grid=(256,1,1) block=(512,1,1) lds=163840
.amdgcn_target "amdgcn-amd-amdhsa--gfx950"
.text
.globl parallel_sum__linear_attn_block__dense_activation_squared_relu__prompt_kernel
.p2align 8
.type parallel_sum__linear_attn_block__dense_activation_squared_relu__prompt_kernel,@function
parallel_sum__linear_attn_block__dense_activation_squared_relu__prompt_kernel:
s_cmp_ge_u32 s2, 256
s_cbranch_scc1 kernel_exit
s_load_dwordx16 s[8:23], s[0:1], 0
s_load_dwordx4 s[24:27], s[0:1], 64
s_load_dwordx2 s[28:29], s[0:1], 80
s_getpc_b64 s[36:37]
entry_pc:
s_and_b32 s37, s37, 0xffff
s_mov_b32 s38, role_E_end-entry_pc+1024
s_mov_b32 s39, 0x20000
v_lshlrev_b32 v2, 12, v0
s_lshl_b32 s59, s2, 4
s_and_b32 s59, s59, 0xf80
buffer_load_dword v63, v2, s[36:39], s59 offen
v_lshrrev_b32 v1, 6, v0
v_and_b32 v0, 63, v0
v_readfirstlane_b32 s3, v1
s_lshr_b32 s6, s2, 4
s_and_b32 s5, s2, 4
s_lshl_b32 s5, s5, 2
s_add_u32 s5, s5, s6
s_cmp_ge_u32 s3, 4
s_cbranch_scc1 helpers
v_lshrrev_b32 v4, 3, v0
v_and_b32 v5, 7, v0
v_mul_u32_u24 v6, 896, v4
v_lshl_add_u32 v6, v5, 4, v6
s_lshl_b32 s59, s5, 2
s_add_u32 s59, s59, s3
s_bfe_u32 s47, s2, 0x10000
s_lshl1_add_u32 s60, s59, s47
s_mul_i32 s59, s60, 7168
s_mov_b32 s34, 1835008
s_mov_b32 s35, 0x20000
s_waitcnt lgkmcnt(0)
s_mov_b32 s32, s8
s_and_b32 s33, s9, 0xffff
buffer_load_dwordx4 v[176:179], v6, s[32:35], s59 offen offset:0
buffer_load_dwordx4 v[180:183], v6, s[32:35], s59 offen offset:128
buffer_load_dwordx4 v[184:187], v6, s[32:35], s59 offen offset:256
buffer_load_dwordx4 v[188:191], v6, s[32:35], s59 offen offset:384
buffer_load_dwordx4 v[192:195], v6, s[32:35], s59 offen offset:512
buffer_load_dwordx4 v[196:199], v6, s[32:35], s59 offen offset:640
buffer_load_dwordx4 v[200:203], v6, s[32:35], s59 offen offset:768
s_load_dword s14, s[28:29], 12
s_xor_b32 s60, s60, 1
s_mul_i32 s60, s60, 7168
s_lshr_b32 s30, s3, 1
s_and_b32 s31, s3, 1
s_and_b32 s4, s2, 3
s_lshl_b32 s4, s4, 1
s_bfe_u32 s7, s2, 0x10003
s_add_u32 s4, s4, s7
s_lshl_b32 s4, s4, 2
s_lshr_b32 s4, 0x74652130, s4
s_and_b32 s4, s4, 7
s_sub_u32 s46, 7, s4
s_min_u32 s46, s46, s4
s_mov_b32 s63, 30000
s_mul_i32 s59, s30, 30720
s_add_u32 s59, s59, 4096
s_lshl1_add_u32 s61, s31, s47
s_lshl_b32 s61, s61, 7
s_add_u32 s61, s61, s59
s_lshl_b32 s47, s47, 8
s_sub_u32 s47, 128, s47
v_mul_u32_u24 v8, 528, v5
v_lshl_add_u32 v8, v4, 4, v8
v_add_u32 v8, s61, v8
v_mov_b32 v27, 0x3f803f80
v_lshlrev_b32 v20, 4, v0
v_add_u32 v10, s59, v20
s_lshl_b32 s61, s31, 11
v_add_u32 v11, s61, v10
v_bfe_u32 v2, v0, 2, 2
v_lshlrev_b32 v2, 6, v2
v_add_u32 v2, 65536, v2
s_lshl_b32 s61, s4, 2
s_lshr_b32 s45, 0x42345600, s61
s_and_b32 s45, s45, 15
s_lshl_b32 s45, s45, 3
s_min_u32 s61, s46, 2
s_lshr_b32 s61, 112, s61
s_mul_i32 s61, s61, s31
s_add_u32 s45, s45, s61
s_lshl_b32 s61, s31, 9
s_cmp_eq_u32 s46, 0
s_cbranch_scc1 setup_E
s_mov_b32 s44, 128
v_lshrrev_b32 v1, 4, v0
v_mul_u32_u24 v9, 272, v1
v_add_u32 v9, v9, v10
v_lshl_add_u32 v2, v1, 10, v2
v_and_b32 v3, 3, v0
v_lshlrev_b32 v3, 2, v3
v_and_b32 v62, 16, v0
v_add_u32 v60, s45, v3
v_cmp_le_u32 vcc, s44, v60
v_subrev_u32 v61, 32, v60
s_nop 0
v_cndmask_b32 v60, v60, v61, vcc
v_xor_b32 v60, v60, v62
v_lshrrev_b32 v1, 6, v60
v_lshl_add_u32 v28, v1, 12, v2
v_bfe_u32 v1, v60, 5, 1
v_lshl_add_u32 v28, v1, 9, v28
v_and_b32 v1, 31, v60
v_lshl_add_u32 v28, v1, 1, v28
v_add_u32 v29, 0x10000, v28
s_add_u32 s45, s45, 16
v_add_u32 v60, s45, v3
v_cmp_le_u32 vcc, s44, v60
v_subrev_u32 v61, 32, v60
s_nop 0
v_cndmask_b32 v60, v60, v61, vcc
v_xor_b32 v60, v60, v62
v_lshrrev_b32 v1, 6, v60
v_lshl_add_u32 v30, v1, 12, v2
v_bfe_u32 v1, v60, 5, 1
v_lshl_add_u32 v30, v1, 9, v30
v_and_b32 v1, 31, v60
v_lshl_add_u32 v30, v1, 1, v30
v_add_u32 v31, 0x10000, v30
s_add_u32 s45, s45, 12
v_add_u32 v60, s45, v3
v_cmp_le_u32 vcc, s44, v60
v_subrev_u32 v61, 32, v60
s_nop 0
v_cndmask_b32 v60, v60, v61, vcc
v_xor_b32 v60, v60, v62
v_lshrrev_b32 v1, 6, v60
v_lshl_add_u32 v32, v1, 12, v2
v_bfe_u32 v1, v60, 5, 1
v_lshl_add_u32 v32, v1, 9, v32
v_and_b32 v1, 31, v60
v_lshl_add_u32 v32, v1, 1, v32
v_add_u32 v33, 0x10000, v32
s_add_u32 s45, s45, 16
v_add_u32 v60, s45, v3
v_cmp_le_u32 vcc, s44, v60
v_subrev_u32 v61, 32, v60
s_nop 0
v_cndmask_b32 v60, v60, v61, vcc
v_xor_b32 v60, v60, v62
v_lshrrev_b32 v1, 6, v60
v_lshl_add_u32 v34, v1, 12, v2
v_bfe_u32 v1, v60, 5, 1
v_lshl_add_u32 v34, v1, 9, v34
v_and_b32 v1, 31, v60
v_lshl_add_u32 v34, v1, 1, v34
v_add_u32 v35, 0x10000, v34
v_add_u32 v60, v3, v62
v_lshl_add_u32 v14, v60, 1, v2
v_add_u32 v14, s61, v14
v_add_u32 v15, 0x10000, v14
v_xor_b32 v16, 32, v14
v_xor_b32 v17, 32, v15
v_and_b32 v36, 31, v0
s_branch setup_join
setup_E:
s_mov_b32 s44, 256
v_lshrrev_b32 v1, 5, v0
v_lshl_add_u32 v9, v1, 4, v10
v_lshl_add_u32 v2, v1, 10, v2
v_and_b32 v60, 2, v0
v_and_b32 v61, 1, v0
v_bfe_u32 v1, v0, 4, 1
v_lshlrev_b32 v3, 3, v60
v_lshl_add_u32 v3, v1, 3, v3
v_lshl_add_u32 v3, v61, 2, v3
v_lshl_add_u32 v16, v3, 1, v2
v_add_u32 v16, s61, v16
v_add_u32 v17, 0x10000, v16
v_lshl_add_u32 v14, v60, 2, v2
v_lshl_add_u32 v14, v61, 4, v14
v_lshl_add_u32 v14, v1, 5, v14
v_add_u32 v14, s61, v14
v_add_u32 v15, 0x10000, v14
v_add_u32 v60, s45, v3
v_cmp_le_u32 vcc, s44, v60
v_subrev_u32 v61, 32, v60
s_nop 0
v_cndmask_b32 v60, v60, v61, vcc
v_lshrrev_b32 v1, 6, v60
v_lshl_add_u32 v28, v1, 12, v2
v_bfe_u32 v1, v60, 5, 1
v_lshl_add_u32 v28, v1, 9, v28
v_and_b32 v1, 31, v60
v_lshl_add_u32 v28, v1, 1, v28
v_add_u32 v29, 0x10000, v28
s_add_u32 s45, s45, 28
v_add_u32 v60, s45, v3
v_cmp_le_u32 vcc, s44, v60
v_subrev_u32 v61, 32, v60
s_nop 0
v_cndmask_b32 v60, v60, v61, vcc
v_lshrrev_b32 v1, 6, v60
v_lshl_add_u32 v30, v1, 12, v2
v_bfe_u32 v1, v60, 5, 1
v_lshl_add_u32 v30, v1, 9, v30
v_and_b32 v1, 31, v60
v_lshl_add_u32 v30, v1, 1, v30
v_add_u32 v31, 0x10000, v30
v_and_b32 v36, 19, v0
v_bfe_u32 v37, v0, 2, 1
v_lshl_add_u32 v36, v37, 3, v36
v_bfe_u32 v37, v0, 3, 1
v_lshl_add_u32 v36, v37, 2, v36
setup_join:
s_lshl_b32 s61, s4, 2
s_sub_u32 s61, s61, 2
s_max_i32 s61, s61, 0
s_lshl_b32 s59, s61, 7
s_lshl_b32 s61, s31, 6
s_add_u32 s59, s59, s61
s_add_u32 s40, s18, s59
s_addc_u32 s41, s19, 0
s_and_b32 s41, s41, 0xffff
s_sub_u32 s42, 3584, s59
s_mov_b32 s43, 0x20000
v_lshrrev_b32 v37, 5, v0
v_lshlrev_b32 v37, 31, v37
v_lshl_add_u32 v36, v36, 1, v37
buffer_load_dwordx4 v[204:207], v6, s[32:35], s60 offen offset:0
buffer_load_dwordx4 v[208:211], v6, s[32:35], s60 offen offset:128
buffer_load_dwordx4 v[212:215], v6, s[32:35], s60 offen offset:256
buffer_load_dwordx4 v[216:219], v6, s[32:35], s60 offen offset:384
buffer_load_dwordx4 v[220:223], v6, s[32:35], s60 offen offset:512
buffer_load_dwordx4 v[224:227], v6, s[32:35], s60 offen offset:640
buffer_load_dwordx4 v[228:231], v6, s[32:35], s60 offen offset:768
s_barrier
s_mov_b32 s58, 0xffff0000
v_mov_b32 v232, 0
v_mov_b32 v233, 0
s_waitcnt vmcnt(13)
v_dot2c_f32_bf16 v232, v176, v27
v_dot2c_f32_bf16 v233, v176, v176
v_dot2c_f32_bf16 v232, v177, v27
v_dot2c_f32_bf16 v233, v177, v177
v_dot2c_f32_bf16 v232, v178, v27
v_dot2c_f32_bf16 v233, v178, v178
v_dot2c_f32_bf16 v232, v179, v27
v_dot2c_f32_bf16 v233, v179, v179
s_waitcnt vmcnt(12)
v_dot2c_f32_bf16 v232, v180, v27
v_dot2c_f32_bf16 v233, v180, v180
v_dot2c_f32_bf16 v232, v181, v27
v_dot2c_f32_bf16 v233, v181, v181
v_dot2c_f32_bf16 v232, v182, v27
v_dot2c_f32_bf16 v233, v182, v182
v_dot2c_f32_bf16 v232, v183, v27
v_dot2c_f32_bf16 v233, v183, v183
s_waitcnt vmcnt(11)
v_dot2c_f32_bf16 v232, v184, v27
v_dot2c_f32_bf16 v233, v184, v184
v_dot2c_f32_bf16 v232, v185, v27
v_dot2c_f32_bf16 v233, v185, v185
v_dot2c_f32_bf16 v232, v186, v27
v_dot2c_f32_bf16 v233, v186, v186
v_dot2c_f32_bf16 v232, v187, v27
v_dot2c_f32_bf16 v233, v187, v187
s_waitcnt vmcnt(10)
v_dot2c_f32_bf16 v232, v188, v27
v_dot2c_f32_bf16 v233, v188, v188
v_dot2c_f32_bf16 v232, v189, v27
v_dot2c_f32_bf16 v233, v189, v189
v_dot2c_f32_bf16 v232, v190, v27
v_dot2c_f32_bf16 v233, v190, v190
v_dot2c_f32_bf16 v232, v191, v27
v_dot2c_f32_bf16 v233, v191, v191
s_waitcnt vmcnt(9)
v_dot2c_f32_bf16 v232, v192, v27
v_dot2c_f32_bf16 v233, v192, v192
v_dot2c_f32_bf16 v232, v193, v27
v_dot2c_f32_bf16 v233, v193, v193
v_dot2c_f32_bf16 v232, v194, v27
v_dot2c_f32_bf16 v233, v194, v194
v_dot2c_f32_bf16 v232, v195, v27
v_dot2c_f32_bf16 v233, v195, v195
s_waitcnt vmcnt(8)
v_dot2c_f32_bf16 v232, v196, v27
v_dot2c_f32_bf16 v233, v196, v196
v_dot2c_f32_bf16 v232, v197, v27
v_dot2c_f32_bf16 v233, v197, v197
v_dot2c_f32_bf16 v232, v198, v27
v_dot2c_f32_bf16 v233, v198, v198
v_dot2c_f32_bf16 v232, v199, v27
v_dot2c_f32_bf16 v233, v199, v199
s_waitcnt vmcnt(7)
v_dot2c_f32_bf16 v232, v200, v27
v_dot2c_f32_bf16 v233, v200, v200
v_dot2c_f32_bf16 v232, v201, v27
v_dot2c_f32_bf16 v233, v201, v201
v_dot2c_f32_bf16 v232, v202, v27
v_dot2c_f32_bf16 v233, v202, v202
v_dot2c_f32_bf16 v232, v203, v27
v_dot2c_f32_bf16 v233, v203, v203
s_waitcnt lgkmcnt(0)
s_add_u32 s14, s14, 1
v_mov_b32 v23, s14
v_and_b32 v26, 0xffff, v23
v_add_f32_dpp v232, v232, v232 quad_perm:[1,0,3,2] row_mask:0xf bank_mask:0xf
v_add_f32_dpp v233, v233, v233 quad_perm:[1,0,3,2] row_mask:0xf bank_mask:0xf
s_nop 0
v_add_f32_dpp v232, v232, v232 quad_perm:[2,3,0,1] row_mask:0xf bank_mask:0xf
v_add_f32_dpp v233, v233, v233 quad_perm:[2,3,0,1] row_mask:0xf bank_mask:0xf
s_nop 0
v_add_f32_dpp v232, v232, v232 row_half_mirror row_mask:0xf bank_mask:0xf
v_add_f32_dpp v233, v233, v233 row_half_mirror row_mask:0xf bank_mask:0xf
v_mul_f32 v232, 0x3b124925, v232
v_mul_f32 v233, 0x3b124925, v233
v_fma_f32 v233, -v232, v232, v233
v_max_f32 v233, 0, v233
v_add_f32 v233, 0x3727c5ac, v233
v_rsq_f32 v234, v233
s_nop 0
v_mul_f32 v235, -v232, v234
v_lshlrev_b32 v236, 16, v176
v_and_b32 v237, s58, v176
v_lshlrev_b32 v238, 16, v177
v_and_b32 v239, s58, v177
v_lshlrev_b32 v240, 16, v178
v_and_b32 v241, s58, v178
v_lshlrev_b32 v242, 16, v179
v_and_b32 v243, s58, v179
v_pk_fma_f32 v[236:237], v[236:237], v[234:235], v[234:235] op_sel:[0,0,1] op_sel_hi:[1,0,1]
v_pk_fma_f32 v[238:239], v[238:239], v[234:235], v[234:235] op_sel:[0,0,1] op_sel_hi:[1,0,1]
v_pk_fma_f32 v[240:241], v[240:241], v[234:235], v[234:235] op_sel:[0,0,1] op_sel_hi:[1,0,1]
v_pk_fma_f32 v[242:243], v[242:243], v[234:235], v[234:235] op_sel:[0,0,1] op_sel_hi:[1,0,1]
v_cvt_pk_bf16_f32 v176, v236, v237
v_cvt_pk_bf16_f32 v177, v238, v239
v_cvt_pk_bf16_f32 v178, v240, v241
v_cvt_pk_bf16_f32 v179, v242, v243
ds_write_b128 v8, v[176:179] offset:0
v_lshlrev_b32 v236, 16, v180
v_and_b32 v237, s58, v180
v_lshlrev_b32 v238, 16, v181
v_and_b32 v239, s58, v181
v_lshlrev_b32 v240, 16, v182
v_and_b32 v241, s58, v182
v_lshlrev_b32 v242, 16, v183
v_and_b32 v243, s58, v183
v_pk_fma_f32 v[236:237], v[236:237], v[234:235], v[234:235] op_sel:[0,0,1] op_sel_hi:[1,0,1]
v_pk_fma_f32 v[238:239], v[238:239], v[234:235], v[234:235] op_sel:[0,0,1] op_sel_hi:[1,0,1]
v_pk_fma_f32 v[240:241], v[240:241], v[234:235], v[234:235] op_sel:[0,0,1] op_sel_hi:[1,0,1]
v_pk_fma_f32 v[242:243], v[242:243], v[234:235], v[234:235] op_sel:[0,0,1] op_sel_hi:[1,0,1]
v_cvt_pk_bf16_f32 v180, v236, v237
v_cvt_pk_bf16_f32 v181, v238, v239
v_cvt_pk_bf16_f32 v182, v240, v241
v_cvt_pk_bf16_f32 v183, v242, v243
ds_write_b128 v8, v[180:183] offset:4224
v_lshlrev_b32 v236, 16, v184
v_and_b32 v237, s58, v184
v_lshlrev_b32 v238, 16, v185
v_and_b32 v239, s58, v185
v_lshlrev_b32 v240, 16, v186
v_and_b32 v241, s58, v186
v_lshlrev_b32 v242, 16, v187
v_and_b32 v243, s58, v187
v_pk_fma_f32 v[236:237], v[236:237], v[234:235], v[234:235] op_sel:[0,0,1] op_sel_hi:[1,0,1]
v_pk_fma_f32 v[238:239], v[238:239], v[234:235], v[234:235] op_sel:[0,0,1] op_sel_hi:[1,0,1]
v_pk_fma_f32 v[240:241], v[240:241], v[234:235], v[234:235] op_sel:[0,0,1] op_sel_hi:[1,0,1]
v_pk_fma_f32 v[242:243], v[242:243], v[234:235], v[234:235] op_sel:[0,0,1] op_sel_hi:[1,0,1]
v_cvt_pk_bf16_f32 v184, v236, v237
v_cvt_pk_bf16_f32 v185, v238, v239
v_cvt_pk_bf16_f32 v186, v240, v241
v_cvt_pk_bf16_f32 v187, v242, v243
ds_write_b128 v8, v[184:187] offset:8448
v_lshlrev_b32 v236, 16, v188
v_and_b32 v237, s58, v188
v_lshlrev_b32 v238, 16, v189
v_and_b32 v239, s58, v189
v_lshlrev_b32 v240, 16, v190
v_and_b32 v241, s58, v190
v_lshlrev_b32 v242, 16, v191
v_and_b32 v243, s58, v191
v_pk_fma_f32 v[236:237], v[236:237], v[234:235], v[234:235] op_sel:[0,0,1] op_sel_hi:[1,0,1]
v_pk_fma_f32 v[238:239], v[238:239], v[234:235], v[234:235] op_sel:[0,0,1] op_sel_hi:[1,0,1]
v_pk_fma_f32 v[240:241], v[240:241], v[234:235], v[234:235] op_sel:[0,0,1] op_sel_hi:[1,0,1]
v_pk_fma_f32 v[242:243], v[242:243], v[234:235], v[234:235] op_sel:[0,0,1] op_sel_hi:[1,0,1]
v_cvt_pk_bf16_f32 v188, v236, v237
v_cvt_pk_bf16_f32 v189, v238, v239
v_cvt_pk_bf16_f32 v190, v240, v241
v_cvt_pk_bf16_f32 v191, v242, v243
ds_write_b128 v8, v[188:191] offset:12672
v_lshlrev_b32 v236, 16, v192
v_and_b32 v237, s58, v192
v_lshlrev_b32 v238, 16, v193
v_and_b32 v239, s58, v193
v_lshlrev_b32 v240, 16, v194
v_and_b32 v241, s58, v194
v_lshlrev_b32 v242, 16, v195
v_and_b32 v243, s58, v195
v_pk_fma_f32 v[236:237], v[236:237], v[234:235], v[234:235] op_sel:[0,0,1] op_sel_hi:[1,0,1]
v_pk_fma_f32 v[238:239], v[238:239], v[234:235], v[234:235] op_sel:[0,0,1] op_sel_hi:[1,0,1]
v_pk_fma_f32 v[240:241], v[240:241], v[234:235], v[234:235] op_sel:[0,0,1] op_sel_hi:[1,0,1]
v_pk_fma_f32 v[242:243], v[242:243], v[234:235], v[234:235] op_sel:[0,0,1] op_sel_hi:[1,0,1]
v_cvt_pk_bf16_f32 v192, v236, v237
v_cvt_pk_bf16_f32 v193, v238, v239
v_cvt_pk_bf16_f32 v194, v240, v241
v_cvt_pk_bf16_f32 v195, v242, v243
ds_write_b128 v8, v[192:195] offset:16896
v_lshlrev_b32 v236, 16, v196
v_and_b32 v237, s58, v196
v_lshlrev_b32 v238, 16, v197
v_and_b32 v239, s58, v197
v_lshlrev_b32 v240, 16, v198
v_and_b32 v241, s58, v198
v_lshlrev_b32 v242, 16, v199
v_and_b32 v243, s58, v199
v_pk_fma_f32 v[236:237], v[236:237], v[234:235], v[234:235] op_sel:[0,0,1] op_sel_hi:[1,0,1]
v_pk_fma_f32 v[238:239], v[238:239], v[234:235], v[234:235] op_sel:[0,0,1] op_sel_hi:[1,0,1]
v_pk_fma_f32 v[240:241], v[240:241], v[234:235], v[234:235] op_sel:[0,0,1] op_sel_hi:[1,0,1]
v_pk_fma_f32 v[242:243], v[242:243], v[234:235], v[234:235] op_sel:[0,0,1] op_sel_hi:[1,0,1]
v_cvt_pk_bf16_f32 v196, v236, v237
v_cvt_pk_bf16_f32 v197, v238, v239
v_cvt_pk_bf16_f32 v198, v240, v241
v_cvt_pk_bf16_f32 v199, v242, v243
ds_write_b128 v8, v[196:199] offset:21120
v_lshlrev_b32 v236, 16, v200
v_and_b32 v237, s58, v200
v_lshlrev_b32 v238, 16, v201
v_and_b32 v239, s58, v201
v_lshlrev_b32 v240, 16, v202
v_and_b32 v241, s58, v202
v_lshlrev_b32 v242, 16, v203
v_and_b32 v243, s58, v203
v_pk_fma_f32 v[236:237], v[236:237], v[234:235], v[234:235] op_sel:[0,0,1] op_sel_hi:[1,0,1]
v_pk_fma_f32 v[238:239], v[238:239], v[234:235], v[234:235] op_sel:[0,0,1] op_sel_hi:[1,0,1]
v_pk_fma_f32 v[240:241], v[240:241], v[234:235], v[234:235] op_sel:[0,0,1] op_sel_hi:[1,0,1]
v_pk_fma_f32 v[242:243], v[242:243], v[234:235], v[234:235] op_sel:[0,0,1] op_sel_hi:[1,0,1]
v_cvt_pk_bf16_f32 v200, v236, v237
v_cvt_pk_bf16_f32 v201, v238, v239
v_cvt_pk_bf16_f32 v202, v240, v241
v_cvt_pk_bf16_f32 v203, v242, v243
ds_write_b128 v8, v[200:203] offset:25344
v_mov_b32 v232, 0
v_mov_b32 v233, 0
s_waitcnt vmcnt(6)
v_dot2c_f32_bf16 v232, v204, v27
v_dot2c_f32_bf16 v233, v204, v204
v_dot2c_f32_bf16 v232, v205, v27
v_dot2c_f32_bf16 v233, v205, v205
v_dot2c_f32_bf16 v232, v206, v27
v_dot2c_f32_bf16 v233, v206, v206
v_dot2c_f32_bf16 v232, v207, v27
v_dot2c_f32_bf16 v233, v207, v207
s_waitcnt vmcnt(5)
v_dot2c_f32_bf16 v232, v208, v27
v_dot2c_f32_bf16 v233, v208, v208
v_dot2c_f32_bf16 v232, v209, v27
v_dot2c_f32_bf16 v233, v209, v209
v_dot2c_f32_bf16 v232, v210, v27
v_dot2c_f32_bf16 v233, v210, v210
v_dot2c_f32_bf16 v232, v211, v27
v_dot2c_f32_bf16 v233, v211, v211
s_waitcnt vmcnt(4)
v_dot2c_f32_bf16 v232, v212, v27
v_dot2c_f32_bf16 v233, v212, v212
v_dot2c_f32_bf16 v232, v213, v27
v_dot2c_f32_bf16 v233, v213, v213
v_dot2c_f32_bf16 v232, v214, v27
v_dot2c_f32_bf16 v233, v214, v214
v_dot2c_f32_bf16 v232, v215, v27
v_dot2c_f32_bf16 v233, v215, v215
s_waitcnt vmcnt(3)
v_dot2c_f32_bf16 v232, v216, v27
v_dot2c_f32_bf16 v233, v216, v216
v_dot2c_f32_bf16 v232, v217, v27
v_dot2c_f32_bf16 v233, v217, v217
v_dot2c_f32_bf16 v232, v218, v27
v_dot2c_f32_bf16 v233, v218, v218
v_dot2c_f32_bf16 v232, v219, v27
v_dot2c_f32_bf16 v233, v219, v219
s_waitcnt vmcnt(2)
v_dot2c_f32_bf16 v232, v220, v27
v_dot2c_f32_bf16 v233, v220, v220
v_dot2c_f32_bf16 v232, v221, v27
v_dot2c_f32_bf16 v233, v221, v221
v_dot2c_f32_bf16 v232, v222, v27
v_dot2c_f32_bf16 v233, v222, v222
v_dot2c_f32_bf16 v232, v223, v27
v_dot2c_f32_bf16 v233, v223, v223
s_waitcnt vmcnt(1)
v_dot2c_f32_bf16 v232, v224, v27
v_dot2c_f32_bf16 v233, v224, v224
v_dot2c_f32_bf16 v232, v225, v27
v_dot2c_f32_bf16 v233, v225, v225
v_dot2c_f32_bf16 v232, v226, v27
v_dot2c_f32_bf16 v233, v226, v226
v_dot2c_f32_bf16 v232, v227, v27
v_dot2c_f32_bf16 v233, v227, v227
s_waitcnt vmcnt(0)
v_dot2c_f32_bf16 v232, v228, v27
v_dot2c_f32_bf16 v233, v228, v228
v_dot2c_f32_bf16 v232, v229, v27
v_dot2c_f32_bf16 v233, v229, v229
v_dot2c_f32_bf16 v232, v230, v27
v_dot2c_f32_bf16 v233, v230, v230
v_dot2c_f32_bf16 v232, v231, v27
v_dot2c_f32_bf16 v233, v231, v231
v_add_u32 v8, s47, v8
buffer_load_ushort v56, v36, s[40:43], 0 offen offset:0
buffer_load_ushort v57, v36, s[40:43], 0 offen offset:128
buffer_load_ushort v58, v36, s[40:43], 0 offen offset:256
buffer_load_ushort v59, v36, s[40:43], 0 offen offset:384
v_add_f32_dpp v232, v232, v232 quad_perm:[1,0,3,2] row_mask:0xf bank_mask:0xf
v_add_f32_dpp v233, v233, v233 quad_perm:[1,0,3,2] row_mask:0xf bank_mask:0xf
s_nop 0
v_add_f32_dpp v232, v232, v232 quad_perm:[2,3,0,1] row_mask:0xf bank_mask:0xf
v_add_f32_dpp v233, v233, v233 quad_perm:[2,3,0,1] row_mask:0xf bank_mask:0xf
s_nop 0
v_add_f32_dpp v232, v232, v232 row_half_mirror row_mask:0xf bank_mask:0xf
v_add_f32_dpp v233, v233, v233 row_half_mirror row_mask:0xf bank_mask:0xf
v_mul_f32 v232, 0x3b124925, v232
v_mul_f32 v233, 0x3b124925, v233
v_fma_f32 v233, -v232, v232, v233
v_max_f32 v233, 0, v233
v_add_f32 v233, 0x3727c5ac, v233
v_rsq_f32 v234, v233
s_nop 0
v_mul_f32 v235, -v232, v234
v_lshlrev_b32 v236, 16, v204
v_and_b32 v237, s58, v204
v_lshlrev_b32 v238, 16, v205
v_and_b32 v239, s58, v205
v_lshlrev_b32 v240, 16, v206
v_and_b32 v241, s58, v206
v_lshlrev_b32 v242, 16, v207
v_and_b32 v243, s58, v207
v_pk_fma_f32 v[236:237], v[236:237], v[234:235], v[234:235] op_sel:[0,0,1] op_sel_hi:[1,0,1]
v_pk_fma_f32 v[238:239], v[238:239], v[234:235], v[234:235] op_sel:[0,0,1] op_sel_hi:[1,0,1]
v_pk_fma_f32 v[240:241], v[240:241], v[234:235], v[234:235] op_sel:[0,0,1] op_sel_hi:[1,0,1]
v_pk_fma_f32 v[242:243], v[242:243], v[234:235], v[234:235] op_sel:[0,0,1] op_sel_hi:[1,0,1]
v_cvt_pk_bf16_f32 v204, v236, v237
v_cvt_pk_bf16_f32 v205, v238, v239
v_cvt_pk_bf16_f32 v206, v240, v241
v_cvt_pk_bf16_f32 v207, v242, v243
ds_write_b128 v8, v[204:207] offset:0
v_lshlrev_b32 v236, 16, v208
v_and_b32 v237, s58, v208
v_lshlrev_b32 v238, 16, v209
v_and_b32 v239, s58, v209
v_lshlrev_b32 v240, 16, v210
v_and_b32 v241, s58, v210
v_lshlrev_b32 v242, 16, v211
v_and_b32 v243, s58, v211
v_pk_fma_f32 v[236:237], v[236:237], v[234:235], v[234:235] op_sel:[0,0,1] op_sel_hi:[1,0,1]
v_pk_fma_f32 v[238:239], v[238:239], v[234:235], v[234:235] op_sel:[0,0,1] op_sel_hi:[1,0,1]
v_pk_fma_f32 v[240:241], v[240:241], v[234:235], v[234:235] op_sel:[0,0,1] op_sel_hi:[1,0,1]
v_pk_fma_f32 v[242:243], v[242:243], v[234:235], v[234:235] op_sel:[0,0,1] op_sel_hi:[1,0,1]
v_cvt_pk_bf16_f32 v208, v236, v237
v_cvt_pk_bf16_f32 v209, v238, v239
v_cvt_pk_bf16_f32 v210, v240, v241
v_cvt_pk_bf16_f32 v211, v242, v243
ds_write_b128 v8, v[208:211] offset:4224
v_lshlrev_b32 v236, 16, v212
v_and_b32 v237, s58, v212
v_lshlrev_b32 v238, 16, v213
v_and_b32 v239, s58, v213
v_lshlrev_b32 v240, 16, v214
v_and_b32 v241, s58, v214
v_lshlrev_b32 v242, 16, v215
v_and_b32 v243, s58, v215
v_pk_fma_f32 v[236:237], v[236:237], v[234:235], v[234:235] op_sel:[0,0,1] op_sel_hi:[1,0,1]
v_pk_fma_f32 v[238:239], v[238:239], v[234:235], v[234:235] op_sel:[0,0,1] op_sel_hi:[1,0,1]
v_pk_fma_f32 v[240:241], v[240:241], v[234:235], v[234:235] op_sel:[0,0,1] op_sel_hi:[1,0,1]
v_pk_fma_f32 v[242:243], v[242:243], v[234:235], v[234:235] op_sel:[0,0,1] op_sel_hi:[1,0,1]
v_cvt_pk_bf16_f32 v212, v236, v237
v_cvt_pk_bf16_f32 v213, v238, v239
v_cvt_pk_bf16_f32 v214, v240, v241
v_cvt_pk_bf16_f32 v215, v242, v243
ds_write_b128 v8, v[212:215] offset:8448
v_lshlrev_b32 v236, 16, v216
v_and_b32 v237, s58, v216
v_lshlrev_b32 v238, 16, v217
v_and_b32 v239, s58, v217
v_lshlrev_b32 v240, 16, v218
v_and_b32 v241, s58, v218
v_lshlrev_b32 v242, 16, v219
v_and_b32 v243, s58, v219
v_pk_fma_f32 v[236:237], v[236:237], v[234:235], v[234:235] op_sel:[0,0,1] op_sel_hi:[1,0,1]
v_pk_fma_f32 v[238:239], v[238:239], v[234:235], v[234:235] op_sel:[0,0,1] op_sel_hi:[1,0,1]
v_pk_fma_f32 v[240:241], v[240:241], v[234:235], v[234:235] op_sel:[0,0,1] op_sel_hi:[1,0,1]
v_pk_fma_f32 v[242:243], v[242:243], v[234:235], v[234:235] op_sel:[0,0,1] op_sel_hi:[1,0,1]
v_cvt_pk_bf16_f32 v216, v236, v237
v_cvt_pk_bf16_f32 v217, v238, v239
v_cvt_pk_bf16_f32 v218, v240, v241
v_cvt_pk_bf16_f32 v219, v242, v243
ds_write_b128 v8, v[216:219] offset:12672
s_barrier
v_lshlrev_b32 v236, 16, v220
v_and_b32 v237, s58, v220
v_lshlrev_b32 v238, 16, v221
v_and_b32 v239, s58, v221
v_lshlrev_b32 v240, 16, v222
v_and_b32 v241, s58, v222
v_lshlrev_b32 v242, 16, v223
v_and_b32 v243, s58, v223
v_pk_fma_f32 v[236:237], v[236:237], v[234:235], v[234:235] op_sel:[0,0,1] op_sel_hi:[1,0,1]
v_pk_fma_f32 v[238:239], v[238:239], v[234:235], v[234:235] op_sel:[0,0,1] op_sel_hi:[1,0,1]
v_pk_fma_f32 v[240:241], v[240:241], v[234:235], v[234:235] op_sel:[0,0,1] op_sel_hi:[1,0,1]
v_pk_fma_f32 v[242:243], v[242:243], v[234:235], v[234:235] op_sel:[0,0,1] op_sel_hi:[1,0,1]
v_cvt_pk_bf16_f32 v220, v236, v237
v_cvt_pk_bf16_f32 v221, v238, v239
v_cvt_pk_bf16_f32 v222, v240, v241
v_cvt_pk_bf16_f32 v223, v242, v243
ds_write_b128 v8, v[220:223] offset:16896
v_lshlrev_b32 v236, 16, v224
v_and_b32 v237, s58, v224
v_lshlrev_b32 v238, 16, v225
v_and_b32 v239, s58, v225
v_lshlrev_b32 v240, 16, v226
v_and_b32 v241, s58, v226
v_lshlrev_b32 v242, 16, v227
v_and_b32 v243, s58, v227
v_pk_fma_f32 v[236:237], v[236:237], v[234:235], v[234:235] op_sel:[0,0,1] op_sel_hi:[1,0,1]
v_pk_fma_f32 v[238:239], v[238:239], v[234:235], v[234:235] op_sel:[0,0,1] op_sel_hi:[1,0,1]
v_pk_fma_f32 v[240:241], v[240:241], v[234:235], v[234:235] op_sel:[0,0,1] op_sel_hi:[1,0,1]
v_pk_fma_f32 v[242:243], v[242:243], v[234:235], v[234:235] op_sel:[0,0,1] op_sel_hi:[1,0,1]
v_cvt_pk_bf16_f32 v224, v236, v237
v_cvt_pk_bf16_f32 v225, v238, v239
v_cvt_pk_bf16_f32 v226, v240, v241
v_cvt_pk_bf16_f32 v227, v242, v243
ds_write_b128 v8, v[224:227] offset:21120
v_lshlrev_b32 v236, 16, v228
v_and_b32 v237, s58, v228
v_lshlrev_b32 v238, 16, v229
v_and_b32 v239, s58, v229
v_lshlrev_b32 v240, 16, v230
v_and_b32 v241, s58, v230
v_lshlrev_b32 v242, 16, v231
v_and_b32 v243, s58, v231
v_pk_fma_f32 v[236:237], v[236:237], v[234:235], v[234:235] op_sel:[0,0,1] op_sel_hi:[1,0,1]
v_pk_fma_f32 v[238:239], v[238:239], v[234:235], v[234:235] op_sel:[0,0,1] op_sel_hi:[1,0,1]
v_pk_fma_f32 v[240:241], v[240:241], v[234:235], v[234:235] op_sel:[0,0,1] op_sel_hi:[1,0,1]
v_pk_fma_f32 v[242:243], v[242:243], v[234:235], v[234:235] op_sel:[0,0,1] op_sel_hi:[1,0,1]
v_cvt_pk_bf16_f32 v228, v236, v237
v_cvt_pk_bf16_f32 v229, v238, v239
v_cvt_pk_bf16_f32 v230, v240, v241
v_cvt_pk_bf16_f32 v231, v242, v243
ds_write_b128 v8, v[228:231] offset:25344
s_cmp_gt_u32 s46, 1
s_cbranch_scc1 comp_M
s_cmp_eq_u32 s46, 0
s_cbranch_scc1 comp_E
s_branch comp_N
helpers:
s_and_b32 s4, s2, 3
s_lshl_b32 s4, s4, 1
s_bfe_u32 s7, s2, 0x10003
s_add_u32 s4, s4, s7
s_lshl_b32 s4, s4, 2
s_lshr_b32 s4, 0x74652130, s4
s_and_b32 s4, s4, 7
s_sub_u32 s46, 7, s4
s_min_u32 s46, s46, s4
s_mov_b32 s63, 30000
s_lshl_b32 s59, s3, 8
s_sub_u32 s59, s59, 1024
v_lshl_add_u32 v42, v0, 2, s59
v_mov_b32 v2, 0
ds_write_b32 v42, v2
s_waitcnt lgkmcnt(0)
s_load_dword s14, s[28:29], 12
s_mov_b32 s32, s10
s_and_b32 s33, s11, 0xffff
s_mov_b32 s34, 1204224
s_mov_b32 s35, 0x20000
s_cmp_ge_u32 s3, 6
s_cbranch_scc1 protos
s_cmp_gt_u32 s46, 1
s_cbranch_scc1 load_M
s_cmp_eq_u32 s46, 0
s_cbranch_scc1 load_E
s_branch load_N
protos:
s_cmp_eq_u32 s3, 6
s_cselect_b32 s36, s18, s22
s_cselect_b32 s37, s19, s23
s_cselect_b32 s38, 28, 7
s_lshl_b32 s38, s38, 7
s_and_b32 s37, s37, 0xffff
s_mov_b32 s39, 0x20000
v_lshlrev_b32 v2, 11, v0
s_lshl_b32 s59, s6, 7
buffer_load_dword v38, v2, s[36:39], s59 offen
s_cmp_gt_u32 s46, 1
s_cbranch_scc1 proto_M
s_cmp_eq_u32 s46, 0
s_cbranch_scc1 proto_E
s_branch proto_N
kernel_exit:
s_endpgm
.p2align 7
role_M_start:
.p2align 6
proto_M:
s_sub_u32 s30, s3, 6
s_mov_b32 s31, 0
s_barrier
s_mov_b32 s52, s28
s_and_b32 s53, s29, 0xffff
s_mov_b32 s54, 67108864
s_mov_b32 s55, 0x20000
s_waitcnt lgkmcnt(0)
s_add_u32 s14, s14, 1
s_cmp_gt_u32 s4, 3
s_subb_u32 s60, s4, 0
s_mul_i32 s61, s5, 7
s_add_u32 s60, s60, s61
s_lshl_b32 s61, s3, 8
s_add_u32 s60, s60, s61
s_lshl_b32 s60, s60, 7
s_add_u32 s60, s60, 22937600
s_load_dword s26, s[28:29], s60 glc
s_barrier
s_sub_u32 s59, s4, 3
s_cmp_gt_u32 s59, 1
s_cbranch_scc1 pM_nol11
s_lshr_b32 s59, s4, 1
s_lshl_b32 s59, s59, 1
s_add_u32 s59, s59, s30
s_lshl_b32 s59, s59, 5
s_add_u32 s61, s59, s5
s_lshl_b32 s61, s61, 7
s_lshr_b32 s59, s61, 11
s_lshl_b32 s59, s59, 17
s_and_b32 s58, s61, 2047
s_add_u32 s59, s59, s58
s_add_u32 s59, s59, 1048576
s_add_u32 s60, s59, 65536
s_add_u32 s61, s61, 5242880
v_lshrrev_b32 v20, 3, v0
v_lshlrev_b32 v20, 11, v20
v_and_b32 v33, 7, v0
v_lshl_add_u32 v20, v33, 4, v20
v_lshlrev_b32 v13, 4, v0
s_and_b32 s58, s14, 0xffff
v_mov_b32 v12, s58
s_mov_b32 s58, 0xffff0000
v_mov_b32 v28, 0x3f80
v_mov_b32 v29, 1.0
v_add_u32 v21, 16384, v20
v_add_u32 v22, 16384, v21
v_add_u32 v23, 16384, v22
v_add_u32 v24, 16384, v23
v_add_u32 v25, 16384, v24
v_add_u32 v26, 16384, v25
v_add_u32 v27, 16384, v26
pM_tk2:
s_cmp_ge_u32 s31, 23
s_cbranch_scc1 pM_tk2x
s_barrier
s_add_u32 s31, s31, 1
s_branch pM_tk2
pM_tk2x:
pM_l1_3:
buffer_load_dwordx4 v[64:67], v20, s[52:55], s59 offen sc1
buffer_load_dwordx4 v[68:71], v21, s[52:55], s59 offen sc1
buffer_load_dwordx4 v[72:75], v22, s[52:55], s59 offen sc1
buffer_load_dwordx4 v[76:79], v23, s[52:55], s59 offen sc1
buffer_load_dwordx4 v[80:83], v24, s[52:55], s59 offen sc1
buffer_load_dwordx4 v[84:87], v25, s[52:55], s59 offen sc1
buffer_load_dwordx4 v[88:91], v26, s[52:55], s59 offen sc1
buffer_load_dwordx4 v[92:95], v27, s[52:55], s59 offen sc1
s_cmp_ge_u32 s31, 45
s_cbranch_scc1 pM_tk4
s_barrier
s_add_u32 s31, s31, 1
pM_tk4:
s_waitcnt vmcnt(7)
v_lshlrev_b32 v128, 16, v64
v_lshlrev_b32 v129, 16, v65
v_lshlrev_b32 v130, 16, v66
v_and_b32 v132, s58, v64
v_and_b32 v133, s58, v65
v_and_b32 v134, s58, v66
v_and_b32 v135, s58, v67
v_mov_b32 v131, 0
v_xor_b32 v3, v67, v12
s_waitcnt vmcnt(6)
v_xor_b32 v10, v71, v12
v_or_b32 v3, v3, v10
v_and_b32 v71, s58, v71
v_add_f32 v135, v135, v71
v_dot2c_f32_bf16 v128, v68, v28
v_dot2c_f32_bf16 v132, v68, v29
v_dot2c_f32_bf16 v129, v69, v28
v_dot2c_f32_bf16 v133, v69, v29
v_dot2c_f32_bf16 v130, v70, v28
v_dot2c_f32_bf16 v134, v70, v29
s_waitcnt vmcnt(5)
v_xor_b32 v10, v75, v12
v_or_b32 v3, v3, v10
v_and_b32 v75, s58, v75
v_add_f32 v135, v135, v75
v_dot2c_f32_bf16 v128, v72, v28
v_dot2c_f32_bf16 v132, v72, v29
v_dot2c_f32_bf16 v129, v73, v28
v_dot2c_f32_bf16 v133, v73, v29
v_dot2c_f32_bf16 v130, v74, v28
v_dot2c_f32_bf16 v134, v74, v29
s_waitcnt vmcnt(4)
v_xor_b32 v10, v79, v12
v_or_b32 v3, v3, v10
v_and_b32 v79, s58, v79
v_add_f32 v135, v135, v79
v_dot2c_f32_bf16 v128, v76, v28
v_dot2c_f32_bf16 v132, v76, v29
v_dot2c_f32_bf16 v129, v77, v28
v_dot2c_f32_bf16 v133, v77, v29
v_dot2c_f32_bf16 v130, v78, v28
v_dot2c_f32_bf16 v134, v78, v29
s_waitcnt vmcnt(3)
v_xor_b32 v10, v83, v12
v_or_b32 v3, v3, v10
v_and_b32 v83, s58, v83
v_add_f32 v135, v135, v83
v_dot2c_f32_bf16 v128, v80, v28
v_dot2c_f32_bf16 v132, v80, v29
v_dot2c_f32_bf16 v129, v81, v28
v_dot2c_f32_bf16 v133, v81, v29
v_dot2c_f32_bf16 v130, v82, v28
v_dot2c_f32_bf16 v134, v82, v29
s_waitcnt vmcnt(2)
v_xor_b32 v10, v87, v12
v_or_b32 v3, v3, v10
v_and_b32 v87, s58, v87
v_add_f32 v135, v135, v87
v_dot2c_f32_bf16 v128, v84, v28
v_dot2c_f32_bf16 v132, v84, v29
v_dot2c_f32_bf16 v129, v85, v28
v_dot2c_f32_bf16 v133, v85, v29
v_dot2c_f32_bf16 v130, v86, v28
v_dot2c_f32_bf16 v134, v86, v29
s_waitcnt vmcnt(1)
v_xor_b32 v10, v91, v12
v_or_b32 v3, v3, v10
v_and_b32 v91, s58, v91
v_add_f32 v135, v135, v91
v_dot2c_f32_bf16 v128, v88, v28
v_dot2c_f32_bf16 v132, v88, v29
v_dot2c_f32_bf16 v129, v89, v28
v_dot2c_f32_bf16 v133, v89, v29
v_dot2c_f32_bf16 v130, v90, v28
v_dot2c_f32_bf16 v134, v90, v29
s_waitcnt vmcnt(0)
v_xor_b32 v10, v95, v12
v_or_b32 v3, v3, v10
v_and_b32 v95, s58, v95
v_add_f32 v135, v135, v95
v_dot2c_f32_bf16 v128, v92, v28
v_dot2c_f32_bf16 v132, v92, v29
v_dot2c_f32_bf16 v129, v93, v28
v_dot2c_f32_bf16 v133, v93, v29
v_dot2c_f32_bf16 v130, v94, v28
v_dot2c_f32_bf16 v134, v94, v29
v_and_b32 v3, 0xffff, v3
v_cmp_ne_u32 vcc, 0, v3
v_permlane16_swap_b32 v128, v129
v_permlane16_swap_b32 v130, v131
v_permlane16_swap_b32 v132, v133
v_permlane16_swap_b32 v134, v135
s_cbranch_vccz pM_giveup5
s_sub_u32 s63, s63, 1
s_cmp_gt_i32 s63, 0
s_cbranch_scc1 pM_l1_3
pM_giveup5:
v_add_f32 v128, v128, v129
v_add_f32 v130, v130, v131
v_add_f32 v132, v132, v133
v_add_f32 v134, v134, v135
v_permlane32_swap_b32 v128, v130
s_nop 0
v_permlane32_swap_b32 v132, v134
v_add_f32 v128, v128, v130
v_add_f32 v132, v132, v134
s_nop 0
v_add_f32_dpp v128, v128, v128 row_ror:8 row_mask:0xf bank_mask:0xf
v_add_f32_dpp v132, v132, v132 row_ror:8 row_mask:0xf bank_mask:0xf
v_cvt_pk_bf16_f32 v64, v128, v132
v_cvt_pk_bf16_f32 v65, v128, v132
s_nop 1
v_permlane16_swap_b32 v64, v65
v_mov_b32 v66, v64
v_mov_b32 v67, v65
s_nop 0
v_permlane32_swap_b32 v64, v66
v_permlane32_swap_b32 v65, v67
v_and_or_b32 v67, v67, s58, v12
s_mov_b64 exec, 0xff
buffer_store_dwordx4 v[64:67], v13, s[52:55], s61 offen sc1
s_mov_b64 exec, -1
pM_nol11:
s_cmp_eq_u32 s30, 0
s_mov_b32 s59, 42
s_cselect_b32 s59, 36, s59
pM_tk6:
s_cmp_ge_u32 s31, s59
s_cbranch_scc1 pM_tk6x
s_barrier
s_add_u32 s31, s31, 1
s_branch pM_tk6
pM_tk6x:
s_waitcnt vmcnt(0)
s_mov_b32 s32, s8
s_and_b32 s33, s9, 0xffff
s_mov_b32 s34, 1835008
s_mov_b32 s35, 0x20000
s_mov_b32 s36, s28
s_and_b32 s37, s29, 0xffff
s_mov_b32 s38, 67108864
s_mov_b32 s39, 0x20000
s_mov_b64 s[0:1], s[22:23]
s_sub_u32 s57, s3, 4
s_cmp_gt_u32 s4, 3
s_subb_u32 s58, s4, 0
s_mul_i32 s61, s5, 7
s_add_u32 s61, s61, s58
s_lshl_b32 s60, s57, 8
s_add_u32 s60, s60, s61
s_lshl_b32 s60, s60, 7
s_add_u32 s60, s60, 23068672
s_add_u32 s48, s28, s60
s_addc_u32 s49, s29, 0
s_waitcnt lgkmcnt(0)
s_mov_b32 s26, s14
s_load_dwordx16 s[8:23], s[48:49], 0 glc
s_lshl_b32 s61, s61, 5
s_add_u32 s61, s61, s57
s_lshl_b32 s61, s61, 11
s_mul_i32 s60, s5, 0
s_add_u32 s61, s61, s60
s_add_u32 s61, s61, 6291456
s_lshl_b32 s58, s58, 7
s_and_b32 s60, s57, 1
s_lshl_b32 s60, s60, 6
s_add_u32 s58, s58, s60
s_lshr_b32 s27, s57, 1
s_lshl_b32 s60, s5, 1
s_add_u32 s60, s60, s27
s_mul_i32 s60, s60, 28672
s_add_u32 s60, s60, s58
v_lshrrev_b32 v41, 2, v0
v_and_b32 v39, 3, v0
v_mul_u32_u24 v36, 896, v41
v_lshl_add_u32 v36, v39, 4, v36
v_mul_u32_u24 v41, 80, v41
v_lshl_add_u32 v41, v39, 4, v41
v_bfe_u32 v37, v0, 5, 1
v_lshlrev_b32 v37, 3, v37
v_and_b32 v39, 31, v0
v_lshl_add_u32 v38, v39, 6, v37
v_lshl_add_u32 v40, v39, 4, v38
v_lshlrev_b32 v39, 4, v0
s_mul_i32 s27, s27, 30720
s_and_b32 s57, s57, 1
s_lshl_b32 s57, s57, 11
s_add_u32 s27, s27, s57
s_add_u32 s57, s57, s27
s_add_u32 s57, s57, 20480
s_add_u32 s27, s27, 28672
v_add_u32 v33, s57, v39
v_add_u32 v40, s57, v40
v_add_u32 v41, s57, v41
v_add_u32 v38, s27, v38
v_and_b32 v43, 15, v0
v_lshl_add_u32 v43, v37, 1, v43
v_mul_u32_u24 v43, 0x9e3a, v43
v_or_b32 v43, 1, v43
v_mov_b32 v34, s26
s_cmp_lg_u32 s30, 0
s_cbranch_scc1 pM_mp7x
s_cmp_eq_u32 s4, 3
s_cselect_b32 s56, 0, 0x7f
s_sub_u32 s52, s61, 4096
v_lshlrev_b32 v2, 7, v0
pM_mp7:
s_cmp_ge_u32 s31, 42
s_cbranch_scc1 pM_mp7x
s_barrier
s_add_u32 s31, s31, 1
s_mov_b32 s57, 0
s_cmp_eq_u32 s23, s26
s_addc_u32 s57, s57, s57
s_cmp_eq_u32 s21, s26
s_addc_u32 s57, s57, s57
s_cmp_eq_u32 s19, s26
s_addc_u32 s57, s57, s57
s_cmp_eq_u32 s17, s26
s_addc_u32 s57, s57, s57
s_cmp_eq_u32 s15, s26
s_addc_u32 s57, s57, s57
s_cmp_eq_u32 s13, s26
s_addc_u32 s57, s57, s57
s_cmp_eq_u32 s11, s26
s_addc_u32 s57, s57, s57
s_cmp_eq_u32 s9, s26
s_addc_u32 s57, s57, s57
s_and_b32 s57, s57, s56
s_cbranch_scc0 pM_mp7n
s_ff1_i32_b32 s59, s57
s_bitset0_b32 s56, s59
s_lshl_b32 s59, s59, 13
s_add_u32 s59, s59, s52
buffer_load_dword v3, v2, s[36:39], s59 offen sc1
pM_mp7n:
s_getreg_b32 s59, hwreg(HW_REG_IB_STS, 8, 4)
s_cmp_gt_u32 s59, 0
s_cbranch_scc1 pM_mp7
s_cmp_ge_u32 s31, 41
s_cbranch_scc1 pM_mp7
s_load_dwordx16 s[8:23], s[48:49], 0 glc
s_branch pM_mp7
pM_mp7x:
pM_tk8:
s_cmp_ge_u32 s31, 43
s_cbranch_scc1 pM_tk8x
s_barrier
s_add_u32 s31, s31, 1
s_branch pM_tk8
pM_tk8x:
s_mov_b32 s40, s0
s_and_b32 s41, s1, 0xffff
s_mov_b32 s42, 896
s_mov_b32 s43, 0x20000
s_mov_b32 s44, s24
s_and_b32 s45, s25, 0xffff
s_mov_b32 s46, 1835008
s_mov_b32 s47, 0x20000
s_add_u32 s57, s60, 14336
s_add_u32 m0, s27, 0
s_nop 0
buffer_load_dwordx4 v36, s[32:35], s60 offen lds
buffer_load_dwordx2 v[136:137], v37, s[40:43], s58 offen offset:0
buffer_load_dwordx2 v[138:139], v37, s[40:43], s58 offen offset:32
s_add_u32 m0, s27, 1024
s_nop 0
buffer_load_dwordx4 v36, s[32:35], s57 offen lds
buffer_load_dwordx2 v[140:141], v37, s[40:43], s58 offen offset:16
buffer_load_dwordx2 v[142:143], v37, s[40:43], s58 offen offset:48
s_load_dwordx16 s[8:23], s[48:49], 0 glc
s_add_u32 s50, s61, 0
s_add_u32 s51, s61, 8192
s_add_u32 s52, s61, 16384
s_add_u32 s53, s61, 24576
s_add_u32 s54, s61, 32768
s_add_u32 s55, s61, 40960
s_add_u32 s56, s61, 49152
v_mov_b32 v35, 0x3f80
v_mov_b32 v15, 1.0
v_mov_b32 v32, 0
pM_tk9:
s_cmp_ge_u32 s31, 45
s_cbranch_scc1 pM_tk9x
s_barrier
s_add_u32 s31, s31, 1
s_branch pM_tk9
pM_tk9x:
s_cmp_eq_u32 s4, 3
s_cbranch_scc1 gM_exit
s_branch gather_M
.p2align 6
load_M:
s_mul_i32 s49, s4, 56
s_lshr_b32 s49, s49, 6
s_lshl_b32 s49, s49, 7
s_lshl_b32 s60, s4, 2
s_sub_u32 s60, s60, 2
s_max_i32 s60, s60, 0
s_lshl_b32 s59, s60, 7
s_add_u32 s36, s16, s59
s_addc_u32 s37, s17, 0
s_and_b32 s37, s37, 0xffff
s_sub_u32 s38, 1605632, s59
s_mov_b32 s39, 0x20000
s_mul_i32 s59, s60, 57344
s_add_u32 s40, s20, s59
s_addc_u32 s41, s21, 0
s_and_b32 s41, s41, 0xffff
s_sub_u32 s42, 1605632, s59
s_mov_b32 s43, 0x20000
s_add_u32 s7, s4, 1
s_cmp_gt_u32 s4, 3
s_cselect_b32 s7, s4, s7
s_cmp_eq_u32 s4, 3
s_cselect_b32 s7, 3, s7
s_cmp_ge_u32 s7, 7
s_cselect_b32 s7, 0, s7
s_mul_i32 s50, s7, 128
s_add_u32 s7, s7, 1
s_cmp_ge_u32 s7, 7
s_cselect_b32 s7, 0, s7
s_mul_i32 s51, s7, 128
s_add_u32 s7, s7, 1
s_cmp_ge_u32 s7, 7
s_cselect_b32 s7, 0, s7
s_mul_i32 s52, s7, 128
s_add_u32 s7, s7, 1
s_cmp_ge_u32 s7, 7
s_cselect_b32 s7, 0, s7
s_mul_i32 s53, s7, 128
s_add_u32 s7, s7, 1
s_cmp_ge_u32 s7, 7
s_cselect_b32 s7, 0, s7
s_mul_i32 s54, s7, 128
s_add_u32 s7, s7, 1
s_cmp_ge_u32 s7, 7
s_cselect_b32 s7, 0, s7
s_mul_i32 s55, s7, 128
s_add_u32 s7, s7, 1
s_cmp_ge_u32 s7, 7
s_cselect_b32 s7, 0, s7
s_mul_i32 s56, s7, 128
s_sub_u32 s30, s3, 4
s_lshl_b32 s31, s30, 11
s_lshl_b32 s59, s30, 4
v_bfe_u32 v12, v0, 2, 3
v_add_u32 v12, s59, v12
v_lshrrev_b32 v13, 5, v0
v_lshlrev_b32 v13, 6, v13
v_and_b32 v14, 3, v0
v_lshl_add_u32 v13, v14, 4, v13
v_mul_u32_u24 v2, 2688, v12
v_add_u32 v2, v2, v13
v_xor_b32 v5, 32, v2
v_mul_u32_u24 v3, 3584, v12
v_add_u32 v3, v3, v13
v_xor_b32 v6, 32, v3
v_bfe_u32 v12, v0, 2, 2
v_and_b32 v14, 16, v0
v_add_u32 v12, v12, v14
s_lshl_b32 s59, s30, 3
v_add_u32 v12, s59, v12
v_mul_u32_u24 v4, 896, v12
v_add_u32 v4, v4, v13
v_xor_b32 v7, 32, v4
s_lshl_b32 s61, s6, 1
s_add_u32 s61, s61, s30
s_mul_i32 s60, s61, 14
v_and_b32 v17, 15, v0
v_min_u32 v17, 13, v17
v_add_u32 v17, s60, v17
v_mul_u32_u24 v17, 2688, v17
v_lshrrev_b32 v9, 4, v0
v_and_b32 v10, 1, v9
v_lshl_add_u32 v17, v10, 7, v17
v_lshrrev_b32 v9, 1, v9
v_mul_u32_u24 v9, 896, v9
v_add_u32 v17, v9, v17
v_add_u32 v17, 896, v17
v_add_u32 v17, s49, v17
s_mul_i32 s60, s61, 14
v_and_b32 v18, 15, v0
v_min_u32 v18, 13, v18
v_add_u32 v18, s60, v18
v_mul_u32_u24 v18, 3584, v18
v_lshrrev_b32 v9, 4, v0
v_min_u32 v9, 3, v9
v_lshl_add_u32 v18, v9, 7, v18
s_barrier
buffer_load_dword v49, v17, s[32:35], 0 offen
buffer_load_dword v50, v18, s[36:39], 0 offen
s_waitcnt lgkmcnt(0)
s_add_u32 s14, s14, 1
s_mul_i32 s60, s61, 8
v_and_b32 v19, 7, v0
v_min_u32 v19, 7, v19
v_add_u32 v19, s60, v19
v_mul_u32_u24 v19, 896, v19
v_mov_b32 v9, s50
v_mov_b32 v10, s51
v_cmp_le_u32 vcc, 8, v0
s_nop 1
v_cndmask_b32 v9, v9, v10, vcc
v_mov_b32 v10, s52
v_cmp_le_u32 vcc, 16, v0
s_nop 1
v_cndmask_b32 v9, v9, v10, vcc
v_mov_b32 v10, s53
v_cmp_le_u32 vcc, 24, v0
s_nop 1
v_cndmask_b32 v9, v9, v10, vcc
v_add_u32 v19, v9, v19
s_mul_i32 s60, s61, 8
v_and_b32 v20, 7, v0
v_min_u32 v20, 7, v20
v_add_u32 v20, s60, v20
v_mul_u32_u24 v20, 896, v20
v_mov_b32 v9, s54
v_mov_b32 v10, s55
v_cmp_le_u32 vcc, 8, v0
s_nop 1
v_cndmask_b32 v9, v9, v10, vcc
v_mov_b32 v10, s56
v_cmp_le_u32 vcc, 16, v0
s_nop 1
v_cndmask_b32 v9, v9, v10, vcc
v_add_u32 v20, v9, v20
s_cmp_gt_u32 s4, 3
s_subb_u32 s60, s4, 0
s_mul_i32 s61, s5, 7
s_add_u32 s60, s60, s61
s_lshl_b32 s61, s3, 8
s_add_u32 s60, s60, s61
s_lshl_b32 s60, s60, 7
s_add_u32 s60, s60, 22937600
s_load_dword s26, s[28:29], s60 glc
s_barrier
s_add_u32 m0, s31, 65536
s_add_u32 s59, s49, 896
buffer_load_dwordx4 v2, s[32:35], s59 offen  lds
s_add_u32 m0, s31, 66560
s_add_u32 s59, s49, 22400
buffer_load_dwordx4 v5, s[32:35], s59 offen  lds
s_add_u32 m0, s31, 69632
s_add_u32 s59, s49, 1024
buffer_load_dwordx4 v2, s[32:35], s59 offen  lds
s_add_u32 m0, s31, 70656
s_add_u32 s59, s49, 22528
buffer_load_dwordx4 v5, s[32:35], s59 offen  lds
s_add_u32 m0, s31, 73728
s_add_u32 s59, s49, 86912
buffer_load_dwordx4 v2, s[32:35], s59 offen  lds
s_add_u32 m0, s31, 74752
s_add_u32 s59, s49, 108416
buffer_load_dwordx4 v5, s[32:35], s59 offen  lds
s_add_u32 m0, s31, 77824
s_add_u32 s59, s49, 87040
buffer_load_dwordx4 v2, s[32:35], s59 offen  lds
s_add_u32 m0, s31, 78848
s_add_u32 s59, s49, 108544
buffer_load_dwordx4 v5, s[32:35], s59 offen  lds
s_add_u32 m0, s31, 81920
s_add_u32 s59, s49, 172928
buffer_load_dwordx4 v2, s[32:35], s59 offen  lds
s_add_u32 m0, s31, 82944
s_add_u32 s59, s49, 194432
buffer_load_dwordx4 v5, s[32:35], s59 offen  lds
s_add_u32 m0, s31, 86016
s_add_u32 s59, s49, 173056
buffer_load_dwordx4 v2, s[32:35], s59 offen  lds
s_add_u32 m0, s31, 87040
s_add_u32 s59, s49, 194560
buffer_load_dwordx4 v5, s[32:35], s59 offen  lds
s_add_u32 m0, s31, 90112
s_add_u32 s59, s49, 258944
buffer_load_dwordx4 v2, s[32:35], s59 offen  lds
s_add_u32 m0, s31, 91136
s_add_u32 s59, s49, 280448
buffer_load_dwordx4 v5, s[32:35], s59 offen  lds
s_add_u32 m0, s31, 94208
s_add_u32 s59, s49, 259072
buffer_load_dwordx4 v2, s[32:35], s59 offen  lds
s_add_u32 m0, s31, 95232
s_add_u32 s59, s49, 280576
buffer_load_dwordx4 v5, s[32:35], s59 offen  lds
s_add_u32 m0, s31, 98304
s_add_u32 s59, s49, 344960
buffer_load_dwordx4 v2, s[32:35], s59 offen  lds
s_add_u32 m0, s31, 99328
s_add_u32 s59, s49, 366464
buffer_load_dwordx4 v5, s[32:35], s59 offen  lds
s_add_u32 m0, s31, 102400
s_add_u32 s59, s49, 345088
buffer_load_dwordx4 v2, s[32:35], s59 offen  lds
s_add_u32 m0, s31, 103424
s_add_u32 s59, s49, 366592
buffer_load_dwordx4 v5, s[32:35], s59 offen  lds
s_add_u32 m0, s31, 106496
s_add_u32 s59, s49, 430976
buffer_load_dwordx4 v2, s[32:35], s59 offen  lds
s_add_u32 m0, s31, 107520
s_add_u32 s59, s49, 452480
buffer_load_dwordx4 v5, s[32:35], s59 offen  lds
s_waitcnt vmcnt(14)
s_barrier
s_add_u32 m0, s31, 110592
s_add_u32 s59, s49, 431104
buffer_load_dwordx4 v2, s[32:35], s59 offen  lds
s_add_u32 m0, s31, 111616
s_add_u32 s59, s49, 452608
buffer_load_dwordx4 v5, s[32:35], s59 offen  lds
s_add_u32 m0, s31, 114688
s_add_u32 s59, s49, 516992
buffer_load_dwordx4 v2, s[32:35], s59 offen  lds
s_add_u32 m0, s31, 115712
s_add_u32 s59, s49, 538496
buffer_load_dwordx4 v5, s[32:35], s59 offen  lds
s_add_u32 m0, s31, 118784
s_add_u32 s59, s49, 517120
buffer_load_dwordx4 v2, s[32:35], s59 offen  lds
s_add_u32 m0, s31, 119808
s_add_u32 s59, s49, 538624
buffer_load_dwordx4 v5, s[32:35], s59 offen  lds
s_add_u32 m0, s31, 122880
s_add_u32 s59, s49, 603008
buffer_load_dwordx4 v2, s[32:35], s59 offen  lds
s_add_u32 m0, s31, 123904
s_add_u32 s59, s49, 624512
buffer_load_dwordx4 v5, s[32:35], s59 offen  lds
s_waitcnt vmcnt(14)
s_barrier
s_add_u32 m0, s31, 126976
s_add_u32 s59, s49, 603136
buffer_load_dwordx4 v2, s[32:35], s59 offen  lds
s_add_u32 m0, s31, 128000
s_add_u32 s59, s49, 624640
buffer_load_dwordx4 v5, s[32:35], s59 offen  lds
s_add_u32 m0, s31, 131072
s_add_u32 s59, s49, 689024
buffer_load_dwordx4 v2, s[32:35], s59 offen  lds
s_add_u32 m0, s31, 132096
s_add_u32 s59, s49, 710528
buffer_load_dwordx4 v5, s[32:35], s59 offen  lds
s_add_u32 m0, s31, 135168
s_add_u32 s59, s49, 689152
buffer_load_dwordx4 v2, s[32:35], s59 offen  lds
s_add_u32 m0, s31, 136192
s_add_u32 s59, s49, 710656
buffer_load_dwordx4 v5, s[32:35], s59 offen  lds
s_add_u32 m0, s31, 139264
s_add_u32 s59, s49, 775040
buffer_load_dwordx4 v2, s[32:35], s59 offen  lds
s_add_u32 m0, s31, 140288
s_add_u32 s59, s49, 796544
buffer_load_dwordx4 v5, s[32:35], s59 offen  lds
s_waitcnt vmcnt(14)
s_barrier
s_add_u32 m0, s31, 143360
s_add_u32 s59, s49, 775168
buffer_load_dwordx4 v2, s[32:35], s59 offen  lds
s_add_u32 m0, s31, 144384
s_add_u32 s59, s49, 796672
buffer_load_dwordx4 v5, s[32:35], s59 offen  lds
s_add_u32 m0, s31, 147456
s_add_u32 s59, s49, 861056
buffer_load_dwordx4 v2, s[32:35], s59 offen  lds
s_add_u32 m0, s31, 148480
s_add_u32 s59, s49, 882560
buffer_load_dwordx4 v5, s[32:35], s59 offen  lds
s_add_u32 m0, s31, 151552
s_add_u32 s59, s49, 861184
buffer_load_dwordx4 v2, s[32:35], s59 offen  lds
s_add_u32 m0, s31, 152576
s_add_u32 s59, s49, 882688
buffer_load_dwordx4 v5, s[32:35], s59 offen  lds
s_add_u32 m0, s31, 155648
s_add_u32 s59, s49, 947072
buffer_load_dwordx4 v2, s[32:35], s59 offen  lds
s_add_u32 m0, s31, 156672
s_add_u32 s59, s49, 968576
buffer_load_dwordx4 v5, s[32:35], s59 offen  lds
s_waitcnt vmcnt(14)
s_barrier
s_add_u32 m0, s31, 159744
s_add_u32 s59, s49, 947200
buffer_load_dwordx4 v2, s[32:35], s59 offen  lds
s_add_u32 m0, s31, 160768
s_add_u32 s59, s49, 968704
buffer_load_dwordx4 v5, s[32:35], s59 offen  lds
s_add_u32 m0, s31, 65536
s_add_u32 s59, s49, 1033088
buffer_load_dwordx4 v2, s[32:35], s59 offen  lds
s_add_u32 m0, s31, 66560
s_add_u32 s59, s49, 1054592
buffer_load_dwordx4 v5, s[32:35], s59 offen  lds
s_add_u32 m0, s31, 69632
s_add_u32 s59, s49, 1033216
buffer_load_dwordx4 v2, s[32:35], s59 offen  lds
s_add_u32 m0, s31, 70656
s_add_u32 s59, s49, 1054720
buffer_load_dwordx4 v5, s[32:35], s59 offen  lds
s_add_u32 m0, s31, 73728
s_add_u32 s59, s49, 1119104
buffer_load_dwordx4 v2, s[32:35], s59 offen  lds
s_add_u32 m0, s31, 74752
s_add_u32 s59, s49, 1140608
buffer_load_dwordx4 v5, s[32:35], s59 offen  lds
s_waitcnt vmcnt(14)
s_barrier
s_add_u32 m0, s31, 77824
s_add_u32 s59, s49, 1119232
buffer_load_dwordx4 v2, s[32:35], s59 offen  lds
s_add_u32 m0, s31, 78848
s_add_u32 s59, s49, 1140736
buffer_load_dwordx4 v5, s[32:35], s59 offen  lds
s_add_u32 m0, s31, 81920
s_add_u32 s59, s49, 1792
buffer_load_dwordx4 v2, s[32:35], s59 offen  lds
s_add_u32 m0, s31, 82944
s_add_u32 s59, s49, 23296
buffer_load_dwordx4 v5, s[32:35], s59 offen  lds
s_add_u32 m0, s31, 86016
s_add_u32 s59, s49, 1920
buffer_load_dwordx4 v2, s[32:35], s59 offen  lds
s_add_u32 m0, s31, 87040
s_add_u32 s59, s49, 23424
buffer_load_dwordx4 v5, s[32:35], s59 offen  lds
s_add_u32 m0, s31, 90112
s_add_u32 s59, s49, 87808
buffer_load_dwordx4 v2, s[32:35], s59 offen  lds
s_add_u32 m0, s31, 91136
s_add_u32 s59, s49, 109312
buffer_load_dwordx4 v5, s[32:35], s59 offen  lds
s_waitcnt vmcnt(14)
s_barrier
s_add_u32 m0, s31, 94208
s_add_u32 s59, s49, 87936
buffer_load_dwordx4 v2, s[32:35], s59 offen  lds
s_add_u32 m0, s31, 95232
s_add_u32 s59, s49, 109440
buffer_load_dwordx4 v5, s[32:35], s59 offen  lds
s_add_u32 m0, s31, 98304
s_add_u32 s59, s49, 173824
buffer_load_dwordx4 v2, s[32:35], s59 offen  lds
s_add_u32 m0, s31, 99328
s_add_u32 s59, s49, 195328
buffer_load_dwordx4 v5, s[32:35], s59 offen  lds
s_add_u32 m0, s31, 102400
s_add_u32 s59, s49, 173952
buffer_load_dwordx4 v2, s[32:35], s59 offen  lds
s_add_u32 m0, s31, 103424
s_add_u32 s59, s49, 195456
buffer_load_dwordx4 v5, s[32:35], s59 offen  lds
s_add_u32 m0, s31, 106496
s_add_u32 s59, s49, 259840
buffer_load_dwordx4 v2, s[32:35], s59 offen  lds
s_add_u32 m0, s31, 107520
s_add_u32 s59, s49, 281344
buffer_load_dwordx4 v5, s[32:35], s59 offen  lds
s_waitcnt vmcnt(14)
s_barrier
s_add_u32 m0, s31, 110592
s_add_u32 s59, s49, 259968
buffer_load_dwordx4 v2, s[32:35], s59 offen  lds
s_add_u32 m0, s31, 111616
s_add_u32 s59, s49, 281472
buffer_load_dwordx4 v5, s[32:35], s59 offen  lds
s_add_u32 m0, s31, 114688
s_add_u32 s59, s49, 345856
buffer_load_dwordx4 v2, s[32:35], s59 offen  lds
s_add_u32 m0, s31, 115712
s_add_u32 s59, s49, 367360
buffer_load_dwordx4 v5, s[32:35], s59 offen  lds
s_add_u32 m0, s31, 118784
s_add_u32 s59, s49, 345984
buffer_load_dwordx4 v2, s[32:35], s59 offen  lds
s_add_u32 m0, s31, 119808
s_add_u32 s59, s49, 367488
buffer_load_dwordx4 v5, s[32:35], s59 offen  lds
s_add_u32 m0, s31, 122880
s_add_u32 s59, s49, 431872
buffer_load_dwordx4 v2, s[32:35], s59 offen  lds
s_add_u32 m0, s31, 123904
s_add_u32 s59, s49, 453376
buffer_load_dwordx4 v5, s[32:35], s59 offen  lds
s_waitcnt vmcnt(14)
s_barrier
s_add_u32 m0, s31, 126976
s_add_u32 s59, s49, 432000
buffer_load_dwordx4 v2, s[32:35], s59 offen  lds
s_add_u32 m0, s31, 128000
s_add_u32 s59, s49, 453504
buffer_load_dwordx4 v5, s[32:35], s59 offen  lds
s_add_u32 m0, s31, 131072
s_add_u32 s59, s49, 517888
buffer_load_dwordx4 v2, s[32:35], s59 offen  lds
s_add_u32 m0, s31, 132096
s_add_u32 s59, s49, 539392
buffer_load_dwordx4 v5, s[32:35], s59 offen  lds
s_add_u32 m0, s31, 135168
s_add_u32 s59, s49, 518016
buffer_load_dwordx4 v2, s[32:35], s59 offen  lds
s_add_u32 m0, s31, 136192
s_add_u32 s59, s49, 539520
buffer_load_dwordx4 v5, s[32:35], s59 offen  lds
s_add_u32 m0, s31, 139264
s_add_u32 s59, s49, 603904
buffer_load_dwordx4 v2, s[32:35], s59 offen  lds
s_add_u32 m0, s31, 140288
s_add_u32 s59, s49, 625408
buffer_load_dwordx4 v5, s[32:35], s59 offen  lds
s_waitcnt vmcnt(14)
s_barrier
s_add_u32 m0, s31, 143360
s_add_u32 s59, s49, 604032
buffer_load_dwordx4 v2, s[32:35], s59 offen  lds
s_add_u32 m0, s31, 144384
s_add_u32 s59, s49, 625536
buffer_load_dwordx4 v5, s[32:35], s59 offen  lds
s_add_u32 m0, s31, 147456
s_add_u32 s59, s49, 689920
buffer_load_dwordx4 v2, s[32:35], s59 offen  lds
s_add_u32 m0, s31, 148480
s_add_u32 s59, s49, 711424
buffer_load_dwordx4 v5, s[32:35], s59 offen  lds
s_add_u32 m0, s31, 151552
s_add_u32 s59, s49, 690048
buffer_load_dwordx4 v2, s[32:35], s59 offen  lds
s_add_u32 m0, s31, 152576
s_add_u32 s59, s49, 711552
buffer_load_dwordx4 v5, s[32:35], s59 offen  lds
s_add_u32 m0, s31, 155648
s_add_u32 s59, s49, 775936
buffer_load_dwordx4 v2, s[32:35], s59 offen  lds
s_add_u32 m0, s31, 156672
s_add_u32 s59, s49, 797440
buffer_load_dwordx4 v5, s[32:35], s59 offen  lds
s_waitcnt vmcnt(14)
s_barrier
s_add_u32 m0, s31, 159744
s_add_u32 s59, s49, 776064
buffer_load_dwordx4 v2, s[32:35], s59 offen  lds
s_add_u32 m0, s31, 160768
s_add_u32 s59, s49, 797568
buffer_load_dwordx4 v5, s[32:35], s59 offen  lds
s_add_u32 m0, s31, 65536
s_add_u32 s59, s49, 861952
buffer_load_dwordx4 v2, s[32:35], s59 offen  lds
s_add_u32 m0, s31, 66560
s_add_u32 s59, s49, 883456
buffer_load_dwordx4 v5, s[32:35], s59 offen  lds
s_add_u32 m0, s31, 69632
s_add_u32 s59, s49, 862080
buffer_load_dwordx4 v2, s[32:35], s59 offen  lds
s_add_u32 m0, s31, 70656
s_add_u32 s59, s49, 883584
buffer_load_dwordx4 v5, s[32:35], s59 offen  lds
s_add_u32 m0, s31, 73728
s_add_u32 s59, s49, 947968
buffer_load_dwordx4 v2, s[32:35], s59 offen  lds
s_add_u32 m0, s31, 74752
s_add_u32 s59, s49, 969472
buffer_load_dwordx4 v5, s[32:35], s59 offen  lds
s_waitcnt vmcnt(14)
s_barrier
s_add_u32 m0, s31, 77824
s_add_u32 s59, s49, 948096
buffer_load_dwordx4 v2, s[32:35], s59 offen  lds
s_add_u32 m0, s31, 78848
s_add_u32 s59, s49, 969600
buffer_load_dwordx4 v5, s[32:35], s59 offen  lds
s_add_u32 m0, s31, 81920
s_add_u32 s59, s49, 1033984
buffer_load_dwordx4 v2, s[32:35], s59 offen  lds
s_add_u32 m0, s31, 82944
s_add_u32 s59, s49, 1055488
buffer_load_dwordx4 v5, s[32:35], s59 offen  lds
s_add_u32 m0, s31, 86016
s_add_u32 s59, s49, 1034112
buffer_load_dwordx4 v2, s[32:35], s59 offen  lds
s_add_u32 m0, s31, 87040
s_add_u32 s59, s49, 1055616
buffer_load_dwordx4 v5, s[32:35], s59 offen  lds
s_add_u32 m0, s31, 90112
s_add_u32 s59, s49, 1120000
buffer_load_dwordx4 v2, s[32:35], s59 offen  lds
s_add_u32 m0, s31, 91136
s_add_u32 s59, s49, 1141504
buffer_load_dwordx4 v5, s[32:35], s59 offen  lds
s_waitcnt vmcnt(14)
s_barrier
s_add_u32 m0, s31, 94208
s_add_u32 s59, s49, 1120128
buffer_load_dwordx4 v2, s[32:35], s59 offen  lds
s_add_u32 m0, s31, 95232
s_add_u32 s59, s49, 1141632
buffer_load_dwordx4 v5, s[32:35], s59 offen  lds
s_add_u32 m0, s31, 98304
s_mov_b32 s59, 0
buffer_load_dwordx4 v3, s[36:39], s59 offen  lds
s_add_u32 m0, s31, 99328
s_mov_b32 s59, 28672
buffer_load_dwordx4 v6, s[36:39], s59 offen  lds
s_add_u32 m0, s31, 102400
s_mov_b32 s59, 114688
buffer_load_dwordx4 v3, s[36:39], s59 offen  lds
s_add_u32 m0, s31, 103424
s_mov_b32 s59, 143360
buffer_load_dwordx4 v6, s[36:39], s59 offen  lds
s_add_u32 m0, s31, 106496
s_mov_b32 s59, 229376
buffer_load_dwordx4 v3, s[36:39], s59 offen  lds
s_add_u32 m0, s31, 107520
s_mov_b32 s59, 258048
buffer_load_dwordx4 v6, s[36:39], s59 offen  lds
s_waitcnt vmcnt(14)
s_barrier
s_add_u32 m0, s31, 110592
s_mov_b32 s59, 344064
buffer_load_dwordx4 v3, s[36:39], s59 offen  lds
s_add_u32 m0, s31, 111616
s_mov_b32 s59, 372736
buffer_load_dwordx4 v6, s[36:39], s59 offen  lds
s_add_u32 m0, s31, 114688
s_mov_b32 s59, 458752
buffer_load_dwordx4 v3, s[36:39], s59 offen  lds
s_add_u32 m0, s31, 115712
s_mov_b32 s59, 487424
buffer_load_dwordx4 v6, s[36:39], s59 offen  lds
s_add_u32 m0, s31, 118784
s_mov_b32 s59, 573440
buffer_load_dwordx4 v3, s[36:39], s59 offen  lds
s_add_u32 m0, s31, 119808
s_mov_b32 s59, 602112
buffer_load_dwordx4 v6, s[36:39], s59 offen  lds
s_add_u32 m0, s31, 122880
s_mov_b32 s59, 688128
buffer_load_dwordx4 v3, s[36:39], s59 offen  lds
s_add_u32 m0, s31, 123904
s_mov_b32 s59, 716800
buffer_load_dwordx4 v6, s[36:39], s59 offen  lds
s_waitcnt vmcnt(14)
s_barrier
s_add_u32 m0, s31, 126976
s_mov_b32 s59, 802816
buffer_load_dwordx4 v3, s[36:39], s59 offen  lds
s_add_u32 m0, s31, 128000
s_mov_b32 s59, 831488
buffer_load_dwordx4 v6, s[36:39], s59 offen  lds
s_add_u32 m0, s31, 131072
s_mov_b32 s59, 917504
buffer_load_dwordx4 v3, s[36:39], s59 offen  lds
s_add_u32 m0, s31, 132096
s_mov_b32 s59, 946176
buffer_load_dwordx4 v6, s[36:39], s59 offen  lds
s_add_u32 m0, s31, 135168
s_mov_b32 s59, 1032192
buffer_load_dwordx4 v3, s[36:39], s59 offen  lds
s_add_u32 m0, s31, 136192
s_mov_b32 s59, 1060864
buffer_load_dwordx4 v6, s[36:39], s59 offen  lds
s_add_u32 m0, s31, 139264
s_mov_b32 s59, 1146880
buffer_load_dwordx4 v3, s[36:39], s59 offen  lds
s_add_u32 m0, s31, 140288
s_mov_b32 s59, 1175552
buffer_load_dwordx4 v6, s[36:39], s59 offen  lds
s_waitcnt vmcnt(14)
s_barrier
s_add_u32 m0, s31, 143360
s_mov_b32 s59, 1261568
buffer_load_dwordx4 v3, s[36:39], s59 offen  lds
s_add_u32 m0, s31, 144384
s_mov_b32 s59, 1290240
buffer_load_dwordx4 v6, s[36:39], s59 offen  lds
s_add_u32 m0, s31, 147456
s_mov_b32 s59, 1376256
buffer_load_dwordx4 v3, s[36:39], s59 offen  lds
s_add_u32 m0, s31, 148480
s_mov_b32 s59, 1404928
buffer_load_dwordx4 v6, s[36:39], s59 offen  lds
s_waitcnt vmcnt(18)
s_barrier
s_add_u32 m0, s31, 151552
s_mov_b32 s59, 1490944
buffer_load_dwordx4 v3, s[36:39], s59 offen  lds
s_add_u32 m0, s31, 152576
s_mov_b32 s59, 1519616
buffer_load_dwordx4 v6, s[36:39], s59 offen  lds
s_add_u32 m0, s31, 155648
s_mov_b32 s59, 128
buffer_load_dwordx4 v3, s[36:39], s59 offen  lds
s_add_u32 m0, s31, 156672
s_mov_b32 s59, 28800
buffer_load_dwordx4 v6, s[36:39], s59 offen  lds
s_add_u32 m0, s31, 159744
s_mov_b32 s59, 114816
buffer_load_dwordx4 v3, s[36:39], s59 offen  lds
s_add_u32 m0, s31, 160768
s_mov_b32 s59, 143488
buffer_load_dwordx4 v6, s[36:39], s59 offen  lds
s_add_u32 m0, s31, 65536
s_mov_b32 s59, 229504
buffer_load_dwordx4 v3, s[36:39], s59 offen  lds
s_add_u32 m0, s31, 66560
s_mov_b32 s59, 258176
buffer_load_dwordx4 v6, s[36:39], s59 offen  lds
s_waitcnt vmcnt(18)
s_barrier
s_add_u32 m0, s31, 69632
s_mov_b32 s59, 344192
buffer_load_dwordx4 v3, s[36:39], s59 offen  lds
s_add_u32 m0, s31, 70656
s_mov_b32 s59, 372864
buffer_load_dwordx4 v6, s[36:39], s59 offen  lds
s_add_u32 m0, s31, 73728
s_mov_b32 s59, 458880
buffer_load_dwordx4 v3, s[36:39], s59 offen  lds
s_add_u32 m0, s31, 74752
s_mov_b32 s59, 487552
buffer_load_dwordx4 v6, s[36:39], s59 offen  lds
s_add_u32 m0, s31, 77824
s_mov_b32 s59, 573568
buffer_load_dwordx4 v3, s[36:39], s59 offen  lds
s_add_u32 m0, s31, 78848
s_mov_b32 s59, 602240
buffer_load_dwordx4 v6, s[36:39], s59 offen  lds
s_waitcnt vmcnt(16)
s_barrier
s_add_u32 m0, s31, 81920
s_mov_b32 s59, 688256
buffer_load_dwordx4 v3, s[36:39], s59 offen  lds
s_add_u32 m0, s31, 82944
s_mov_b32 s59, 716928
buffer_load_dwordx4 v6, s[36:39], s59 offen  lds
s_add_u32 m0, s31, 86016
s_mov_b32 s59, 802944
buffer_load_dwordx4 v3, s[36:39], s59 offen  lds
s_add_u32 m0, s31, 87040
s_mov_b32 s59, 831616
buffer_load_dwordx4 v6, s[36:39], s59 offen  lds
s_add_u32 m0, s31, 90112
s_mov_b32 s59, 917632
buffer_load_dwordx4 v3, s[36:39], s59 offen  lds
s_add_u32 m0, s31, 91136
s_mov_b32 s59, 946304
buffer_load_dwordx4 v6, s[36:39], s59 offen  lds
s_add_u32 m0, s31, 94208
s_mov_b32 s59, 1032320
buffer_load_dwordx4 v3, s[36:39], s59 offen  lds
s_add_u32 m0, s31, 95232
s_mov_b32 s59, 1060992
buffer_load_dwordx4 v6, s[36:39], s59 offen  lds
s_add_u32 m0, s31, 98304
s_mov_b32 s59, 1147008
buffer_load_dwordx4 v3, s[36:39], s59 offen  lds
s_add_u32 m0, s31, 99328
s_mov_b32 s59, 1175680
buffer_load_dwordx4 v6, s[36:39], s59 offen  lds
s_waitcnt vmcnt(18)
s_barrier
s_add_u32 m0, s31, 102400
s_mov_b32 s59, 1261696
buffer_load_dwordx4 v3, s[36:39], s59 offen  lds
s_add_u32 m0, s31, 103424
s_mov_b32 s59, 1290368
buffer_load_dwordx4 v6, s[36:39], s59 offen  lds
s_add_u32 m0, s31, 106496
s_mov_b32 s59, 1376384
buffer_load_dwordx4 v3, s[36:39], s59 offen  lds
s_add_u32 m0, s31, 107520
s_mov_b32 s59, 1405056
buffer_load_dwordx4 v6, s[36:39], s59 offen  lds
s_add_u32 m0, s31, 110592
s_mov_b32 s59, 1491072
buffer_load_dwordx4 v3, s[36:39], s59 offen  lds
s_add_u32 m0, s31, 111616
s_mov_b32 s59, 1519744
buffer_load_dwordx4 v6, s[36:39], s59 offen  lds
s_add_u32 m0, s31, 114688
s_mov_b32 s59, 256
buffer_load_dwordx4 v3, s[36:39], s59 offen  lds
s_add_u32 m0, s31, 115712
s_mov_b32 s59, 28928
buffer_load_dwordx4 v6, s[36:39], s59 offen  lds
s_waitcnt vmcnt(18)
s_barrier
s_add_u32 m0, s31, 118784
s_mov_b32 s59, 114944
buffer_load_dwordx4 v3, s[36:39], s59 offen  lds
s_add_u32 m0, s31, 119808
s_mov_b32 s59, 143616
buffer_load_dwordx4 v6, s[36:39], s59 offen  lds
s_add_u32 m0, s31, 122880
s_mov_b32 s59, 229632
buffer_load_dwordx4 v3, s[36:39], s59 offen  lds
s_add_u32 m0, s31, 123904
s_mov_b32 s59, 258304
buffer_load_dwordx4 v6, s[36:39], s59 offen  lds
s_add_u32 m0, s31, 126976
s_mov_b32 s59, 344320
buffer_load_dwordx4 v3, s[36:39], s59 offen  lds
s_add_u32 m0, s31, 128000
s_mov_b32 s59, 372992
buffer_load_dwordx4 v6, s[36:39], s59 offen  lds
s_add_u32 m0, s31, 131072
s_mov_b32 s59, 459008
buffer_load_dwordx4 v3, s[36:39], s59 offen  lds
s_add_u32 m0, s31, 132096
s_mov_b32 s59, 487680
buffer_load_dwordx4 v6, s[36:39], s59 offen  lds
s_add_u32 m0, s31, 135168
s_mov_b32 s59, 573696
buffer_load_dwordx4 v3, s[36:39], s59 offen  lds
s_add_u32 m0, s31, 136192
s_mov_b32 s59, 602368
buffer_load_dwordx4 v6, s[36:39], s59 offen  lds
s_waitcnt vmcnt(20)
s_barrier
s_add_u32 m0, s31, 139264
s_mov_b32 s59, 688384
buffer_load_dwordx4 v3, s[36:39], s59 offen  lds
s_add_u32 m0, s31, 140288
s_mov_b32 s59, 717056
buffer_load_dwordx4 v6, s[36:39], s59 offen  lds
s_add_u32 m0, s31, 143360
s_mov_b32 s59, 803072
buffer_load_dwordx4 v3, s[36:39], s59 offen  lds
s_add_u32 m0, s31, 144384
s_mov_b32 s59, 831744
buffer_load_dwordx4 v6, s[36:39], s59 offen  lds
s_add_u32 m0, s31, 147456
s_mov_b32 s59, 917760
buffer_load_dwordx4 v3, s[36:39], s59 offen  lds
s_add_u32 m0, s31, 148480
s_mov_b32 s59, 946432
buffer_load_dwordx4 v6, s[36:39], s59 offen  lds
s_add_u32 m0, s31, 151552
s_mov_b32 s59, 1032448
buffer_load_dwordx4 v3, s[36:39], s59 offen  lds
s_add_u32 m0, s31, 152576
s_mov_b32 s59, 1061120
buffer_load_dwordx4 v6, s[36:39], s59 offen  lds
s_add_u32 m0, s31, 155648
s_mov_b32 s59, 1147136
buffer_load_dwordx4 v3, s[36:39], s59 offen  lds
s_add_u32 m0, s31, 156672
s_mov_b32 s59, 1175808
buffer_load_dwordx4 v6, s[36:39], s59 offen  lds
s_waitcnt vmcnt(22)
s_barrier
s_add_u32 m0, s31, 159744
s_mov_b32 s59, 1261824
buffer_load_dwordx4 v3, s[36:39], s59 offen  lds
s_add_u32 m0, s31, 160768
s_mov_b32 s59, 1290496
buffer_load_dwordx4 v6, s[36:39], s59 offen  lds
s_add_u32 m0, s31, 65536
s_mov_b32 s59, 1376512
buffer_load_dwordx4 v3, s[36:39], s59 offen  lds
s_add_u32 m0, s31, 66560
s_mov_b32 s59, 1405184
buffer_load_dwordx4 v6, s[36:39], s59 offen  lds
s_add_u32 m0, s31, 69632
s_mov_b32 s59, 1491200
buffer_load_dwordx4 v3, s[36:39], s59 offen  lds
s_add_u32 m0, s31, 70656
s_mov_b32 s59, 1519872
buffer_load_dwordx4 v6, s[36:39], s59 offen  lds
s_add_u32 m0, s31, 73728
s_mov_b32 s59, 384
buffer_load_dwordx4 v3, s[36:39], s59 offen  lds
s_add_u32 m0, s31, 74752
s_mov_b32 s59, 29056
buffer_load_dwordx4 v6, s[36:39], s59 offen  lds
s_add_u32 m0, s31, 77824
s_mov_b32 s59, 115072
buffer_load_dwordx4 v3, s[36:39], s59 offen  lds
s_add_u32 m0, s31, 78848
s_mov_b32 s59, 143744
buffer_load_dwordx4 v6, s[36:39], s59 offen  lds
s_waitcnt vmcnt(24)
s_barrier
s_add_u32 m0, s31, 81920
s_mov_b32 s59, 229760
buffer_load_dwordx4 v3, s[36:39], s59 offen  lds
s_add_u32 m0, s31, 82944
s_mov_b32 s59, 258432
buffer_load_dwordx4 v6, s[36:39], s59 offen  lds
s_add_u32 m0, s31, 86016
s_mov_b32 s59, 344448
buffer_load_dwordx4 v3, s[36:39], s59 offen  lds
s_add_u32 m0, s31, 87040
s_mov_b32 s59, 373120
buffer_load_dwordx4 v6, s[36:39], s59 offen  lds
s_add_u32 m0, s31, 90112
s_mov_b32 s59, 459136
buffer_load_dwordx4 v3, s[36:39], s59 offen  lds
s_add_u32 m0, s31, 91136
s_mov_b32 s59, 487808
buffer_load_dwordx4 v6, s[36:39], s59 offen  lds
s_add_u32 m0, s31, 94208
s_mov_b32 s59, 573824
buffer_load_dwordx4 v3, s[36:39], s59 offen  lds
s_add_u32 m0, s31, 95232
s_mov_b32 s59, 602496
buffer_load_dwordx4 v6, s[36:39], s59 offen  lds
s_add_u32 m0, s31, 98304
s_mov_b32 s59, 688512
buffer_load_dwordx4 v3, s[36:39], s59 offen  lds
s_add_u32 m0, s31, 99328
s_mov_b32 s59, 717184
buffer_load_dwordx4 v6, s[36:39], s59 offen  lds
buffer_load_dword v51, v19, s[40:43], 0 offen
s_waitcnt vmcnt(27)
s_barrier
s_add_u32 m0, s31, 102400
s_mov_b32 s59, 803200
buffer_load_dwordx4 v3, s[36:39], s59 offen  lds
s_add_u32 m0, s31, 103424
s_mov_b32 s59, 831872
buffer_load_dwordx4 v6, s[36:39], s59 offen  lds
s_add_u32 m0, s31, 106496
s_mov_b32 s59, 917888
buffer_load_dwordx4 v3, s[36:39], s59 offen  lds
s_add_u32 m0, s31, 107520
s_mov_b32 s59, 946560
buffer_load_dwordx4 v6, s[36:39], s59 offen  lds
s_add_u32 m0, s31, 110592
s_mov_b32 s59, 1032576
buffer_load_dwordx4 v3, s[36:39], s59 offen  lds
s_add_u32 m0, s31, 111616
s_mov_b32 s59, 1061248
buffer_load_dwordx4 v6, s[36:39], s59 offen  lds
s_add_u32 m0, s31, 114688
s_mov_b32 s59, 1147264
buffer_load_dwordx4 v3, s[36:39], s59 offen  lds
s_add_u32 m0, s31, 115712
s_mov_b32 s59, 1175936
buffer_load_dwordx4 v6, s[36:39], s59 offen  lds
s_add_u32 m0, s31, 118784
s_mov_b32 s59, 1261952
buffer_load_dwordx4 v3, s[36:39], s59 offen  lds
s_add_u32 m0, s31, 119808
s_mov_b32 s59, 1290624
buffer_load_dwordx4 v6, s[36:39], s59 offen  lds
s_waitcnt vmcnt(29)
s_barrier
s_add_u32 m0, s31, 122880
s_mov_b32 s59, 1376640
buffer_load_dwordx4 v3, s[36:39], s59 offen  lds
s_add_u32 m0, s31, 123904
s_mov_b32 s59, 1405312
buffer_load_dwordx4 v6, s[36:39], s59 offen  lds
s_add_u32 m0, s31, 126976
s_mov_b32 s59, 1491328
buffer_load_dwordx4 v3, s[36:39], s59 offen  lds
s_add_u32 m0, s31, 128000
s_mov_b32 s59, 1520000
buffer_load_dwordx4 v6, s[36:39], s59 offen  lds
s_add_u32 m0, s31, 131072
s_add_u32 s59, s50, 0
buffer_load_dwordx4 v4, s[40:43], s59 offen  lds
s_add_u32 m0, s31, 132096
s_add_u32 s59, s50, 3584
buffer_load_dwordx4 v7, s[40:43], s59 offen  lds
s_add_u32 m0, s31, 135168
s_add_u32 s59, s50, 28672
buffer_load_dwordx4 v4, s[40:43], s59 offen  lds
s_add_u32 m0, s31, 136192
s_add_u32 s59, s50, 32256
buffer_load_dwordx4 v7, s[40:43], s59 offen  lds
s_waitcnt vmcnt(29)
s_barrier
s_add_u32 m0, s31, 139264
s_add_u32 s59, s50, 57344
buffer_load_dwordx4 v4, s[40:43], s59 offen  lds
s_add_u32 m0, s31, 140288
s_add_u32 s59, s50, 60928
buffer_load_dwordx4 v7, s[40:43], s59 offen  lds
s_add_u32 m0, s31, 143360
s_add_u32 s59, s50, 86016
buffer_load_dwordx4 v4, s[40:43], s59 offen  lds
s_add_u32 m0, s31, 144384
s_add_u32 s59, s50, 89600
buffer_load_dwordx4 v7, s[40:43], s59 offen  lds
s_add_u32 m0, s31, 147456
s_add_u32 s59, s50, 114688
buffer_load_dwordx4 v4, s[40:43], s59 offen  lds
s_add_u32 m0, s31, 148480
s_add_u32 s59, s50, 118272
buffer_load_dwordx4 v7, s[40:43], s59 offen  lds
s_add_u32 m0, s31, 151552
s_add_u32 s59, s50, 143360
buffer_load_dwordx4 v4, s[40:43], s59 offen  lds
s_add_u32 m0, s31, 152576
s_add_u32 s59, s50, 146944
buffer_load_dwordx4 v7, s[40:43], s59 offen  lds
s_waitcnt vmcnt(29)
s_barrier
s_add_u32 m0, s31, 155648
s_add_u32 s59, s51, 0
buffer_load_dwordx4 v4, s[40:43], s59 offen  lds
s_add_u32 m0, s31, 156672
s_add_u32 s59, s51, 3584
buffer_load_dwordx4 v7, s[40:43], s59 offen  lds
s_add_u32 m0, s31, 159744
s_add_u32 s59, s51, 28672
buffer_load_dwordx4 v4, s[40:43], s59 offen  lds
s_add_u32 m0, s31, 160768
s_add_u32 s59, s51, 32256
buffer_load_dwordx4 v7, s[40:43], s59 offen  lds
s_add_u32 m0, s31, 65536
s_add_u32 s59, s51, 57344
buffer_load_dwordx4 v4, s[40:43], s59 offen  lds
s_add_u32 m0, s31, 66560
s_add_u32 s59, s51, 60928
buffer_load_dwordx4 v7, s[40:43], s59 offen  lds
s_add_u32 m0, s31, 69632
s_add_u32 s59, s51, 86016
buffer_load_dwordx4 v4, s[40:43], s59 offen  lds
s_add_u32 m0, s31, 70656
s_add_u32 s59, s51, 89600
buffer_load_dwordx4 v7, s[40:43], s59 offen  lds
s_waitcnt vmcnt(28)
s_barrier
s_add_u32 m0, s31, 73728
s_add_u32 s59, s51, 114688
buffer_load_dwordx4 v4, s[40:43], s59 offen  lds
s_add_u32 m0, s31, 74752
s_add_u32 s59, s51, 118272
buffer_load_dwordx4 v7, s[40:43], s59 offen  lds
s_add_u32 m0, s31, 77824
s_add_u32 s59, s51, 143360
buffer_load_dwordx4 v4, s[40:43], s59 offen  lds
s_add_u32 m0, s31, 78848
s_add_u32 s59, s51, 146944
buffer_load_dwordx4 v7, s[40:43], s59 offen  lds
s_add_u32 m0, s31, 81920
s_add_u32 s59, s50, 172032
buffer_load_dwordx4 v4, s[40:43], s59 offen  lds
s_add_u32 m0, s31, 82944
s_add_u32 s59, s50, 175616
buffer_load_dwordx4 v7, s[40:43], s59 offen  lds
s_add_u32 m0, s31, 86016
s_add_u32 s59, s50, 200704
buffer_load_dwordx4 v4, s[40:43], s59 offen  lds
s_add_u32 m0, s31, 87040
s_add_u32 s59, s50, 204288
buffer_load_dwordx4 v7, s[40:43], s59 offen  lds
s_waitcnt vmcnt(28)
s_barrier
s_add_u32 m0, s31, 90112
s_add_u32 s59, s51, 172032
buffer_load_dwordx4 v4, s[40:43], s59 offen  lds
s_add_u32 m0, s31, 91136
s_add_u32 s59, s51, 175616
buffer_load_dwordx4 v7, s[40:43], s59 offen  lds
s_add_u32 m0, s31, 94208
s_add_u32 s59, s51, 200704
buffer_load_dwordx4 v4, s[40:43], s59 offen  lds
s_add_u32 m0, s31, 95232
s_add_u32 s59, s51, 204288
buffer_load_dwordx4 v7, s[40:43], s59 offen  lds
s_add_u32 m0, s31, 98304
s_add_u32 s59, s52, 0
buffer_load_dwordx4 v4, s[40:43], s59 offen  lds
s_add_u32 m0, s31, 99328
s_add_u32 s59, s52, 3584
buffer_load_dwordx4 v7, s[40:43], s59 offen  lds
s_add_u32 m0, s31, 102400
s_add_u32 s59, s52, 28672
buffer_load_dwordx4 v4, s[40:43], s59 offen  lds
s_add_u32 m0, s31, 103424
s_add_u32 s59, s52, 32256
buffer_load_dwordx4 v7, s[40:43], s59 offen  lds
s_waitcnt vmcnt(28)
s_barrier
s_add_u32 m0, s31, 106496
s_add_u32 s59, s52, 57344
buffer_load_dwordx4 v4, s[40:43], s59 offen  lds
s_add_u32 m0, s31, 107520
s_add_u32 s59, s52, 60928
buffer_load_dwordx4 v7, s[40:43], s59 offen  lds
s_add_u32 m0, s31, 110592
s_add_u32 s59, s52, 86016
buffer_load_dwordx4 v4, s[40:43], s59 offen  lds
s_add_u32 m0, s31, 111616
s_add_u32 s59, s52, 89600
buffer_load_dwordx4 v7, s[40:43], s59 offen  lds
s_add_u32 m0, s31, 114688
s_add_u32 s59, s52, 114688
buffer_load_dwordx4 v4, s[40:43], s59 offen  lds
s_add_u32 m0, s31, 115712
s_add_u32 s59, s52, 118272
buffer_load_dwordx4 v7, s[40:43], s59 offen  lds
s_waitcnt vmcnt(26)
s_barrier
s_add_u32 m0, s31, 118784
s_add_u32 s59, s52, 143360
buffer_load_dwordx4 v4, s[40:43], s59 offen  lds
s_add_u32 m0, s31, 119808
s_add_u32 s59, s52, 146944
buffer_load_dwordx4 v7, s[40:43], s59 offen  lds
s_add_u32 m0, s31, 122880
s_add_u32 s59, s52, 172032
buffer_load_dwordx4 v4, s[40:43], s59 offen  lds
s_add_u32 m0, s31, 123904
s_add_u32 s59, s52, 175616
buffer_load_dwordx4 v7, s[40:43], s59 offen  lds
s_waitcnt vmcnt(22)
s_barrier
s_add_u32 m0, s31, 126976
s_add_u32 s59, s52, 200704
buffer_load_dwordx4 v4, s[40:43], s59 offen  lds
s_add_u32 m0, s31, 128000
s_add_u32 s59, s52, 204288
buffer_load_dwordx4 v7, s[40:43], s59 offen  lds
buffer_load_dword v52, v20, s[40:43], 0 offen
s_waitcnt vmcnt(17)
s_barrier
s_waitcnt vmcnt(17)
s_barrier
s_add_u32 m0, s31, 20480
s_add_u32 s59, s53, 0
buffer_load_dwordx4 v4, s[40:43], s59 offen  lds
s_add_u32 m0, s31, 21504
s_add_u32 s59, s53, 3584
buffer_load_dwordx4 v7, s[40:43], s59 offen  lds
s_add_u32 m0, s31, 24576
s_add_u32 s59, s53, 28672
buffer_load_dwordx4 v4, s[40:43], s59 offen  lds
s_add_u32 m0, s31, 25600
s_add_u32 s59, s53, 32256
buffer_load_dwordx4 v7, s[40:43], s59 offen  lds
s_add_u32 m0, s31, 51200
s_add_u32 s59, s53, 57344
buffer_load_dwordx4 v4, s[40:43], s59 offen  lds
s_add_u32 m0, s31, 52224
s_add_u32 s59, s53, 60928
buffer_load_dwordx4 v7, s[40:43], s59 offen  lds
s_add_u32 m0, s31, 55296
s_add_u32 s59, s53, 86016
buffer_load_dwordx4 v4, s[40:43], s59 offen  lds
s_add_u32 m0, s31, 56320
s_add_u32 s59, s53, 89600
buffer_load_dwordx4 v7, s[40:43], s59 offen  lds
s_waitcnt vmcnt(17)
s_barrier
s_add_u32 m0, s31, 131072
s_add_u32 s59, s53, 114688
buffer_load_dwordx4 v4, s[40:43], s59 offen  lds
s_add_u32 m0, s31, 132096
s_add_u32 s59, s53, 118272
buffer_load_dwordx4 v7, s[40:43], s59 offen  lds
s_add_u32 m0, s31, 135168
s_add_u32 s59, s53, 143360
buffer_load_dwordx4 v4, s[40:43], s59 offen  lds
s_add_u32 m0, s31, 136192
s_add_u32 s59, s53, 146944
buffer_load_dwordx4 v7, s[40:43], s59 offen  lds
s_add_u32 m0, s31, 139264
s_add_u32 s59, s53, 172032
buffer_load_dwordx4 v4, s[40:43], s59 offen  lds
s_add_u32 m0, s31, 140288
s_add_u32 s59, s53, 175616
buffer_load_dwordx4 v7, s[40:43], s59 offen  lds
s_add_u32 m0, s31, 143360
s_add_u32 s59, s53, 200704
buffer_load_dwordx4 v4, s[40:43], s59 offen  lds
s_add_u32 m0, s31, 144384
s_add_u32 s59, s53, 204288
buffer_load_dwordx4 v7, s[40:43], s59 offen  lds
s_waitcnt vmcnt(17)
s_barrier
s_add_u32 m0, s31, 147456
s_add_u32 s59, s54, 0
buffer_load_dwordx4 v4, s[40:43], s59 offen  lds
s_add_u32 m0, s31, 148480
s_add_u32 s59, s54, 3584
buffer_load_dwordx4 v7, s[40:43], s59 offen  lds
s_add_u32 m0, s31, 151552
s_add_u32 s59, s54, 28672
buffer_load_dwordx4 v4, s[40:43], s59 offen  lds
s_add_u32 m0, s31, 152576
s_add_u32 s59, s54, 32256
buffer_load_dwordx4 v7, s[40:43], s59 offen  lds
s_add_u32 m0, s31, 155648
s_add_u32 s59, s54, 57344
buffer_load_dwordx4 v4, s[40:43], s59 offen  lds
s_add_u32 m0, s31, 156672
s_add_u32 s59, s54, 60928
buffer_load_dwordx4 v7, s[40:43], s59 offen  lds
s_waitcnt vmcnt(14)
s_barrier
s_add_u32 m0, s31, 159744
s_add_u32 s59, s54, 86016
buffer_load_dwordx4 v4, s[40:43], s59 offen  lds
s_add_u32 m0, s31, 160768
s_add_u32 s59, s54, 89600
buffer_load_dwordx4 v7, s[40:43], s59 offen  lds
s_add_u32 m0, s31, 65536
s_add_u32 s59, s54, 114688
buffer_load_dwordx4 v4, s[40:43], s59 offen  lds
s_add_u32 m0, s31, 66560
s_add_u32 s59, s54, 118272
buffer_load_dwordx4 v7, s[40:43], s59 offen  lds
s_add_u32 m0, s31, 69632
s_add_u32 s59, s54, 143360
buffer_load_dwordx4 v4, s[40:43], s59 offen  lds
s_add_u32 m0, s31, 70656
s_add_u32 s59, s54, 146944
buffer_load_dwordx4 v7, s[40:43], s59 offen  lds
s_add_u32 m0, s31, 73728
s_add_u32 s59, s54, 172032
buffer_load_dwordx4 v4, s[40:43], s59 offen  lds
s_add_u32 m0, s31, 74752
s_add_u32 s59, s54, 175616
buffer_load_dwordx4 v7, s[40:43], s59 offen  lds
s_waitcnt vmcnt(14)
s_barrier
s_add_u32 m0, s31, 77824
s_add_u32 s59, s54, 200704
buffer_load_dwordx4 v4, s[40:43], s59 offen  lds
s_add_u32 m0, s31, 78848
s_add_u32 s59, s54, 204288
buffer_load_dwordx4 v7, s[40:43], s59 offen  lds
s_add_u32 m0, s31, 81920
s_add_u32 s59, s55, 0
buffer_load_dwordx4 v4, s[40:43], s59 offen  lds
s_add_u32 m0, s31, 82944
s_add_u32 s59, s55, 3584
buffer_load_dwordx4 v7, s[40:43], s59 offen  lds
s_add_u32 m0, s31, 86016
s_add_u32 s59, s55, 28672
buffer_load_dwordx4 v4, s[40:43], s59 offen  lds
s_add_u32 m0, s31, 87040
s_add_u32 s59, s55, 32256
buffer_load_dwordx4 v7, s[40:43], s59 offen  lds
s_add_u32 m0, s31, 90112
s_add_u32 s59, s55, 57344
buffer_load_dwordx4 v4, s[40:43], s59 offen  lds
s_add_u32 m0, s31, 91136
s_add_u32 s59, s55, 60928
buffer_load_dwordx4 v7, s[40:43], s59 offen  lds
s_waitcnt vmcnt(14)
s_barrier
s_add_u32 m0, s31, 94208
s_add_u32 s59, s55, 86016
buffer_load_dwordx4 v4, s[40:43], s59 offen  lds
s_add_u32 m0, s31, 95232
s_add_u32 s59, s55, 89600
buffer_load_dwordx4 v7, s[40:43], s59 offen  lds
s_add_u32 m0, s31, 98304
s_add_u32 s59, s55, 114688
buffer_load_dwordx4 v4, s[40:43], s59 offen  lds
s_add_u32 m0, s31, 99328
s_add_u32 s59, s55, 118272
buffer_load_dwordx4 v7, s[40:43], s59 offen  lds
s_add_u32 m0, s31, 102400
s_add_u32 s59, s55, 143360
buffer_load_dwordx4 v4, s[40:43], s59 offen  lds
s_add_u32 m0, s31, 103424
s_add_u32 s59, s55, 146944
buffer_load_dwordx4 v7, s[40:43], s59 offen  lds
s_add_u32 m0, s31, 106496
s_add_u32 s59, s55, 172032
buffer_load_dwordx4 v4, s[40:43], s59 offen  lds
s_add_u32 m0, s31, 107520
s_add_u32 s59, s55, 175616
buffer_load_dwordx4 v7, s[40:43], s59 offen  lds
s_waitcnt vmcnt(14)
s_barrier
s_add_u32 m0, s31, 110592
s_add_u32 s59, s55, 200704
buffer_load_dwordx4 v4, s[40:43], s59 offen  lds
s_add_u32 m0, s31, 111616
s_add_u32 s59, s55, 204288
buffer_load_dwordx4 v7, s[40:43], s59 offen  lds
s_add_u32 m0, s31, 114688
s_add_u32 s59, s56, 0
buffer_load_dwordx4 v4, s[40:43], s59 offen  lds
s_add_u32 m0, s31, 115712
s_add_u32 s59, s56, 3584
buffer_load_dwordx4 v7, s[40:43], s59 offen  lds
s_add_u32 m0, s31, 118784
s_add_u32 s59, s56, 28672
buffer_load_dwordx4 v4, s[40:43], s59 offen  lds
s_add_u32 m0, s31, 119808
s_add_u32 s59, s56, 32256
buffer_load_dwordx4 v7, s[40:43], s59 offen  lds
s_add_u32 m0, s31, 122880
s_add_u32 s59, s56, 57344
buffer_load_dwordx4 v4, s[40:43], s59 offen  lds
s_add_u32 m0, s31, 123904
s_add_u32 s59, s56, 60928
buffer_load_dwordx4 v7, s[40:43], s59 offen  lds
s_waitcnt vmcnt(14)
s_barrier
s_add_u32 m0, s31, 126976
s_add_u32 s59, s56, 86016
buffer_load_dwordx4 v4, s[40:43], s59 offen  lds
s_add_u32 m0, s31, 128000
s_add_u32 s59, s56, 89600
buffer_load_dwordx4 v7, s[40:43], s59 offen  lds
s_add_u32 m0, s31, 131072
s_add_u32 s59, s56, 114688
buffer_load_dwordx4 v4, s[40:43], s59 offen  lds
s_add_u32 m0, s31, 132096
s_add_u32 s59, s56, 118272
buffer_load_dwordx4 v7, s[40:43], s59 offen  lds
s_add_u32 m0, s31, 135168
s_add_u32 s59, s56, 143360
buffer_load_dwordx4 v4, s[40:43], s59 offen  lds
s_add_u32 m0, s31, 136192
s_add_u32 s59, s56, 146944
buffer_load_dwordx4 v7, s[40:43], s59 offen  lds
s_add_u32 m0, s31, 139264
s_add_u32 s59, s56, 172032
buffer_load_dwordx4 v4, s[40:43], s59 offen  lds
s_add_u32 m0, s31, 140288
s_add_u32 s59, s56, 175616
buffer_load_dwordx4 v7, s[40:43], s59 offen  lds
s_waitcnt vmcnt(14)
s_barrier
s_add_u32 m0, s31, 143360
s_add_u32 s59, s56, 200704
buffer_load_dwordx4 v4, s[40:43], s59 offen  lds
s_add_u32 m0, s31, 144384
s_add_u32 s59, s56, 204288
buffer_load_dwordx4 v7, s[40:43], s59 offen  lds
s_mov_b32 s32, s8
s_and_b32 s33, s9, 0xffff
s_mov_b32 s34, 1835008
s_mov_b32 s35, 0x20000
s_mov_b32 s36, s28
s_and_b32 s37, s29, 0xffff
s_mov_b32 s38, 67108864
s_mov_b32 s39, 0x20000
s_mov_b64 s[0:1], s[22:23]
s_sub_u32 s57, s3, 4
s_cmp_gt_u32 s4, 3
s_subb_u32 s58, s4, 0
s_mul_i32 s61, s5, 7
s_add_u32 s61, s61, s58
s_lshl_b32 s60, s57, 8
s_add_u32 s60, s60, s61
s_lshl_b32 s60, s60, 7
s_add_u32 s60, s60, 23068672
s_add_u32 s48, s28, s60
s_addc_u32 s49, s29, 0
s_waitcnt lgkmcnt(0)
s_mov_b32 s26, s14
s_load_dwordx16 s[8:23], s[48:49], 0 glc
s_lshl_b32 s61, s61, 5
s_add_u32 s61, s61, s57
s_lshl_b32 s61, s61, 11
s_mul_i32 s60, s5, 0
s_add_u32 s61, s61, s60
s_add_u32 s61, s61, 6291456
s_lshl_b32 s58, s58, 7
s_and_b32 s60, s57, 1
s_lshl_b32 s60, s60, 6
s_add_u32 s58, s58, s60
s_lshr_b32 s27, s57, 1
s_lshl_b32 s60, s5, 1
s_add_u32 s60, s60, s27
s_mul_i32 s60, s60, 28672
s_add_u32 s60, s60, s58
v_lshrrev_b32 v41, 2, v0
v_and_b32 v39, 3, v0
v_mul_u32_u24 v36, 896, v41
v_lshl_add_u32 v36, v39, 4, v36
v_mul_u32_u24 v41, 80, v41
v_lshl_add_u32 v41, v39, 4, v41
v_bfe_u32 v37, v0, 5, 1
v_lshlrev_b32 v37, 3, v37
v_and_b32 v39, 31, v0
v_lshl_add_u32 v38, v39, 6, v37
v_lshl_add_u32 v40, v39, 4, v38
v_lshlrev_b32 v39, 4, v0
s_mul_i32 s27, s27, 30720
s_and_b32 s57, s57, 1
s_lshl_b32 s57, s57, 11
s_add_u32 s27, s27, s57
s_add_u32 s57, s57, s27
s_add_u32 s57, s57, 20480
s_add_u32 s27, s27, 28672
v_add_u32 v33, s57, v39
v_add_u32 v40, s57, v40
v_add_u32 v41, s57, v41
v_add_u32 v38, s27, v38
v_and_b32 v43, 15, v0
v_lshl_add_u32 v43, v37, 1, v43
v_mul_u32_u24 v43, 0x9e3a, v43
v_or_b32 v43, 1, v43
v_mov_b32 v34, s26
s_waitcnt vmcnt(8)
s_barrier
s_mov_b32 s40, s0
s_and_b32 s41, s1, 0xffff
s_mov_b32 s42, 896
s_mov_b32 s43, 0x20000
s_mov_b32 s44, s24
s_and_b32 s45, s25, 0xffff
s_mov_b32 s46, 1835008
s_mov_b32 s47, 0x20000
s_add_u32 s57, s60, 14336
s_add_u32 m0, s27, 0
s_nop 0
buffer_load_dwordx4 v36, s[32:35], s60 offen lds
buffer_load_dwordx2 v[136:137], v37, s[40:43], s58 offen offset:0
buffer_load_dwordx2 v[138:139], v37, s[40:43], s58 offen offset:32
s_add_u32 m0, s27, 1024
s_nop 0
buffer_load_dwordx4 v36, s[32:35], s57 offen lds
buffer_load_dwordx2 v[140:141], v37, s[40:43], s58 offen offset:16
buffer_load_dwordx2 v[142:143], v37, s[40:43], s58 offen offset:48
s_load_dwordx16 s[8:23], s[48:49], 0 glc
s_add_u32 s50, s61, 0
s_add_u32 s51, s61, 8192
s_add_u32 s52, s61, 16384
s_add_u32 s53, s61, 24576
s_add_u32 s54, s61, 32768
s_add_u32 s55, s61, 40960
s_add_u32 s56, s61, 49152
v_mov_b32 v35, 0x3f80
v_mov_b32 v15, 1.0
v_mov_b32 v32, 0
s_waitcnt vmcnt(6)
s_barrier
s_waitcnt vmcnt(6)
s_barrier
s_cmp_eq_u32 s4, 3
s_cbranch_scc1 gM_exit
s_branch gather_M
.p2align 6
comp_M:
s_lshl_b32 s59, s31, 11
s_sub_u32 s60, 2048, s59
v_add_u32 v10, s60, v10
v_and_b32 v25, 15, v0
v_lshrrev_b32 v1, 4, v0
v_lshlrev_b32 v20, 9, v1
v_lshl_add_u32 v20, v25, 4, v20
v_subrev_u32 v25, 12, v25
v_ashrrev_i32 v25, 31, v25
v_bfe_i32 v63, v0, 4, 1
v_not_b32 v62, v63
v_sub_u32 v61, 47, v0
v_ashrrev_i32 v61, 31, v61
s_mov_b32 s56, 0x3fb8aa3b
s_mov_b32 s57, 0x358637bd
s_mov_b32 s36, s28
s_and_b32 s37, s29, 0xffff
s_mov_b32 s38, 67108864
s_mov_b32 s39, 0x20000
s_mov_b32 s40, 875176216
s_mov_b32 s41, 1510404
s_mov_b32 s42, 1683112240
s_mov_b32 s43, 2561028
s_cmp_eq_u32 s4, 3
s_cselect_b32 s40, 892019225, s40
s_cselect_b32 s41, 1445125, s41
s_cselect_b32 s42, 1699955249, s42
s_cselect_b32 s43, 2495749, s43
s_cmp_eq_u32 s4, 4
s_cselect_b32 s40, 53684512, s40
s_waitcnt lgkmcnt(0)
s_barrier
ds_read_b128 v[64:67], v9 offset:0
ds_read_b128 v[68:71], v9 offset:256
ds_read_b64_tr_b16 v[36:37], v28 offset:0
ds_read_b64_tr_b16 v[38:39], v28 offset:256
ds_read_b64_tr_b16 v[40:41], v30 offset:0
ds_read_b64_tr_b16 v[42:43], v30 offset:256
ds_read_b128 v[72:75], v9 offset:2112
ds_read_b128 v[76:79], v9 offset:2368
ds_read_b64_tr_b16 v[44:45], v28 offset:8192
ds_read_b64_tr_b16 v[46:47], v28 offset:8448
ds_read_b64_tr_b16 v[48:49], v30 offset:8192
ds_read_b64_tr_b16 v[50:51], v30 offset:8448
s_waitcnt lgkmcnt(8)
v_mfma_f32_16x16x32_bf16 v[176:179], v[64:67], v[36:39], 0
s_barrier
ds_read_b128 v[80:83], v9 offset:4224
ds_read_b128 v[84:87], v9 offset:4480
ds_read_b64_tr_b16 v[52:53], v28 offset:16384
ds_read_b64_tr_b16 v[54:55], v28 offset:16640
v_mfma_f32_16x16x32_bf16 v[180:183], v[68:71], v[36:39], 0
s_waitcnt lgkmcnt(6)
v_mfma_f32_16x16x32_bf16 v[184:187], v[64:67], v[40:43], 0
ds_read_b64_tr_b16 v[36:37], v30 offset:16384
ds_read_b64_tr_b16 v[38:39], v30 offset:16640
v_mfma_f32_16x16x32_bf16 v[188:191], v[68:71], v[40:43], 0
s_cselect_b32 s41, 2037003, s41
s_cselect_b32 s42, 56840512, s42
v_mfma_f32_16x16x32_bf16 v[176:179], v[72:75], v[44:47], v[176:179]
ds_read_b128 v[88:91], v9 offset:6336
ds_read_b128 v[92:95], v9 offset:6592
ds_read_b64_tr_b16 v[40:41], v28 offset:24576
ds_read_b64_tr_b16 v[42:43], v28 offset:24832
v_mfma_f32_16x16x32_bf16 v[180:183], v[76:79], v[44:47], v[180:183]
s_waitcnt lgkmcnt(6)
s_cselect_b32 s43, 3613971, s43
s_cmp_eq_u32 s4, 5
v_mfma_f32_16x16x32_bf16 v[184:187], v[72:75], v[48:51], v[184:187]
ds_read_b64_tr_b16 v[44:45], v30 offset:24576
ds_read_b64_tr_b16 v[46:47], v30 offset:24832
v_mfma_f32_16x16x32_bf16 v[188:191], v[76:79], v[48:51], v[188:191]
s_cselect_b32 s40, 167915816, s40
s_cselect_b32 s41, 2563603, s41
v_mfma_f32_16x16x32_bf16 v[176:179], v[80:83], v[52:55], v[176:179]
s_barrier
ds_read_b128 v[96:99], v9 offset:8448
ds_read_b128 v[100:103], v9 offset:8704
ds_read_b64_tr_b16 v[48:49], v28 offset:32768
ds_read_b64_tr_b16 v[50:51], v28 offset:33024
v_mfma_f32_16x16x32_bf16 v[180:183], v[84:87], v[52:55], v[180:183]
s_waitcnt lgkmcnt(6)
s_cselect_b32 s42, 302145872, s42
s_cselect_b32 s43, 4666915, s43
v_mfma_f32_16x16x32_bf16 v[184:187], v[80:83], v[36:39], v[184:187]
ds_read_b64_tr_b16 v[52:53], v30 offset:32768
ds_read_b64_tr_b16 v[54:55], v30 offset:33024
v_mfma_f32_16x16x32_bf16 v[188:191], v[84:87], v[36:39], v[188:191]
s_bfe_u32 s48, s40, 0x80000
s_lshl_b32 s48, s48, 13
v_mfma_f32_16x16x32_bf16 v[176:179], v[88:91], v[40:43], v[176:179]
ds_read_b128 v[104:107], v9 offset:10560
ds_read_b128 v[108:111], v9 offset:10816
ds_read_b64_tr_b16 v[36:37], v28 offset:40960
ds_read_b64_tr_b16 v[38:39], v28 offset:41216
v_mfma_f32_16x16x32_bf16 v[180:183], v[92:95], v[40:43], v[180:183]
s_waitcnt lgkmcnt(6)
s_bfe_u32 s8, s42, 0x80000
s_lshl_b32 s8, s8, 3
v_mfma_f32_16x16x32_bf16 v[184:187], v[88:91], v[44:47], v[184:187]
ds_read_b64_tr_b16 v[40:41], v30 offset:40960
ds_read_b64_tr_b16 v[42:43], v30 offset:41216
v_mfma_f32_16x16x32_bf16 v[188:191], v[92:95], v[44:47], v[188:191]
s_bfe_u32 s49, s40, 0x80008
s_lshl_b32 s49, s49, 13
v_mfma_f32_16x16x32_bf16 v[176:179], v[96:99], v[48:51], v[176:179]
s_barrier
ds_read_b128 v[112:115], v9 offset:12672
ds_read_b128 v[116:119], v9 offset:12928
ds_read_b64_tr_b16 v[44:45], v28 offset:49152
ds_read_b64_tr_b16 v[46:47], v28 offset:49408
v_mfma_f32_16x16x32_bf16 v[180:183], v[100:103], v[48:51], v[180:183]
s_waitcnt lgkmcnt(6)
s_bfe_u32 s9, s42, 0x80008
s_lshl_b32 s9, s9, 3
v_mfma_f32_16x16x32_bf16 v[184:187], v[96:99], v[52:55], v[184:187]
ds_read_b64_tr_b16 v[48:49], v30 offset:49152
ds_read_b64_tr_b16 v[50:51], v30 offset:49408
v_mfma_f32_16x16x32_bf16 v[188:191], v[100:103], v[52:55], v[188:191]
s_bfe_u32 s50, s40, 0x80010
s_lshl_b32 s50, s50, 13
v_mfma_f32_16x16x32_bf16 v[176:179], v[104:107], v[36:39], v[176:179]
ds_read_b128 v[120:123], v9 offset:14784
ds_read_b128 v[124:127], v9 offset:15040
ds_read_b64_tr_b16 v[52:53], v28 offset:57344
ds_read_b64_tr_b16 v[54:55], v28 offset:57600
v_mfma_f32_16x16x32_bf16 v[180:183], v[108:111], v[36:39], v[180:183]
s_waitcnt lgkmcnt(6)
s_bfe_u32 s10, s42, 0x80010
s_lshl_b32 s10, s10, 3
v_mfma_f32_16x16x32_bf16 v[184:187], v[104:107], v[40:43], v[184:187]
ds_read_b64_tr_b16 v[36:37], v30 offset:57344
ds_read_b64_tr_b16 v[38:39], v30 offset:57600
v_mfma_f32_16x16x32_bf16 v[188:191], v[108:111], v[40:43], v[188:191]
s_bfe_u32 s51, s40, 0x80018
s_lshl_b32 s51, s51, 13
v_mfma_f32_16x16x32_bf16 v[176:179], v[112:115], v[44:47], v[176:179]
s_barrier
ds_read_b128 v[128:131], v9 offset:16896
ds_read_b128 v[132:135], v9 offset:17152
ds_read_b64_tr_b16 v[40:41], v29 offset:0
ds_read_b64_tr_b16 v[42:43], v29 offset:256
v_mfma_f32_16x16x32_bf16 v[180:183], v[116:119], v[44:47], v[180:183]
s_waitcnt lgkmcnt(6)
s_bfe_u32 s11, s42, 0x80018
s_lshl_b32 s11, s11, 3
v_mfma_f32_16x16x32_bf16 v[184:187], v[112:115], v[48:51], v[184:187]
ds_read_b64_tr_b16 v[44:45], v31 offset:0
ds_read_b64_tr_b16 v[46:47], v31 offset:256
v_mfma_f32_16x16x32_bf16 v[188:191], v[116:119], v[48:51], v[188:191]
s_bfe_u32 s52, s41, 0x80000
s_lshl_b32 s52, s52, 13
v_mfma_f32_16x16x32_bf16 v[176:179], v[120:123], v[52:55], v[176:179]
ds_read_b128 v[136:139], v9 offset:19008
ds_read_b128 v[140:143], v9 offset:19264
ds_read_b64_tr_b16 v[48:49], v29 offset:8192
ds_read_b64_tr_b16 v[50:51], v29 offset:8448
v_mfma_f32_16x16x32_bf16 v[180:183], v[124:127], v[52:55], v[180:183]
s_waitcnt lgkmcnt(6)
s_bfe_u32 s12, s43, 0x80000
s_lshl_b32 s12, s12, 3
v_mfma_f32_16x16x32_bf16 v[184:187], v[120:123], v[36:39], v[184:187]
ds_read_b64_tr_b16 v[52:53], v31 offset:8192
ds_read_b64_tr_b16 v[54:55], v31 offset:8448
v_mfma_f32_16x16x32_bf16 v[188:191], v[124:127], v[36:39], v[188:191]
s_bfe_u32 s53, s41, 0x80008
s_lshl_b32 s53, s53, 13
v_mfma_f32_16x16x32_bf16 v[176:179], v[128:131], v[40:43], v[176:179]
s_barrier
ds_read_b128 v[144:147], v9 offset:21120
ds_read_b128 v[148:151], v9 offset:21376
ds_read_b64_tr_b16 v[36:37], v29 offset:16384
ds_read_b64_tr_b16 v[38:39], v29 offset:16640
v_mfma_f32_16x16x32_bf16 v[180:183], v[132:135], v[40:43], v[180:183]
s_waitcnt lgkmcnt(6)
s_bfe_u32 s13, s43, 0x80008
s_lshl_b32 s13, s13, 3
v_mfma_f32_16x16x32_bf16 v[184:187], v[128:131], v[44:47], v[184:187]
ds_read_b64_tr_b16 v[40:41], v31 offset:16384
ds_read_b64_tr_b16 v[42:43], v31 offset:16640
v_mfma_f32_16x16x32_bf16 v[188:191], v[132:135], v[44:47], v[188:191]
s_bfe_u32 s54, s41, 0x80010
s_lshl_b32 s54, s54, 13
v_mfma_f32_16x16x32_bf16 v[176:179], v[136:139], v[48:51], v[176:179]
ds_read_b128 v[152:155], v9 offset:23232
ds_read_b128 v[156:159], v9 offset:23488
ds_read_b64_tr_b16 v[44:45], v29 offset:24576
ds_read_b64_tr_b16 v[46:47], v29 offset:24832
v_mfma_f32_16x16x32_bf16 v[180:183], v[140:143], v[48:51], v[180:183]
s_waitcnt lgkmcnt(6)
s_bfe_u32 s14, s43, 0x80010
s_lshl_b32 s14, s14, 3
v_mfma_f32_16x16x32_bf16 v[184:187], v[136:139], v[52:55], v[184:187]
ds_read_b64_tr_b16 v[48:49], v31 offset:24576
ds_read_b64_tr_b16 v[50:51], v31 offset:24832
v_mfma_f32_16x16x32_bf16 v[188:191], v[140:143], v[52:55], v[188:191]
s_mul_i32 s59, s5, 458752
s_lshl_b32 s60, s3, 11
v_mfma_f32_16x16x32_bf16 v[176:179], v[144:147], v[36:39], v[176:179]
s_barrier
ds_read_b128 v[160:163], v9 offset:25344
ds_read_b128 v[164:167], v9 offset:25600
ds_read_b64_tr_b16 v[52:53], v28 offset:0
ds_read_b64_tr_b16 v[54:55], v28 offset:256
v_mfma_f32_16x16x32_bf16 v[180:183], v[148:151], v[36:39], v[180:183]
s_waitcnt lgkmcnt(6)
s_add_u32 s59, s59, s60
s_add_u32 s59, s59, 6291456
v_mfma_f32_16x16x32_bf16 v[184:187], v[144:147], v[40:43], v[184:187]
ds_read_b64_tr_b16 v[36:37], v30 offset:0
ds_read_b64_tr_b16 v[38:39], v30 offset:256
v_mfma_f32_16x16x32_bf16 v[188:191], v[148:151], v[40:43], v[188:191]
v_add_u32 v24, s59, v20
v_and_b32 v13, 31, v0
v_mfma_f32_16x16x32_bf16 v[176:179], v[152:155], v[44:47], v[176:179]
ds_read_b128 v[168:171], v9 offset:27456
ds_read_b128 v[172:175], v9 offset:27712
ds_read_b64_tr_b16 v[40:41], v28 offset:8192
ds_read_b64_tr_b16 v[42:43], v28 offset:8448
v_mfma_f32_16x16x32_bf16 v[180:183], v[156:159], v[44:47], v[180:183]
s_waitcnt lgkmcnt(6)
v_mul_u32_u24 v13, 0x9e3a, v13
v_or_b32 v13, 1, v13
v_mfma_f32_16x16x32_bf16 v[184:187], v[152:155], v[48:51], v[184:187]
ds_read_b64_tr_b16 v[44:45], v30 offset:8192
ds_read_b64_tr_b16 v[46:47], v30 offset:8448
v_mfma_f32_16x16x32_bf16 v[188:191], v[156:159], v[48:51], v[188:191]
s_mul_i32 s59, s5, 896
s_lshl_b32 s60, s3, 15
v_mfma_f32_16x16x32_bf16 v[176:179], v[160:163], v[52:55], v[176:179]
s_barrier
ds_read_b64_tr_b16 v[48:49], v28 offset:16384
ds_read_b64_tr_b16 v[50:51], v28 offset:16640
v_mfma_f32_16x16x32_bf16 v[180:183], v[164:167], v[52:55], v[180:183]
s_waitcnt lgkmcnt(4)
s_add_u32 s59, s59, s60
s_add_u32 s59, s59, 23068672
v_mfma_f32_16x16x32_bf16 v[184:187], v[160:163], v[36:39], v[184:187]
ds_read_b64_tr_b16 v[52:53], v30 offset:16384
ds_read_b64_tr_b16 v[54:55], v30 offset:16640
v_mfma_f32_16x16x32_bf16 v[188:191], v[164:167], v[36:39], v[188:191]
v_subrev_u32 v21, 63, v0
v_and_b32 v21, 2147483648, v21
v_mfma_f32_16x16x32_bf16 v[176:179], v[168:171], v[40:43], v[176:179]
ds_read_b64_tr_b16 v[36:37], v28 offset:24576
ds_read_b64_tr_b16 v[38:39], v28 offset:24832
v_mfma_f32_16x16x32_bf16 v[180:183], v[172:175], v[40:43], v[180:183]
s_waitcnt lgkmcnt(4)
v_or_b32 v21, s59, v21
s_lshl_b32 s59, s4, 1
v_mfma_f32_16x16x32_bf16 v[184:187], v[168:171], v[44:47], v[184:187]
ds_read_b64_tr_b16 v[40:41], v30 offset:24576
ds_read_b64_tr_b16 v[42:43], v30 offset:24832
v_mfma_f32_16x16x32_bf16 v[188:191], v[172:175], v[44:47], v[188:191]
s_add_u32 s59, s59, s31
s_lshl_b32 s59, s59, 5
s_add_u32 s59, s59, s5
s_lshl_b32 s59, s59, 1
s_add_u32 s59, s59, s30
s_lshl_b32 s59, s59, 11
s_add_u32 s59, s59, 1048576
s_add_u32 s60, s59, 131072
s_waitcnt vmcnt(2)
v_lshl_or_b32 v4, v57, 16, v56
s_waitcnt vmcnt(0)
v_lshl_or_b32 v5, v59, 16, v58
v_mov_b32 v7, 0
v_and_b32 v6, 0x3f80, v62
s_nop 1
v_mfma_f32_16x16x16_bf16 v[240:243], v[4:5], v[6:7], 0
v_mfma_f32_16x16x16_bf16 v[248:251], v[4:5], v[6:7], 0
v_and_b32 v6, 0x3f80, v63
s_nop 1
v_mfma_f32_16x16x16_bf16 v[244:247], v[4:5], v[6:7], 0
v_mfma_f32_16x16x16_bf16 v[252:255], v[4:5], v[6:7], 0
v_mfma_f32_16x16x32_bf16 v[192:195], v[64:67], v[48:51], 0
s_barrier
ds_read_b64_tr_b16 v[44:45], v28 offset:32768
ds_read_b64_tr_b16 v[46:47], v28 offset:33024
v_mfma_f32_16x16x32_bf16 v[196:199], v[68:71], v[48:51], 0
s_waitcnt lgkmcnt(4)
v_mfma_f32_16x16x32_bf16 v[200:203], v[64:67], v[52:55], 0
ds_read_b64_tr_b16 v[48:49], v30 offset:32768
ds_read_b64_tr_b16 v[50:51], v30 offset:33024
v_mfma_f32_16x16x32_bf16 v[204:207], v[68:71], v[52:55], 0
v_mul_f32 v56, s56, v176
v_mul_f32 v57, s56, v177
v_mul_f32 v58, s56, v178
v_mul_f32 v59, s56, v179
v_exp_f32 v56, v56 clamp
v_mfma_f32_16x16x32_bf16 v[192:195], v[72:75], v[36:39], v[192:195]
ds_read_b64_tr_b16 v[52:53], v28 offset:40960
ds_read_b64_tr_b16 v[54:55], v28 offset:41216
v_mfma_f32_16x16x32_bf16 v[196:199], v[76:79], v[36:39], v[196:199]
s_waitcnt lgkmcnt(4)
v_max_f32 v176, s57, v176
v_exp_f32 v57, v57 clamp
v_max_f32 v177, s57, v177
v_exp_f32 v58, v58 clamp
v_mfma_f32_16x16x32_bf16 v[200:203], v[72:75], v[40:43], v[200:203]
ds_read_b64_tr_b16 v[36:37], v30 offset:40960
ds_read_b64_tr_b16 v[38:39], v30 offset:41216
v_mfma_f32_16x16x32_bf16 v[204:207], v[76:79], v[40:43], v[204:207]
v_max_f32 v178, s57, v178
v_exp_f32 v59, v59 clamp
v_max_f32 v179, s57, v179
v_add_f32 v176, v176, v56
v_mfma_f32_16x16x32_bf16 v[192:195], v[80:83], v[44:47], v[192:195]
s_barrier
ds_read_b64_tr_b16 v[40:41], v28 offset:49152
ds_read_b64_tr_b16 v[42:43], v28 offset:49408
v_mfma_f32_16x16x32_bf16 v[196:199], v[84:87], v[44:47], v[196:199]
s_waitcnt lgkmcnt(4)
v_add_f32 v177, v177, v57
v_add_f32 v178, v178, v58
v_add_f32 v179, v179, v59
v_cvt_pk_bf16_f32 v176, v176, v177
v_cvt_pk_bf16_f32 v177, v178, v179
v_mfma_f32_16x16x32_bf16 v[200:203], v[80:83], v[48:51], v[200:203]
ds_read_b64_tr_b16 v[44:45], v30 offset:49152
ds_read_b64_tr_b16 v[46:47], v30 offset:49408
v_mfma_f32_16x16x32_bf16 v[204:207], v[84:87], v[48:51], v[204:207]
v_mul_f32 v56, s56, v180
v_mul_f32 v57, s56, v181
v_mul_f32 v58, s56, v182
v_mul_f32 v59, s56, v183
v_exp_f32 v56, v56 clamp
v_mfma_f32_16x16x32_bf16 v[192:195], v[88:91], v[52:55], v[192:195]
ds_read_b64_tr_b16 v[48:49], v28 offset:57344
ds_read_b64_tr_b16 v[50:51], v28 offset:57600
v_mfma_f32_16x16x32_bf16 v[196:199], v[92:95], v[52:55], v[196:199]
s_waitcnt lgkmcnt(4)
v_max_f32 v180, s57, v180
v_exp_f32 v57, v57 clamp
v_max_f32 v181, s57, v181
v_exp_f32 v58, v58 clamp
v_mfma_f32_16x16x32_bf16 v[200:203], v[88:91], v[36:39], v[200:203]
ds_read_b64_tr_b16 v[52:53], v30 offset:57344
ds_read_b64_tr_b16 v[54:55], v30 offset:57600
v_mfma_f32_16x16x32_bf16 v[204:207], v[92:95], v[36:39], v[204:207]
v_max_f32 v182, s57, v182
v_exp_f32 v59, v59 clamp
v_max_f32 v183, s57, v183
v_add_f32 v180, v180, v56
v_mfma_f32_16x16x32_bf16 v[192:195], v[96:99], v[40:43], v[192:195]
s_barrier
ds_read_b64_tr_b16 v[36:37], v29 offset:0
ds_read_b64_tr_b16 v[38:39], v29 offset:256
v_mfma_f32_16x16x32_bf16 v[196:199], v[100:103], v[40:43], v[196:199]
s_waitcnt lgkmcnt(4)
v_add_f32 v181, v181, v57
v_add_f32 v182, v182, v58
v_add_f32 v183, v183, v59
v_cvt_pk_bf16_f32 v178, v180, v181
v_cvt_pk_bf16_f32 v179, v182, v183
v_mfma_f32_16x16x32_bf16 v[200:203], v[96:99], v[44:47], v[200:203]
ds_read_b64_tr_b16 v[40:41], v31 offset:0
ds_read_b64_tr_b16 v[42:43], v31 offset:256
v_mfma_f32_16x16x32_bf16 v[204:207], v[100:103], v[44:47], v[204:207]
v_mul_f32 v56, s56, v184
v_mul_f32 v57, s56, v185
v_mul_f32 v58, s56, v186
v_mul_f32 v59, s56, v187
v_exp_f32 v56, v56 clamp
v_mfma_f32_16x16x32_bf16 v[192:195], v[104:107], v[48:51], v[192:195]
ds_read_b64_tr_b16 v[44:45], v29 offset:8192
ds_read_b64_tr_b16 v[46:47], v29 offset:8448
v_mfma_f32_16x16x32_bf16 v[196:199], v[108:111], v[48:51], v[196:199]
s_waitcnt lgkmcnt(4)
v_max_f32 v184, s57, v184
v_exp_f32 v57, v57 clamp
v_max_f32 v185, s57, v185
v_exp_f32 v58, v58 clamp
v_mfma_f32_16x16x32_bf16 v[200:203], v[104:107], v[52:55], v[200:203]
ds_read_b64_tr_b16 v[48:49], v31 offset:8192
ds_read_b64_tr_b16 v[50:51], v31 offset:8448
v_mfma_f32_16x16x32_bf16 v[204:207], v[108:111], v[52:55], v[204:207]
v_max_f32 v186, s57, v186
v_exp_f32 v59, v59 clamp
v_max_f32 v187, s57, v187
v_add_f32 v184, v184, v56
v_mfma_f32_16x16x32_bf16 v[192:195], v[112:115], v[36:39], v[192:195]
s_barrier
ds_read_b64_tr_b16 v[52:53], v29 offset:16384
ds_read_b64_tr_b16 v[54:55], v29 offset:16640
v_mfma_f32_16x16x32_bf16 v[196:199], v[116:119], v[36:39], v[196:199]
s_waitcnt lgkmcnt(4)
v_add_f32 v185, v185, v57
v_add_f32 v186, v186, v58
v_add_f32 v187, v187, v59
v_cvt_pk_bf16_f32 v180, v184, v185
v_cvt_pk_bf16_f32 v181, v186, v187
v_mfma_f32_16x16x32_bf16 v[200:203], v[112:115], v[40:43], v[200:203]
ds_read_b64_tr_b16 v[36:37], v31 offset:16384
ds_read_b64_tr_b16 v[38:39], v31 offset:16640
v_mfma_f32_16x16x32_bf16 v[204:207], v[116:119], v[40:43], v[204:207]
v_mul_f32 v56, s56, v188
v_mul_f32 v57, s56, v189
v_mul_f32 v58, s56, v190
v_mul_f32 v59, s56, v191
v_exp_f32 v56, v56 clamp
v_mfma_f32_16x16x32_bf16 v[192:195], v[120:123], v[44:47], v[192:195]
ds_read_b64_tr_b16 v[40:41], v29 offset:24576
ds_read_b64_tr_b16 v[42:43], v29 offset:24832
v_mfma_f32_16x16x32_bf16 v[196:199], v[124:127], v[44:47], v[196:199]
s_waitcnt lgkmcnt(4)
v_max_f32 v188, s57, v188
v_exp_f32 v57, v57 clamp
v_max_f32 v189, s57, v189
v_exp_f32 v58, v58 clamp
v_mfma_f32_16x16x32_bf16 v[200:203], v[120:123], v[48:51], v[200:203]
ds_read_b64_tr_b16 v[44:45], v31 offset:24576
ds_read_b64_tr_b16 v[46:47], v31 offset:24832
v_mfma_f32_16x16x32_bf16 v[204:207], v[124:127], v[48:51], v[204:207]
v_max_f32 v190, s57, v190
v_exp_f32 v59, v59 clamp
v_max_f32 v191, s57, v191
v_add_f32 v188, v188, v56
v_mfma_f32_16x16x32_bf16 v[192:195], v[128:131], v[52:55], v[192:195]
s_barrier
ds_read_b64_tr_b16 v[48:49], v28 offset:0
ds_read_b64_tr_b16 v[50:51], v28 offset:256
v_mfma_f32_16x16x32_bf16 v[196:199], v[132:135], v[52:55], v[196:199]
s_waitcnt lgkmcnt(4)
v_add_f32 v189, v189, v57
v_add_f32 v190, v190, v58
v_add_f32 v191, v191, v59
v_cvt_pk_bf16_f32 v182, v188, v189
v_cvt_pk_bf16_f32 v183, v190, v191
v_mfma_f32_16x16x32_bf16 v[200:203], v[128:131], v[36:39], v[200:203]
ds_read_b64_tr_b16 v[52:53], v30 offset:0
ds_read_b64_tr_b16 v[54:55], v30 offset:256
v_mfma_f32_16x16x32_bf16 v[204:207], v[132:135], v[36:39], v[204:207]
v_mfma_f32_16x16x32_bf16 v[192:195], v[136:139], v[40:43], v[192:195]
ds_read_b64_tr_b16 v[36:37], v28 offset:8192
ds_read_b64_tr_b16 v[38:39], v28 offset:8448
v_mfma_f32_16x16x32_bf16 v[196:199], v[140:143], v[40:43], v[196:199]
s_waitcnt lgkmcnt(4)
v_mfma_f32_16x16x32_bf16 v[200:203], v[136:139], v[44:47], v[200:203]
ds_read_b64_tr_b16 v[40:41], v30 offset:8192
ds_read_b64_tr_b16 v[42:43], v30 offset:8448
v_mfma_f32_16x16x32_bf16 v[204:207], v[140:143], v[44:47], v[204:207]
v_mfma_f32_16x16x32_bf16 v[192:195], v[144:147], v[48:51], v[192:195]
s_barrier
ds_read_b64_tr_b16 v[44:45], v28 offset:16384
ds_read_b64_tr_b16 v[46:47], v28 offset:16640
v_mfma_f32_16x16x32_bf16 v[196:199], v[148:151], v[48:51], v[196:199]
s_waitcnt lgkmcnt(4)
v_mfma_f32_16x16x32_bf16 v[200:203], v[144:147], v[52:55], v[200:203]
ds_read_b64_tr_b16 v[48:49], v30 offset:16384
ds_read_b64_tr_b16 v[50:51], v30 offset:16640
v_mfma_f32_16x16x32_bf16 v[204:207], v[148:151], v[52:55], v[204:207]
v_mfma_f32_16x16x32_bf16 v[192:195], v[152:155], v[36:39], v[192:195]
ds_read_b64_tr_b16 v[52:53], v28 offset:24576
ds_read_b64_tr_b16 v[54:55], v28 offset:24832
v_mfma_f32_16x16x32_bf16 v[196:199], v[156:159], v[36:39], v[196:199]
s_waitcnt lgkmcnt(4)
v_mfma_f32_16x16x32_bf16 v[200:203], v[152:155], v[40:43], v[200:203]
ds_read_b64_tr_b16 v[36:37], v30 offset:24576
ds_read_b64_tr_b16 v[38:39], v30 offset:24832
v_mfma_f32_16x16x32_bf16 v[204:207], v[156:159], v[40:43], v[204:207]
v_mfma_f32_16x16x32_bf16 v[192:195], v[160:163], v[44:47], v[192:195]
s_barrier
ds_read_b64_tr_b16 v[40:41], v14 offset:32768
ds_read_b64_tr_b16 v[42:43], v14 offset:33024
v_mfma_f32_16x16x32_bf16 v[196:199], v[164:167], v[44:47], v[196:199]
s_waitcnt lgkmcnt(4)
v_mfma_f32_16x16x32_bf16 v[200:203], v[160:163], v[48:51], v[200:203]
ds_read_b64_tr_b16 v[44:45], v16 offset:32768
ds_read_b64_tr_b16 v[46:47], v16 offset:33024
v_mfma_f32_16x16x32_bf16 v[204:207], v[164:167], v[48:51], v[204:207]
v_mfma_f32_16x16x32_bf16 v[192:195], v[168:171], v[52:55], v[192:195]
ds_read_b64_tr_b16 v[48:49], v14 offset:36864
ds_read_b64_tr_b16 v[50:51], v14 offset:37120
v_mfma_f32_16x16x32_bf16 v[196:199], v[172:175], v[52:55], v[196:199]
s_waitcnt lgkmcnt(4)
v_mfma_f32_16x16x32_bf16 v[200:203], v[168:171], v[36:39], v[200:203]
ds_read_b64_tr_b16 v[52:53], v16 offset:36864
ds_read_b64_tr_b16 v[54:55], v16 offset:37120
v_mfma_f32_16x16x32_bf16 v[204:207], v[172:175], v[36:39], v[204:207]
s_barrier
v_cvt_pk_bf16_f32 v184, v192, v193
v_cvt_pk_bf16_f32 v185, v194, v195
v_cvt_pk_bf16_f32 v186, v196, v197
v_cvt_pk_bf16_f32 v187, v198, v199
v_cvt_pk_bf16_f32 v188, v200, v201
v_cvt_pk_bf16_f32 v189, v202, v203
s_nop 0
v_cvt_pk_bf16_f32 v190, v204, v205
v_cvt_pk_bf16_f32 v191, v206, v207
v_bfi_b32 v188, v25, v188, v27
v_bfi_b32 v189, v25, v189, v27
v_bfi_b32 v190, v25, v190, v27
v_bfi_b32 v191, v25, v191, v27
v_mfma_f32_16x16x32_bf16 v[192:195], v[176:179], v[184:187], 0
v_mfma_f32_16x16x32_bf16 v[196:199], v[180:183], v[184:187], 0
v_mfma_f32_16x16x32_bf16 v[200:203], v[176:179], v[188:191], 0
v_mfma_f32_16x16x32_bf16 v[204:207], v[180:183], v[188:191], 0
v_mfma_f32_16x16x32_bf16 v[240:243], v[40:43], v[64:67], v[240:243]
ds_read_b64_tr_b16 v[36:37], v14 offset:40960
ds_read_b64_tr_b16 v[38:39], v14 offset:41216
v_mfma_f32_16x16x32_bf16 v[248:251], v[40:43], v[68:71], v[248:251]
s_waitcnt lgkmcnt(4)
v_mfma_f32_16x16x32_bf16 v[244:247], v[44:47], v[64:67], v[244:247]
ds_read_b64_tr_b16 v[40:41], v16 offset:40960
ds_read_b64_tr_b16 v[42:43], v16 offset:41216
v_mfma_f32_16x16x32_bf16 v[252:255], v[44:47], v[68:71], v[252:255]
v_mfma_f32_16x16x32_bf16 v[240:243], v[48:51], v[72:75], v[240:243]
ds_read_b64_tr_b16 v[44:45], v14 offset:45056
ds_read_b64_tr_b16 v[46:47], v14 offset:45312
v_mfma_f32_16x16x32_bf16 v[248:251], v[48:51], v[76:79], v[248:251]
s_waitcnt lgkmcnt(4)
v_cvt_pk_bf16_f32 v192, v192, v193
v_cvt_pk_bf16_f32 v193, v194, v195
v_cvt_pk_bf16_f32 v194, v196, v197
v_cvt_pk_bf16_f32 v195, v198, v199
v_mfma_f32_16x16x32_bf16 v[244:247], v[52:55], v[72:75], v[244:247]
ds_read_b64_tr_b16 v[48:49], v16 offset:45056
ds_read_b64_tr_b16 v[50:51], v16 offset:45312
v_mfma_f32_16x16x32_bf16 v[252:255], v[52:55], v[76:79], v[252:255]
v_cvt_pk_bf16_f32 v196, v200, v201
v_cvt_pk_bf16_f32 v197, v202, v203
v_cvt_pk_bf16_f32 v198, v204, v205
v_cvt_pk_bf16_f32 v199, v206, v207
v_mfma_f32_16x16x32_bf16 v[240:243], v[36:39], v[80:83], v[240:243]
s_barrier
ds_read_b64_tr_b16 v[52:53], v14 offset:49152
ds_read_b64_tr_b16 v[54:55], v14 offset:49408
v_mfma_f32_16x16x32_bf16 v[248:251], v[36:39], v[84:87], v[248:251]
s_waitcnt lgkmcnt(4)
v_mov_b32 v200, v195
v_mov_b32 v201, v195
v_and_or_b32 v202, v195, s58, v26
v_lshl_or_b32 v195, v195, 16, v26
v_mfma_f32_16x16x32_bf16 v[244:247], v[40:43], v[80:83], v[244:247]
ds_read_b64_tr_b16 v[36:37], v16 offset:49152
ds_read_b64_tr_b16 v[38:39], v16 offset:49408
v_mfma_f32_16x16x32_bf16 v[252:255], v[40:43], v[84:87], v[252:255]
v_mov_b32 v204, v199
v_mov_b32 v205, v199
v_and_or_b32 v206, v199, s58, v26
v_lshl_or_b32 v199, v199, 16, v26
v_mfma_f32_16x16x32_bf16 v[240:243], v[44:47], v[88:91], v[240:243]
ds_read_b64_tr_b16 v[40:41], v14 offset:53248
ds_read_b64_tr_b16 v[42:43], v14 offset:53504
v_mfma_f32_16x16x32_bf16 v[248:251], v[44:47], v[92:95], v[248:251]
s_waitcnt lgkmcnt(4)
v_permlane16_swap_b32 v200, v201
v_permlane32_swap_b32 v195, v202
v_bfi_b32 v194, v61, v200, v194
buffer_store_dwordx4 v[192:195], v20, s[36:39], s59 offen offset:0 sc1
v_mfma_f32_16x16x32_bf16 v[244:247], v[48:51], v[88:91], v[244:247]
ds_read_b64_tr_b16 v[44:45], v16 offset:53248
ds_read_b64_tr_b16 v[46:47], v16 offset:53504
v_mfma_f32_16x16x32_bf16 v[252:255], v[48:51], v[92:95], v[252:255]
v_permlane16_swap_b32 v204, v205
v_permlane32_swap_b32 v199, v206
v_bfi_b32 v198, v61, v204, v198
buffer_store_dwordx4 v[196:199], v20, s[36:39], s59 offen offset:256 sc1
v_mfma_f32_16x16x32_bf16 v[240:243], v[52:55], v[96:99], v[240:243]
ds_read_b64_tr_b16 v[48:49], v14 offset:57344
ds_read_b64_tr_b16 v[50:51], v14 offset:57600
v_mfma_f32_16x16x32_bf16 v[248:251], v[52:55], v[100:103], v[248:251]
s_waitcnt lgkmcnt(4)
v_mov_b32 v7, 0
v_and_b32 v6, 1.0, v62
v_mfma_f32_16x16x32_bf16 v[244:247], v[36:39], v[96:99], v[244:247]
ds_read_b64_tr_b16 v[52:53], v16 offset:57344
ds_read_b64_tr_b16 v[54:55], v16 offset:57600
v_mfma_f32_16x16x32_bf16 v[252:255], v[36:39], v[100:103], v[252:255]
v_mfma_f32_16x16x16_bf16 v[208:211], v[4:5], v[6:7], 0
v_mfma_f32_16x16x16_bf16 v[216:219], v[4:5], v[6:7], 0
v_and_b32 v6, 1.0, v63
v_mfma_f32_16x16x32_bf16 v[240:243], v[40:43], v[104:107], v[240:243]
ds_read_b64_tr_b16 v[36:37], v14 offset:61440
ds_read_b64_tr_b16 v[38:39], v14 offset:61696
v_mfma_f32_16x16x32_bf16 v[248:251], v[40:43], v[108:111], v[248:251]
s_waitcnt lgkmcnt(4)
v_mfma_f32_16x16x16_bf16 v[212:215], v[4:5], v[6:7], 0
v_mfma_f32_16x16x16_bf16 v[220:223], v[4:5], v[6:7], 0
v_mfma_f32_16x16x32_bf16 v[244:247], v[44:47], v[104:107], v[244:247]
ds_read_b64_tr_b16 v[40:41], v16 offset:61440
ds_read_b64_tr_b16 v[42:43], v16 offset:61696
v_mfma_f32_16x16x32_bf16 v[252:255], v[44:47], v[108:111], v[252:255]
s_lshl_b32 s44, s31, 12
s_sub_u32 s45, 4096, s44
v_mfma_f32_16x16x32_bf16 v[240:243], v[48:51], v[112:115], v[240:243]
s_barrier
ds_read_b64_tr_b16 v[44:45], v15 offset:0
ds_read_b64_tr_b16 v[46:47], v15 offset:256
v_mfma_f32_16x16x32_bf16 v[248:251], v[48:51], v[116:119], v[248:251]
s_waitcnt lgkmcnt(4)
v_add_u32 v28, s44, v14
v_add_u32 v29, s44, v15
v_mfma_f32_16x16x32_bf16 v[244:247], v[52:55], v[112:115], v[244:247]
ds_read_b64_tr_b16 v[48:49], v17 offset:0
ds_read_b64_tr_b16 v[50:51], v17 offset:256
v_mfma_f32_16x16x32_bf16 v[252:255], v[52:55], v[116:119], v[252:255]
v_add_u32 v30, s44, v16
v_add_u32 v31, s44, v17
v_mfma_f32_16x16x32_bf16 v[240:243], v[36:39], v[120:123], v[240:243]
ds_read_b64_tr_b16 v[52:53], v15 offset:4096
ds_read_b64_tr_b16 v[54:55], v15 offset:4352
v_mfma_f32_16x16x32_bf16 v[248:251], v[36:39], v[124:127], v[248:251]
s_waitcnt lgkmcnt(4)
v_add_u32 v32, s45, v14
v_add_u32 v33, s45, v15
v_mfma_f32_16x16x32_bf16 v[244:247], v[40:43], v[120:123], v[244:247]
ds_read_b64_tr_b16 v[36:37], v17 offset:4096
ds_read_b64_tr_b16 v[38:39], v17 offset:4352
v_mfma_f32_16x16x32_bf16 v[252:255], v[40:43], v[124:127], v[252:255]
v_add_u32 v34, s45, v16
v_add_u32 v35, s45, v17
v_mfma_f32_16x16x32_bf16 v[240:243], v[44:47], v[128:131], v[240:243]
ds_read_b64_tr_b16 v[40:41], v15 offset:8192
ds_read_b64_tr_b16 v[42:43], v15 offset:8448
v_mfma_f32_16x16x32_bf16 v[248:251], v[44:47], v[132:135], v[248:251]
s_waitcnt lgkmcnt(4)
v_subrev_u32 v12, 0x10000, v28
v_subrev_u32 v18, 0x10000, v30
v_mfma_f32_16x16x32_bf16 v[244:247], v[48:51], v[128:131], v[244:247]
ds_read_b64_tr_b16 v[44:45], v17 offset:8192
ds_read_b64_tr_b16 v[46:47], v17 offset:8448
v_mfma_f32_16x16x32_bf16 v[252:255], v[48:51], v[132:135], v[252:255]
v_subrev_u32 v19, 0x10000, v32
v_subrev_u32 v60, 0x10000, v34
v_mfma_f32_16x16x32_bf16 v[240:243], v[52:55], v[136:139], v[240:243]
ds_read_b64_tr_b16 v[48:49], v15 offset:12288
ds_read_b64_tr_b16 v[50:51], v15 offset:12544
v_mfma_f32_16x16x32_bf16 v[248:251], v[52:55], v[140:143], v[248:251]
s_waitcnt lgkmcnt(4)
v_mfma_f32_16x16x32_bf16 v[244:247], v[36:39], v[136:139], v[244:247]
ds_read_b64_tr_b16 v[52:53], v17 offset:12288
ds_read_b64_tr_b16 v[54:55], v17 offset:12544
v_mfma_f32_16x16x32_bf16 v[252:255], v[36:39], v[140:143], v[252:255]
v_mfma_f32_16x16x32_bf16 v[240:243], v[40:43], v[144:147], v[240:243]
s_barrier
ds_read_b64_tr_b16 v[36:37], v15 offset:16384
ds_read_b64_tr_b16 v[38:39], v15 offset:16640
v_mfma_f32_16x16x32_bf16 v[248:251], v[40:43], v[148:151], v[248:251]
s_waitcnt lgkmcnt(4)
v_mfma_f32_16x16x32_bf16 v[244:247], v[44:47], v[144:147], v[244:247]
ds_read_b64_tr_b16 v[40:41], v17 offset:16384
ds_read_b64_tr_b16 v[42:43], v17 offset:16640
v_mfma_f32_16x16x32_bf16 v[252:255], v[44:47], v[148:151], v[252:255]
v_mfma_f32_16x16x32_bf16 v[240:243], v[48:51], v[152:155], v[240:243]
ds_read_b64_tr_b16 v[44:45], v15 offset:20480
ds_read_b64_tr_b16 v[46:47], v15 offset:20736
v_mfma_f32_16x16x32_bf16 v[248:251], v[48:51], v[156:159], v[248:251]
s_waitcnt lgkmcnt(4)
v_mfma_f32_16x16x32_bf16 v[244:247], v[52:55], v[152:155], v[244:247]
ds_read_b64_tr_b16 v[48:49], v17 offset:20480
ds_read_b64_tr_b16 v[50:51], v17 offset:20736
v_mfma_f32_16x16x32_bf16 v[252:255], v[52:55], v[156:159], v[252:255]
v_mfma_f32_16x16x32_bf16 v[240:243], v[36:39], v[160:163], v[240:243]
ds_read_b64_tr_b16 v[52:53], v15 offset:24576
ds_read_b64_tr_b16 v[54:55], v15 offset:24832
v_mfma_f32_16x16x32_bf16 v[248:251], v[36:39], v[164:167], v[248:251]
s_waitcnt lgkmcnt(4)
v_mfma_f32_16x16x32_bf16 v[244:247], v[40:43], v[160:163], v[244:247]
ds_read_b64_tr_b16 v[36:37], v17 offset:24576
ds_read_b64_tr_b16 v[38:39], v17 offset:24832
v_mfma_f32_16x16x32_bf16 v[252:255], v[40:43], v[164:167], v[252:255]
v_mfma_f32_16x16x32_bf16 v[240:243], v[44:47], v[168:171], v[240:243]
ds_read_b64_tr_b16 v[40:41], v15 offset:28672
ds_read_b64_tr_b16 v[42:43], v15 offset:28928
v_mfma_f32_16x16x32_bf16 v[248:251], v[44:47], v[172:175], v[248:251]
s_waitcnt lgkmcnt(4)
v_mfma_f32_16x16x32_bf16 v[244:247], v[48:51], v[168:171], v[244:247]
ds_read_b64_tr_b16 v[44:45], v17 offset:28672
ds_read_b64_tr_b16 v[46:47], v17 offset:28928
v_mfma_f32_16x16x32_bf16 v[252:255], v[48:51], v[172:175], v[252:255]
v_mfma_f32_16x16x32_bf16 v[208:211], v[52:55], v[64:67], v[208:211]
s_barrier
ds_read_b64_tr_b16 v[48:49], v14 offset:0
ds_read_b64_tr_b16 v[50:51], v14 offset:256
v_mfma_f32_16x16x32_bf16 v[216:219], v[52:55], v[68:71], v[216:219]
s_waitcnt lgkmcnt(4)
v_mfma_f32_16x16x32_bf16 v[212:215], v[36:39], v[64:67], v[212:215]
ds_read_b64_tr_b16 v[52:53], v16 offset:0
ds_read_b64_tr_b16 v[54:55], v16 offset:256
v_mfma_f32_16x16x32_bf16 v[220:223], v[36:39], v[68:71], v[220:223]
v_mul_f32 v240, v240, abs(v240)
v_mul_f32 v241, v241, abs(v241)
v_mfma_f32_16x16x32_bf16 v[208:211], v[40:43], v[72:75], v[208:211]
ds_read_b64_tr_b16 v[36:37], v14 offset:4096
ds_read_b64_tr_b16 v[38:39], v14 offset:4352
v_mfma_f32_16x16x32_bf16 v[216:219], v[40:43], v[76:79], v[216:219]
s_waitcnt lgkmcnt(4)
v_mul_f32 v242, v242, abs(v242)
v_mul_f32 v243, v243, abs(v243)
v_mfma_f32_16x16x32_bf16 v[212:215], v[44:47], v[72:75], v[212:215]
ds_read_b64_tr_b16 v[40:41], v16 offset:4096
ds_read_b64_tr_b16 v[42:43], v16 offset:4352
v_mfma_f32_16x16x32_bf16 v[220:223], v[44:47], v[76:79], v[220:223]
v_mul_f32 v244, v244, abs(v244)
v_mul_f32 v245, v245, abs(v245)
v_mfma_f32_16x16x32_bf16 v[208:211], v[48:51], v[80:83], v[208:211]
ds_read_b64_tr_b16 v[44:45], v14 offset:8192
ds_read_b64_tr_b16 v[46:47], v14 offset:8448
v_mfma_f32_16x16x32_bf16 v[216:219], v[48:51], v[84:87], v[216:219]
s_waitcnt lgkmcnt(4)
v_mul_f32 v246, v246, abs(v246)
v_mul_f32 v247, v247, abs(v247)
v_mfma_f32_16x16x32_bf16 v[212:215], v[52:55], v[80:83], v[212:215]
ds_read_b64_tr_b16 v[48:49], v16 offset:8192
ds_read_b64_tr_b16 v[50:51], v16 offset:8448
v_mfma_f32_16x16x32_bf16 v[220:223], v[52:55], v[84:87], v[220:223]
v_cvt_pk_bf16_f32 v176, v240, v241
v_cvt_pk_bf16_f32 v177, v242, v243
v_mfma_f32_16x16x32_bf16 v[208:211], v[36:39], v[88:91], v[208:211]
ds_read_b64_tr_b16 v[52:53], v14 offset:12288
ds_read_b64_tr_b16 v[54:55], v14 offset:12544
v_mfma_f32_16x16x32_bf16 v[216:219], v[36:39], v[92:95], v[216:219]
s_waitcnt lgkmcnt(4)
v_cvt_pk_bf16_f32 v178, v244, v245
v_cvt_pk_bf16_f32 v179, v246, v247
v_mfma_f32_16x16x32_bf16 v[212:215], v[40:43], v[88:91], v[212:215]
ds_read_b64_tr_b16 v[36:37], v16 offset:12288
ds_read_b64_tr_b16 v[38:39], v16 offset:12544
v_mfma_f32_16x16x32_bf16 v[220:223], v[40:43], v[92:95], v[220:223]
v_pk_max_i16 v176, v176, 0
v_pk_max_i16 v177, v177, 0
v_mfma_f32_16x16x32_bf16 v[208:211], v[44:47], v[96:99], v[208:211]
s_barrier
ds_read_b64_tr_b16 v[40:41], v14 offset:16384
ds_read_b64_tr_b16 v[42:43], v14 offset:16640
v_mfma_f32_16x16x32_bf16 v[216:219], v[44:47], v[100:103], v[216:219]
s_waitcnt lgkmcnt(4)
v_pk_max_i16 v178, v178, 0
v_pk_max_i16 v179, v179, 0
v_mfma_f32_16x16x32_bf16 v[212:215], v[48:51], v[96:99], v[212:215]
ds_read_b64_tr_b16 v[44:45], v16 offset:16384
ds_read_b64_tr_b16 v[46:47], v16 offset:16640
v_mfma_f32_16x16x32_bf16 v[220:223], v[48:51], v[100:103], v[220:223]
v_mul_f32 v248, v248, abs(v248)
v_mul_f32 v249, v249, abs(v249)
v_mfma_f32_16x16x32_bf16 v[208:211], v[52:55], v[104:107], v[208:211]
ds_read_b64_tr_b16 v[48:49], v14 offset:20480
ds_read_b64_tr_b16 v[50:51], v14 offset:20736
v_mfma_f32_16x16x32_bf16 v[216:219], v[52:55], v[108:111], v[216:219]
s_waitcnt lgkmcnt(4)
v_mul_f32 v250, v250, abs(v250)
v_mul_f32 v251, v251, abs(v251)
v_mfma_f32_16x16x32_bf16 v[212:215], v[36:39], v[104:107], v[212:215]
ds_read_b64_tr_b16 v[52:53], v16 offset:20480
ds_read_b64_tr_b16 v[54:55], v16 offset:20736
v_mfma_f32_16x16x32_bf16 v[220:223], v[36:39], v[108:111], v[220:223]
v_mul_f32 v252, v252, abs(v252)
v_mul_f32 v253, v253, abs(v253)
v_mfma_f32_16x16x32_bf16 v[208:211], v[40:43], v[112:115], v[208:211]
ds_read_b64_tr_b16 v[36:37], v14 offset:24576
ds_read_b64_tr_b16 v[38:39], v14 offset:24832
v_mfma_f32_16x16x32_bf16 v[216:219], v[40:43], v[116:119], v[216:219]
s_waitcnt lgkmcnt(4)
v_mul_f32 v254, v254, abs(v254)
v_mul_f32 v255, v255, abs(v255)
v_mfma_f32_16x16x32_bf16 v[212:215], v[44:47], v[112:115], v[212:215]
ds_read_b64_tr_b16 v[40:41], v16 offset:24576
ds_read_b64_tr_b16 v[42:43], v16 offset:24832
v_mfma_f32_16x16x32_bf16 v[220:223], v[44:47], v[116:119], v[220:223]
v_cvt_pk_bf16_f32 v180, v248, v249
v_cvt_pk_bf16_f32 v181, v250, v251
v_mfma_f32_16x16x32_bf16 v[208:211], v[48:51], v[120:123], v[208:211]
ds_read_b64_tr_b16 v[44:45], v14 offset:28672
ds_read_b64_tr_b16 v[46:47], v14 offset:28928
v_mfma_f32_16x16x32_bf16 v[216:219], v[48:51], v[124:127], v[216:219]
s_waitcnt lgkmcnt(4)
v_cvt_pk_bf16_f32 v182, v252, v253
v_cvt_pk_bf16_f32 v183, v254, v255
v_mfma_f32_16x16x32_bf16 v[212:215], v[52:55], v[120:123], v[212:215]
ds_read_b64_tr_b16 v[48:49], v16 offset:28672
ds_read_b64_tr_b16 v[50:51], v16 offset:28928
v_mfma_f32_16x16x32_bf16 v[220:223], v[52:55], v[124:127], v[220:223]
v_pk_max_i16 v180, v180, 0
v_pk_max_i16 v181, v181, 0
v_mfma_f32_16x16x32_bf16 v[208:211], v[36:39], v[128:131], v[208:211]
s_barrier
ds_read_b64_tr_b16 v[52:53], v14 offset:32768
ds_read_b64_tr_b16 v[54:55], v14 offset:33024
v_mfma_f32_16x16x32_bf16 v[216:219], v[36:39], v[132:135], v[216:219]
s_waitcnt lgkmcnt(4)
v_pk_max_i16 v182, v182, 0
v_pk_max_i16 v183, v183, 0
v_mfma_f32_16x16x32_bf16 v[212:215], v[40:43], v[128:131], v[212:215]
ds_read_b64_tr_b16 v[36:37], v16 offset:32768
ds_read_b64_tr_b16 v[38:39], v16 offset:33024
v_mfma_f32_16x16x32_bf16 v[220:223], v[40:43], v[132:135], v[220:223]
v_mov_b32 v6, 0
v_and_b32 v7, 0x3f80, v62
v_mfma_f32_16x16x32_bf16 v[208:211], v[44:47], v[136:139], v[208:211]
ds_read_b64_tr_b16 v[40:41], v14 offset:36864
ds_read_b64_tr_b16 v[42:43], v14 offset:37120
v_mfma_f32_16x16x32_bf16 v[216:219], v[44:47], v[140:143], v[216:219]
s_waitcnt lgkmcnt(4)
v_mfma_f32_16x16x32_bf16 v[212:215], v[48:51], v[136:139], v[212:215]
ds_read_b64_tr_b16 v[44:45], v16 offset:36864
ds_read_b64_tr_b16 v[46:47], v16 offset:37120
v_mfma_f32_16x16x32_bf16 v[220:223], v[48:51], v[140:143], v[220:223]
v_mfma_f32_16x16x16_bf16 v[240:243], v[4:5], v[6:7], 0
v_mfma_f32_16x16x16_bf16 v[248:251], v[4:5], v[6:7], 0
v_mfma_f32_16x16x32_bf16 v[208:211], v[52:55], v[144:147], v[208:211]
ds_read_b64_tr_b16 v[48:49], v14 offset:40960
ds_read_b64_tr_b16 v[50:51], v14 offset:41216
v_mfma_f32_16x16x32_bf16 v[216:219], v[52:55], v[148:151], v[216:219]
s_waitcnt lgkmcnt(4)
v_and_b32 v7, 0x3f80, v63
v_mfma_f32_16x16x32_bf16 v[212:215], v[36:39], v[144:147], v[212:215]
ds_read_b64_tr_b16 v[52:53], v16 offset:40960
ds_read_b64_tr_b16 v[54:55], v16 offset:41216
v_mfma_f32_16x16x32_bf16 v[220:223], v[36:39], v[148:151], v[220:223]
v_mfma_f32_16x16x16_bf16 v[244:247], v[4:5], v[6:7], 0
v_mfma_f32_16x16x16_bf16 v[252:255], v[4:5], v[6:7], 0
v_mfma_f32_16x16x32_bf16 v[208:211], v[40:43], v[152:155], v[208:211]
ds_read_b64_tr_b16 v[36:37], v14 offset:45056
ds_read_b64_tr_b16 v[38:39], v14 offset:45312
v_mfma_f32_16x16x32_bf16 v[216:219], v[40:43], v[156:159], v[216:219]
s_waitcnt lgkmcnt(4)
v_mfma_f32_16x16x32_bf16 v[212:215], v[44:47], v[152:155], v[212:215]
ds_read_b64_tr_b16 v[40:41], v16 offset:45056
ds_read_b64_tr_b16 v[42:43], v16 offset:45312
v_mfma_f32_16x16x32_bf16 v[220:223], v[44:47], v[156:159], v[220:223]
v_mfma_f32_16x16x32_bf16 v[208:211], v[48:51], v[160:163], v[208:211]
s_barrier
ds_read_b64_tr_b16 v[44:45], v14 offset:49152
ds_read_b64_tr_b16 v[46:47], v14 offset:49408
v_mfma_f32_16x16x32_bf16 v[216:219], v[48:51], v[164:167], v[216:219]
s_waitcnt lgkmcnt(4)
v_mfma_f32_16x16x32_bf16 v[212:215], v[52:55], v[160:163], v[212:215]
ds_read_b64_tr_b16 v[48:49], v16 offset:49152
ds_read_b64_tr_b16 v[50:51], v16 offset:49408
v_mfma_f32_16x16x32_bf16 v[220:223], v[52:55], v[164:167], v[220:223]
v_mfma_f32_16x16x32_bf16 v[208:211], v[36:39], v[168:171], v[208:211]
ds_read_b64_tr_b16 v[52:53], v14 offset:53248
ds_read_b64_tr_b16 v[54:55], v14 offset:53504
v_mfma_f32_16x16x32_bf16 v[216:219], v[36:39], v[172:175], v[216:219]
s_waitcnt lgkmcnt(4)
v_mfma_f32_16x16x32_bf16 v[212:215], v[40:43], v[168:171], v[212:215]
ds_read_b64_tr_b16 v[36:37], v16 offset:53248
ds_read_b64_tr_b16 v[38:39], v16 offset:53504
v_mfma_f32_16x16x32_bf16 v[220:223], v[40:43], v[172:175], v[220:223]
v_mfma_f32_16x16x32_bf16 v[240:243], v[44:47], v[64:67], v[240:243]
ds_read_b64_tr_b16 v[40:41], v14 offset:57344
ds_read_b64_tr_b16 v[42:43], v14 offset:57600
v_mfma_f32_16x16x32_bf16 v[248:251], v[44:47], v[68:71], v[248:251]
s_waitcnt lgkmcnt(4)
v_mfma_f32_16x16x32_bf16 v[244:247], v[48:51], v[64:67], v[244:247]
ds_read_b64_tr_b16 v[44:45], v16 offset:57344
ds_read_b64_tr_b16 v[46:47], v16 offset:57600
v_mfma_f32_16x16x32_bf16 v[252:255], v[48:51], v[68:71], v[252:255]
v_mul_f32 v208, v208, abs(v208)
v_mul_f32 v209, v209, abs(v209)
v_mfma_f32_16x16x32_bf16 v[240:243], v[52:55], v[72:75], v[240:243]
ds_read_b64_tr_b16 v[48:49], v14 offset:61440
ds_read_b64_tr_b16 v[50:51], v14 offset:61696
v_mfma_f32_16x16x32_bf16 v[248:251], v[52:55], v[76:79], v[248:251]
s_waitcnt lgkmcnt(4)
v_mul_f32 v210, v210, abs(v210)
v_mul_f32 v211, v211, abs(v211)
v_mfma_f32_16x16x32_bf16 v[244:247], v[36:39], v[72:75], v[244:247]
ds_read_b64_tr_b16 v[52:53], v16 offset:61440
ds_read_b64_tr_b16 v[54:55], v16 offset:61696
v_mfma_f32_16x16x32_bf16 v[252:255], v[36:39], v[76:79], v[252:255]
v_mul_f32 v212, v212, abs(v212)
v_mul_f32 v213, v213, abs(v213)
v_mfma_f32_16x16x32_bf16 v[240:243], v[40:43], v[80:83], v[240:243]
s_barrier
ds_read_b64_tr_b16 v[36:37], v15 offset:0
ds_read_b64_tr_b16 v[38:39], v15 offset:256
v_mfma_f32_16x16x32_bf16 v[248:251], v[40:43], v[84:87], v[248:251]
s_waitcnt lgkmcnt(4)
v_mul_f32 v214, v214, abs(v214)
v_mul_f32 v215, v215, abs(v215)
v_mfma_f32_16x16x32_bf16 v[244:247], v[44:47], v[80:83], v[244:247]
ds_read_b64_tr_b16 v[40:41], v17 offset:0
ds_read_b64_tr_b16 v[42:43], v17 offset:256
v_mfma_f32_16x16x32_bf16 v[252:255], v[44:47], v[84:87], v[252:255]
v_cvt_pk_bf16_f32 v184, v208, v209
v_cvt_pk_bf16_f32 v185, v210, v211
v_mfma_f32_16x16x32_bf16 v[240:243], v[48:51], v[88:91], v[240:243]
ds_read_b64_tr_b16 v[44:45], v15 offset:4096
ds_read_b64_tr_b16 v[46:47], v15 offset:4352
v_mfma_f32_16x16x32_bf16 v[248:251], v[48:51], v[92:95], v[248:251]
s_waitcnt lgkmcnt(4)
v_cvt_pk_bf16_f32 v186, v212, v213
v_cvt_pk_bf16_f32 v187, v214, v215
v_mfma_f32_16x16x32_bf16 v[244:247], v[52:55], v[88:91], v[244:247]
ds_read_b64_tr_b16 v[48:49], v17 offset:4096
ds_read_b64_tr_b16 v[50:51], v17 offset:4352
v_mfma_f32_16x16x32_bf16 v[252:255], v[52:55], v[92:95], v[252:255]
v_pk_max_i16 v184, v184, 0
v_pk_max_i16 v185, v185, 0
v_mfma_f32_16x16x32_bf16 v[240:243], v[36:39], v[96:99], v[240:243]
ds_read_b64_tr_b16 v[52:53], v15 offset:8192
ds_read_b64_tr_b16 v[54:55], v15 offset:8448
v_mfma_f32_16x16x32_bf16 v[248:251], v[36:39], v[100:103], v[248:251]
s_waitcnt lgkmcnt(4)
v_pk_max_i16 v186, v186, 0
v_pk_max_i16 v187, v187, 0
v_mfma_f32_16x16x32_bf16 v[244:247], v[40:43], v[96:99], v[244:247]
ds_read_b64_tr_b16 v[36:37], v17 offset:8192
ds_read_b64_tr_b16 v[38:39], v17 offset:8448
v_mfma_f32_16x16x32_bf16 v[252:255], v[40:43], v[100:103], v[252:255]
v_mul_f32 v216, v216, abs(v216)
v_mul_f32 v217, v217, abs(v217)
v_mfma_f32_16x16x32_bf16 v[240:243], v[44:47], v[104:107], v[240:243]
ds_read_b64_tr_b16 v[40:41], v15 offset:12288
ds_read_b64_tr_b16 v[42:43], v15 offset:12544
v_mfma_f32_16x16x32_bf16 v[248:251], v[44:47], v[108:111], v[248:251]
s_waitcnt lgkmcnt(4)
v_mul_f32 v218, v218, abs(v218)
v_mul_f32 v219, v219, abs(v219)
v_mfma_f32_16x16x32_bf16 v[244:247], v[48:51], v[104:107], v[244:247]
ds_read_b64_tr_b16 v[44:45], v17 offset:12288
ds_read_b64_tr_b16 v[46:47], v17 offset:12544
v_mfma_f32_16x16x32_bf16 v[252:255], v[48:51], v[108:111], v[252:255]
v_mul_f32 v220, v220, abs(v220)
v_mul_f32 v221, v221, abs(v221)
v_mfma_f32_16x16x32_bf16 v[240:243], v[52:55], v[112:115], v[240:243]
s_barrier
ds_read_b64_tr_b16 v[48:49], v15 offset:16384
ds_read_b64_tr_b16 v[50:51], v15 offset:16640
v_mfma_f32_16x16x32_bf16 v[248:251], v[52:55], v[116:119], v[248:251]
s_waitcnt lgkmcnt(4)
v_mul_f32 v222, v222, abs(v222)
v_mul_f32 v223, v223, abs(v223)
v_mfma_f32_16x16x32_bf16 v[244:247], v[36:39], v[112:115], v[244:247]
ds_read_b64_tr_b16 v[52:53], v17 offset:16384
ds_read_b64_tr_b16 v[54:55], v17 offset:16640
v_mfma_f32_16x16x32_bf16 v[252:255], v[36:39], v[116:119], v[252:255]
v_cvt_pk_bf16_f32 v188, v216, v217
v_cvt_pk_bf16_f32 v189, v218, v219
v_mfma_f32_16x16x32_bf16 v[240:243], v[40:43], v[120:123], v[240:243]
ds_read_b64_tr_b16 v[36:37], v15 offset:20480
ds_read_b64_tr_b16 v[38:39], v15 offset:20736
v_mfma_f32_16x16x32_bf16 v[248:251], v[40:43], v[124:127], v[248:251]
s_waitcnt lgkmcnt(4)
v_cvt_pk_bf16_f32 v190, v220, v221
v_cvt_pk_bf16_f32 v191, v222, v223
v_mfma_f32_16x16x32_bf16 v[244:247], v[44:47], v[120:123], v[244:247]
ds_read_b64_tr_b16 v[40:41], v17 offset:20480
ds_read_b64_tr_b16 v[42:43], v17 offset:20736
v_mfma_f32_16x16x32_bf16 v[252:255], v[44:47], v[124:127], v[252:255]
v_pk_max_i16 v188, v188, 0
v_pk_max_i16 v189, v189, 0
v_mfma_f32_16x16x32_bf16 v[240:243], v[48:51], v[128:131], v[240:243]
ds_read_b64_tr_b16 v[44:45], v15 offset:24576
ds_read_b64_tr_b16 v[46:47], v15 offset:24832
v_mfma_f32_16x16x32_bf16 v[248:251], v[48:51], v[132:135], v[248:251]
s_waitcnt lgkmcnt(4)
v_pk_max_i16 v190, v190, 0
v_pk_max_i16 v191, v191, 0
v_mfma_f32_16x16x32_bf16 v[244:247], v[52:55], v[128:131], v[244:247]
ds_read_b64_tr_b16 v[48:49], v17 offset:24576
ds_read_b64_tr_b16 v[50:51], v17 offset:24832
v_mfma_f32_16x16x32_bf16 v[252:255], v[52:55], v[132:135], v[252:255]
v_mov_b32 v6, 0
v_and_b32 v7, 1.0, v62
v_mfma_f32_16x16x32_bf16 v[240:243], v[36:39], v[136:139], v[240:243]
ds_read_b64_tr_b16 v[52:53], v15 offset:28672
ds_read_b64_tr_b16 v[54:55], v15 offset:28928
v_mfma_f32_16x16x32_bf16 v[248:251], v[36:39], v[140:143], v[248:251]
s_waitcnt lgkmcnt(4)
v_mfma_f32_16x16x32_bf16 v[244:247], v[40:43], v[136:139], v[244:247]
ds_read_b64_tr_b16 v[36:37], v17 offset:28672
ds_read_b64_tr_b16 v[38:39], v17 offset:28928
v_mfma_f32_16x16x32_bf16 v[252:255], v[40:43], v[140:143], v[252:255]
v_mfma_f32_16x16x16_bf16 v[208:211], v[4:5], v[6:7], 0
v_mfma_f32_16x16x16_bf16 v[216:219], v[4:5], v[6:7], 0
v_mfma_f32_16x16x32_bf16 v[240:243], v[44:47], v[144:147], v[240:243]
s_barrier
ds_read_b64_tr_b16 v[40:41], v14 offset:0
ds_read_b64_tr_b16 v[42:43], v14 offset:256
v_mfma_f32_16x16x32_bf16 v[248:251], v[44:47], v[148:151], v[248:251]
s_waitcnt lgkmcnt(4)
v_and_b32 v7, 1.0, v63
v_mfma_f32_16x16x32_bf16 v[244:247], v[48:51], v[144:147], v[244:247]
ds_read_b64_tr_b16 v[44:45], v16 offset:0
ds_read_b64_tr_b16 v[46:47], v16 offset:256
v_mfma_f32_16x16x32_bf16 v[252:255], v[48:51], v[148:151], v[252:255]
v_mfma_f32_16x16x16_bf16 v[212:215], v[4:5], v[6:7], 0
v_mfma_f32_16x16x16_bf16 v[220:223], v[4:5], v[6:7], 0
v_mfma_f32_16x16x32_bf16 v[240:243], v[52:55], v[152:155], v[240:243]
ds_read_b64_tr_b16 v[48:49], v14 offset:4096
ds_read_b64_tr_b16 v[50:51], v14 offset:4352
v_mfma_f32_16x16x32_bf16 v[248:251], v[52:55], v[156:159], v[248:251]
s_waitcnt lgkmcnt(4)
v_mfma_f32_16x16x32_bf16 v[244:247], v[36:39], v[152:155], v[244:247]
ds_read_b64_tr_b16 v[52:53], v16 offset:4096
ds_read_b64_tr_b16 v[54:55], v16 offset:4352
v_mfma_f32_16x16x32_bf16 v[252:255], v[36:39], v[156:159], v[252:255]
v_mfma_f32_16x16x32_bf16 v[240:243], v[40:43], v[160:163], v[240:243]
ds_read_b64_tr_b16 v[36:37], v14 offset:8192
ds_read_b64_tr_b16 v[38:39], v14 offset:8448
v_mfma_f32_16x16x32_bf16 v[248:251], v[40:43], v[164:167], v[248:251]
s_waitcnt lgkmcnt(4)
v_mfma_f32_16x16x32_bf16 v[244:247], v[44:47], v[160:163], v[244:247]
ds_read_b64_tr_b16 v[40:41], v16 offset:8192
ds_read_b64_tr_b16 v[42:43], v16 offset:8448
v_mfma_f32_16x16x32_bf16 v[252:255], v[44:47], v[164:167], v[252:255]
v_mfma_f32_16x16x32_bf16 v[240:243], v[48:51], v[168:171], v[240:243]
ds_read_b64_tr_b16 v[44:45], v14 offset:12288
ds_read_b64_tr_b16 v[46:47], v14 offset:12544
v_mfma_f32_16x16x32_bf16 v[248:251], v[48:51], v[172:175], v[248:251]
s_waitcnt lgkmcnt(4)
v_mfma_f32_16x16x32_bf16 v[244:247], v[52:55], v[168:171], v[244:247]
ds_read_b64_tr_b16 v[48:49], v16 offset:12288
ds_read_b64_tr_b16 v[50:51], v16 offset:12544
v_mfma_f32_16x16x32_bf16 v[252:255], v[52:55], v[172:175], v[252:255]
v_mfma_f32_16x16x32_bf16 v[208:211], v[36:39], v[64:67], v[208:211]
s_barrier
ds_read_b64_tr_b16 v[52:53], v14 offset:16384
ds_read_b64_tr_b16 v[54:55], v14 offset:16640
v_mfma_f32_16x16x32_bf16 v[216:219], v[36:39], v[68:71], v[216:219]
s_waitcnt lgkmcnt(4)
v_mfma_f32_16x16x32_bf16 v[212:215], v[40:43], v[64:67], v[212:215]
ds_read_b64_tr_b16 v[36:37], v16 offset:16384
ds_read_b64_tr_b16 v[38:39], v16 offset:16640
v_mfma_f32_16x16x32_bf16 v[220:223], v[40:43], v[68:71], v[220:223]
v_mul_f32 v240, v240, abs(v240)
v_mul_f32 v241, v241, abs(v241)
v_mfma_f32_16x16x32_bf16 v[208:211], v[44:47], v[72:75], v[208:211]
ds_read_b64_tr_b16 v[40:41], v14 offset:20480
ds_read_b64_tr_b16 v[42:43], v14 offset:20736
v_mfma_f32_16x16x32_bf16 v[216:219], v[44:47], v[76:79], v[216:219]
s_waitcnt lgkmcnt(4)
v_mul_f32 v242, v242, abs(v242)
v_mul_f32 v243, v243, abs(v243)
v_mfma_f32_16x16x32_bf16 v[212:215], v[48:51], v[72:75], v[212:215]
ds_read_b64_tr_b16 v[44:45], v16 offset:20480
ds_read_b64_tr_b16 v[46:47], v16 offset:20736
v_mfma_f32_16x16x32_bf16 v[220:223], v[48:51], v[76:79], v[220:223]
v_mul_f32 v244, v244, abs(v244)
v_mul_f32 v245, v245, abs(v245)
v_mfma_f32_16x16x32_bf16 v[208:211], v[52:55], v[80:83], v[208:211]
ds_read_b64_tr_b16 v[48:49], v14 offset:24576
ds_read_b64_tr_b16 v[50:51], v14 offset:24832
v_mfma_f32_16x16x32_bf16 v[216:219], v[52:55], v[84:87], v[216:219]
s_waitcnt lgkmcnt(4)
v_mul_f32 v246, v246, abs(v246)
v_mul_f32 v247, v247, abs(v247)
v_mfma_f32_16x16x32_bf16 v[212:215], v[36:39], v[80:83], v[212:215]
ds_read_b64_tr_b16 v[52:53], v16 offset:24576
ds_read_b64_tr_b16 v[54:55], v16 offset:24832
v_mfma_f32_16x16x32_bf16 v[220:223], v[36:39], v[84:87], v[220:223]
v_cvt_pk_bf16_f32 v192, v240, v241
v_cvt_pk_bf16_f32 v193, v242, v243
v_mfma_f32_16x16x32_bf16 v[208:211], v[40:43], v[88:91], v[208:211]
ds_read_b64_tr_b16 v[36:37], v14 offset:28672
ds_read_b64_tr_b16 v[38:39], v14 offset:28928
v_mfma_f32_16x16x32_bf16 v[216:219], v[40:43], v[92:95], v[216:219]
s_waitcnt lgkmcnt(4)
v_cvt_pk_bf16_f32 v194, v244, v245
v_cvt_pk_bf16_f32 v195, v246, v247
v_mfma_f32_16x16x32_bf16 v[212:215], v[44:47], v[88:91], v[212:215]
ds_read_b64_tr_b16 v[40:41], v16 offset:28672
ds_read_b64_tr_b16 v[42:43], v16 offset:28928
v_mfma_f32_16x16x32_bf16 v[220:223], v[44:47], v[92:95], v[220:223]
v_pk_max_i16 v192, v192, 0
v_pk_max_i16 v193, v193, 0
v_mfma_f32_16x16x32_bf16 v[208:211], v[48:51], v[96:99], v[208:211]
s_barrier
ds_read_b64_tr_b16 v[44:45], v14 offset:32768
ds_read_b64_tr_b16 v[46:47], v14 offset:33024
v_mfma_f32_16x16x32_bf16 v[216:219], v[48:51], v[100:103], v[216:219]
s_waitcnt lgkmcnt(4)
v_pk_max_i16 v194, v194, 0
v_pk_max_i16 v195, v195, 0
v_mfma_f32_16x16x32_bf16 v[212:215], v[52:55], v[96:99], v[212:215]
ds_read_b64_tr_b16 v[48:49], v16 offset:32768
ds_read_b64_tr_b16 v[50:51], v16 offset:33024
v_mfma_f32_16x16x32_bf16 v[220:223], v[52:55], v[100:103], v[220:223]
v_mul_f32 v248, v248, abs(v248)
v_mul_f32 v249, v249, abs(v249)
v_mfma_f32_16x16x32_bf16 v[208:211], v[36:39], v[104:107], v[208:211]
ds_read_b64_tr_b16 v[52:53], v14 offset:36864
ds_read_b64_tr_b16 v[54:55], v14 offset:37120
v_mfma_f32_16x16x32_bf16 v[216:219], v[36:39], v[108:111], v[216:219]
s_waitcnt lgkmcnt(4)
v_mul_f32 v250, v250, abs(v250)
v_mul_f32 v251, v251, abs(v251)
v_mfma_f32_16x16x32_bf16 v[212:215], v[40:43], v[104:107], v[212:215]
ds_read_b64_tr_b16 v[36:37], v16 offset:36864
ds_read_b64_tr_b16 v[38:39], v16 offset:37120
v_mfma_f32_16x16x32_bf16 v[220:223], v[40:43], v[108:111], v[220:223]
v_mul_f32 v252, v252, abs(v252)
v_mul_f32 v253, v253, abs(v253)
v_mfma_f32_16x16x32_bf16 v[208:211], v[44:47], v[112:115], v[208:211]
ds_read_b64_tr_b16 v[40:41], v14 offset:40960
ds_read_b64_tr_b16 v[42:43], v14 offset:41216
v_mfma_f32_16x16x32_bf16 v[216:219], v[44:47], v[116:119], v[216:219]
s_waitcnt lgkmcnt(4)
v_mul_f32 v254, v254, abs(v254)
v_mul_f32 v255, v255, abs(v255)
v_mfma_f32_16x16x32_bf16 v[212:215], v[48:51], v[112:115], v[212:215]
ds_read_b64_tr_b16 v[44:45], v16 offset:40960
ds_read_b64_tr_b16 v[46:47], v16 offset:41216
v_mfma_f32_16x16x32_bf16 v[220:223], v[48:51], v[116:119], v[220:223]
v_cvt_pk_bf16_f32 v196, v248, v249
v_cvt_pk_bf16_f32 v197, v250, v251
v_mfma_f32_16x16x32_bf16 v[208:211], v[52:55], v[120:123], v[208:211]
ds_read_b64_tr_b16 v[48:49], v14 offset:45056
ds_read_b64_tr_b16 v[50:51], v14 offset:45312
v_mfma_f32_16x16x32_bf16 v[216:219], v[52:55], v[124:127], v[216:219]
s_waitcnt lgkmcnt(4)
v_cvt_pk_bf16_f32 v198, v252, v253
v_cvt_pk_bf16_f32 v199, v254, v255
v_mfma_f32_16x16x32_bf16 v[212:215], v[36:39], v[120:123], v[212:215]
ds_read_b64_tr_b16 v[52:53], v16 offset:45056
ds_read_b64_tr_b16 v[54:55], v16 offset:45312
v_mfma_f32_16x16x32_bf16 v[220:223], v[36:39], v[124:127], v[220:223]
v_pk_max_i16 v196, v196, 0
v_pk_max_i16 v197, v197, 0
v_mfma_f32_16x16x32_bf16 v[208:211], v[40:43], v[128:131], v[208:211]
s_barrier
ds_read_b64_tr_b16 v[36:37], v14 offset:49152
ds_read_b64_tr_b16 v[38:39], v14 offset:49408
v_mfma_f32_16x16x32_bf16 v[216:219], v[40:43], v[132:135], v[216:219]
s_waitcnt lgkmcnt(4)
v_pk_max_i16 v198, v198, 0
v_pk_max_i16 v199, v199, 0
v_mfma_f32_16x16x32_bf16 v[212:215], v[44:47], v[128:131], v[212:215]
ds_read_b64_tr_b16 v[40:41], v16 offset:49152
ds_read_b64_tr_b16 v[42:43], v16 offset:49408
v_mfma_f32_16x16x32_bf16 v[220:223], v[44:47], v[132:135], v[220:223]
v_mfma_f32_16x16x32_bf16 v[208:211], v[48:51], v[136:139], v[208:211]
ds_read_b64_tr_b16 v[44:45], v14 offset:53248
ds_read_b64_tr_b16 v[46:47], v14 offset:53504
v_mfma_f32_16x16x32_bf16 v[216:219], v[48:51], v[140:143], v[216:219]
s_waitcnt lgkmcnt(4)
v_mfma_f32_16x16x32_bf16 v[212:215], v[52:55], v[136:139], v[212:215]
ds_read_b64_tr_b16 v[48:49], v16 offset:53248
ds_read_b64_tr_b16 v[50:51], v16 offset:53504
v_mfma_f32_16x16x32_bf16 v[220:223], v[52:55], v[140:143], v[220:223]
v_mfma_f32_16x16x32_bf16 v[208:211], v[36:39], v[144:147], v[208:211]
ds_read_b64_tr_b16 v[52:53], v14 offset:57344
ds_read_b64_tr_b16 v[54:55], v14 offset:57600
v_mfma_f32_16x16x32_bf16 v[216:219], v[36:39], v[148:151], v[216:219]
s_waitcnt lgkmcnt(4)
v_mfma_f32_16x16x32_bf16 v[212:215], v[40:43], v[144:147], v[212:215]
ds_read_b64_tr_b16 v[36:37], v16 offset:57344
ds_read_b64_tr_b16 v[38:39], v16 offset:57600
v_mfma_f32_16x16x32_bf16 v[220:223], v[40:43], v[148:151], v[220:223]
v_mfma_f32_16x16x32_bf16 v[208:211], v[44:47], v[152:155], v[208:211]
ds_read_b64_tr_b16 v[40:41], v14 offset:61440
ds_read_b64_tr_b16 v[42:43], v14 offset:61696
v_mfma_f32_16x16x32_bf16 v[216:219], v[44:47], v[156:159], v[216:219]
s_waitcnt lgkmcnt(4)
v_mfma_f32_16x16x32_bf16 v[212:215], v[48:51], v[152:155], v[212:215]
ds_read_b64_tr_b16 v[44:45], v16 offset:61440
ds_read_b64_tr_b16 v[46:47], v16 offset:61696
v_mfma_f32_16x16x32_bf16 v[220:223], v[48:51], v[156:159], v[220:223]
v_mfma_f32_16x16x32_bf16 v[208:211], v[52:55], v[160:163], v[208:211]
s_barrier
ds_read_b64_tr_b16 v[48:49], v29 offset:0
ds_read_b64_tr_b16 v[50:51], v29 offset:256
v_mfma_f32_16x16x32_bf16 v[216:219], v[52:55], v[164:167], v[216:219]
s_waitcnt lgkmcnt(4)
v_mfma_f32_16x16x32_bf16 v[212:215], v[36:39], v[160:163], v[212:215]
ds_read_b64_tr_b16 v[52:53], v31 offset:0
ds_read_b64_tr_b16 v[54:55], v31 offset:256
v_mfma_f32_16x16x32_bf16 v[220:223], v[36:39], v[164:167], v[220:223]
v_mfma_f32_16x16x32_bf16 v[208:211], v[40:43], v[168:171], v[208:211]
ds_read_b64_tr_b16 v[36:37], v29 offset:8192
ds_read_b64_tr_b16 v[38:39], v29 offset:8448
v_mfma_f32_16x16x32_bf16 v[216:219], v[40:43], v[172:175], v[216:219]
s_waitcnt lgkmcnt(4)
v_mfma_f32_16x16x32_bf16 v[212:215], v[44:47], v[168:171], v[212:215]
ds_read_b64_tr_b16 v[40:41], v31 offset:8192
ds_read_b64_tr_b16 v[42:43], v31 offset:8448
v_mfma_f32_16x16x32_bf16 v[220:223], v[44:47], v[172:175], v[220:223]
v_mfma_f32_16x16x32_bf16 v[240:243], v[48:51], v[176:179], 0
s_barrier
ds_read_b64_tr_b16 v[44:45], v29 offset:16384
ds_read_b64_tr_b16 v[46:47], v29 offset:16640
v_mfma_f32_16x16x32_bf16 v[248:251], v[48:51], v[180:183], 0
s_waitcnt lgkmcnt(4)
v_mfma_f32_16x16x32_bf16 v[244:247], v[52:55], v[176:179], 0
ds_read_b64_tr_b16 v[48:49], v31 offset:16384
ds_read_b64_tr_b16 v[50:51], v31 offset:16640
v_mfma_f32_16x16x32_bf16 v[252:255], v[52:55], v[180:183], 0
v_mul_f32 v208, v208, abs(v208)
v_mul_f32 v209, v209, abs(v209)
v_mul_f32 v210, v210, abs(v210)
v_mfma_f32_16x16x32_bf16 v[240:243], v[36:39], v[184:187], v[240:243]
ds_read_b64_tr_b16 v[52:53], v29 offset:24576
ds_read_b64_tr_b16 v[54:55], v29 offset:24832
v_mfma_f32_16x16x32_bf16 v[248:251], v[36:39], v[188:191], v[248:251]
s_waitcnt lgkmcnt(4)
v_mul_f32 v211, v211, abs(v211)
v_mul_f32 v212, v212, abs(v212)
v_mul_f32 v213, v213, abs(v213)
v_mfma_f32_16x16x32_bf16 v[244:247], v[40:43], v[184:187], v[244:247]
ds_read_b64_tr_b16 v[36:37], v31 offset:24576
ds_read_b64_tr_b16 v[38:39], v31 offset:24832
v_mfma_f32_16x16x32_bf16 v[252:255], v[40:43], v[188:191], v[252:255]
v_mul_f32 v214, v214, abs(v214)
v_mul_f32 v215, v215, abs(v215)
v_cvt_pk_bf16_f32 v200, v208, v209
v_mfma_f32_16x16x32_bf16 v[240:243], v[44:47], v[192:195], v[240:243]
s_barrier
ds_read_b64_tr_b16 v[40:41], v28 offset:0
ds_read_b64_tr_b16 v[42:43], v28 offset:256
v_mfma_f32_16x16x32_bf16 v[248:251], v[44:47], v[196:199], v[248:251]
s_waitcnt lgkmcnt(4)
v_cvt_pk_bf16_f32 v201, v210, v211
v_cvt_pk_bf16_f32 v202, v212, v213
v_cvt_pk_bf16_f32 v203, v214, v215
v_mfma_f32_16x16x32_bf16 v[244:247], v[48:51], v[192:195], v[244:247]
ds_read_b64_tr_b16 v[44:45], v30 offset:0
ds_read_b64_tr_b16 v[46:47], v30 offset:256
v_mfma_f32_16x16x32_bf16 v[252:255], v[48:51], v[196:199], v[252:255]
v_pk_max_i16 v200, v200, 0
v_pk_max_i16 v201, v201, 0
v_pk_max_i16 v202, v202, 0
v_mfma_f32_16x16x32_bf16 v[224:227], v[52:55], v[176:179], 0
ds_read_b64_tr_b16 v[48:49], v28 offset:8192
ds_read_b64_tr_b16 v[50:51], v28 offset:8448
v_mfma_f32_16x16x32_bf16 v[232:235], v[52:55], v[180:183], 0
s_waitcnt lgkmcnt(4)
v_pk_max_i16 v203, v203, 0
v_mul_f32 v216, v216, abs(v216)
v_mul_f32 v217, v217, abs(v217)
v_mfma_f32_16x16x32_bf16 v[228:231], v[36:39], v[176:179], 0
ds_read_b64_tr_b16 v[52:53], v30 offset:8192
ds_read_b64_tr_b16 v[54:55], v30 offset:8448
v_mfma_f32_16x16x32_bf16 v[236:239], v[36:39], v[180:183], 0
v_mul_f32 v218, v218, abs(v218)
v_mul_f32 v219, v219, abs(v219)
v_mul_f32 v220, v220, abs(v220)
v_mfma_f32_16x16x32_bf16 v[224:227], v[40:43], v[184:187], v[224:227]
s_barrier
ds_read_b64_tr_b16 v[36:37], v28 offset:16384
ds_read_b64_tr_b16 v[38:39], v28 offset:16640
v_mfma_f32_16x16x32_bf16 v[232:235], v[40:43], v[188:191], v[232:235]
s_waitcnt lgkmcnt(4)
v_mul_f32 v221, v221, abs(v221)
v_mul_f32 v222, v222, abs(v222)
v_mul_f32 v223, v223, abs(v223)
v_mfma_f32_16x16x32_bf16 v[228:231], v[44:47], v[184:187], v[228:231]
ds_read_b64_tr_b16 v[40:41], v30 offset:16384
ds_read_b64_tr_b16 v[42:43], v30 offset:16640
v_mfma_f32_16x16x32_bf16 v[236:239], v[44:47], v[188:191], v[236:239]
v_cvt_pk_bf16_f32 v204, v216, v217
v_cvt_pk_bf16_f32 v205, v218, v219
v_cvt_pk_bf16_f32 v206, v220, v221
v_mfma_f32_16x16x32_bf16 v[224:227], v[48:51], v[192:195], v[224:227]
ds_read_b64_tr_b16 v[44:45], v28 offset:24576
ds_read_b64_tr_b16 v[46:47], v28 offset:24832
v_mfma_f32_16x16x32_bf16 v[232:235], v[48:51], v[196:199], v[232:235]
s_waitcnt lgkmcnt(4)
v_cvt_pk_bf16_f32 v207, v222, v223
v_pk_max_i16 v204, v204, 0
v_pk_max_i16 v205, v205, 0
v_mfma_f32_16x16x32_bf16 v[228:231], v[52:55], v[192:195], v[228:231]
ds_read_b64_tr_b16 v[48:49], v30 offset:24576
ds_read_b64_tr_b16 v[50:51], v30 offset:24832
v_mfma_f32_16x16x32_bf16 v[236:239], v[52:55], v[196:199], v[236:239]
v_pk_max_i16 v206, v206, 0
v_pk_max_i16 v207, v207, 0
ds_write_b128 v11, v[176:179] offset:0
ds_write_b128 v11, v[180:183] offset:1024
ds_write_b128 v11, v[184:187] offset:4096
ds_write_b128 v11, v[188:191] offset:5120
ds_write_b128 v11, v[192:195] offset:8192
ds_write_b128 v11, v[196:199] offset:9216
ds_write_b128 v11, v[200:203] offset:12288
ds_write_b128 v11, v[204:207] offset:13312
v_mfma_f32_16x16x32_bf16 v[240:243], v[36:39], v[200:203], v[240:243]
v_mfma_f32_16x16x32_bf16 v[248:251], v[36:39], v[204:207], v[248:251]
s_waitcnt lgkmcnt(10)
v_mfma_f32_16x16x32_bf16 v[244:247], v[40:43], v[200:203], v[244:247]
v_mfma_f32_16x16x32_bf16 v[252:255], v[40:43], v[204:207], v[252:255]
v_mfma_f32_16x16x32_bf16 v[224:227], v[44:47], v[200:203], v[224:227]
v_mfma_f32_16x16x32_bf16 v[232:235], v[44:47], v[204:207], v[232:235]
s_waitcnt lgkmcnt(8)
v_mfma_f32_16x16x32_bf16 v[228:231], v[48:51], v[200:203], v[228:231]
v_mfma_f32_16x16x32_bf16 v[236:239], v[48:51], v[204:207], v[236:239]
s_waitcnt lgkmcnt(0)
s_barrier
ds_read_b128 v[64:67], v10 offset:0
ds_read_b128 v[68:71], v10 offset:1024
ds_read_b64_tr_b16 v[52:53], v33 offset:0
ds_read_b64_tr_b16 v[54:55], v33 offset:256
ds_read_b64_tr_b16 v[36:37], v35 offset:0
ds_read_b64_tr_b16 v[38:39], v35 offset:256
ds_read_b128 v[72:75], v10 offset:4096
ds_read_b128 v[76:79], v10 offset:5120
ds_read_b64_tr_b16 v[40:41], v33 offset:8192
ds_read_b64_tr_b16 v[42:43], v33 offset:8448
ds_read_b64_tr_b16 v[44:45], v35 offset:8192
ds_read_b64_tr_b16 v[46:47], v35 offset:8448
s_waitcnt lgkmcnt(8)
v_mfma_f32_16x16x32_bf16 v[240:243], v[52:55], v[64:67], v[240:243]
ds_read_b128 v[80:83], v10 offset:8192
ds_read_b128 v[84:87], v10 offset:9216
ds_read_b64_tr_b16 v[48:49], v33 offset:16384
ds_read_b64_tr_b16 v[50:51], v33 offset:16640
v_mfma_f32_16x16x32_bf16 v[248:251], v[52:55], v[68:71], v[248:251]
s_waitcnt lgkmcnt(6)
v_mfma_f32_16x16x32_bf16 v[244:247], v[36:39], v[64:67], v[244:247]
ds_read_b64_tr_b16 v[52:53], v35 offset:16384
ds_read_b64_tr_b16 v[54:55], v35 offset:16640
v_mfma_f32_16x16x32_bf16 v[252:255], v[36:39], v[68:71], v[252:255]
v_mfma_f32_16x16x32_bf16 v[240:243], v[40:43], v[72:75], v[240:243]
ds_read_b128 v[88:91], v10 offset:12288
ds_read_b128 v[92:95], v10 offset:13312
ds_read_b64_tr_b16 v[36:37], v32 offset:16384
ds_read_b64_tr_b16 v[38:39], v32 offset:16640
v_mfma_f32_16x16x32_bf16 v[248:251], v[40:43], v[76:79], v[248:251]
s_waitcnt lgkmcnt(6)
v_mfma_f32_16x16x32_bf16 v[244:247], v[44:47], v[72:75], v[244:247]
ds_read_b64_tr_b16 v[40:41], v34 offset:16384
ds_read_b64_tr_b16 v[42:43], v34 offset:16640
v_mfma_f32_16x16x32_bf16 v[252:255], v[44:47], v[76:79], v[252:255]
v_mfma_f32_16x16x32_bf16 v[240:243], v[48:51], v[80:83], v[240:243]
ds_read_b64_tr_b16 v[44:45], v33 offset:24576
ds_read_b64_tr_b16 v[46:47], v33 offset:24832
v_mfma_f32_16x16x32_bf16 v[248:251], v[48:51], v[84:87], v[248:251]
s_waitcnt lgkmcnt(4)
v_mfma_f32_16x16x32_bf16 v[244:247], v[52:55], v[80:83], v[244:247]
ds_read_b64_tr_b16 v[48:49], v35 offset:24576
ds_read_b64_tr_b16 v[50:51], v35 offset:24832
v_mfma_f32_16x16x32_bf16 v[252:255], v[52:55], v[84:87], v[252:255]
v_mfma_f32_16x16x32_bf16 v[240:243], v[36:39], v[88:91], v[240:243]
ds_read_b64_tr_b16 v[52:53], v32 offset:0
ds_read_b64_tr_b16 v[54:55], v32 offset:256
v_mfma_f32_16x16x32_bf16 v[248:251], v[36:39], v[92:95], v[248:251]
s_waitcnt lgkmcnt(4)
v_mfma_f32_16x16x32_bf16 v[244:247], v[40:43], v[88:91], v[244:247]
ds_read_b64_tr_b16 v[36:37], v34 offset:0
ds_read_b64_tr_b16 v[38:39], v34 offset:256
v_mfma_f32_16x16x32_bf16 v[252:255], v[40:43], v[92:95], v[252:255]
v_mfma_f32_16x16x32_bf16 v[224:227], v[44:47], v[64:67], v[224:227]
ds_read_b64_tr_b16 v[40:41], v32 offset:8192
ds_read_b64_tr_b16 v[42:43], v32 offset:8448
v_mfma_f32_16x16x32_bf16 v[232:235], v[44:47], v[68:71], v[232:235]
s_waitcnt lgkmcnt(4)
v_mfma_f32_16x16x32_bf16 v[228:231], v[48:51], v[64:67], v[228:231]
ds_read_b64_tr_b16 v[44:45], v34 offset:8192
ds_read_b64_tr_b16 v[46:47], v34 offset:8448
v_mfma_f32_16x16x32_bf16 v[236:239], v[48:51], v[68:71], v[236:239]
v_cvt_pk_bf16_f32 v240, v240, v241
v_cvt_pk_bf16_f32 v241, v242, v243
v_cvt_pk_bf16_f32 v242, v244, v245
v_mfma_f32_16x16x32_bf16 v[224:227], v[52:55], v[72:75], v[224:227]
ds_read_b64_tr_b16 v[48:49], v32 offset:24576
ds_read_b64_tr_b16 v[50:51], v32 offset:24832
v_mfma_f32_16x16x32_bf16 v[232:235], v[52:55], v[76:79], v[232:235]
s_waitcnt lgkmcnt(4)
v_cvt_pk_bf16_f32 v243, v246, v247
buffer_store_dwordx4 v[240:243], v24, s[36:39], s48 offen offset:0 sc1
v_cvt_pk_bf16_f32 v244, v248, v249
v_mfma_f32_16x16x32_bf16 v[228:231], v[36:39], v[72:75], v[228:231]
ds_read_b64_tr_b16 v[52:53], v34 offset:24576
ds_read_b64_tr_b16 v[54:55], v34 offset:24832
v_mfma_f32_16x16x32_bf16 v[236:239], v[36:39], v[76:79], v[236:239]
v_cvt_pk_bf16_f32 v245, v250, v251
v_cvt_pk_bf16_f32 v246, v252, v253
v_cvt_pk_bf16_f32 v247, v254, v255
v_mfma_f32_16x16x32_bf16 v[224:227], v[40:43], v[80:83], v[224:227]
s_barrier
ds_read_b64_tr_b16 v[36:37], v28 offset:32768
ds_read_b64_tr_b16 v[38:39], v28 offset:33024
v_mfma_f32_16x16x32_bf16 v[232:235], v[40:43], v[84:87], v[232:235]
s_waitcnt lgkmcnt(4)
v_add3_u32 v22, v240, v241, v242
v_add3_u32 v1, v243, v244, v245
v_add3_u32 v22, v22, v246, v247
v_mfma_f32_16x16x32_bf16 v[228:231], v[44:47], v[80:83], v[228:231]
ds_read_b64_tr_b16 v[40:41], v30 offset:32768
ds_read_b64_tr_b16 v[42:43], v30 offset:33024
v_mfma_f32_16x16x32_bf16 v[236:239], v[44:47], v[84:87], v[236:239]
v_add_u32 v22, v22, v1
v_mul_lo_u32 v22, v22, v13
buffer_store_dwordx4 v[244:247], v24, s[36:39], s48 offen offset:256 sc1
v_mfma_f32_16x16x32_bf16 v[224:227], v[48:51], v[88:91], v[224:227]
ds_read_b64_tr_b16 v[44:45], v32 offset:32768
ds_read_b64_tr_b16 v[46:47], v32 offset:33024
v_mfma_f32_16x16x32_bf16 v[232:235], v[48:51], v[92:95], v[232:235]
s_waitcnt lgkmcnt(4)
v_mfma_f32_16x16x32_bf16 v[228:231], v[52:55], v[88:91], v[228:231]
ds_read_b64_tr_b16 v[48:49], v34 offset:32768
ds_read_b64_tr_b16 v[50:51], v34 offset:33024
v_mfma_f32_16x16x32_bf16 v[236:239], v[52:55], v[92:95], v[236:239]
v_add_u32_dpp v22, v22, v22 row_ror:8 row_mask:0xf bank_mask:0xf
v_mfma_f32_16x16x32_bf16 v[208:211], v[36:39], v[176:179], 0
ds_read_b64_tr_b16 v[52:53], v28 offset:40960
ds_read_b64_tr_b16 v[54:55], v28 offset:41216
v_mfma_f32_16x16x32_bf16 v[216:219], v[36:39], v[180:183], 0
s_waitcnt lgkmcnt(4)
v_add_u32_dpp v22, v22, v22 row_ror:4 row_mask:0xf bank_mask:0xf
v_mfma_f32_16x16x32_bf16 v[212:215], v[40:43], v[176:179], 0
ds_read_b64_tr_b16 v[36:37], v30 offset:40960
ds_read_b64_tr_b16 v[38:39], v30 offset:41216
v_mfma_f32_16x16x32_bf16 v[220:223], v[40:43], v[180:183], 0
v_add_u32_dpp v22, v22, v22 row_ror:2 row_mask:0xf bank_mask:0xf
v_mfma_f32_16x16x32_bf16 v[208:211], v[44:47], v[64:67], v[208:211]
ds_read_b64_tr_b16 v[40:41], v32 offset:40960
ds_read_b64_tr_b16 v[42:43], v32 offset:41216
v_mfma_f32_16x16x32_bf16 v[216:219], v[44:47], v[68:71], v[216:219]
s_waitcnt lgkmcnt(4)
v_add_u32_dpp v22, v22, v22 row_ror:1 row_mask:0xf bank_mask:0xf
v_mfma_f32_16x16x32_bf16 v[212:215], v[48:51], v[64:67], v[212:215]
ds_read_b64_tr_b16 v[44:45], v34 offset:40960
ds_read_b64_tr_b16 v[46:47], v34 offset:41216
v_mfma_f32_16x16x32_bf16 v[220:223], v[48:51], v[68:71], v[220:223]
v_add_u32_dpp v22, v22, v22 row_bcast:15 row_mask:0xa bank_mask:0xf
v_mfma_f32_16x16x32_bf16 v[208:211], v[52:55], v[184:187], v[208:211]
s_barrier
ds_read_b64_tr_b16 v[48:49], v28 offset:49152
ds_read_b64_tr_b16 v[50:51], v28 offset:49408
v_mfma_f32_16x16x32_bf16 v[216:219], v[52:55], v[188:191], v[216:219]
s_waitcnt lgkmcnt(4)
v_add_u32_dpp v22, v22, v22 row_bcast:31 row_mask:0xc bank_mask:0xf
v_add_u32 v22, v22, v23
buffer_store_dwordx2 v[22:23], v21, s[36:39], s8 offen sc1
v_mfma_f32_16x16x32_bf16 v[212:215], v[36:39], v[184:187], v[212:215]
ds_read_b64_tr_b16 v[52:53], v30 offset:49152
ds_read_b64_tr_b16 v[54:55], v30 offset:49408
v_mfma_f32_16x16x32_bf16 v[220:223], v[36:39], v[188:191], v[220:223]
v_cvt_pk_bf16_f32 v224, v224, v225
v_cvt_pk_bf16_f32 v225, v226, v227
v_cvt_pk_bf16_f32 v226, v228, v229
v_mfma_f32_16x16x32_bf16 v[208:211], v[40:43], v[72:75], v[208:211]
ds_read_b64_tr_b16 v[36:37], v32 offset:49152
ds_read_b64_tr_b16 v[38:39], v32 offset:49408
v_mfma_f32_16x16x32_bf16 v[216:219], v[40:43], v[76:79], v[216:219]
s_waitcnt lgkmcnt(4)
v_cvt_pk_bf16_f32 v227, v230, v231
buffer_store_dwordx4 v[224:227], v24, s[36:39], s49 offen offset:0 sc1
v_cvt_pk_bf16_f32 v228, v232, v233
v_mfma_f32_16x16x32_bf16 v[212:215], v[44:47], v[72:75], v[212:215]
ds_read_b64_tr_b16 v[40:41], v34 offset:49152
ds_read_b64_tr_b16 v[42:43], v34 offset:49408
v_mfma_f32_16x16x32_bf16 v[220:223], v[44:47], v[76:79], v[220:223]
v_cvt_pk_bf16_f32 v229, v234, v235
v_cvt_pk_bf16_f32 v230, v236, v237
v_cvt_pk_bf16_f32 v231, v238, v239
v_mfma_f32_16x16x32_bf16 v[208:211], v[48:51], v[192:195], v[208:211]
ds_read_b64_tr_b16 v[44:45], v28 offset:57344
ds_read_b64_tr_b16 v[46:47], v28 offset:57600
v_mfma_f32_16x16x32_bf16 v[216:219], v[48:51], v[196:199], v[216:219]
s_waitcnt lgkmcnt(4)
v_add3_u32 v22, v224, v225, v226
v_add3_u32 v1, v227, v228, v229
v_add3_u32 v22, v22, v230, v231
v_mfma_f32_16x16x32_bf16 v[212:215], v[52:55], v[192:195], v[212:215]
ds_read_b64_tr_b16 v[48:49], v30 offset:57344
ds_read_b64_tr_b16 v[50:51], v30 offset:57600
v_mfma_f32_16x16x32_bf16 v[220:223], v[52:55], v[196:199], v[220:223]
v_add_u32 v22, v22, v1
v_mul_lo_u32 v22, v22, v13
buffer_store_dwordx4 v[228:231], v24, s[36:39], s49 offen offset:256 sc1
v_mfma_f32_16x16x32_bf16 v[208:211], v[36:39], v[80:83], v[208:211]
ds_read_b64_tr_b16 v[52:53], v32 offset:57344
ds_read_b64_tr_b16 v[54:55], v32 offset:57600
v_mfma_f32_16x16x32_bf16 v[216:219], v[36:39], v[84:87], v[216:219]
s_waitcnt lgkmcnt(4)
v_mfma_f32_16x16x32_bf16 v[212:215], v[40:43], v[80:83], v[212:215]
ds_read_b64_tr_b16 v[36:37], v34 offset:57344
ds_read_b64_tr_b16 v[38:39], v34 offset:57600
v_mfma_f32_16x16x32_bf16 v[220:223], v[40:43], v[84:87], v[220:223]
v_add_u32_dpp v22, v22, v22 row_ror:8 row_mask:0xf bank_mask:0xf
v_mfma_f32_16x16x32_bf16 v[208:211], v[44:47], v[200:203], v[208:211]
s_barrier
ds_read_b64_tr_b16 v[40:41], v12 offset:20480
ds_read_b64_tr_b16 v[42:43], v12 offset:20736
v_mfma_f32_16x16x32_bf16 v[216:219], v[44:47], v[204:207], v[216:219]
s_waitcnt lgkmcnt(4)
v_add_u32_dpp v22, v22, v22 row_ror:4 row_mask:0xf bank_mask:0xf
v_mfma_f32_16x16x32_bf16 v[212:215], v[48:51], v[200:203], v[212:215]
ds_read_b64_tr_b16 v[44:45], v18 offset:20480
ds_read_b64_tr_b16 v[46:47], v18 offset:20736
v_mfma_f32_16x16x32_bf16 v[220:223], v[48:51], v[204:207], v[220:223]
v_add_u32_dpp v22, v22, v22 row_ror:2 row_mask:0xf bank_mask:0xf
v_mfma_f32_16x16x32_bf16 v[208:211], v[52:55], v[88:91], v[208:211]
ds_read_b64_tr_b16 v[48:49], v19 offset:20480
ds_read_b64_tr_b16 v[50:51], v19 offset:20736
v_mfma_f32_16x16x32_bf16 v[216:219], v[52:55], v[92:95], v[216:219]
s_waitcnt lgkmcnt(4)
v_add_u32_dpp v22, v22, v22 row_ror:1 row_mask:0xf bank_mask:0xf
v_mfma_f32_16x16x32_bf16 v[212:215], v[36:39], v[88:91], v[212:215]
ds_read_b64_tr_b16 v[52:53], v60 offset:20480
ds_read_b64_tr_b16 v[54:55], v60 offset:20736
v_mfma_f32_16x16x32_bf16 v[220:223], v[36:39], v[92:95], v[220:223]
v_add_u32_dpp v22, v22, v22 row_bcast:15 row_mask:0xa bank_mask:0xf
s_nop 1
v_add_u32_dpp v22, v22, v22 row_bcast:31 row_mask:0xc bank_mask:0xf
v_add_u32 v22, v22, v23
buffer_store_dwordx2 v[22:23], v21, s[36:39], s9 offen sc1
v_mfma_f32_16x16x32_bf16 v[240:243], v[40:43], v[176:179], 0
ds_read_b64_tr_b16 v[36:37], v12 offset:51200
ds_read_b64_tr_b16 v[38:39], v12 offset:51456
v_mfma_f32_16x16x32_bf16 v[248:251], v[40:43], v[180:183], 0
s_waitcnt lgkmcnt(4)
v_mfma_f32_16x16x32_bf16 v[244:247], v[44:47], v[176:179], 0
ds_read_b64_tr_b16 v[40:41], v18 offset:51200
ds_read_b64_tr_b16 v[42:43], v18 offset:51456
v_mfma_f32_16x16x32_bf16 v[252:255], v[44:47], v[180:183], 0
v_cvt_pk_bf16_f32 v208, v208, v209
v_cvt_pk_bf16_f32 v209, v210, v211
v_mfma_f32_16x16x32_bf16 v[240:243], v[48:51], v[64:67], v[240:243]
ds_read_b64_tr_b16 v[44:45], v19 offset:51200
ds_read_b64_tr_b16 v[46:47], v19 offset:51456
v_mfma_f32_16x16x32_bf16 v[248:251], v[48:51], v[68:71], v[248:251]
s_waitcnt lgkmcnt(4)
v_cvt_pk_bf16_f32 v210, v212, v213
v_cvt_pk_bf16_f32 v211, v214, v215
v_mfma_f32_16x16x32_bf16 v[244:247], v[52:55], v[64:67], v[244:247]
ds_read_b64_tr_b16 v[48:49], v60 offset:51200
ds_read_b64_tr_b16 v[50:51], v60 offset:51456
v_mfma_f32_16x16x32_bf16 v[252:255], v[52:55], v[68:71], v[252:255]
buffer_store_dwordx4 v[208:211], v24, s[36:39], s50 offen offset:0 sc1
v_cvt_pk_bf16_f32 v212, v216, v217
v_mfma_f32_16x16x32_bf16 v[240:243], v[36:39], v[184:187], v[240:243]
s_barrier
ds_read_b64_tr_b16 v[52:53], v29 offset:0
ds_read_b64_tr_b16 v[54:55], v29 offset:256
v_mfma_f32_16x16x32_bf16 v[248:251], v[36:39], v[188:191], v[248:251]
s_waitcnt lgkmcnt(4)
v_cvt_pk_bf16_f32 v213, v218, v219
v_cvt_pk_bf16_f32 v214, v220, v221
v_mfma_f32_16x16x32_bf16 v[244:247], v[40:43], v[184:187], v[244:247]
ds_read_b64_tr_b16 v[36:37], v31 offset:0
ds_read_b64_tr_b16 v[38:39], v31 offset:256
v_mfma_f32_16x16x32_bf16 v[252:255], v[40:43], v[188:191], v[252:255]
v_cvt_pk_bf16_f32 v215, v222, v223
v_add3_u32 v22, v208, v209, v210
v_mfma_f32_16x16x32_bf16 v[240:243], v[44:47], v[72:75], v[240:243]
ds_read_b64_tr_b16 v[40:41], v33 offset:0
ds_read_b64_tr_b16 v[42:43], v33 offset:256
v_mfma_f32_16x16x32_bf16 v[248:251], v[44:47], v[76:79], v[248:251]
s_waitcnt lgkmcnt(4)
v_add3_u32 v1, v211, v212, v213
v_add3_u32 v22, v22, v214, v215
v_mfma_f32_16x16x32_bf16 v[244:247], v[48:51], v[72:75], v[244:247]
ds_read_b64_tr_b16 v[44:45], v35 offset:0
ds_read_b64_tr_b16 v[46:47], v35 offset:256
v_mfma_f32_16x16x32_bf16 v[252:255], v[48:51], v[76:79], v[252:255]
v_add_u32 v22, v22, v1
v_mul_lo_u32 v22, v22, v13
v_mfma_f32_16x16x32_bf16 v[240:243], v[52:55], v[192:195], v[240:243]
ds_read_b64_tr_b16 v[48:49], v29 offset:8192
ds_read_b64_tr_b16 v[50:51], v29 offset:8448
v_mfma_f32_16x16x32_bf16 v[248:251], v[52:55], v[196:199], v[248:251]
s_waitcnt lgkmcnt(4)
buffer_store_dwordx4 v[212:215], v24, s[36:39], s50 offen offset:256 sc1
v_mfma_f32_16x16x32_bf16 v[244:247], v[36:39], v[192:195], v[244:247]
ds_read_b64_tr_b16 v[52:53], v31 offset:8192
ds_read_b64_tr_b16 v[54:55], v31 offset:8448
v_mfma_f32_16x16x32_bf16 v[252:255], v[36:39], v[196:199], v[252:255]
v_add_u32_dpp v22, v22, v22 row_ror:8 row_mask:0xf bank_mask:0xf
v_mfma_f32_16x16x32_bf16 v[240:243], v[40:43], v[80:83], v[240:243]
ds_read_b64_tr_b16 v[36:37], v33 offset:8192
ds_read_b64_tr_b16 v[38:39], v33 offset:8448
v_mfma_f32_16x16x32_bf16 v[248:251], v[40:43], v[84:87], v[248:251]
s_waitcnt lgkmcnt(4)
v_add_u32_dpp v22, v22, v22 row_ror:4 row_mask:0xf bank_mask:0xf
v_mfma_f32_16x16x32_bf16 v[244:247], v[44:47], v[80:83], v[244:247]
ds_read_b64_tr_b16 v[40:41], v35 offset:8192
ds_read_b64_tr_b16 v[42:43], v35 offset:8448
v_mfma_f32_16x16x32_bf16 v[252:255], v[44:47], v[84:87], v[252:255]
v_add_u32_dpp v22, v22, v22 row_ror:2 row_mask:0xf bank_mask:0xf
v_mfma_f32_16x16x32_bf16 v[240:243], v[48:51], v[200:203], v[240:243]
s_barrier
ds_read_b64_tr_b16 v[44:45], v29 offset:16384
ds_read_b64_tr_b16 v[46:47], v29 offset:16640
v_mfma_f32_16x16x32_bf16 v[248:251], v[48:51], v[204:207], v[248:251]
s_waitcnt lgkmcnt(4)
v_add_u32_dpp v22, v22, v22 row_ror:1 row_mask:0xf bank_mask:0xf
v_mfma_f32_16x16x32_bf16 v[244:247], v[52:55], v[200:203], v[244:247]
ds_read_b64_tr_b16 v[48:49], v31 offset:16384
ds_read_b64_tr_b16 v[50:51], v31 offset:16640
v_mfma_f32_16x16x32_bf16 v[252:255], v[52:55], v[204:207], v[252:255]
v_add_u32_dpp v22, v22, v22 row_bcast:15 row_mask:0xa bank_mask:0xf
v_mfma_f32_16x16x32_bf16 v[240:243], v[36:39], v[88:91], v[240:243]
ds_read_b64_tr_b16 v[52:53], v33 offset:16384
ds_read_b64_tr_b16 v[54:55], v33 offset:16640
v_mfma_f32_16x16x32_bf16 v[248:251], v[36:39], v[92:95], v[248:251]
s_waitcnt lgkmcnt(4)
v_add_u32_dpp v22, v22, v22 row_bcast:31 row_mask:0xc bank_mask:0xf
v_add_u32 v22, v22, v23
v_mfma_f32_16x16x32_bf16 v[244:247], v[40:43], v[88:91], v[244:247]
ds_read_b64_tr_b16 v[36:37], v35 offset:16384
ds_read_b64_tr_b16 v[38:39], v35 offset:16640
v_mfma_f32_16x16x32_bf16 v[252:255], v[40:43], v[92:95], v[252:255]
buffer_store_dwordx2 v[22:23], v21, s[36:39], s10 offen sc1
v_mfma_f32_16x16x32_bf16 v[224:227], v[44:47], v[176:179], 0
ds_read_b64_tr_b16 v[40:41], v29 offset:24576
ds_read_b64_tr_b16 v[42:43], v29 offset:24832
v_mfma_f32_16x16x32_bf16 v[232:235], v[44:47], v[180:183], 0
s_waitcnt lgkmcnt(4)
v_mfma_f32_16x16x32_bf16 v[228:231], v[48:51], v[176:179], 0
ds_read_b64_tr_b16 v[44:45], v31 offset:24576
ds_read_b64_tr_b16 v[46:47], v31 offset:24832
v_mfma_f32_16x16x32_bf16 v[236:239], v[48:51], v[180:183], 0
v_cvt_pk_bf16_f32 v240, v240, v241
v_cvt_pk_bf16_f32 v241, v242, v243
v_cvt_pk_bf16_f32 v242, v244, v245
v_cvt_pk_bf16_f32 v243, v246, v247
v_mfma_f32_16x16x32_bf16 v[224:227], v[52:55], v[64:67], v[224:227]
ds_read_b64_tr_b16 v[48:49], v33 offset:24576
ds_read_b64_tr_b16 v[50:51], v33 offset:24832
v_mfma_f32_16x16x32_bf16 v[232:235], v[52:55], v[68:71], v[232:235]
s_waitcnt lgkmcnt(4)
buffer_store_dwordx4 v[240:243], v24, s[36:39], s51 offen offset:0 sc1
v_cvt_pk_bf16_f32 v244, v248, v249
v_cvt_pk_bf16_f32 v245, v250, v251
v_cvt_pk_bf16_f32 v246, v252, v253
v_mfma_f32_16x16x32_bf16 v[228:231], v[36:39], v[64:67], v[228:231]
ds_read_b64_tr_b16 v[52:53], v35 offset:24576
ds_read_b64_tr_b16 v[54:55], v35 offset:24832
v_mfma_f32_16x16x32_bf16 v[236:239], v[36:39], v[68:71], v[236:239]
v_cvt_pk_bf16_f32 v247, v254, v255
v_add3_u32 v22, v240, v241, v242
v_add3_u32 v1, v243, v244, v245
v_add3_u32 v22, v22, v246, v247
v_mfma_f32_16x16x32_bf16 v[224:227], v[40:43], v[184:187], v[224:227]
s_barrier
ds_read_b64_tr_b16 v[36:37], v28 offset:0
ds_read_b64_tr_b16 v[38:39], v28 offset:256
v_mfma_f32_16x16x32_bf16 v[232:235], v[40:43], v[188:191], v[232:235]
s_waitcnt lgkmcnt(4)
v_add_u32 v22, v22, v1
v_mul_lo_u32 v22, v22, v13
buffer_store_dwordx4 v[244:247], v24, s[36:39], s51 offen offset:256 sc1
v_mfma_f32_16x16x32_bf16 v[228:231], v[44:47], v[184:187], v[228:231]
ds_read_b64_tr_b16 v[40:41], v30 offset:0
ds_read_b64_tr_b16 v[42:43], v30 offset:256
v_mfma_f32_16x16x32_bf16 v[236:239], v[44:47], v[188:191], v[236:239]
v_add_u32_dpp v22, v22, v22 row_ror:8 row_mask:0xf bank_mask:0xf
s_nop 1
v_add_u32_dpp v22, v22, v22 row_ror:4 row_mask:0xf bank_mask:0xf
v_mfma_f32_16x16x32_bf16 v[224:227], v[48:51], v[72:75], v[224:227]
ds_read_b64_tr_b16 v[44:45], v32 offset:0
ds_read_b64_tr_b16 v[46:47], v32 offset:256
v_mfma_f32_16x16x32_bf16 v[232:235], v[48:51], v[76:79], v[232:235]
s_waitcnt lgkmcnt(4)
v_add_u32_dpp v22, v22, v22 row_ror:2 row_mask:0xf bank_mask:0xf
s_nop 1
v_add_u32_dpp v22, v22, v22 row_ror:1 row_mask:0xf bank_mask:0xf
v_mfma_f32_16x16x32_bf16 v[228:231], v[52:55], v[72:75], v[228:231]
ds_read_b64_tr_b16 v[48:49], v34 offset:0
ds_read_b64_tr_b16 v[50:51], v34 offset:256
v_mfma_f32_16x16x32_bf16 v[236:239], v[52:55], v[76:79], v[236:239]
v_add_u32_dpp v22, v22, v22 row_bcast:15 row_mask:0xa bank_mask:0xf
s_nop 1
v_add_u32_dpp v22, v22, v22 row_bcast:31 row_mask:0xc bank_mask:0xf
v_add_u32 v22, v22, v23
buffer_store_dwordx2 v[22:23], v21, s[36:39], s11 offen sc1
v_mfma_f32_16x16x32_bf16 v[224:227], v[36:39], v[192:195], v[224:227]
ds_read_b64_tr_b16 v[52:53], v28 offset:8192
ds_read_b64_tr_b16 v[54:55], v28 offset:8448
v_mfma_f32_16x16x32_bf16 v[232:235], v[36:39], v[196:199], v[232:235]
s_waitcnt lgkmcnt(4)
v_mfma_f32_16x16x32_bf16 v[228:231], v[40:43], v[192:195], v[228:231]
ds_read_b64_tr_b16 v[36:37], v30 offset:8192
ds_read_b64_tr_b16 v[38:39], v30 offset:8448
v_mfma_f32_16x16x32_bf16 v[236:239], v[40:43], v[196:199], v[236:239]
v_mfma_f32_16x16x32_bf16 v[224:227], v[44:47], v[80:83], v[224:227]
ds_read_b64_tr_b16 v[40:41], v32 offset:8192
ds_read_b64_tr_b16 v[42:43], v32 offset:8448
v_mfma_f32_16x16x32_bf16 v[232:235], v[44:47], v[84:87], v[232:235]
s_waitcnt lgkmcnt(4)
v_mfma_f32_16x16x32_bf16 v[228:231], v[48:51], v[80:83], v[228:231]
ds_read_b64_tr_b16 v[44:45], v34 offset:8192
ds_read_b64_tr_b16 v[46:47], v34 offset:8448
v_mfma_f32_16x16x32_bf16 v[236:239], v[48:51], v[84:87], v[236:239]
v_mfma_f32_16x16x32_bf16 v[224:227], v[52:55], v[200:203], v[224:227]
s_barrier
ds_read_b64_tr_b16 v[48:49], v28 offset:16384
ds_read_b64_tr_b16 v[50:51], v28 offset:16640
v_mfma_f32_16x16x32_bf16 v[232:235], v[52:55], v[204:207], v[232:235]
s_waitcnt lgkmcnt(4)
v_mfma_f32_16x16x32_bf16 v[228:231], v[36:39], v[200:203], v[228:231]
ds_read_b64_tr_b16 v[52:53], v30 offset:16384
ds_read_b64_tr_b16 v[54:55], v30 offset:16640
v_mfma_f32_16x16x32_bf16 v[236:239], v[36:39], v[204:207], v[236:239]
v_mfma_f32_16x16x32_bf16 v[224:227], v[40:43], v[88:91], v[224:227]
ds_read_b64_tr_b16 v[36:37], v32 offset:16384
ds_read_b64_tr_b16 v[38:39], v32 offset:16640
v_mfma_f32_16x16x32_bf16 v[232:235], v[40:43], v[92:95], v[232:235]
s_waitcnt lgkmcnt(4)
v_mfma_f32_16x16x32_bf16 v[228:231], v[44:47], v[88:91], v[228:231]
ds_read_b64_tr_b16 v[40:41], v34 offset:16384
ds_read_b64_tr_b16 v[42:43], v34 offset:16640
v_mfma_f32_16x16x32_bf16 v[236:239], v[44:47], v[92:95], v[236:239]
v_mfma_f32_16x16x32_bf16 v[208:211], v[48:51], v[176:179], 0
ds_read_b64_tr_b16 v[44:45], v28 offset:24576
ds_read_b64_tr_b16 v[46:47], v28 offset:24832
v_mfma_f32_16x16x32_bf16 v[216:219], v[48:51], v[180:183], 0
s_waitcnt lgkmcnt(4)
v_mfma_f32_16x16x32_bf16 v[212:215], v[52:55], v[176:179], 0
ds_read_b64_tr_b16 v[48:49], v30 offset:24576
ds_read_b64_tr_b16 v[50:51], v30 offset:24832
v_mfma_f32_16x16x32_bf16 v[220:223], v[52:55], v[180:183], 0
v_cvt_pk_bf16_f32 v224, v224, v225
v_cvt_pk_bf16_f32 v225, v226, v227
v_cvt_pk_bf16_f32 v226, v228, v229
v_cvt_pk_bf16_f32 v227, v230, v231
v_mfma_f32_16x16x32_bf16 v[208:211], v[36:39], v[64:67], v[208:211]
ds_read_b64_tr_b16 v[52:53], v32 offset:24576
ds_read_b64_tr_b16 v[54:55], v32 offset:24832
v_mfma_f32_16x16x32_bf16 v[216:219], v[36:39], v[68:71], v[216:219]
s_waitcnt lgkmcnt(4)
buffer_store_dwordx4 v[224:227], v24, s[36:39], s52 offen offset:0 sc1
v_cvt_pk_bf16_f32 v228, v232, v233
v_cvt_pk_bf16_f32 v229, v234, v235
v_cvt_pk_bf16_f32 v230, v236, v237
v_mfma_f32_16x16x32_bf16 v[212:215], v[40:43], v[64:67], v[212:215]
ds_read_b64_tr_b16 v[36:37], v34 offset:24576
ds_read_b64_tr_b16 v[38:39], v34 offset:24832
v_mfma_f32_16x16x32_bf16 v[220:223], v[40:43], v[68:71], v[220:223]
v_cvt_pk_bf16_f32 v231, v238, v239
v_add3_u32 v22, v224, v225, v226
v_add3_u32 v1, v227, v228, v229
v_add3_u32 v22, v22, v230, v231
v_mfma_f32_16x16x32_bf16 v[208:211], v[44:47], v[184:187], v[208:211]
s_barrier
ds_read_b64_tr_b16 v[40:41], v28 offset:32768
ds_read_b64_tr_b16 v[42:43], v28 offset:33024
v_mfma_f32_16x16x32_bf16 v[216:219], v[44:47], v[188:191], v[216:219]
s_waitcnt lgkmcnt(4)
v_add_u32 v22, v22, v1
v_mul_lo_u32 v22, v22, v13
buffer_store_dwordx4 v[228:231], v24, s[36:39], s52 offen offset:256 sc1
v_mfma_f32_16x16x32_bf16 v[212:215], v[48:51], v[184:187], v[212:215]
ds_read_b64_tr_b16 v[44:45], v30 offset:32768
ds_read_b64_tr_b16 v[46:47], v30 offset:33024
v_mfma_f32_16x16x32_bf16 v[220:223], v[48:51], v[188:191], v[220:223]
v_add_u32_dpp v22, v22, v22 row_ror:8 row_mask:0xf bank_mask:0xf
s_nop 1
v_add_u32_dpp v22, v22, v22 row_ror:4 row_mask:0xf bank_mask:0xf
v_mfma_f32_16x16x32_bf16 v[208:211], v[52:55], v[72:75], v[208:211]
ds_read_b64_tr_b16 v[48:49], v32 offset:32768
ds_read_b64_tr_b16 v[50:51], v32 offset:33024
v_mfma_f32_16x16x32_bf16 v[216:219], v[52:55], v[76:79], v[216:219]
s_waitcnt lgkmcnt(4)
v_add_u32_dpp v22, v22, v22 row_ror:2 row_mask:0xf bank_mask:0xf
s_nop 1
v_add_u32_dpp v22, v22, v22 row_ror:1 row_mask:0xf bank_mask:0xf
v_mfma_f32_16x16x32_bf16 v[212:215], v[36:39], v[72:75], v[212:215]
ds_read_b64_tr_b16 v[52:53], v34 offset:32768
ds_read_b64_tr_b16 v[54:55], v34 offset:33024
v_mfma_f32_16x16x32_bf16 v[220:223], v[36:39], v[76:79], v[220:223]
v_add_u32_dpp v22, v22, v22 row_bcast:15 row_mask:0xa bank_mask:0xf
s_nop 1
v_add_u32_dpp v22, v22, v22 row_bcast:31 row_mask:0xc bank_mask:0xf
v_add_u32 v22, v22, v23
buffer_store_dwordx2 v[22:23], v21, s[36:39], s12 offen sc1
v_mfma_f32_16x16x32_bf16 v[208:211], v[40:43], v[192:195], v[208:211]
ds_read_b64_tr_b16 v[36:37], v28 offset:40960
ds_read_b64_tr_b16 v[38:39], v28 offset:41216
v_mfma_f32_16x16x32_bf16 v[216:219], v[40:43], v[196:199], v[216:219]
s_waitcnt lgkmcnt(4)
v_mfma_f32_16x16x32_bf16 v[212:215], v[44:47], v[192:195], v[212:215]
ds_read_b64_tr_b16 v[40:41], v30 offset:40960
ds_read_b64_tr_b16 v[42:43], v30 offset:41216
v_mfma_f32_16x16x32_bf16 v[220:223], v[44:47], v[196:199], v[220:223]
v_mfma_f32_16x16x32_bf16 v[208:211], v[48:51], v[80:83], v[208:211]
ds_read_b64_tr_b16 v[44:45], v32 offset:40960
ds_read_b64_tr_b16 v[46:47], v32 offset:41216
v_mfma_f32_16x16x32_bf16 v[216:219], v[48:51], v[84:87], v[216:219]
s_waitcnt lgkmcnt(4)
v_mfma_f32_16x16x32_bf16 v[212:215], v[52:55], v[80:83], v[212:215]
ds_read_b64_tr_b16 v[48:49], v34 offset:40960
ds_read_b64_tr_b16 v[50:51], v34 offset:41216
v_mfma_f32_16x16x32_bf16 v[220:223], v[52:55], v[84:87], v[220:223]
v_mfma_f32_16x16x32_bf16 v[208:211], v[36:39], v[200:203], v[208:211]
s_barrier
ds_read_b64_tr_b16 v[52:53], v28 offset:49152
ds_read_b64_tr_b16 v[54:55], v28 offset:49408
v_mfma_f32_16x16x32_bf16 v[216:219], v[36:39], v[204:207], v[216:219]
s_waitcnt lgkmcnt(4)
v_mfma_f32_16x16x32_bf16 v[212:215], v[40:43], v[200:203], v[212:215]
ds_read_b64_tr_b16 v[36:37], v30 offset:49152
ds_read_b64_tr_b16 v[38:39], v30 offset:49408
v_mfma_f32_16x16x32_bf16 v[220:223], v[40:43], v[204:207], v[220:223]
v_mfma_f32_16x16x32_bf16 v[208:211], v[44:47], v[88:91], v[208:211]
ds_read_b64_tr_b16 v[40:41], v32 offset:49152
ds_read_b64_tr_b16 v[42:43], v32 offset:49408
v_mfma_f32_16x16x32_bf16 v[216:219], v[44:47], v[92:95], v[216:219]
s_waitcnt lgkmcnt(4)
v_mfma_f32_16x16x32_bf16 v[212:215], v[48:51], v[88:91], v[212:215]
ds_read_b64_tr_b16 v[44:45], v34 offset:49152
ds_read_b64_tr_b16 v[46:47], v34 offset:49408
v_mfma_f32_16x16x32_bf16 v[220:223], v[48:51], v[92:95], v[220:223]
v_mfma_f32_16x16x32_bf16 v[240:243], v[52:55], v[176:179], 0
ds_read_b64_tr_b16 v[48:49], v28 offset:57344
ds_read_b64_tr_b16 v[50:51], v28 offset:57600
v_mfma_f32_16x16x32_bf16 v[248:251], v[52:55], v[180:183], 0
s_waitcnt lgkmcnt(4)
v_mfma_f32_16x16x32_bf16 v[244:247], v[36:39], v[176:179], 0
ds_read_b64_tr_b16 v[52:53], v30 offset:57344
ds_read_b64_tr_b16 v[54:55], v30 offset:57600
v_mfma_f32_16x16x32_bf16 v[252:255], v[36:39], v[180:183], 0
v_cvt_pk_bf16_f32 v208, v208, v209
v_cvt_pk_bf16_f32 v209, v210, v211
v_cvt_pk_bf16_f32 v210, v212, v213
v_cvt_pk_bf16_f32 v211, v214, v215
v_mfma_f32_16x16x32_bf16 v[240:243], v[40:43], v[64:67], v[240:243]
ds_read_b64_tr_b16 v[36:37], v32 offset:57344
ds_read_b64_tr_b16 v[38:39], v32 offset:57600
v_mfma_f32_16x16x32_bf16 v[248:251], v[40:43], v[68:71], v[248:251]
s_waitcnt lgkmcnt(4)
buffer_store_dwordx4 v[208:211], v24, s[36:39], s53 offen offset:0 sc1
v_cvt_pk_bf16_f32 v212, v216, v217
v_cvt_pk_bf16_f32 v213, v218, v219
v_cvt_pk_bf16_f32 v214, v220, v221
v_mfma_f32_16x16x32_bf16 v[244:247], v[44:47], v[64:67], v[244:247]
ds_read_b64_tr_b16 v[40:41], v34 offset:57344
ds_read_b64_tr_b16 v[42:43], v34 offset:57600
v_mfma_f32_16x16x32_bf16 v[252:255], v[44:47], v[68:71], v[252:255]
v_cvt_pk_bf16_f32 v215, v222, v223
v_add3_u32 v22, v208, v209, v210
v_add3_u32 v1, v211, v212, v213
v_add3_u32 v22, v22, v214, v215
v_mfma_f32_16x16x32_bf16 v[240:243], v[48:51], v[184:187], v[240:243]
s_barrier
ds_read_b64_tr_b16 v[44:45], v29 offset:0
ds_read_b64_tr_b16 v[46:47], v29 offset:256
v_mfma_f32_16x16x32_bf16 v[248:251], v[48:51], v[188:191], v[248:251]
s_waitcnt lgkmcnt(4)
v_add_u32 v22, v22, v1
v_mul_lo_u32 v22, v22, v13
buffer_store_dwordx4 v[212:215], v24, s[36:39], s53 offen offset:256 sc1
v_mfma_f32_16x16x32_bf16 v[244:247], v[52:55], v[184:187], v[244:247]
ds_read_b64_tr_b16 v[48:49], v31 offset:0
ds_read_b64_tr_b16 v[50:51], v31 offset:256
v_mfma_f32_16x16x32_bf16 v[252:255], v[52:55], v[188:191], v[252:255]
v_add_u32_dpp v22, v22, v22 row_ror:8 row_mask:0xf bank_mask:0xf
s_nop 1
v_add_u32_dpp v22, v22, v22 row_ror:4 row_mask:0xf bank_mask:0xf
v_mfma_f32_16x16x32_bf16 v[240:243], v[36:39], v[72:75], v[240:243]
ds_read_b64_tr_b16 v[52:53], v33 offset:0
ds_read_b64_tr_b16 v[54:55], v33 offset:256
v_mfma_f32_16x16x32_bf16 v[248:251], v[36:39], v[76:79], v[248:251]
s_waitcnt lgkmcnt(4)
v_add_u32_dpp v22, v22, v22 row_ror:2 row_mask:0xf bank_mask:0xf
s_nop 1
v_add_u32_dpp v22, v22, v22 row_ror:1 row_mask:0xf bank_mask:0xf
v_mfma_f32_16x16x32_bf16 v[244:247], v[40:43], v[72:75], v[244:247]
ds_read_b64_tr_b16 v[36:37], v35 offset:0
ds_read_b64_tr_b16 v[38:39], v35 offset:256
v_mfma_f32_16x16x32_bf16 v[252:255], v[40:43], v[76:79], v[252:255]
v_add_u32_dpp v22, v22, v22 row_bcast:15 row_mask:0xa bank_mask:0xf
s_nop 1
v_add_u32_dpp v22, v22, v22 row_bcast:31 row_mask:0xc bank_mask:0xf
v_add_u32 v22, v22, v23
buffer_store_dwordx2 v[22:23], v21, s[36:39], s13 offen sc1
v_mfma_f32_16x16x32_bf16 v[240:243], v[44:47], v[192:195], v[240:243]
ds_read_b64_tr_b16 v[40:41], v29 offset:8192
ds_read_b64_tr_b16 v[42:43], v29 offset:8448
v_mfma_f32_16x16x32_bf16 v[248:251], v[44:47], v[196:199], v[248:251]
s_waitcnt lgkmcnt(4)
s_barrier
v_mfma_f32_16x16x32_bf16 v[244:247], v[48:51], v[192:195], v[244:247]
ds_read_b64_tr_b16 v[44:45], v31 offset:8192
ds_read_b64_tr_b16 v[46:47], v31 offset:8448
v_mfma_f32_16x16x32_bf16 v[252:255], v[48:51], v[196:199], v[252:255]
v_mfma_f32_16x16x32_bf16 v[240:243], v[52:55], v[80:83], v[240:243]
ds_read_b64_tr_b16 v[48:49], v33 offset:8192
ds_read_b64_tr_b16 v[50:51], v33 offset:8448
v_mfma_f32_16x16x32_bf16 v[248:251], v[52:55], v[84:87], v[248:251]
s_waitcnt lgkmcnt(4)
v_mfma_f32_16x16x32_bf16 v[244:247], v[36:39], v[80:83], v[244:247]
ds_read_b64_tr_b16 v[52:53], v35 offset:8192
ds_read_b64_tr_b16 v[54:55], v35 offset:8448
v_mfma_f32_16x16x32_bf16 v[252:255], v[36:39], v[84:87], v[252:255]
v_mfma_f32_16x16x32_bf16 v[240:243], v[40:43], v[200:203], v[240:243]
v_mfma_f32_16x16x32_bf16 v[248:251], v[40:43], v[204:207], v[248:251]
s_waitcnt lgkmcnt(2)
v_mfma_f32_16x16x32_bf16 v[244:247], v[44:47], v[200:203], v[244:247]
v_mfma_f32_16x16x32_bf16 v[252:255], v[44:47], v[204:207], v[252:255]
v_mfma_f32_16x16x32_bf16 v[240:243], v[48:51], v[88:91], v[240:243]
v_mfma_f32_16x16x32_bf16 v[248:251], v[48:51], v[92:95], v[248:251]
s_waitcnt lgkmcnt(0)
v_mfma_f32_16x16x32_bf16 v[244:247], v[52:55], v[88:91], v[244:247]
v_mfma_f32_16x16x32_bf16 v[252:255], v[52:55], v[92:95], v[252:255]
s_mul_i32 s59, s30, 30720
s_lshl_b32 s60, s31, 12
s_add_u32 s59, s59, s60
s_add_u32 s59, s59, 20480
v_and_b32 v2, 32, v0
v_lshl_add_u32 v2, v2, 5, v20
v_add_u32 v2, s59, v2
s_lshl_b32 s59, s3, 8
v_lshl_add_u32 v3, v0, 2, s59
s_cmp_lg_u32 s4, 3
s_nop 7
s_cbranch_scc1 cM_own1
v_cvt_pk_bf16_f32 v240, v240, v241
v_cvt_pk_bf16_f32 v241, v242, v243
v_cvt_pk_bf16_f32 v242, v244, v245
v_cvt_pk_bf16_f32 v243, v246, v247
buffer_store_dwordx4 v[240:243], v24, s[36:39], s54 offen offset:0 sc1
v_cvt_pk_bf16_f32 v244, v248, v249
v_cvt_pk_bf16_f32 v245, v250, v251
v_cvt_pk_bf16_f32 v246, v252, v253
v_cvt_pk_bf16_f32 v247, v254, v255
v_add3_u32 v22, v240, v241, v242
v_add3_u32 v1, v243, v244, v245
v_add3_u32 v22, v22, v246, v247
v_add_u32 v22, v22, v1
v_mul_lo_u32 v22, v22, v13
buffer_store_dwordx4 v[244:247], v24, s[36:39], s54 offen offset:256 sc1
s_nop 0
v_add_u32_dpp v22, v22, v22 row_ror:8 row_mask:0xf bank_mask:0xf
s_nop 1
v_add_u32_dpp v22, v22, v22 row_ror:4 row_mask:0xf bank_mask:0xf
s_nop 1
v_add_u32_dpp v22, v22, v22 row_ror:2 row_mask:0xf bank_mask:0xf
s_nop 1
v_add_u32_dpp v22, v22, v22 row_ror:1 row_mask:0xf bank_mask:0xf
s_nop 1
v_add_u32_dpp v22, v22, v22 row_bcast:15 row_mask:0xa bank_mask:0xf
s_nop 1
v_add_u32_dpp v22, v22, v22 row_bcast:31 row_mask:0xc bank_mask:0xf
v_add_u32 v22, v22, v23
buffer_store_dwordx2 v[22:23], v21, s[36:39], s14 offen sc1
s_branch cM_fin2
cM_own1:
ds_write_b128 v2, v[240:243] offset:0
ds_write_b128 v2, v[244:247] offset:1024
ds_write_b128 v2, v[248:251] offset:256
ds_write_b128 v2, v[252:255] offset:1280
ds_write_b32 v3, v27
cM_fin2:
s_endpgm
.p2align 6
gather_M:
gM_top:
s_mov_b32 s31, 1
s_mov_b32 s27, 0xffff0000
s_waitcnt vmcnt(0)
ds_read2_b64 v[128:131], v38 offset0:0 offset1:4
ds_read2_b64 v[132:135], v38 offset0:2 offset1:6
s_cmp_lg_u32 s9, s26
s_cbranch_scc1 gM_wait0
gM_go0:
buffer_load_dwordx4 v[64:67], v39, s[36:39], s50 offen offset:0 sc1
buffer_load_dwordx4 v[68:71], v39, s[36:39], s50 offen offset:1024 sc1
s_waitcnt lgkmcnt(0)
s_load_dwordx16 s[8:23], s[48:49], 0 glc
v_lshlrev_b32 v16, 16, v128
v_and_b32 v17, s27, v128
v_lshlrev_b32 v18, 16, v129
v_and_b32 v19, s27, v129
v_lshlrev_b32 v20, 16, v130
v_and_b32 v21, s27, v130
v_lshlrev_b32 v22, 16, v131
v_and_b32 v23, s27, v131
v_lshlrev_b32 v24, 16, v132
v_and_b32 v25, s27, v132
v_lshlrev_b32 v26, 16, v133
v_and_b32 v27, s27, v133
v_lshlrev_b32 v28, 16, v134
v_and_b32 v29, s27, v134
v_lshlrev_b32 v30, 16, v135
v_and_b32 v31, s27, v135
s_mov_b32 s31, 0
s_cmp_lg_u32 s11, s26
s_cbranch_scc1 gM_wait1
gM_go1:
buffer_load_dwordx4 v[72:75], v39, s[36:39], s51 offen offset:0 sc1
buffer_load_dwordx4 v[76:79], v39, s[36:39], s51 offen offset:1024 sc1
s_cmp_lg_u32 s13, s26
s_cbranch_scc1 gM_wait2
gM_go2:
buffer_load_dwordx4 v[80:83], v39, s[36:39], s52 offen offset:0 sc1
buffer_load_dwordx4 v[84:87], v39, s[36:39], s52 offen offset:1024 sc1
v_dot2c_f32_bf16 v16, v136, v35
v_dot2c_f32_bf16 v17, v136, v15
v_dot2c_f32_bf16 v18, v137, v35
v_dot2c_f32_bf16 v19, v137, v15
v_dot2c_f32_bf16 v20, v138, v35
v_dot2c_f32_bf16 v21, v138, v15
v_dot2c_f32_bf16 v22, v139, v35
v_dot2c_f32_bf16 v23, v139, v15
v_dot2c_f32_bf16 v24, v140, v35
v_dot2c_f32_bf16 v25, v140, v15
v_dot2c_f32_bf16 v26, v141, v35
v_dot2c_f32_bf16 v27, v141, v15
v_dot2c_f32_bf16 v28, v142, v35
v_dot2c_f32_bf16 v29, v142, v15
v_dot2c_f32_bf16 v30, v143, v35
v_dot2c_f32_bf16 v31, v143, v15
s_cmp_lg_u32 s15, s26
s_cbranch_scc1 gM_wait3
gM_go3:
buffer_load_dwordx4 v[88:91], v39, s[36:39], s53 offen offset:0 sc1
buffer_load_dwordx4 v[92:95], v39, s[36:39], s53 offen offset:1024 sc1
s_waitcnt vmcnt(7)
v_add3_u32 v32, v32, v64, v65
v_add3_u32 v32, v32, v66, v67
s_waitcnt vmcnt(6)
v_add3_u32 v32, v32, v68, v69
v_add3_u32 v32, v32, v70, v71
v_dot2c_f32_bf16 v16, v64, v35
v_dot2c_f32_bf16 v17, v64, v15
v_dot2c_f32_bf16 v18, v65, v35
v_dot2c_f32_bf16 v19, v65, v15
v_dot2c_f32_bf16 v20, v66, v35
v_dot2c_f32_bf16 v21, v66, v15
v_dot2c_f32_bf16 v22, v67, v35
v_dot2c_f32_bf16 v23, v67, v15
v_dot2c_f32_bf16 v24, v68, v35
v_dot2c_f32_bf16 v25, v68, v15
v_dot2c_f32_bf16 v26, v69, v35
v_dot2c_f32_bf16 v27, v69, v15
v_dot2c_f32_bf16 v28, v70, v35
v_dot2c_f32_bf16 v29, v70, v15
v_dot2c_f32_bf16 v30, v71, v35
v_dot2c_f32_bf16 v31, v71, v15
s_cmp_lg_u32 s17, s26
s_cbranch_scc1 gM_wait4
gM_go4:
buffer_load_dwordx4 v[96:99], v39, s[36:39], s54 offen offset:0 sc1
buffer_load_dwordx4 v[100:103], v39, s[36:39], s54 offen offset:1024 sc1
s_waitcnt vmcnt(7)
v_add3_u32 v32, v32, v72, v73
v_add3_u32 v32, v32, v74, v75
s_waitcnt vmcnt(6)
v_add3_u32 v32, v32, v76, v77
v_add3_u32 v32, v32, v78, v79
v_dot2c_f32_bf16 v16, v72, v35
v_dot2c_f32_bf16 v17, v72, v15
v_dot2c_f32_bf16 v18, v73, v35
v_dot2c_f32_bf16 v19, v73, v15
v_dot2c_f32_bf16 v20, v74, v35
v_dot2c_f32_bf16 v21, v74, v15
v_dot2c_f32_bf16 v22, v75, v35
v_dot2c_f32_bf16 v23, v75, v15
v_dot2c_f32_bf16 v24, v76, v35
v_dot2c_f32_bf16 v25, v76, v15
v_dot2c_f32_bf16 v26, v77, v35
v_dot2c_f32_bf16 v27, v77, v15
v_dot2c_f32_bf16 v28, v78, v35
v_dot2c_f32_bf16 v29, v78, v15
v_dot2c_f32_bf16 v30, v79, v35
v_dot2c_f32_bf16 v31, v79, v15
s_cmp_lg_u32 s19, s26
s_cbranch_scc1 gM_wait5
gM_go5:
buffer_load_dwordx4 v[104:107], v39, s[36:39], s55 offen offset:0 sc1
buffer_load_dwordx4 v[108:111], v39, s[36:39], s55 offen offset:1024 sc1
s_waitcnt vmcnt(7)
v_add3_u32 v32, v32, v80, v81
v_add3_u32 v32, v32, v82, v83
s_waitcnt vmcnt(6)
v_add3_u32 v32, v32, v84, v85
v_add3_u32 v32, v32, v86, v87
v_dot2c_f32_bf16 v16, v80, v35
v_dot2c_f32_bf16 v17, v80, v15
v_dot2c_f32_bf16 v18, v81, v35
v_dot2c_f32_bf16 v19, v81, v15
v_dot2c_f32_bf16 v20, v82, v35
v_dot2c_f32_bf16 v21, v82, v15
v_dot2c_f32_bf16 v22, v83, v35
v_dot2c_f32_bf16 v23, v83, v15
v_dot2c_f32_bf16 v24, v84, v35
v_dot2c_f32_bf16 v25, v84, v15
v_dot2c_f32_bf16 v26, v85, v35
v_dot2c_f32_bf16 v27, v85, v15
v_dot2c_f32_bf16 v28, v86, v35
v_dot2c_f32_bf16 v29, v86, v15
v_dot2c_f32_bf16 v30, v87, v35
v_dot2c_f32_bf16 v31, v87, v15
s_cmp_lg_u32 s21, s26
s_cbranch_scc1 gM_wait6
gM_go6:
buffer_load_dwordx4 v[112:115], v39, s[36:39], s56 offen offset:0 sc1
buffer_load_dwordx4 v[116:119], v39, s[36:39], s56 offen offset:1024 sc1
s_mul_i32 s30, s26, 7
s_sub_u32 s30, s30, s8
s_sub_u32 s30, s30, s10
s_sub_u32 s30, s30, s12
s_sub_u32 s30, s30, s14
s_sub_u32 s30, s30, s16
s_sub_u32 s30, s30, s18
s_sub_u32 s30, s30, s20
s_cmp_lg_u32 s31, 0
s_cbranch_scc1 gM_sum
gM_ownw:
ds_read_b32 v160, v42
s_sub_u32 s63, s63, 1
s_cmp_le_i32 s63, 0
s_waitcnt lgkmcnt(0)
s_cbranch_scc1 gM_redo
v_cmp_eq_u32 vcc, 0, v160
s_cbranch_vccnz gM_ownw
gM_redo:
ds_read_b128 v[160:163], v33 offset:0
ds_read_b128 v[164:167], v33 offset:1024
ds_read_b128 v[168:171], v33 offset:2048
ds_read_b128 v[172:175], v33 offset:3072
s_waitcnt lgkmcnt(0)
v_add_f32 v16, v16, v160
v_add_f32 v17, v17, v161
v_add_f32 v18, v18, v162
v_add_f32 v19, v19, v163
v_add_f32 v20, v20, v164
v_add_f32 v21, v21, v165
v_add_f32 v22, v22, v166
v_add_f32 v23, v23, v167
v_add_f32 v24, v24, v168
v_add_f32 v25, v25, v169
v_add_f32 v26, v26, v170
v_add_f32 v27, v27, v171
v_add_f32 v28, v28, v172
v_add_f32 v29, v29, v173
v_add_f32 v30, v30, v174
v_add_f32 v31, v31, v175
gM_sum:
s_waitcnt vmcnt(7)
v_add3_u32 v32, v32, v88, v89
v_add3_u32 v32, v32, v90, v91
s_waitcnt vmcnt(6)
v_add3_u32 v32, v32, v92, v93
v_add3_u32 v32, v32, v94, v95
v_dot2c_f32_bf16 v16, v88, v35
v_dot2c_f32_bf16 v17, v88, v15
v_dot2c_f32_bf16 v18, v89, v35
v_dot2c_f32_bf16 v19, v89, v15
v_dot2c_f32_bf16 v20, v90, v35
v_dot2c_f32_bf16 v21, v90, v15
v_dot2c_f32_bf16 v22, v91, v35
v_dot2c_f32_bf16 v23, v91, v15
v_dot2c_f32_bf16 v24, v92, v35
v_dot2c_f32_bf16 v25, v92, v15
v_dot2c_f32_bf16 v26, v93, v35
v_dot2c_f32_bf16 v27, v93, v15
v_dot2c_f32_bf16 v28, v94, v35
v_dot2c_f32_bf16 v29, v94, v15
v_dot2c_f32_bf16 v30, v95, v35
v_dot2c_f32_bf16 v31, v95, v15
s_waitcnt vmcnt(5)
v_add3_u32 v32, v32, v96, v97
v_add3_u32 v32, v32, v98, v99
s_waitcnt vmcnt(4)
v_add3_u32 v32, v32, v100, v101
v_add3_u32 v32, v32, v102, v103
v_dot2c_f32_bf16 v16, v96, v35
v_dot2c_f32_bf16 v17, v96, v15
v_dot2c_f32_bf16 v18, v97, v35
v_dot2c_f32_bf16 v19, v97, v15
v_dot2c_f32_bf16 v20, v98, v35
v_dot2c_f32_bf16 v21, v98, v15
v_dot2c_f32_bf16 v22, v99, v35
v_dot2c_f32_bf16 v23, v99, v15
v_dot2c_f32_bf16 v24, v100, v35
v_dot2c_f32_bf16 v25, v100, v15
v_dot2c_f32_bf16 v26, v101, v35
v_dot2c_f32_bf16 v27, v101, v15
v_dot2c_f32_bf16 v28, v102, v35
v_dot2c_f32_bf16 v29, v102, v15
v_dot2c_f32_bf16 v30, v103, v35
v_dot2c_f32_bf16 v31, v103, v15
s_waitcnt vmcnt(3)
v_add3_u32 v32, v32, v104, v105
v_add3_u32 v32, v32, v106, v107
s_waitcnt vmcnt(2)
v_add3_u32 v32, v32, v108, v109
v_add3_u32 v32, v32, v110, v111
v_dot2c_f32_bf16 v16, v104, v35
v_dot2c_f32_bf16 v17, v104, v15
v_dot2c_f32_bf16 v18, v105, v35
v_dot2c_f32_bf16 v19, v105, v15
v_dot2c_f32_bf16 v20, v106, v35
v_dot2c_f32_bf16 v21, v106, v15
v_dot2c_f32_bf16 v22, v107, v35
v_dot2c_f32_bf16 v23, v107, v15
v_dot2c_f32_bf16 v24, v108, v35
v_dot2c_f32_bf16 v25, v108, v15
v_dot2c_f32_bf16 v26, v109, v35
v_dot2c_f32_bf16 v27, v109, v15
v_dot2c_f32_bf16 v28, v110, v35
v_dot2c_f32_bf16 v29, v110, v15
v_dot2c_f32_bf16 v30, v111, v35
v_dot2c_f32_bf16 v31, v111, v15
s_waitcnt vmcnt(0)
v_add3_u32 v32, v32, v112, v113
v_add3_u32 v32, v32, v114, v115
v_add3_u32 v32, v32, v116, v117
v_add3_u32 v32, v32, v118, v119
v_mul_lo_u32 v32, v32, v43
v_dot2c_f32_bf16 v16, v112, v35
v_dot2c_f32_bf16 v17, v112, v15
v_add_u32_dpp v32, v32, v32 row_ror:8 row_mask:0xf bank_mask:0xf
v_dot2c_f32_bf16 v18, v113, v35
v_dot2c_f32_bf16 v19, v113, v15
v_add_u32_dpp v32, v32, v32 row_ror:4 row_mask:0xf bank_mask:0xf
v_dot2c_f32_bf16 v20, v114, v35
v_dot2c_f32_bf16 v21, v114, v15
v_add_u32_dpp v32, v32, v32 row_ror:2 row_mask:0xf bank_mask:0xf
v_dot2c_f32_bf16 v22, v115, v35
v_dot2c_f32_bf16 v23, v115, v15
v_add_u32_dpp v32, v32, v32 row_ror:1 row_mask:0xf bank_mask:0xf
v_dot2c_f32_bf16 v24, v116, v35
v_dot2c_f32_bf16 v25, v116, v15
v_add_u32_dpp v32, v32, v32 row_bcast:15 row_mask:0xa bank_mask:0xf
v_dot2c_f32_bf16 v26, v117, v35
v_dot2c_f32_bf16 v27, v117, v15
v_add_u32_dpp v32, v32, v32 row_bcast:31 row_mask:0xc bank_mask:0xf
v_dot2c_f32_bf16 v28, v118, v35
v_dot2c_f32_bf16 v29, v118, v15
v_readlane_b32 s59, v32, 63
v_dot2c_f32_bf16 v30, v119, v35
v_dot2c_f32_bf16 v31, v119, v15
s_add_u32 s59, s59, s30
s_cmp_lg_u32 s59, 0
s_cbranch_scc1 gM_fail
gM_done:
s_waitcnt lgkmcnt(0)
v_cvt_pk_bf16_f32 v16, v16, v17
v_cvt_pk_bf16_f32 v17, v18, v19
v_cvt_pk_bf16_f32 v18, v20, v21
v_cvt_pk_bf16_f32 v19, v22, v23
ds_write2_b64 v40, v[16:17], v[18:19] offset0:0 offset1:4
v_cvt_pk_bf16_f32 v20, v24, v25
v_cvt_pk_bf16_f32 v21, v26, v27
v_cvt_pk_bf16_f32 v22, v28, v29
v_cvt_pk_bf16_f32 v23, v30, v31
ds_write2_b64 v40, v[20:21], v[22:23] offset0:2 offset1:6
ds_read_b128 v[24:27], v41 offset:0
ds_read_b128 v[28:31], v41 offset:1280
s_waitcnt lgkmcnt(1)
buffer_store_dwordx4 v[24:27], v36, s[44:47], s60 offen
s_waitcnt lgkmcnt(0)
buffer_store_dwordx4 v[28:31], v36, s[44:47], s57 offen
s_lshl_b32 s59, s5, 3
s_add_u32 s59, s59, s4
s_lshl_b32 s59, s59, 3
s_add_u32 s59, s59, s3
s_cmp_lg_u32 s59, 23
s_cbranch_scc1 gM_exit
s_mov_b64 exec, 1
buffer_store_dword v34, v39, s[36:39], 0 offen offset:12 sc1
s_mov_b64 exec, -1
gM_exit:
s_endpgm
gM_fail:
s_sub_u32 s63, s63, 64
s_cmp_le_i32 s63, 0
s_cbranch_scc1 gM_done
s_waitcnt lgkmcnt(0)
s_load_dwordx16 s[8:23], s[48:49], 0 glc
v_mov_b32 v32, 0
s_waitcnt lgkmcnt(0)
s_branch gM_top
gM_idle:
s_cmp_lg_u32 s31, 0
s_cbranch_scc1 gM_idle2
ds_read_b32 v160, v42
s_waitcnt lgkmcnt(0)
v_cmp_eq_u32 vcc, 0, v160
s_cbranch_vccnz gM_idle2
s_mov_b32 s31, 1
ds_read_b128 v[160:163], v33 offset:0
ds_read_b128 v[164:167], v33 offset:1024
ds_read_b128 v[168:171], v33 offset:2048
ds_read_b128 v[172:175], v33 offset:3072
s_waitcnt lgkmcnt(0)
s_load_dwordx16 s[8:23], s[48:49], 0 glc
v_add_f32 v16, v16, v160
v_add_f32 v17, v17, v161
v_add_f32 v18, v18, v162
v_add_f32 v19, v19, v163
v_add_f32 v20, v20, v164
v_add_f32 v21, v21, v165
v_add_f32 v22, v22, v166
v_add_f32 v23, v23, v167
v_add_f32 v24, v24, v168
v_add_f32 v25, v25, v169
v_add_f32 v26, v26, v170
v_add_f32 v27, v27, v171
v_add_f32 v28, v28, v172
v_add_f32 v29, v29, v173
v_add_f32 v30, v30, v174
v_add_f32 v31, v31, v175
s_setpc_b64 s[58:59]
gM_idle2:
s_load_dwordx16 s[8:23], s[48:49], 0 glc
s_setpc_b64 s[58:59]
gM_wait0:
s_waitcnt lgkmcnt(0)
s_cmp_eq_u32 s9, s26
s_cbranch_scc1 gM_go0
s_sub_u32 s63, s63, 1
s_cmp_le_i32 s63, 0
s_cbranch_scc1 gM_go0
s_call_b64 s[58:59], gM_idle
s_branch gM_wait0
gM_wait1:
s_waitcnt lgkmcnt(0)
s_cmp_eq_u32 s11, s26
s_cbranch_scc1 gM_go1
s_sub_u32 s63, s63, 1
s_cmp_le_i32 s63, 0
s_cbranch_scc1 gM_go1
s_call_b64 s[58:59], gM_idle
s_branch gM_wait1
gM_wait2:
s_waitcnt lgkmcnt(0)
s_cmp_eq_u32 s13, s26
s_cbranch_scc1 gM_go2
s_sub_u32 s63, s63, 1
s_cmp_le_i32 s63, 0
s_cbranch_scc1 gM_go2
s_call_b64 s[58:59], gM_idle
s_branch gM_wait2
gM_wait3:
s_waitcnt lgkmcnt(0)
s_cmp_eq_u32 s15, s26
s_cbranch_scc1 gM_go3
s_sub_u32 s63, s63, 1
s_cmp_le_i32 s63, 0
s_cbranch_scc1 gM_go3
s_call_b64 s[58:59], gM_idle
s_branch gM_wait3
gM_wait4:
s_waitcnt lgkmcnt(0)
s_cmp_eq_u32 s17, s26
s_cbranch_scc1 gM_go4
s_sub_u32 s63, s63, 1
s_cmp_le_i32 s63, 0
s_cbranch_scc1 gM_go4
s_call_b64 s[58:59], gM_idle
s_branch gM_wait4
gM_wait5:
s_waitcnt lgkmcnt(0)
s_cmp_eq_u32 s19, s26
s_cbranch_scc1 gM_go5
s_sub_u32 s63, s63, 1
s_cmp_le_i32 s63, 0
s_cbranch_scc1 gM_go5
s_call_b64 s[58:59], gM_idle
s_branch gM_wait5
gM_wait6:
s_waitcnt lgkmcnt(0)
s_cmp_eq_u32 s21, s26
s_cbranch_scc1 gM_go6
s_sub_u32 s63, s63, 1
s_cmp_le_i32 s63, 0
s_cbranch_scc1 gM_go6
s_call_b64 s[58:59], gM_idle
s_branch gM_wait6
role_M_end:
.p2align 7
role_N_start:
.p2align 6
proto_N:
s_sub_u32 s30, s3, 6
s_mov_b32 s31, 0
s_barrier
s_mov_b32 s52, s28
s_and_b32 s53, s29, 0xffff
s_mov_b32 s54, 67108864
s_mov_b32 s55, 0x20000
s_waitcnt lgkmcnt(0)
s_add_u32 s14, s14, 1
s_cmp_gt_u32 s4, 3
s_subb_u32 s60, s4, 0
s_mul_i32 s61, s5, 7
s_add_u32 s60, s60, s61
s_lshl_b32 s61, s3, 8
s_add_u32 s60, s60, s61
s_lshl_b32 s60, s60, 7
s_add_u32 s60, s60, 22937600
s_load_dword s26, s[28:29], s60 glc
s_barrier
s_cmp_eq_u32 s30, 0
s_mov_b32 s59, 42
s_cselect_b32 s59, 36, s59
pN_tk1:
s_cmp_ge_u32 s31, s59
s_cbranch_scc1 pN_tk1x
s_barrier
s_add_u32 s31, s31, 1
s_branch pN_tk1
pN_tk1x:
s_waitcnt vmcnt(0)
s_mov_b32 s32, s8
s_and_b32 s33, s9, 0xffff
s_mov_b32 s34, 1835008
s_mov_b32 s35, 0x20000
s_mov_b32 s36, s28
s_and_b32 s37, s29, 0xffff
s_mov_b32 s38, 67108864
s_mov_b32 s39, 0x20000
s_mov_b64 s[0:1], s[22:23]
s_sub_u32 s57, s3, 4
s_cmp_gt_u32 s4, 3
s_subb_u32 s58, s4, 0
s_mul_i32 s61, s5, 7
s_add_u32 s61, s61, s58
s_lshl_b32 s60, s57, 8
s_add_u32 s60, s60, s61
s_lshl_b32 s60, s60, 7
s_add_u32 s60, s60, 23068672
s_add_u32 s48, s28, s60
s_addc_u32 s49, s29, 0
s_waitcnt lgkmcnt(0)
s_mov_b32 s26, s14
s_load_dwordx16 s[8:23], s[48:49], 0 glc
s_lshl_b32 s61, s61, 5
s_add_u32 s61, s61, s57
s_lshl_b32 s61, s61, 11
s_mul_i32 s60, s5, 0
s_add_u32 s61, s61, s60
s_add_u32 s61, s61, 6291456
s_lshl_b32 s58, s58, 7
s_and_b32 s60, s57, 1
s_lshl_b32 s60, s60, 6
s_add_u32 s58, s58, s60
s_lshr_b32 s27, s57, 1
s_lshl_b32 s60, s5, 1
s_add_u32 s60, s60, s27
s_mul_i32 s60, s60, 28672
s_add_u32 s60, s60, s58
v_lshrrev_b32 v41, 2, v0
v_and_b32 v39, 3, v0
v_mul_u32_u24 v36, 896, v41
v_lshl_add_u32 v36, v39, 4, v36
v_mul_u32_u24 v41, 80, v41
v_lshl_add_u32 v41, v39, 4, v41
v_bfe_u32 v37, v0, 5, 1
v_lshlrev_b32 v37, 3, v37
v_and_b32 v39, 31, v0
v_lshl_add_u32 v38, v39, 6, v37
v_lshl_add_u32 v40, v39, 4, v38
v_lshlrev_b32 v39, 4, v0
s_mul_i32 s27, s27, 30720
s_and_b32 s57, s57, 1
s_lshl_b32 s57, s57, 11
s_add_u32 s27, s27, s57
s_add_u32 s57, s57, s27
s_add_u32 s57, s57, 20480
s_add_u32 s27, s27, 28672
v_add_u32 v33, s57, v39
v_add_u32 v40, s57, v40
v_add_u32 v41, s57, v41
v_add_u32 v38, s27, v38
v_and_b32 v43, 15, v0
v_lshl_add_u32 v43, v37, 1, v43
v_mul_u32_u24 v43, 0x9e3a, v43
v_or_b32 v43, 1, v43
v_mov_b32 v34, s26
s_cmp_lg_u32 s30, 0
s_cbranch_scc1 pN_mp2x
s_cmp_eq_u32 s4, 3
s_cselect_b32 s56, 0, 0x7f
s_sub_u32 s52, s61, 4096
v_lshlrev_b32 v2, 7, v0
pN_mp2:
s_cmp_ge_u32 s31, 42
s_cbranch_scc1 pN_mp2x
s_barrier
s_add_u32 s31, s31, 1
s_mov_b32 s57, 0
s_cmp_eq_u32 s23, s26
s_addc_u32 s57, s57, s57
s_cmp_eq_u32 s21, s26
s_addc_u32 s57, s57, s57
s_cmp_eq_u32 s19, s26
s_addc_u32 s57, s57, s57
s_cmp_eq_u32 s17, s26
s_addc_u32 s57, s57, s57
s_cmp_eq_u32 s15, s26
s_addc_u32 s57, s57, s57
s_cmp_eq_u32 s13, s26
s_addc_u32 s57, s57, s57
s_cmp_eq_u32 s11, s26
s_addc_u32 s57, s57, s57
s_cmp_eq_u32 s9, s26
s_addc_u32 s57, s57, s57
s_and_b32 s57, s57, s56
s_cbranch_scc0 pN_mp2n
s_ff1_i32_b32 s59, s57
s_bitset0_b32 s56, s59
s_lshl_b32 s59, s59, 13
s_add_u32 s59, s59, s52
buffer_load_dword v3, v2, s[36:39], s59 offen sc1
pN_mp2n:
s_getreg_b32 s59, hwreg(HW_REG_IB_STS, 8, 4)
s_cmp_gt_u32 s59, 0
s_cbranch_scc1 pN_mp2
s_cmp_ge_u32 s31, 41
s_cbranch_scc1 pN_mp2
s_load_dwordx16 s[8:23], s[48:49], 0 glc
s_branch pN_mp2
pN_mp2x:
pN_tk3:
s_cmp_ge_u32 s31, 43
s_cbranch_scc1 pN_tk3x
s_barrier
s_add_u32 s31, s31, 1
s_branch pN_tk3
pN_tk3x:
s_mov_b32 s40, s0
s_and_b32 s41, s1, 0xffff
s_mov_b32 s42, 896
s_mov_b32 s43, 0x20000
s_mov_b32 s44, s24
s_and_b32 s45, s25, 0xffff
s_mov_b32 s46, 1835008
s_mov_b32 s47, 0x20000
s_add_u32 s57, s60, 14336
s_add_u32 m0, s27, 0
s_nop 0
buffer_load_dwordx4 v36, s[32:35], s60 offen lds
buffer_load_dwordx2 v[136:137], v37, s[40:43], s58 offen offset:0
buffer_load_dwordx2 v[138:139], v37, s[40:43], s58 offen offset:32
s_add_u32 m0, s27, 1024
s_nop 0
buffer_load_dwordx4 v36, s[32:35], s57 offen lds
buffer_load_dwordx2 v[140:141], v37, s[40:43], s58 offen offset:16
buffer_load_dwordx2 v[142:143], v37, s[40:43], s58 offen offset:48
s_load_dwordx16 s[8:23], s[48:49], 0 glc
s_add_u32 s50, s61, 0
s_add_u32 s51, s61, 8192
s_add_u32 s52, s61, 16384
s_add_u32 s53, s61, 24576
s_add_u32 s54, s61, 32768
s_add_u32 s55, s61, 40960
s_add_u32 s56, s61, 49152
v_mov_b32 v35, 0x3f80
v_mov_b32 v15, 1.0
v_mov_b32 v32, 0
pN_tk4:
s_cmp_ge_u32 s31, 45
s_cbranch_scc1 pN_tk4x
s_barrier
s_add_u32 s31, s31, 1
s_branch pN_tk4
pN_tk4x:
s_branch gather_N
.p2align 6
load_N:
s_mul_i32 s49, s4, 56
s_lshr_b32 s49, s49, 6
s_lshl_b32 s49, s49, 7
s_lshl_b32 s60, s4, 2
s_sub_u32 s60, s60, 2
s_max_i32 s60, s60, 0
s_lshl_b32 s59, s60, 7
s_add_u32 s36, s16, s59
s_addc_u32 s37, s17, 0
s_and_b32 s37, s37, 0xffff
s_sub_u32 s38, 1605632, s59
s_mov_b32 s39, 0x20000
s_mul_i32 s59, s60, 57344
s_add_u32 s40, s20, s59
s_addc_u32 s41, s21, 0
s_and_b32 s41, s41, 0xffff
s_sub_u32 s42, 1605632, s59
s_mov_b32 s43, 0x20000
s_add_u32 s7, s4, 1
s_cmp_gt_u32 s4, 3
s_cselect_b32 s7, s4, s7
s_cmp_eq_u32 s4, 3
s_cselect_b32 s7, 3, s7
s_cmp_ge_u32 s7, 7
s_cselect_b32 s7, 0, s7
s_mul_i32 s50, s7, 128
s_add_u32 s7, s7, 1
s_cmp_ge_u32 s7, 7
s_cselect_b32 s7, 0, s7
s_mul_i32 s51, s7, 128
s_add_u32 s7, s7, 1
s_cmp_ge_u32 s7, 7
s_cselect_b32 s7, 0, s7
s_mul_i32 s52, s7, 128
s_add_u32 s7, s7, 1
s_cmp_ge_u32 s7, 7
s_cselect_b32 s7, 0, s7
s_mul_i32 s53, s7, 128
s_add_u32 s7, s7, 1
s_cmp_ge_u32 s7, 7
s_cselect_b32 s7, 0, s7
s_mul_i32 s54, s7, 128
s_add_u32 s7, s7, 1
s_cmp_ge_u32 s7, 7
s_cselect_b32 s7, 0, s7
s_mul_i32 s55, s7, 128
s_add_u32 s7, s7, 1
s_cmp_ge_u32 s7, 7
s_cselect_b32 s7, 0, s7
s_mul_i32 s56, s7, 128
s_sub_u32 s30, s3, 4
s_lshl_b32 s31, s30, 11
s_lshl_b32 s59, s30, 4
v_bfe_u32 v12, v0, 2, 3
v_add_u32 v12, s59, v12
v_lshrrev_b32 v13, 5, v0
v_lshlrev_b32 v13, 6, v13
v_and_b32 v14, 3, v0
v_lshl_add_u32 v13, v14, 4, v13
v_mul_u32_u24 v2, 2688, v12
v_add_u32 v2, v2, v13
v_xor_b32 v5, 32, v2
v_mul_u32_u24 v3, 3584, v12
v_add_u32 v3, v3, v13
v_xor_b32 v6, 32, v3
v_bfe_u32 v12, v0, 2, 2
v_and_b32 v14, 16, v0
v_add_u32 v12, v12, v14
s_lshl_b32 s59, s30, 3
v_add_u32 v12, s59, v12
v_mul_u32_u24 v4, 896, v12
v_add_u32 v4, v4, v13
v_xor_b32 v7, 32, v4
s_lshl_b32 s61, s6, 1
s_add_u32 s61, s61, s30
s_mul_i32 s60, s61, 14
v_and_b32 v17, 15, v0
v_min_u32 v17, 13, v17
v_add_u32 v17, s60, v17
v_mul_u32_u24 v17, 2688, v17
v_lshrrev_b32 v9, 4, v0
v_and_b32 v10, 1, v9
v_lshl_add_u32 v17, v10, 7, v17
v_lshrrev_b32 v9, 1, v9
v_mul_u32_u24 v9, 896, v9
v_add_u32 v17, v9, v17
v_add_u32 v17, 896, v17
v_add_u32 v17, s49, v17
s_mul_i32 s60, s61, 14
v_and_b32 v18, 15, v0
v_min_u32 v18, 13, v18
v_add_u32 v18, s60, v18
v_mul_u32_u24 v18, 3584, v18
v_lshrrev_b32 v9, 4, v0
v_min_u32 v9, 3, v9
v_lshl_add_u32 v18, v9, 7, v18
s_barrier
buffer_load_dword v49, v17, s[32:35], 0 offen
buffer_load_dword v50, v18, s[36:39], 0 offen
s_waitcnt lgkmcnt(0)
s_add_u32 s14, s14, 1
s_mul_i32 s60, s61, 8
v_and_b32 v19, 7, v0
v_min_u32 v19, 7, v19
v_add_u32 v19, s60, v19
v_mul_u32_u24 v19, 896, v19
v_mov_b32 v9, s50
v_mov_b32 v10, s51
v_cmp_le_u32 vcc, 8, v0
s_nop 1
v_cndmask_b32 v9, v9, v10, vcc
v_mov_b32 v10, s52
v_cmp_le_u32 vcc, 16, v0
s_nop 1
v_cndmask_b32 v9, v9, v10, vcc
v_mov_b32 v10, s53
v_cmp_le_u32 vcc, 24, v0
s_nop 1
v_cndmask_b32 v9, v9, v10, vcc
v_add_u32 v19, v9, v19
s_mul_i32 s60, s61, 8
v_and_b32 v20, 7, v0
v_min_u32 v20, 7, v20
v_add_u32 v20, s60, v20
v_mul_u32_u24 v20, 896, v20
v_mov_b32 v9, s54
v_mov_b32 v10, s55
v_cmp_le_u32 vcc, 8, v0
s_nop 1
v_cndmask_b32 v9, v9, v10, vcc
v_mov_b32 v10, s56
v_cmp_le_u32 vcc, 16, v0
s_nop 1
v_cndmask_b32 v9, v9, v10, vcc
v_add_u32 v20, v9, v20
s_cmp_gt_u32 s4, 3
s_subb_u32 s60, s4, 0
s_mul_i32 s61, s5, 7
s_add_u32 s60, s60, s61
s_lshl_b32 s61, s3, 8
s_add_u32 s60, s60, s61
s_lshl_b32 s60, s60, 7
s_add_u32 s60, s60, 22937600
s_load_dword s26, s[28:29], s60 glc
s_barrier
s_add_u32 m0, s31, 65536
s_add_u32 s59, s49, 896
buffer_load_dwordx4 v2, s[32:35], s59 offen  lds
s_add_u32 m0, s31, 66560
s_add_u32 s59, s49, 22400
buffer_load_dwordx4 v5, s[32:35], s59 offen  lds
s_add_u32 m0, s31, 69632
s_add_u32 s59, s49, 1024
buffer_load_dwordx4 v2, s[32:35], s59 offen  lds
s_add_u32 m0, s31, 70656
s_add_u32 s59, s49, 22528
buffer_load_dwordx4 v5, s[32:35], s59 offen  lds
s_add_u32 m0, s31, 73728
s_add_u32 s59, s49, 86912
buffer_load_dwordx4 v2, s[32:35], s59 offen  lds
s_add_u32 m0, s31, 74752
s_add_u32 s59, s49, 108416
buffer_load_dwordx4 v5, s[32:35], s59 offen  lds
s_add_u32 m0, s31, 77824
s_add_u32 s59, s49, 87040
buffer_load_dwordx4 v2, s[32:35], s59 offen  lds
s_add_u32 m0, s31, 78848
s_add_u32 s59, s49, 108544
buffer_load_dwordx4 v5, s[32:35], s59 offen  lds
s_add_u32 m0, s31, 81920
s_add_u32 s59, s49, 172928
buffer_load_dwordx4 v2, s[32:35], s59 offen  lds
s_add_u32 m0, s31, 82944
s_add_u32 s59, s49, 194432
buffer_load_dwordx4 v5, s[32:35], s59 offen  lds
s_add_u32 m0, s31, 86016
s_add_u32 s59, s49, 173056
buffer_load_dwordx4 v2, s[32:35], s59 offen  lds
s_add_u32 m0, s31, 87040
s_add_u32 s59, s49, 194560
buffer_load_dwordx4 v5, s[32:35], s59 offen  lds
s_add_u32 m0, s31, 90112
s_add_u32 s59, s49, 258944
buffer_load_dwordx4 v2, s[32:35], s59 offen  lds
s_add_u32 m0, s31, 91136
s_add_u32 s59, s49, 280448
buffer_load_dwordx4 v5, s[32:35], s59 offen  lds
s_add_u32 m0, s31, 94208
s_add_u32 s59, s49, 259072
buffer_load_dwordx4 v2, s[32:35], s59 offen  lds
s_add_u32 m0, s31, 95232
s_add_u32 s59, s49, 280576
buffer_load_dwordx4 v5, s[32:35], s59 offen  lds
s_add_u32 m0, s31, 98304
s_add_u32 s59, s49, 344960
buffer_load_dwordx4 v2, s[32:35], s59 offen  lds
s_add_u32 m0, s31, 99328
s_add_u32 s59, s49, 366464
buffer_load_dwordx4 v5, s[32:35], s59 offen  lds
s_add_u32 m0, s31, 102400
s_add_u32 s59, s49, 345088
buffer_load_dwordx4 v2, s[32:35], s59 offen  lds
s_add_u32 m0, s31, 103424
s_add_u32 s59, s49, 366592
buffer_load_dwordx4 v5, s[32:35], s59 offen  lds
s_add_u32 m0, s31, 106496
s_add_u32 s59, s49, 430976
buffer_load_dwordx4 v2, s[32:35], s59 offen  lds
s_add_u32 m0, s31, 107520
s_add_u32 s59, s49, 452480
buffer_load_dwordx4 v5, s[32:35], s59 offen  lds
s_waitcnt vmcnt(14)
s_barrier
s_add_u32 m0, s31, 110592
s_add_u32 s59, s49, 431104
buffer_load_dwordx4 v2, s[32:35], s59 offen  lds
s_add_u32 m0, s31, 111616
s_add_u32 s59, s49, 452608
buffer_load_dwordx4 v5, s[32:35], s59 offen  lds
s_add_u32 m0, s31, 114688
s_add_u32 s59, s49, 516992
buffer_load_dwordx4 v2, s[32:35], s59 offen  lds
s_add_u32 m0, s31, 115712
s_add_u32 s59, s49, 538496
buffer_load_dwordx4 v5, s[32:35], s59 offen  lds
s_add_u32 m0, s31, 118784
s_add_u32 s59, s49, 517120
buffer_load_dwordx4 v2, s[32:35], s59 offen  lds
s_add_u32 m0, s31, 119808
s_add_u32 s59, s49, 538624
buffer_load_dwordx4 v5, s[32:35], s59 offen  lds
s_add_u32 m0, s31, 122880
s_add_u32 s59, s49, 603008
buffer_load_dwordx4 v2, s[32:35], s59 offen  lds
s_add_u32 m0, s31, 123904
s_add_u32 s59, s49, 624512
buffer_load_dwordx4 v5, s[32:35], s59 offen  lds
s_waitcnt vmcnt(14)
s_barrier
s_add_u32 m0, s31, 126976
s_add_u32 s59, s49, 603136
buffer_load_dwordx4 v2, s[32:35], s59 offen  lds
s_add_u32 m0, s31, 128000
s_add_u32 s59, s49, 624640
buffer_load_dwordx4 v5, s[32:35], s59 offen  lds
s_add_u32 m0, s31, 131072
s_add_u32 s59, s49, 689024
buffer_load_dwordx4 v2, s[32:35], s59 offen  lds
s_add_u32 m0, s31, 132096
s_add_u32 s59, s49, 710528
buffer_load_dwordx4 v5, s[32:35], s59 offen  lds
s_add_u32 m0, s31, 135168
s_add_u32 s59, s49, 689152
buffer_load_dwordx4 v2, s[32:35], s59 offen  lds
s_add_u32 m0, s31, 136192
s_add_u32 s59, s49, 710656
buffer_load_dwordx4 v5, s[32:35], s59 offen  lds
s_add_u32 m0, s31, 139264
s_add_u32 s59, s49, 775040
buffer_load_dwordx4 v2, s[32:35], s59 offen  lds
s_add_u32 m0, s31, 140288
s_add_u32 s59, s49, 796544
buffer_load_dwordx4 v5, s[32:35], s59 offen  lds
s_waitcnt vmcnt(14)
s_barrier
s_add_u32 m0, s31, 143360
s_add_u32 s59, s49, 775168
buffer_load_dwordx4 v2, s[32:35], s59 offen  lds
s_add_u32 m0, s31, 144384
s_add_u32 s59, s49, 796672
buffer_load_dwordx4 v5, s[32:35], s59 offen  lds
s_add_u32 m0, s31, 147456
s_add_u32 s59, s49, 861056
buffer_load_dwordx4 v2, s[32:35], s59 offen  lds
s_add_u32 m0, s31, 148480
s_add_u32 s59, s49, 882560
buffer_load_dwordx4 v5, s[32:35], s59 offen  lds
s_add_u32 m0, s31, 151552
s_add_u32 s59, s49, 861184
buffer_load_dwordx4 v2, s[32:35], s59 offen  lds
s_add_u32 m0, s31, 152576
s_add_u32 s59, s49, 882688
buffer_load_dwordx4 v5, s[32:35], s59 offen  lds
s_add_u32 m0, s31, 155648
s_add_u32 s59, s49, 947072
buffer_load_dwordx4 v2, s[32:35], s59 offen  lds
s_add_u32 m0, s31, 156672
s_add_u32 s59, s49, 968576
buffer_load_dwordx4 v5, s[32:35], s59 offen  lds
s_add_u32 m0, s31, 159744
s_add_u32 s59, s49, 947200
buffer_load_dwordx4 v2, s[32:35], s59 offen  lds
s_add_u32 m0, s31, 160768
s_add_u32 s59, s49, 968704
buffer_load_dwordx4 v5, s[32:35], s59 offen  lds
s_waitcnt vmcnt(16)
s_barrier
s_add_u32 m0, s31, 65536
s_add_u32 s59, s49, 1033088
buffer_load_dwordx4 v2, s[32:35], s59 offen  lds
s_add_u32 m0, s31, 66560
s_add_u32 s59, s49, 1054592
buffer_load_dwordx4 v5, s[32:35], s59 offen  lds
s_add_u32 m0, s31, 69632
s_add_u32 s59, s49, 1033216
buffer_load_dwordx4 v2, s[32:35], s59 offen  lds
s_add_u32 m0, s31, 70656
s_add_u32 s59, s49, 1054720
buffer_load_dwordx4 v5, s[32:35], s59 offen  lds
s_add_u32 m0, s31, 73728
s_add_u32 s59, s49, 1119104
buffer_load_dwordx4 v2, s[32:35], s59 offen  lds
s_add_u32 m0, s31, 74752
s_add_u32 s59, s49, 1140608
buffer_load_dwordx4 v5, s[32:35], s59 offen  lds
s_add_u32 m0, s31, 77824
s_add_u32 s59, s49, 1119232
buffer_load_dwordx4 v2, s[32:35], s59 offen  lds
s_add_u32 m0, s31, 78848
s_add_u32 s59, s49, 1140736
buffer_load_dwordx4 v5, s[32:35], s59 offen  lds
s_add_u32 m0, s31, 81920
s_add_u32 s59, s49, 1792
buffer_load_dwordx4 v2, s[32:35], s59 offen  lds
s_add_u32 m0, s31, 82944
s_add_u32 s59, s49, 23296
buffer_load_dwordx4 v5, s[32:35], s59 offen  lds
s_waitcnt vmcnt(18)
s_barrier
s_add_u32 m0, s31, 86016
s_add_u32 s59, s49, 1920
buffer_load_dwordx4 v2, s[32:35], s59 offen  lds
s_add_u32 m0, s31, 87040
s_add_u32 s59, s49, 23424
buffer_load_dwordx4 v5, s[32:35], s59 offen  lds
s_add_u32 m0, s31, 90112
s_add_u32 s59, s49, 87808
buffer_load_dwordx4 v2, s[32:35], s59 offen  lds
s_add_u32 m0, s31, 91136
s_add_u32 s59, s49, 109312
buffer_load_dwordx4 v5, s[32:35], s59 offen  lds
s_add_u32 m0, s31, 94208
s_add_u32 s59, s49, 87936
buffer_load_dwordx4 v2, s[32:35], s59 offen  lds
s_add_u32 m0, s31, 95232
s_add_u32 s59, s49, 109440
buffer_load_dwordx4 v5, s[32:35], s59 offen  lds
s_add_u32 m0, s31, 98304
s_add_u32 s59, s49, 173824
buffer_load_dwordx4 v2, s[32:35], s59 offen  lds
s_add_u32 m0, s31, 99328
s_add_u32 s59, s49, 195328
buffer_load_dwordx4 v5, s[32:35], s59 offen  lds
s_add_u32 m0, s31, 102400
s_add_u32 s59, s49, 173952
buffer_load_dwordx4 v2, s[32:35], s59 offen  lds
s_add_u32 m0, s31, 103424
s_add_u32 s59, s49, 195456
buffer_load_dwordx4 v5, s[32:35], s59 offen  lds
s_waitcnt vmcnt(20)
s_barrier
s_add_u32 m0, s31, 106496
s_add_u32 s59, s49, 259840
buffer_load_dwordx4 v2, s[32:35], s59 offen  lds
s_add_u32 m0, s31, 107520
s_add_u32 s59, s49, 281344
buffer_load_dwordx4 v5, s[32:35], s59 offen  lds
s_add_u32 m0, s31, 110592
s_add_u32 s59, s49, 259968
buffer_load_dwordx4 v2, s[32:35], s59 offen  lds
s_add_u32 m0, s31, 111616
s_add_u32 s59, s49, 281472
buffer_load_dwordx4 v5, s[32:35], s59 offen  lds
s_add_u32 m0, s31, 114688
s_add_u32 s59, s49, 345856
buffer_load_dwordx4 v2, s[32:35], s59 offen  lds
s_add_u32 m0, s31, 115712
s_add_u32 s59, s49, 367360
buffer_load_dwordx4 v5, s[32:35], s59 offen  lds
s_add_u32 m0, s31, 118784
s_add_u32 s59, s49, 345984
buffer_load_dwordx4 v2, s[32:35], s59 offen  lds
s_add_u32 m0, s31, 119808
s_add_u32 s59, s49, 367488
buffer_load_dwordx4 v5, s[32:35], s59 offen  lds
s_add_u32 m0, s31, 122880
s_add_u32 s59, s49, 431872
buffer_load_dwordx4 v2, s[32:35], s59 offen  lds
s_add_u32 m0, s31, 123904
s_add_u32 s59, s49, 453376
buffer_load_dwordx4 v5, s[32:35], s59 offen  lds
s_waitcnt vmcnt(22)
s_barrier
s_add_u32 m0, s31, 126976
s_add_u32 s59, s49, 432000
buffer_load_dwordx4 v2, s[32:35], s59 offen  lds
s_add_u32 m0, s31, 128000
s_add_u32 s59, s49, 453504
buffer_load_dwordx4 v5, s[32:35], s59 offen  lds
s_add_u32 m0, s31, 131072
s_add_u32 s59, s49, 517888
buffer_load_dwordx4 v2, s[32:35], s59 offen  lds
s_add_u32 m0, s31, 132096
s_add_u32 s59, s49, 539392
buffer_load_dwordx4 v5, s[32:35], s59 offen  lds
s_add_u32 m0, s31, 135168
s_add_u32 s59, s49, 518016
buffer_load_dwordx4 v2, s[32:35], s59 offen  lds
s_add_u32 m0, s31, 136192
s_add_u32 s59, s49, 539520
buffer_load_dwordx4 v5, s[32:35], s59 offen  lds
s_add_u32 m0, s31, 139264
s_add_u32 s59, s49, 603904
buffer_load_dwordx4 v2, s[32:35], s59 offen  lds
s_add_u32 m0, s31, 140288
s_add_u32 s59, s49, 625408
buffer_load_dwordx4 v5, s[32:35], s59 offen  lds
s_add_u32 m0, s31, 143360
s_add_u32 s59, s49, 604032
buffer_load_dwordx4 v2, s[32:35], s59 offen  lds
s_add_u32 m0, s31, 144384
s_add_u32 s59, s49, 625536
buffer_load_dwordx4 v5, s[32:35], s59 offen  lds
s_add_u32 m0, s31, 147456
s_add_u32 s59, s49, 689920
buffer_load_dwordx4 v2, s[32:35], s59 offen  lds
s_add_u32 m0, s31, 148480
s_add_u32 s59, s49, 711424
buffer_load_dwordx4 v5, s[32:35], s59 offen  lds
s_waitcnt vmcnt(26)
s_barrier
s_add_u32 m0, s31, 151552
s_add_u32 s59, s49, 690048
buffer_load_dwordx4 v2, s[32:35], s59 offen  lds
s_add_u32 m0, s31, 152576
s_add_u32 s59, s49, 711552
buffer_load_dwordx4 v5, s[32:35], s59 offen  lds
s_add_u32 m0, s31, 155648
s_add_u32 s59, s49, 775936
buffer_load_dwordx4 v2, s[32:35], s59 offen  lds
s_add_u32 m0, s31, 156672
s_add_u32 s59, s49, 797440
buffer_load_dwordx4 v5, s[32:35], s59 offen  lds
s_add_u32 m0, s31, 159744
s_add_u32 s59, s49, 776064
buffer_load_dwordx4 v2, s[32:35], s59 offen  lds
s_add_u32 m0, s31, 160768
s_add_u32 s59, s49, 797568
buffer_load_dwordx4 v5, s[32:35], s59 offen  lds
s_add_u32 m0, s31, 65536
s_add_u32 s59, s49, 861952
buffer_load_dwordx4 v2, s[32:35], s59 offen  lds
s_add_u32 m0, s31, 66560
s_add_u32 s59, s49, 883456
buffer_load_dwordx4 v5, s[32:35], s59 offen  lds
s_waitcnt vmcnt(26)
s_barrier
s_add_u32 m0, s31, 69632
s_add_u32 s59, s49, 862080
buffer_load_dwordx4 v2, s[32:35], s59 offen  lds
s_add_u32 m0, s31, 70656
s_add_u32 s59, s49, 883584
buffer_load_dwordx4 v5, s[32:35], s59 offen  lds
s_add_u32 m0, s31, 73728
s_add_u32 s59, s49, 947968
buffer_load_dwordx4 v2, s[32:35], s59 offen  lds
s_add_u32 m0, s31, 74752
s_add_u32 s59, s49, 969472
buffer_load_dwordx4 v5, s[32:35], s59 offen  lds
s_add_u32 m0, s31, 77824
s_add_u32 s59, s49, 948096
buffer_load_dwordx4 v2, s[32:35], s59 offen  lds
s_add_u32 m0, s31, 78848
s_add_u32 s59, s49, 969600
buffer_load_dwordx4 v5, s[32:35], s59 offen  lds
s_add_u32 m0, s31, 81920
s_add_u32 s59, s49, 1033984
buffer_load_dwordx4 v2, s[32:35], s59 offen  lds
s_add_u32 m0, s31, 82944
s_add_u32 s59, s49, 1055488
buffer_load_dwordx4 v5, s[32:35], s59 offen  lds
s_add_u32 m0, s31, 86016
s_add_u32 s59, s49, 1034112
buffer_load_dwordx4 v2, s[32:35], s59 offen  lds
s_add_u32 m0, s31, 87040
s_add_u32 s59, s49, 1055616
buffer_load_dwordx4 v5, s[32:35], s59 offen  lds
s_waitcnt vmcnt(28)
s_barrier
s_add_u32 m0, s31, 90112
s_add_u32 s59, s49, 1120000
buffer_load_dwordx4 v2, s[32:35], s59 offen  lds
s_add_u32 m0, s31, 91136
s_add_u32 s59, s49, 1141504
buffer_load_dwordx4 v5, s[32:35], s59 offen  lds
s_add_u32 m0, s31, 94208
s_add_u32 s59, s49, 1120128
buffer_load_dwordx4 v2, s[32:35], s59 offen  lds
s_add_u32 m0, s31, 95232
s_add_u32 s59, s49, 1141632
buffer_load_dwordx4 v5, s[32:35], s59 offen  lds
s_add_u32 m0, s31, 98304
s_mov_b32 s59, 0
buffer_load_dwordx4 v3, s[36:39], s59 offen  lds
s_add_u32 m0, s31, 99328
s_mov_b32 s59, 28672
buffer_load_dwordx4 v6, s[36:39], s59 offen  lds
s_add_u32 m0, s31, 102400
s_mov_b32 s59, 114688
buffer_load_dwordx4 v3, s[36:39], s59 offen  lds
s_add_u32 m0, s31, 103424
s_mov_b32 s59, 143360
buffer_load_dwordx4 v6, s[36:39], s59 offen  lds
s_waitcnt vmcnt(28)
s_barrier
s_add_u32 m0, s31, 106496
s_mov_b32 s59, 229376
buffer_load_dwordx4 v3, s[36:39], s59 offen  lds
s_add_u32 m0, s31, 107520
s_mov_b32 s59, 258048
buffer_load_dwordx4 v6, s[36:39], s59 offen  lds
s_add_u32 m0, s31, 110592
s_mov_b32 s59, 344064
buffer_load_dwordx4 v3, s[36:39], s59 offen  lds
s_add_u32 m0, s31, 111616
s_mov_b32 s59, 372736
buffer_load_dwordx4 v6, s[36:39], s59 offen  lds
s_add_u32 m0, s31, 114688
s_mov_b32 s59, 458752
buffer_load_dwordx4 v3, s[36:39], s59 offen  lds
s_add_u32 m0, s31, 115712
s_mov_b32 s59, 487424
buffer_load_dwordx4 v6, s[36:39], s59 offen  lds
s_add_u32 m0, s31, 118784
s_mov_b32 s59, 573440
buffer_load_dwordx4 v3, s[36:39], s59 offen  lds
s_add_u32 m0, s31, 119808
s_mov_b32 s59, 602112
buffer_load_dwordx4 v6, s[36:39], s59 offen  lds
s_waitcnt vmcnt(28)
s_barrier
s_add_u32 m0, s31, 122880
s_mov_b32 s59, 688128
buffer_load_dwordx4 v3, s[36:39], s59 offen  lds
s_add_u32 m0, s31, 123904
s_mov_b32 s59, 716800
buffer_load_dwordx4 v6, s[36:39], s59 offen  lds
s_add_u32 m0, s31, 126976
s_mov_b32 s59, 802816
buffer_load_dwordx4 v3, s[36:39], s59 offen  lds
s_add_u32 m0, s31, 128000
s_mov_b32 s59, 831488
buffer_load_dwordx4 v6, s[36:39], s59 offen  lds
s_add_u32 m0, s31, 131072
s_mov_b32 s59, 917504
buffer_load_dwordx4 v3, s[36:39], s59 offen  lds
s_add_u32 m0, s31, 132096
s_mov_b32 s59, 946176
buffer_load_dwordx4 v6, s[36:39], s59 offen  lds
s_add_u32 m0, s31, 135168
s_mov_b32 s59, 1032192
buffer_load_dwordx4 v3, s[36:39], s59 offen  lds
s_add_u32 m0, s31, 136192
s_mov_b32 s59, 1060864
buffer_load_dwordx4 v6, s[36:39], s59 offen  lds
s_waitcnt vmcnt(28)
s_barrier
s_add_u32 m0, s31, 139264
s_mov_b32 s59, 1146880
buffer_load_dwordx4 v3, s[36:39], s59 offen  lds
s_add_u32 m0, s31, 140288
s_mov_b32 s59, 1175552
buffer_load_dwordx4 v6, s[36:39], s59 offen  lds
s_add_u32 m0, s31, 143360
s_mov_b32 s59, 1261568
buffer_load_dwordx4 v3, s[36:39], s59 offen  lds
s_add_u32 m0, s31, 144384
s_mov_b32 s59, 1290240
buffer_load_dwordx4 v6, s[36:39], s59 offen  lds
s_add_u32 m0, s31, 147456
s_mov_b32 s59, 1376256
buffer_load_dwordx4 v3, s[36:39], s59 offen  lds
s_add_u32 m0, s31, 148480
s_mov_b32 s59, 1404928
buffer_load_dwordx4 v6, s[36:39], s59 offen  lds
s_add_u32 m0, s31, 151552
s_mov_b32 s59, 1490944
buffer_load_dwordx4 v3, s[36:39], s59 offen  lds
s_add_u32 m0, s31, 152576
s_mov_b32 s59, 1519616
buffer_load_dwordx4 v6, s[36:39], s59 offen  lds
s_waitcnt vmcnt(28)
s_barrier
s_add_u32 m0, s31, 155648
s_mov_b32 s59, 128
buffer_load_dwordx4 v3, s[36:39], s59 offen  lds
s_add_u32 m0, s31, 156672
s_mov_b32 s59, 28800
buffer_load_dwordx4 v6, s[36:39], s59 offen  lds
s_add_u32 m0, s31, 159744
s_mov_b32 s59, 114816
buffer_load_dwordx4 v3, s[36:39], s59 offen  lds
s_add_u32 m0, s31, 160768
s_mov_b32 s59, 143488
buffer_load_dwordx4 v6, s[36:39], s59 offen  lds
s_add_u32 m0, s31, 65536
s_mov_b32 s59, 229504
buffer_load_dwordx4 v3, s[36:39], s59 offen  lds
s_add_u32 m0, s31, 66560
s_mov_b32 s59, 258176
buffer_load_dwordx4 v6, s[36:39], s59 offen  lds
s_add_u32 m0, s31, 69632
s_mov_b32 s59, 344192
buffer_load_dwordx4 v3, s[36:39], s59 offen  lds
s_add_u32 m0, s31, 70656
s_mov_b32 s59, 372864
buffer_load_dwordx4 v6, s[36:39], s59 offen  lds
s_waitcnt vmcnt(28)
s_barrier
s_add_u32 m0, s31, 73728
s_mov_b32 s59, 458880
buffer_load_dwordx4 v3, s[36:39], s59 offen  lds
s_add_u32 m0, s31, 74752
s_mov_b32 s59, 487552
buffer_load_dwordx4 v6, s[36:39], s59 offen  lds
s_add_u32 m0, s31, 77824
s_mov_b32 s59, 573568
buffer_load_dwordx4 v3, s[36:39], s59 offen  lds
s_add_u32 m0, s31, 78848
s_mov_b32 s59, 602240
buffer_load_dwordx4 v6, s[36:39], s59 offen  lds
s_add_u32 m0, s31, 81920
s_mov_b32 s59, 688256
buffer_load_dwordx4 v3, s[36:39], s59 offen  lds
s_add_u32 m0, s31, 82944
s_mov_b32 s59, 716928
buffer_load_dwordx4 v6, s[36:39], s59 offen  lds
s_waitcnt vmcnt(34)
s_barrier
s_add_u32 m0, s31, 86016
s_mov_b32 s59, 802944
buffer_load_dwordx4 v3, s[36:39], s59 offen  lds
s_add_u32 m0, s31, 87040
s_mov_b32 s59, 831616
buffer_load_dwordx4 v6, s[36:39], s59 offen  lds
s_add_u32 m0, s31, 90112
s_mov_b32 s59, 917632
buffer_load_dwordx4 v3, s[36:39], s59 offen  lds
s_add_u32 m0, s31, 91136
s_mov_b32 s59, 946304
buffer_load_dwordx4 v6, s[36:39], s59 offen  lds
s_add_u32 m0, s31, 94208
s_mov_b32 s59, 1032320
buffer_load_dwordx4 v3, s[36:39], s59 offen  lds
s_add_u32 m0, s31, 95232
s_mov_b32 s59, 1060992
buffer_load_dwordx4 v6, s[36:39], s59 offen  lds
s_waitcnt vmcnt(32)
s_barrier
s_add_u32 m0, s31, 98304
s_mov_b32 s59, 1147008
buffer_load_dwordx4 v3, s[36:39], s59 offen  lds
s_add_u32 m0, s31, 99328
s_mov_b32 s59, 1175680
buffer_load_dwordx4 v6, s[36:39], s59 offen  lds
s_add_u32 m0, s31, 102400
s_mov_b32 s59, 1261696
buffer_load_dwordx4 v3, s[36:39], s59 offen  lds
s_add_u32 m0, s31, 103424
s_mov_b32 s59, 1290368
buffer_load_dwordx4 v6, s[36:39], s59 offen  lds
s_waitcnt vmcnt(28)
s_barrier
s_add_u32 m0, s31, 106496
s_mov_b32 s59, 1376384
buffer_load_dwordx4 v3, s[36:39], s59 offen  lds
s_add_u32 m0, s31, 107520
s_mov_b32 s59, 1405056
buffer_load_dwordx4 v6, s[36:39], s59 offen  lds
s_add_u32 m0, s31, 110592
s_mov_b32 s59, 1491072
buffer_load_dwordx4 v3, s[36:39], s59 offen  lds
s_add_u32 m0, s31, 111616
s_mov_b32 s59, 1519744
buffer_load_dwordx4 v6, s[36:39], s59 offen  lds
s_add_u32 m0, s31, 114688
s_mov_b32 s59, 256
buffer_load_dwordx4 v3, s[36:39], s59 offen  lds
s_add_u32 m0, s31, 115712
s_mov_b32 s59, 28928
buffer_load_dwordx4 v6, s[36:39], s59 offen  lds
s_add_u32 m0, s31, 118784
s_mov_b32 s59, 114944
buffer_load_dwordx4 v3, s[36:39], s59 offen  lds
s_add_u32 m0, s31, 119808
s_mov_b32 s59, 143616
buffer_load_dwordx4 v6, s[36:39], s59 offen  lds
s_waitcnt vmcnt(28)
s_barrier
s_add_u32 m0, s31, 122880
s_mov_b32 s59, 229632
buffer_load_dwordx4 v3, s[36:39], s59 offen  lds
s_add_u32 m0, s31, 123904
s_mov_b32 s59, 258304
buffer_load_dwordx4 v6, s[36:39], s59 offen  lds
s_add_u32 m0, s31, 126976
s_mov_b32 s59, 344320
buffer_load_dwordx4 v3, s[36:39], s59 offen  lds
s_add_u32 m0, s31, 128000
s_mov_b32 s59, 372992
buffer_load_dwordx4 v6, s[36:39], s59 offen  lds
s_add_u32 m0, s31, 131072
s_mov_b32 s59, 459008
buffer_load_dwordx4 v3, s[36:39], s59 offen  lds
s_add_u32 m0, s31, 132096
s_mov_b32 s59, 487680
buffer_load_dwordx4 v6, s[36:39], s59 offen  lds
s_add_u32 m0, s31, 135168
s_mov_b32 s59, 573696
buffer_load_dwordx4 v3, s[36:39], s59 offen  lds
s_add_u32 m0, s31, 136192
s_mov_b32 s59, 602368
buffer_load_dwordx4 v6, s[36:39], s59 offen  lds
buffer_load_dword v51, v19, s[40:43], 0 offen
s_waitcnt vmcnt(29)
s_barrier
s_add_u32 m0, s31, 139264
s_mov_b32 s59, 688384
buffer_load_dwordx4 v3, s[36:39], s59 offen  lds
s_add_u32 m0, s31, 140288
s_mov_b32 s59, 717056
buffer_load_dwordx4 v6, s[36:39], s59 offen  lds
s_add_u32 m0, s31, 143360
s_mov_b32 s59, 803072
buffer_load_dwordx4 v3, s[36:39], s59 offen  lds
s_add_u32 m0, s31, 144384
s_mov_b32 s59, 831744
buffer_load_dwordx4 v6, s[36:39], s59 offen  lds
s_add_u32 m0, s31, 147456
s_mov_b32 s59, 917760
buffer_load_dwordx4 v3, s[36:39], s59 offen  lds
s_add_u32 m0, s31, 148480
s_mov_b32 s59, 946432
buffer_load_dwordx4 v6, s[36:39], s59 offen  lds
s_add_u32 m0, s31, 151552
s_mov_b32 s59, 1032448
buffer_load_dwordx4 v3, s[36:39], s59 offen  lds
s_add_u32 m0, s31, 152576
s_mov_b32 s59, 1061120
buffer_load_dwordx4 v6, s[36:39], s59 offen  lds
s_waitcnt vmcnt(29)
s_barrier
s_add_u32 m0, s31, 155648
s_mov_b32 s59, 1147136
buffer_load_dwordx4 v3, s[36:39], s59 offen  lds
s_add_u32 m0, s31, 156672
s_mov_b32 s59, 1175808
buffer_load_dwordx4 v6, s[36:39], s59 offen  lds
s_add_u32 m0, s31, 159744
s_mov_b32 s59, 1261824
buffer_load_dwordx4 v3, s[36:39], s59 offen  lds
s_add_u32 m0, s31, 160768
s_mov_b32 s59, 1290496
buffer_load_dwordx4 v6, s[36:39], s59 offen  lds
s_add_u32 m0, s31, 65536
s_mov_b32 s59, 1376512
buffer_load_dwordx4 v3, s[36:39], s59 offen  lds
s_add_u32 m0, s31, 66560
s_mov_b32 s59, 1405184
buffer_load_dwordx4 v6, s[36:39], s59 offen  lds
s_add_u32 m0, s31, 69632
s_mov_b32 s59, 1491200
buffer_load_dwordx4 v3, s[36:39], s59 offen  lds
s_add_u32 m0, s31, 70656
s_mov_b32 s59, 1519872
buffer_load_dwordx4 v6, s[36:39], s59 offen  lds
s_waitcnt vmcnt(29)
s_barrier
s_add_u32 m0, s31, 73728
s_mov_b32 s59, 384
buffer_load_dwordx4 v3, s[36:39], s59 offen  lds
s_add_u32 m0, s31, 74752
s_mov_b32 s59, 29056
buffer_load_dwordx4 v6, s[36:39], s59 offen  lds
s_add_u32 m0, s31, 77824
s_mov_b32 s59, 115072
buffer_load_dwordx4 v3, s[36:39], s59 offen  lds
s_add_u32 m0, s31, 78848
s_mov_b32 s59, 143744
buffer_load_dwordx4 v6, s[36:39], s59 offen  lds
s_add_u32 m0, s31, 81920
s_mov_b32 s59, 229760
buffer_load_dwordx4 v3, s[36:39], s59 offen  lds
s_add_u32 m0, s31, 82944
s_mov_b32 s59, 258432
buffer_load_dwordx4 v6, s[36:39], s59 offen  lds
s_add_u32 m0, s31, 86016
s_mov_b32 s59, 344448
buffer_load_dwordx4 v3, s[36:39], s59 offen  lds
s_add_u32 m0, s31, 87040
s_mov_b32 s59, 373120
buffer_load_dwordx4 v6, s[36:39], s59 offen  lds
s_waitcnt vmcnt(29)
s_barrier
s_add_u32 m0, s31, 90112
s_mov_b32 s59, 459136
buffer_load_dwordx4 v3, s[36:39], s59 offen  lds
s_add_u32 m0, s31, 91136
s_mov_b32 s59, 487808
buffer_load_dwordx4 v6, s[36:39], s59 offen  lds
s_add_u32 m0, s31, 94208
s_mov_b32 s59, 573824
buffer_load_dwordx4 v3, s[36:39], s59 offen  lds
s_add_u32 m0, s31, 95232
s_mov_b32 s59, 602496
buffer_load_dwordx4 v6, s[36:39], s59 offen  lds
s_add_u32 m0, s31, 98304
s_mov_b32 s59, 688512
buffer_load_dwordx4 v3, s[36:39], s59 offen  lds
s_add_u32 m0, s31, 99328
s_mov_b32 s59, 717184
buffer_load_dwordx4 v6, s[36:39], s59 offen  lds
s_add_u32 m0, s31, 102400
s_mov_b32 s59, 803200
buffer_load_dwordx4 v3, s[36:39], s59 offen  lds
s_add_u32 m0, s31, 103424
s_mov_b32 s59, 831872
buffer_load_dwordx4 v6, s[36:39], s59 offen  lds
s_waitcnt vmcnt(28)
s_barrier
s_add_u32 m0, s31, 106496
s_mov_b32 s59, 917888
buffer_load_dwordx4 v3, s[36:39], s59 offen  lds
s_add_u32 m0, s31, 107520
s_mov_b32 s59, 946560
buffer_load_dwordx4 v6, s[36:39], s59 offen  lds
s_add_u32 m0, s31, 110592
s_mov_b32 s59, 1032576
buffer_load_dwordx4 v3, s[36:39], s59 offen  lds
s_add_u32 m0, s31, 111616
s_mov_b32 s59, 1061248
buffer_load_dwordx4 v6, s[36:39], s59 offen  lds
s_add_u32 m0, s31, 114688
s_mov_b32 s59, 1147264
buffer_load_dwordx4 v3, s[36:39], s59 offen  lds
s_add_u32 m0, s31, 115712
s_mov_b32 s59, 1175936
buffer_load_dwordx4 v6, s[36:39], s59 offen  lds
s_add_u32 m0, s31, 118784
s_mov_b32 s59, 1261952
buffer_load_dwordx4 v3, s[36:39], s59 offen  lds
s_add_u32 m0, s31, 119808
s_mov_b32 s59, 1290624
buffer_load_dwordx4 v6, s[36:39], s59 offen  lds
s_waitcnt vmcnt(28)
s_barrier
s_add_u32 m0, s31, 122880
s_mov_b32 s59, 1376640
buffer_load_dwordx4 v3, s[36:39], s59 offen  lds
s_add_u32 m0, s31, 123904
s_mov_b32 s59, 1405312
buffer_load_dwordx4 v6, s[36:39], s59 offen  lds
s_add_u32 m0, s31, 126976
s_mov_b32 s59, 1491328
buffer_load_dwordx4 v3, s[36:39], s59 offen  lds
s_add_u32 m0, s31, 128000
s_mov_b32 s59, 1520000
buffer_load_dwordx4 v6, s[36:39], s59 offen  lds
s_add_u32 m0, s31, 131072
s_add_u32 s59, s50, 0
buffer_load_dwordx4 v4, s[40:43], s59 offen  lds
s_add_u32 m0, s31, 132096
s_add_u32 s59, s50, 3584
buffer_load_dwordx4 v7, s[40:43], s59 offen  lds
s_add_u32 m0, s31, 135168
s_add_u32 s59, s50, 28672
buffer_load_dwordx4 v4, s[40:43], s59 offen  lds
s_add_u32 m0, s31, 136192
s_add_u32 s59, s50, 32256
buffer_load_dwordx4 v7, s[40:43], s59 offen  lds
s_waitcnt vmcnt(28)
s_barrier
s_add_u32 m0, s31, 139264
s_add_u32 s59, s50, 57344
buffer_load_dwordx4 v4, s[40:43], s59 offen  lds
s_add_u32 m0, s31, 140288
s_add_u32 s59, s50, 60928
buffer_load_dwordx4 v7, s[40:43], s59 offen  lds
s_add_u32 m0, s31, 143360
s_add_u32 s59, s50, 86016
buffer_load_dwordx4 v4, s[40:43], s59 offen  lds
s_add_u32 m0, s31, 144384
s_add_u32 s59, s50, 89600
buffer_load_dwordx4 v7, s[40:43], s59 offen  lds
s_add_u32 m0, s31, 147456
s_add_u32 s59, s50, 114688
buffer_load_dwordx4 v4, s[40:43], s59 offen  lds
s_add_u32 m0, s31, 148480
s_add_u32 s59, s50, 118272
buffer_load_dwordx4 v7, s[40:43], s59 offen  lds
s_add_u32 m0, s31, 151552
s_add_u32 s59, s50, 143360
buffer_load_dwordx4 v4, s[40:43], s59 offen  lds
s_add_u32 m0, s31, 152576
s_add_u32 s59, s50, 146944
buffer_load_dwordx4 v7, s[40:43], s59 offen  lds
s_waitcnt vmcnt(28)
s_barrier
s_add_u32 m0, s31, 155648
s_add_u32 s59, s51, 0
buffer_load_dwordx4 v4, s[40:43], s59 offen  lds
s_add_u32 m0, s31, 156672
s_add_u32 s59, s51, 3584
buffer_load_dwordx4 v7, s[40:43], s59 offen  lds
s_add_u32 m0, s31, 159744
s_add_u32 s59, s51, 28672
buffer_load_dwordx4 v4, s[40:43], s59 offen  lds
s_add_u32 m0, s31, 160768
s_add_u32 s59, s51, 32256
buffer_load_dwordx4 v7, s[40:43], s59 offen  lds
s_add_u32 m0, s31, 65536
s_add_u32 s59, s51, 57344
buffer_load_dwordx4 v4, s[40:43], s59 offen  lds
s_add_u32 m0, s31, 66560
s_add_u32 s59, s51, 60928
buffer_load_dwordx4 v7, s[40:43], s59 offen  lds
s_add_u32 m0, s31, 69632
s_add_u32 s59, s51, 86016
buffer_load_dwordx4 v4, s[40:43], s59 offen  lds
s_add_u32 m0, s31, 70656
s_add_u32 s59, s51, 89600
buffer_load_dwordx4 v7, s[40:43], s59 offen  lds
s_waitcnt vmcnt(28)
s_barrier
s_add_u32 m0, s31, 73728
s_add_u32 s59, s51, 114688
buffer_load_dwordx4 v4, s[40:43], s59 offen  lds
s_add_u32 m0, s31, 74752
s_add_u32 s59, s51, 118272
buffer_load_dwordx4 v7, s[40:43], s59 offen  lds
s_add_u32 m0, s31, 77824
s_add_u32 s59, s51, 143360
buffer_load_dwordx4 v4, s[40:43], s59 offen  lds
s_add_u32 m0, s31, 78848
s_add_u32 s59, s51, 146944
buffer_load_dwordx4 v7, s[40:43], s59 offen  lds
s_add_u32 m0, s31, 81920
s_add_u32 s59, s50, 172032
buffer_load_dwordx4 v4, s[40:43], s59 offen  lds
s_add_u32 m0, s31, 82944
s_add_u32 s59, s50, 175616
buffer_load_dwordx4 v7, s[40:43], s59 offen  lds
s_add_u32 m0, s31, 86016
s_add_u32 s59, s50, 200704
buffer_load_dwordx4 v4, s[40:43], s59 offen  lds
s_add_u32 m0, s31, 87040
s_add_u32 s59, s50, 204288
buffer_load_dwordx4 v7, s[40:43], s59 offen  lds
s_waitcnt vmcnt(28)
s_barrier
s_add_u32 m0, s31, 90112
s_add_u32 s59, s51, 172032
buffer_load_dwordx4 v4, s[40:43], s59 offen  lds
s_add_u32 m0, s31, 91136
s_add_u32 s59, s51, 175616
buffer_load_dwordx4 v7, s[40:43], s59 offen  lds
s_add_u32 m0, s31, 94208
s_add_u32 s59, s51, 200704
buffer_load_dwordx4 v4, s[40:43], s59 offen  lds
s_add_u32 m0, s31, 95232
s_add_u32 s59, s51, 204288
buffer_load_dwordx4 v7, s[40:43], s59 offen  lds
s_add_u32 m0, s31, 98304
s_add_u32 s59, s52, 0
buffer_load_dwordx4 v4, s[40:43], s59 offen  lds
s_add_u32 m0, s31, 99328
s_add_u32 s59, s52, 3584
buffer_load_dwordx4 v7, s[40:43], s59 offen  lds
s_add_u32 m0, s31, 102400
s_add_u32 s59, s52, 28672
buffer_load_dwordx4 v4, s[40:43], s59 offen  lds
s_add_u32 m0, s31, 103424
s_add_u32 s59, s52, 32256
buffer_load_dwordx4 v7, s[40:43], s59 offen  lds
s_waitcnt vmcnt(28)
s_barrier
s_add_u32 m0, s31, 106496
s_add_u32 s59, s52, 57344
buffer_load_dwordx4 v4, s[40:43], s59 offen  lds
s_add_u32 m0, s31, 107520
s_add_u32 s59, s52, 60928
buffer_load_dwordx4 v7, s[40:43], s59 offen  lds
s_add_u32 m0, s31, 110592
s_add_u32 s59, s52, 86016
buffer_load_dwordx4 v4, s[40:43], s59 offen  lds
s_add_u32 m0, s31, 111616
s_add_u32 s59, s52, 89600
buffer_load_dwordx4 v7, s[40:43], s59 offen  lds
s_add_u32 m0, s31, 114688
s_add_u32 s59, s52, 114688
buffer_load_dwordx4 v4, s[40:43], s59 offen  lds
s_add_u32 m0, s31, 115712
s_add_u32 s59, s52, 118272
buffer_load_dwordx4 v7, s[40:43], s59 offen  lds
s_waitcnt vmcnt(26)
s_barrier
s_add_u32 m0, s31, 118784
s_add_u32 s59, s52, 143360
buffer_load_dwordx4 v4, s[40:43], s59 offen  lds
s_add_u32 m0, s31, 119808
s_add_u32 s59, s52, 146944
buffer_load_dwordx4 v7, s[40:43], s59 offen  lds
s_add_u32 m0, s31, 122880
s_add_u32 s59, s52, 172032
buffer_load_dwordx4 v4, s[40:43], s59 offen  lds
s_add_u32 m0, s31, 123904
s_add_u32 s59, s52, 175616
buffer_load_dwordx4 v7, s[40:43], s59 offen  lds
s_add_u32 m0, s31, 126976
s_add_u32 s59, s52, 200704
buffer_load_dwordx4 v4, s[40:43], s59 offen  lds
s_add_u32 m0, s31, 128000
s_add_u32 s59, s52, 204288
buffer_load_dwordx4 v7, s[40:43], s59 offen  lds
s_waitcnt vmcnt(24)
s_barrier
buffer_load_dword v52, v20, s[40:43], 0 offen
s_waitcnt vmcnt(17)
s_barrier
s_waitcnt vmcnt(17)
s_barrier
s_add_u32 m0, s31, 20480
s_add_u32 s59, s53, 0
buffer_load_dwordx4 v4, s[40:43], s59 offen  lds
s_add_u32 m0, s31, 21504
s_add_u32 s59, s53, 3584
buffer_load_dwordx4 v7, s[40:43], s59 offen  lds
s_add_u32 m0, s31, 24576
s_add_u32 s59, s53, 28672
buffer_load_dwordx4 v4, s[40:43], s59 offen  lds
s_add_u32 m0, s31, 25600
s_add_u32 s59, s53, 32256
buffer_load_dwordx4 v7, s[40:43], s59 offen  lds
s_add_u32 m0, s31, 51200
s_add_u32 s59, s53, 57344
buffer_load_dwordx4 v4, s[40:43], s59 offen  lds
s_add_u32 m0, s31, 52224
s_add_u32 s59, s53, 60928
buffer_load_dwordx4 v7, s[40:43], s59 offen  lds
s_add_u32 m0, s31, 55296
s_add_u32 s59, s53, 86016
buffer_load_dwordx4 v4, s[40:43], s59 offen  lds
s_add_u32 m0, s31, 56320
s_add_u32 s59, s53, 89600
buffer_load_dwordx4 v7, s[40:43], s59 offen  lds
s_waitcnt vmcnt(17)
s_barrier
s_add_u32 m0, s31, 131072
s_add_u32 s59, s53, 114688
buffer_load_dwordx4 v4, s[40:43], s59 offen  lds
s_add_u32 m0, s31, 132096
s_add_u32 s59, s53, 118272
buffer_load_dwordx4 v7, s[40:43], s59 offen  lds
s_add_u32 m0, s31, 135168
s_add_u32 s59, s53, 143360
buffer_load_dwordx4 v4, s[40:43], s59 offen  lds
s_add_u32 m0, s31, 136192
s_add_u32 s59, s53, 146944
buffer_load_dwordx4 v7, s[40:43], s59 offen  lds
s_add_u32 m0, s31, 139264
s_add_u32 s59, s53, 172032
buffer_load_dwordx4 v4, s[40:43], s59 offen  lds
s_add_u32 m0, s31, 140288
s_add_u32 s59, s53, 175616
buffer_load_dwordx4 v7, s[40:43], s59 offen  lds
s_add_u32 m0, s31, 143360
s_add_u32 s59, s53, 200704
buffer_load_dwordx4 v4, s[40:43], s59 offen  lds
s_add_u32 m0, s31, 144384
s_add_u32 s59, s53, 204288
buffer_load_dwordx4 v7, s[40:43], s59 offen  lds
s_waitcnt vmcnt(17)
s_barrier
s_add_u32 m0, s31, 147456
s_add_u32 s59, s54, 0
buffer_load_dwordx4 v4, s[40:43], s59 offen  lds
s_add_u32 m0, s31, 148480
s_add_u32 s59, s54, 3584
buffer_load_dwordx4 v7, s[40:43], s59 offen  lds
s_add_u32 m0, s31, 151552
s_add_u32 s59, s54, 28672
buffer_load_dwordx4 v4, s[40:43], s59 offen  lds
s_add_u32 m0, s31, 152576
s_add_u32 s59, s54, 32256
buffer_load_dwordx4 v7, s[40:43], s59 offen  lds
s_add_u32 m0, s31, 155648
s_add_u32 s59, s54, 57344
buffer_load_dwordx4 v4, s[40:43], s59 offen  lds
s_add_u32 m0, s31, 156672
s_add_u32 s59, s54, 60928
buffer_load_dwordx4 v7, s[40:43], s59 offen  lds
s_waitcnt vmcnt(14)
s_barrier
s_add_u32 m0, s31, 159744
s_add_u32 s59, s54, 86016
buffer_load_dwordx4 v4, s[40:43], s59 offen  lds
s_add_u32 m0, s31, 160768
s_add_u32 s59, s54, 89600
buffer_load_dwordx4 v7, s[40:43], s59 offen  lds
s_add_u32 m0, s31, 65536
s_add_u32 s59, s54, 114688
buffer_load_dwordx4 v4, s[40:43], s59 offen  lds
s_add_u32 m0, s31, 66560
s_add_u32 s59, s54, 118272
buffer_load_dwordx4 v7, s[40:43], s59 offen  lds
s_add_u32 m0, s31, 69632
s_add_u32 s59, s54, 143360
buffer_load_dwordx4 v4, s[40:43], s59 offen  lds
s_add_u32 m0, s31, 70656
s_add_u32 s59, s54, 146944
buffer_load_dwordx4 v7, s[40:43], s59 offen  lds
s_add_u32 m0, s31, 73728
s_add_u32 s59, s54, 172032
buffer_load_dwordx4 v4, s[40:43], s59 offen  lds
s_add_u32 m0, s31, 74752
s_add_u32 s59, s54, 175616
buffer_load_dwordx4 v7, s[40:43], s59 offen  lds
s_waitcnt vmcnt(14)
s_barrier
s_add_u32 m0, s31, 77824
s_add_u32 s59, s54, 200704
buffer_load_dwordx4 v4, s[40:43], s59 offen  lds
s_add_u32 m0, s31, 78848
s_add_u32 s59, s54, 204288
buffer_load_dwordx4 v7, s[40:43], s59 offen  lds
s_add_u32 m0, s31, 81920
s_add_u32 s59, s55, 0
buffer_load_dwordx4 v4, s[40:43], s59 offen  lds
s_add_u32 m0, s31, 82944
s_add_u32 s59, s55, 3584
buffer_load_dwordx4 v7, s[40:43], s59 offen  lds
s_add_u32 m0, s31, 86016
s_add_u32 s59, s55, 28672
buffer_load_dwordx4 v4, s[40:43], s59 offen  lds
s_add_u32 m0, s31, 87040
s_add_u32 s59, s55, 32256
buffer_load_dwordx4 v7, s[40:43], s59 offen  lds
s_add_u32 m0, s31, 90112
s_add_u32 s59, s55, 57344
buffer_load_dwordx4 v4, s[40:43], s59 offen  lds
s_add_u32 m0, s31, 91136
s_add_u32 s59, s55, 60928
buffer_load_dwordx4 v7, s[40:43], s59 offen  lds
s_waitcnt vmcnt(14)
s_barrier
s_add_u32 m0, s31, 94208
s_add_u32 s59, s55, 86016
buffer_load_dwordx4 v4, s[40:43], s59 offen  lds
s_add_u32 m0, s31, 95232
s_add_u32 s59, s55, 89600
buffer_load_dwordx4 v7, s[40:43], s59 offen  lds
s_add_u32 m0, s31, 98304
s_add_u32 s59, s55, 114688
buffer_load_dwordx4 v4, s[40:43], s59 offen  lds
s_add_u32 m0, s31, 99328
s_add_u32 s59, s55, 118272
buffer_load_dwordx4 v7, s[40:43], s59 offen  lds
s_add_u32 m0, s31, 102400
s_add_u32 s59, s55, 143360
buffer_load_dwordx4 v4, s[40:43], s59 offen  lds
s_add_u32 m0, s31, 103424
s_add_u32 s59, s55, 146944
buffer_load_dwordx4 v7, s[40:43], s59 offen  lds
s_add_u32 m0, s31, 106496
s_add_u32 s59, s55, 172032
buffer_load_dwordx4 v4, s[40:43], s59 offen  lds
s_add_u32 m0, s31, 107520
s_add_u32 s59, s55, 175616
buffer_load_dwordx4 v7, s[40:43], s59 offen  lds
s_waitcnt vmcnt(14)
s_barrier
s_add_u32 m0, s31, 110592
s_add_u32 s59, s55, 200704
buffer_load_dwordx4 v4, s[40:43], s59 offen  lds
s_add_u32 m0, s31, 111616
s_add_u32 s59, s55, 204288
buffer_load_dwordx4 v7, s[40:43], s59 offen  lds
s_add_u32 m0, s31, 114688
s_add_u32 s59, s56, 0
buffer_load_dwordx4 v4, s[40:43], s59 offen  lds
s_add_u32 m0, s31, 115712
s_add_u32 s59, s56, 3584
buffer_load_dwordx4 v7, s[40:43], s59 offen  lds
s_add_u32 m0, s31, 118784
s_add_u32 s59, s56, 28672
buffer_load_dwordx4 v4, s[40:43], s59 offen  lds
s_add_u32 m0, s31, 119808
s_add_u32 s59, s56, 32256
buffer_load_dwordx4 v7, s[40:43], s59 offen  lds
s_add_u32 m0, s31, 122880
s_add_u32 s59, s56, 57344
buffer_load_dwordx4 v4, s[40:43], s59 offen  lds
s_add_u32 m0, s31, 123904
s_add_u32 s59, s56, 60928
buffer_load_dwordx4 v7, s[40:43], s59 offen  lds
s_waitcnt vmcnt(14)
s_barrier
s_add_u32 m0, s31, 126976
s_add_u32 s59, s56, 86016
buffer_load_dwordx4 v4, s[40:43], s59 offen  lds
s_add_u32 m0, s31, 128000
s_add_u32 s59, s56, 89600
buffer_load_dwordx4 v7, s[40:43], s59 offen  lds
s_add_u32 m0, s31, 131072
s_add_u32 s59, s56, 114688
buffer_load_dwordx4 v4, s[40:43], s59 offen  lds
s_add_u32 m0, s31, 132096
s_add_u32 s59, s56, 118272
buffer_load_dwordx4 v7, s[40:43], s59 offen  lds
s_add_u32 m0, s31, 135168
s_add_u32 s59, s56, 143360
buffer_load_dwordx4 v4, s[40:43], s59 offen  lds
s_add_u32 m0, s31, 136192
s_add_u32 s59, s56, 146944
buffer_load_dwordx4 v7, s[40:43], s59 offen  lds
s_add_u32 m0, s31, 139264
s_add_u32 s59, s56, 172032
buffer_load_dwordx4 v4, s[40:43], s59 offen  lds
s_add_u32 m0, s31, 140288
s_add_u32 s59, s56, 175616
buffer_load_dwordx4 v7, s[40:43], s59 offen  lds
s_waitcnt vmcnt(14)
s_barrier
s_add_u32 m0, s31, 143360
s_add_u32 s59, s56, 200704
buffer_load_dwordx4 v4, s[40:43], s59 offen  lds
s_add_u32 m0, s31, 144384
s_add_u32 s59, s56, 204288
buffer_load_dwordx4 v7, s[40:43], s59 offen  lds
s_mov_b32 s32, s8
s_and_b32 s33, s9, 0xffff
s_mov_b32 s34, 1835008
s_mov_b32 s35, 0x20000
s_mov_b32 s36, s28
s_and_b32 s37, s29, 0xffff
s_mov_b32 s38, 67108864
s_mov_b32 s39, 0x20000
s_mov_b64 s[0:1], s[22:23]
s_sub_u32 s57, s3, 4
s_cmp_gt_u32 s4, 3
s_subb_u32 s58, s4, 0
s_mul_i32 s61, s5, 7
s_add_u32 s61, s61, s58
s_lshl_b32 s60, s57, 8
s_add_u32 s60, s60, s61
s_lshl_b32 s60, s60, 7
s_add_u32 s60, s60, 23068672
s_add_u32 s48, s28, s60
s_addc_u32 s49, s29, 0
s_waitcnt lgkmcnt(0)
s_mov_b32 s26, s14
s_load_dwordx16 s[8:23], s[48:49], 0 glc
s_lshl_b32 s61, s61, 5
s_add_u32 s61, s61, s57
s_lshl_b32 s61, s61, 11
s_mul_i32 s60, s5, 0
s_add_u32 s61, s61, s60
s_add_u32 s61, s61, 6291456
s_lshl_b32 s58, s58, 7
s_and_b32 s60, s57, 1
s_lshl_b32 s60, s60, 6
s_add_u32 s58, s58, s60
s_lshr_b32 s27, s57, 1
s_lshl_b32 s60, s5, 1
s_add_u32 s60, s60, s27
s_mul_i32 s60, s60, 28672
s_add_u32 s60, s60, s58
v_lshrrev_b32 v41, 2, v0
v_and_b32 v39, 3, v0
v_mul_u32_u24 v36, 896, v41
v_lshl_add_u32 v36, v39, 4, v36
v_mul_u32_u24 v41, 80, v41
v_lshl_add_u32 v41, v39, 4, v41
v_bfe_u32 v37, v0, 5, 1
v_lshlrev_b32 v37, 3, v37
v_and_b32 v39, 31, v0
v_lshl_add_u32 v38, v39, 6, v37
v_lshl_add_u32 v40, v39, 4, v38
v_lshlrev_b32 v39, 4, v0
s_mul_i32 s27, s27, 30720
s_and_b32 s57, s57, 1
s_lshl_b32 s57, s57, 11
s_add_u32 s27, s27, s57
s_add_u32 s57, s57, s27
s_add_u32 s57, s57, 20480
s_add_u32 s27, s27, 28672
v_add_u32 v33, s57, v39
v_add_u32 v40, s57, v40
v_add_u32 v41, s57, v41
v_add_u32 v38, s27, v38
v_and_b32 v43, 15, v0
v_lshl_add_u32 v43, v37, 1, v43
v_mul_u32_u24 v43, 0x9e3a, v43
v_or_b32 v43, 1, v43
v_mov_b32 v34, s26
s_waitcnt vmcnt(8)
s_barrier
s_mov_b32 s40, s0
s_and_b32 s41, s1, 0xffff
s_mov_b32 s42, 896
s_mov_b32 s43, 0x20000
s_mov_b32 s44, s24
s_and_b32 s45, s25, 0xffff
s_mov_b32 s46, 1835008
s_mov_b32 s47, 0x20000
s_add_u32 s57, s60, 14336
s_add_u32 m0, s27, 0
s_nop 0
buffer_load_dwordx4 v36, s[32:35], s60 offen lds
buffer_load_dwordx2 v[136:137], v37, s[40:43], s58 offen offset:0
buffer_load_dwordx2 v[138:139], v37, s[40:43], s58 offen offset:32
s_add_u32 m0, s27, 1024
s_nop 0
buffer_load_dwordx4 v36, s[32:35], s57 offen lds
buffer_load_dwordx2 v[140:141], v37, s[40:43], s58 offen offset:16
buffer_load_dwordx2 v[142:143], v37, s[40:43], s58 offen offset:48
s_load_dwordx16 s[8:23], s[48:49], 0 glc
s_add_u32 s50, s61, 0
s_add_u32 s51, s61, 8192
s_add_u32 s52, s61, 16384
s_add_u32 s53, s61, 24576
s_add_u32 s54, s61, 32768
s_add_u32 s55, s61, 40960
s_add_u32 s56, s61, 49152
v_mov_b32 v35, 0x3f80
v_mov_b32 v15, 1.0
v_mov_b32 v32, 0
s_waitcnt vmcnt(6)
s_barrier
s_waitcnt vmcnt(6)
s_barrier
s_branch gather_N
.p2align 6
comp_N:
s_lshl_b32 s59, s31, 11
s_sub_u32 s60, 2048, s59
v_add_u32 v10, s60, v10
v_and_b32 v25, 15, v0
v_lshrrev_b32 v1, 4, v0
v_lshlrev_b32 v20, 9, v1
v_lshl_add_u32 v20, v25, 4, v20
v_subrev_u32 v25, 12, v25
v_ashrrev_i32 v25, 31, v25
v_bfe_i32 v63, v0, 4, 1
v_not_b32 v62, v63
v_sub_u32 v61, 47, v0
v_ashrrev_i32 v61, 31, v61
s_mov_b32 s56, 0x3fb8aa3b
s_mov_b32 s57, 0x358637bd
s_mov_b32 s36, s28
s_and_b32 s37, s29, 0xffff
s_mov_b32 s38, 67108864
s_mov_b32 s39, 0x20000
s_and_b32 s59, s4, 6
s_add_u32 s59, s59, s31
s_lshl_b32 s59, s59, 1
s_lshl_b32 s59, s59, 5
s_add_u32 s59, s59, s5
s_lshl_b32 s59, s59, 1
s_add_u32 s59, s59, s30
s_lshl_b32 s59, s59, 11
s_add_u32 s59, s59, 1048576
s_add_u32 s60, s59, 131072
s_waitcnt lgkmcnt(0)
s_barrier
ds_read_b128 v[64:67], v9 offset:0
ds_read_b128 v[68:71], v9 offset:256
ds_read_b64_tr_b16 v[36:37], v28 offset:0
ds_read_b64_tr_b16 v[38:39], v28 offset:256
ds_read_b64_tr_b16 v[40:41], v30 offset:0
ds_read_b64_tr_b16 v[42:43], v30 offset:256
ds_read_b64_tr_b16 v[44:45], v32 offset:0
ds_read_b64_tr_b16 v[46:47], v32 offset:256
ds_read_b64_tr_b16 v[48:49], v34 offset:0
ds_read_b64_tr_b16 v[50:51], v34 offset:256
s_waitcnt lgkmcnt(6)
v_mfma_f32_16x16x32_bf16 v[176:179], v[64:67], v[36:39], 0
ds_read_b128 v[72:75], v9 offset:2112
ds_read_b128 v[76:79], v9 offset:2368
ds_read_b64_tr_b16 v[52:53], v28 offset:8192
ds_read_b64_tr_b16 v[54:55], v28 offset:8448
v_mfma_f32_16x16x32_bf16 v[180:183], v[68:71], v[36:39], 0
s_waitcnt lgkmcnt(6)
v_mfma_f32_16x16x32_bf16 v[184:187], v[64:67], v[40:43], 0
ds_read_b64_tr_b16 v[36:37], v30 offset:8192
ds_read_b64_tr_b16 v[38:39], v30 offset:8448
v_mfma_f32_16x16x32_bf16 v[188:191], v[68:71], v[40:43], 0
v_mfma_f32_16x16x32_bf16 v[208:211], v[64:67], v[44:47], 0
ds_read_b64_tr_b16 v[40:41], v32 offset:8192
ds_read_b64_tr_b16 v[42:43], v32 offset:8448
v_mfma_f32_16x16x32_bf16 v[212:215], v[68:71], v[44:47], 0
s_waitcnt lgkmcnt(4)
v_mfma_f32_16x16x32_bf16 v[216:219], v[64:67], v[48:51], 0
ds_read_b64_tr_b16 v[44:45], v34 offset:8192
ds_read_b64_tr_b16 v[46:47], v34 offset:8448
v_mfma_f32_16x16x32_bf16 v[220:223], v[68:71], v[48:51], 0
v_mfma_f32_16x16x32_bf16 v[176:179], v[72:75], v[52:55], v[176:179]
s_barrier
ds_read_b128 v[80:83], v9 offset:4224
ds_read_b128 v[84:87], v9 offset:4480
ds_read_b64_tr_b16 v[48:49], v28 offset:16384
ds_read_b64_tr_b16 v[50:51], v28 offset:16640
v_mfma_f32_16x16x32_bf16 v[180:183], v[76:79], v[52:55], v[180:183]
s_waitcnt lgkmcnt(6)
v_mfma_f32_16x16x32_bf16 v[184:187], v[72:75], v[36:39], v[184:187]
ds_read_b64_tr_b16 v[52:53], v30 offset:16384
ds_read_b64_tr_b16 v[54:55], v30 offset:16640
v_mfma_f32_16x16x32_bf16 v[188:191], v[76:79], v[36:39], v[188:191]
v_mfma_f32_16x16x32_bf16 v[208:211], v[72:75], v[40:43], v[208:211]
ds_read_b64_tr_b16 v[36:37], v32 offset:16384
ds_read_b64_tr_b16 v[38:39], v32 offset:16640
v_mfma_f32_16x16x32_bf16 v[212:215], v[76:79], v[40:43], v[212:215]
s_waitcnt lgkmcnt(4)
v_mfma_f32_16x16x32_bf16 v[216:219], v[72:75], v[44:47], v[216:219]
ds_read_b64_tr_b16 v[40:41], v34 offset:16384
ds_read_b64_tr_b16 v[42:43], v34 offset:16640
v_mfma_f32_16x16x32_bf16 v[220:223], v[76:79], v[44:47], v[220:223]
v_mfma_f32_16x16x32_bf16 v[176:179], v[80:83], v[48:51], v[176:179]
ds_read_b128 v[88:91], v9 offset:6336
ds_read_b128 v[92:95], v9 offset:6592
ds_read_b64_tr_b16 v[44:45], v28 offset:24576
ds_read_b64_tr_b16 v[46:47], v28 offset:24832
v_mfma_f32_16x16x32_bf16 v[180:183], v[84:87], v[48:51], v[180:183]
s_waitcnt lgkmcnt(6)
v_mfma_f32_16x16x32_bf16 v[184:187], v[80:83], v[52:55], v[184:187]
ds_read_b64_tr_b16 v[48:49], v30 offset:24576
ds_read_b64_tr_b16 v[50:51], v30 offset:24832
v_mfma_f32_16x16x32_bf16 v[188:191], v[84:87], v[52:55], v[188:191]
v_mfma_f32_16x16x32_bf16 v[208:211], v[80:83], v[36:39], v[208:211]
ds_read_b64_tr_b16 v[52:53], v32 offset:24576
ds_read_b64_tr_b16 v[54:55], v32 offset:24832
v_mfma_f32_16x16x32_bf16 v[212:215], v[84:87], v[36:39], v[212:215]
s_waitcnt lgkmcnt(4)
v_mfma_f32_16x16x32_bf16 v[216:219], v[80:83], v[40:43], v[216:219]
ds_read_b64_tr_b16 v[36:37], v34 offset:24576
ds_read_b64_tr_b16 v[38:39], v34 offset:24832
v_mfma_f32_16x16x32_bf16 v[220:223], v[84:87], v[40:43], v[220:223]
v_mfma_f32_16x16x32_bf16 v[176:179], v[88:91], v[44:47], v[176:179]
s_barrier
ds_read_b128 v[96:99], v9 offset:8448
ds_read_b128 v[100:103], v9 offset:8704
ds_read_b64_tr_b16 v[40:41], v28 offset:32768
ds_read_b64_tr_b16 v[42:43], v28 offset:33024
v_mfma_f32_16x16x32_bf16 v[180:183], v[92:95], v[44:47], v[180:183]
s_waitcnt lgkmcnt(6)
v_mfma_f32_16x16x32_bf16 v[184:187], v[88:91], v[48:51], v[184:187]
ds_read_b64_tr_b16 v[44:45], v30 offset:32768
ds_read_b64_tr_b16 v[46:47], v30 offset:33024
v_mfma_f32_16x16x32_bf16 v[188:191], v[92:95], v[48:51], v[188:191]
v_mfma_f32_16x16x32_bf16 v[208:211], v[88:91], v[52:55], v[208:211]
ds_read_b64_tr_b16 v[48:49], v32 offset:32768
ds_read_b64_tr_b16 v[50:51], v32 offset:33024
v_mfma_f32_16x16x32_bf16 v[212:215], v[92:95], v[52:55], v[212:215]
s_waitcnt lgkmcnt(4)
v_mfma_f32_16x16x32_bf16 v[216:219], v[88:91], v[36:39], v[216:219]
ds_read_b64_tr_b16 v[52:53], v34 offset:32768
ds_read_b64_tr_b16 v[54:55], v34 offset:33024
v_mfma_f32_16x16x32_bf16 v[220:223], v[92:95], v[36:39], v[220:223]
v_mfma_f32_16x16x32_bf16 v[176:179], v[96:99], v[40:43], v[176:179]
ds_read_b128 v[104:107], v9 offset:10560
ds_read_b128 v[108:111], v9 offset:10816
ds_read_b64_tr_b16 v[36:37], v28 offset:40960
ds_read_b64_tr_b16 v[38:39], v28 offset:41216
v_mfma_f32_16x16x32_bf16 v[180:183], v[100:103], v[40:43], v[180:183]
s_waitcnt lgkmcnt(6)
v_mfma_f32_16x16x32_bf16 v[184:187], v[96:99], v[44:47], v[184:187]
ds_read_b64_tr_b16 v[40:41], v30 offset:40960
ds_read_b64_tr_b16 v[42:43], v30 offset:41216
v_mfma_f32_16x16x32_bf16 v[188:191], v[100:103], v[44:47], v[188:191]
v_mfma_f32_16x16x32_bf16 v[208:211], v[96:99], v[48:51], v[208:211]
ds_read_b64_tr_b16 v[44:45], v32 offset:40960
ds_read_b64_tr_b16 v[46:47], v32 offset:41216
v_mfma_f32_16x16x32_bf16 v[212:215], v[100:103], v[48:51], v[212:215]
s_waitcnt lgkmcnt(4)
v_mfma_f32_16x16x32_bf16 v[216:219], v[96:99], v[52:55], v[216:219]
ds_read_b64_tr_b16 v[48:49], v34 offset:40960
ds_read_b64_tr_b16 v[50:51], v34 offset:41216
v_mfma_f32_16x16x32_bf16 v[220:223], v[100:103], v[52:55], v[220:223]
v_mfma_f32_16x16x32_bf16 v[176:179], v[104:107], v[36:39], v[176:179]
s_barrier
ds_read_b128 v[112:115], v9 offset:12672
ds_read_b128 v[116:119], v9 offset:12928
ds_read_b64_tr_b16 v[52:53], v28 offset:49152
ds_read_b64_tr_b16 v[54:55], v28 offset:49408
v_mfma_f32_16x16x32_bf16 v[180:183], v[108:111], v[36:39], v[180:183]
s_waitcnt lgkmcnt(6)
v_mfma_f32_16x16x32_bf16 v[184:187], v[104:107], v[40:43], v[184:187]
ds_read_b64_tr_b16 v[36:37], v30 offset:49152
ds_read_b64_tr_b16 v[38:39], v30 offset:49408
v_mfma_f32_16x16x32_bf16 v[188:191], v[108:111], v[40:43], v[188:191]
v_mfma_f32_16x16x32_bf16 v[208:211], v[104:107], v[44:47], v[208:211]
ds_read_b64_tr_b16 v[40:41], v32 offset:49152
ds_read_b64_tr_b16 v[42:43], v32 offset:49408
v_mfma_f32_16x16x32_bf16 v[212:215], v[108:111], v[44:47], v[212:215]
s_waitcnt lgkmcnt(4)
v_mfma_f32_16x16x32_bf16 v[216:219], v[104:107], v[48:51], v[216:219]
ds_read_b64_tr_b16 v[44:45], v34 offset:49152
ds_read_b64_tr_b16 v[46:47], v34 offset:49408
v_mfma_f32_16x16x32_bf16 v[220:223], v[108:111], v[48:51], v[220:223]
v_mfma_f32_16x16x32_bf16 v[176:179], v[112:115], v[52:55], v[176:179]
ds_read_b128 v[120:123], v9 offset:14784
ds_read_b128 v[124:127], v9 offset:15040
ds_read_b64_tr_b16 v[48:49], v28 offset:57344
ds_read_b64_tr_b16 v[50:51], v28 offset:57600
v_mfma_f32_16x16x32_bf16 v[180:183], v[116:119], v[52:55], v[180:183]
s_waitcnt lgkmcnt(6)
v_mfma_f32_16x16x32_bf16 v[184:187], v[112:115], v[36:39], v[184:187]
ds_read_b64_tr_b16 v[52:53], v30 offset:57344
ds_read_b64_tr_b16 v[54:55], v30 offset:57600
v_mfma_f32_16x16x32_bf16 v[188:191], v[116:119], v[36:39], v[188:191]
v_mfma_f32_16x16x32_bf16 v[208:211], v[112:115], v[40:43], v[208:211]
ds_read_b64_tr_b16 v[36:37], v32 offset:57344
ds_read_b64_tr_b16 v[38:39], v32 offset:57600
v_mfma_f32_16x16x32_bf16 v[212:215], v[116:119], v[40:43], v[212:215]
s_waitcnt lgkmcnt(4)
v_mfma_f32_16x16x32_bf16 v[216:219], v[112:115], v[44:47], v[216:219]
ds_read_b64_tr_b16 v[40:41], v34 offset:57344
ds_read_b64_tr_b16 v[42:43], v34 offset:57600
v_mfma_f32_16x16x32_bf16 v[220:223], v[116:119], v[44:47], v[220:223]
v_mfma_f32_16x16x32_bf16 v[176:179], v[120:123], v[48:51], v[176:179]
s_barrier
ds_read_b128 v[128:131], v9 offset:16896
ds_read_b128 v[132:135], v9 offset:17152
ds_read_b64_tr_b16 v[44:45], v29 offset:0
ds_read_b64_tr_b16 v[46:47], v29 offset:256
v_mfma_f32_16x16x32_bf16 v[180:183], v[124:127], v[48:51], v[180:183]
s_waitcnt lgkmcnt(6)
v_mfma_f32_16x16x32_bf16 v[184:187], v[120:123], v[52:55], v[184:187]
ds_read_b64_tr_b16 v[48:49], v31 offset:0
ds_read_b64_tr_b16 v[50:51], v31 offset:256
v_mfma_f32_16x16x32_bf16 v[188:191], v[124:127], v[52:55], v[188:191]
v_mfma_f32_16x16x32_bf16 v[208:211], v[120:123], v[36:39], v[208:211]
ds_read_b64_tr_b16 v[52:53], v33 offset:0
ds_read_b64_tr_b16 v[54:55], v33 offset:256
v_mfma_f32_16x16x32_bf16 v[212:215], v[124:127], v[36:39], v[212:215]
s_waitcnt lgkmcnt(4)
v_mfma_f32_16x16x32_bf16 v[216:219], v[120:123], v[40:43], v[216:219]
ds_read_b64_tr_b16 v[36:37], v35 offset:0
ds_read_b64_tr_b16 v[38:39], v35 offset:256
v_mfma_f32_16x16x32_bf16 v[220:223], v[124:127], v[40:43], v[220:223]
v_mfma_f32_16x16x32_bf16 v[176:179], v[128:131], v[44:47], v[176:179]
ds_read_b128 v[136:139], v9 offset:19008
ds_read_b128 v[140:143], v9 offset:19264
ds_read_b64_tr_b16 v[40:41], v29 offset:8192
ds_read_b64_tr_b16 v[42:43], v29 offset:8448
v_mfma_f32_16x16x32_bf16 v[180:183], v[132:135], v[44:47], v[180:183]
s_waitcnt lgkmcnt(6)
v_mfma_f32_16x16x32_bf16 v[184:187], v[128:131], v[48:51], v[184:187]
ds_read_b64_tr_b16 v[44:45], v31 offset:8192
ds_read_b64_tr_b16 v[46:47], v31 offset:8448
v_mfma_f32_16x16x32_bf16 v[188:191], v[132:135], v[48:51], v[188:191]
v_mfma_f32_16x16x32_bf16 v[208:211], v[128:131], v[52:55], v[208:211]
ds_read_b64_tr_b16 v[48:49], v33 offset:8192
ds_read_b64_tr_b16 v[50:51], v33 offset:8448
v_mfma_f32_16x16x32_bf16 v[212:215], v[132:135], v[52:55], v[212:215]
s_waitcnt lgkmcnt(4)
v_mfma_f32_16x16x32_bf16 v[216:219], v[128:131], v[36:39], v[216:219]
ds_read_b64_tr_b16 v[52:53], v35 offset:8192
ds_read_b64_tr_b16 v[54:55], v35 offset:8448
v_mfma_f32_16x16x32_bf16 v[220:223], v[132:135], v[36:39], v[220:223]
v_mfma_f32_16x16x32_bf16 v[176:179], v[136:139], v[40:43], v[176:179]
s_barrier
ds_read_b128 v[144:147], v9 offset:21120
ds_read_b128 v[148:151], v9 offset:21376
ds_read_b64_tr_b16 v[36:37], v29 offset:16384
ds_read_b64_tr_b16 v[38:39], v29 offset:16640
v_mfma_f32_16x16x32_bf16 v[180:183], v[140:143], v[40:43], v[180:183]
s_waitcnt lgkmcnt(6)
v_mfma_f32_16x16x32_bf16 v[184:187], v[136:139], v[44:47], v[184:187]
ds_read_b64_tr_b16 v[40:41], v31 offset:16384
ds_read_b64_tr_b16 v[42:43], v31 offset:16640
v_mfma_f32_16x16x32_bf16 v[188:191], v[140:143], v[44:47], v[188:191]
v_mfma_f32_16x16x32_bf16 v[208:211], v[136:139], v[48:51], v[208:211]
ds_read_b64_tr_b16 v[44:45], v33 offset:16384
ds_read_b64_tr_b16 v[46:47], v33 offset:16640
v_mfma_f32_16x16x32_bf16 v[212:215], v[140:143], v[48:51], v[212:215]
s_waitcnt lgkmcnt(4)
v_mfma_f32_16x16x32_bf16 v[216:219], v[136:139], v[52:55], v[216:219]
ds_read_b64_tr_b16 v[48:49], v35 offset:16384
ds_read_b64_tr_b16 v[50:51], v35 offset:16640
v_mfma_f32_16x16x32_bf16 v[220:223], v[140:143], v[52:55], v[220:223]
v_mfma_f32_16x16x32_bf16 v[176:179], v[144:147], v[36:39], v[176:179]
ds_read_b128 v[152:155], v9 offset:23232
ds_read_b128 v[156:159], v9 offset:23488
ds_read_b64_tr_b16 v[52:53], v29 offset:24576
ds_read_b64_tr_b16 v[54:55], v29 offset:24832
v_mfma_f32_16x16x32_bf16 v[180:183], v[148:151], v[36:39], v[180:183]
s_waitcnt lgkmcnt(6)
v_mfma_f32_16x16x32_bf16 v[184:187], v[144:147], v[40:43], v[184:187]
ds_read_b64_tr_b16 v[36:37], v31 offset:24576
ds_read_b64_tr_b16 v[38:39], v31 offset:24832
v_mfma_f32_16x16x32_bf16 v[188:191], v[148:151], v[40:43], v[188:191]
v_mfma_f32_16x16x32_bf16 v[208:211], v[144:147], v[44:47], v[208:211]
ds_read_b64_tr_b16 v[40:41], v33 offset:24576
ds_read_b64_tr_b16 v[42:43], v33 offset:24832
v_mfma_f32_16x16x32_bf16 v[212:215], v[148:151], v[44:47], v[212:215]
s_waitcnt lgkmcnt(4)
v_mfma_f32_16x16x32_bf16 v[216:219], v[144:147], v[48:51], v[216:219]
ds_read_b64_tr_b16 v[44:45], v35 offset:24576
ds_read_b64_tr_b16 v[46:47], v35 offset:24832
v_mfma_f32_16x16x32_bf16 v[220:223], v[148:151], v[48:51], v[220:223]
v_mfma_f32_16x16x32_bf16 v[176:179], v[152:155], v[52:55], v[176:179]
s_barrier
ds_read_b128 v[160:163], v9 offset:25344
ds_read_b128 v[164:167], v9 offset:25600
ds_read_b64_tr_b16 v[48:49], v28 offset:0
ds_read_b64_tr_b16 v[50:51], v28 offset:256
v_mfma_f32_16x16x32_bf16 v[180:183], v[156:159], v[52:55], v[180:183]
s_waitcnt lgkmcnt(6)
s_waitcnt vmcnt(2)
v_lshl_or_b32 v4, v57, 16, v56
s_waitcnt vmcnt(0)
v_lshl_or_b32 v5, v59, 16, v58
v_mfma_f32_16x16x32_bf16 v[184:187], v[152:155], v[36:39], v[184:187]
ds_read_b64_tr_b16 v[52:53], v30 offset:0
ds_read_b64_tr_b16 v[54:55], v30 offset:256
v_mfma_f32_16x16x32_bf16 v[188:191], v[156:159], v[36:39], v[188:191]
v_mfma_f32_16x16x32_bf16 v[208:211], v[152:155], v[40:43], v[208:211]
ds_read_b64_tr_b16 v[36:37], v32 offset:0
ds_read_b64_tr_b16 v[38:39], v32 offset:256
v_mfma_f32_16x16x32_bf16 v[212:215], v[156:159], v[40:43], v[212:215]
s_waitcnt lgkmcnt(4)
v_mov_b32 v7, 0
v_and_b32 v6, 0x3f80, v62
v_mfma_f32_16x16x32_bf16 v[216:219], v[152:155], v[44:47], v[216:219]
ds_read_b64_tr_b16 v[40:41], v34 offset:0
ds_read_b64_tr_b16 v[42:43], v34 offset:256
v_mfma_f32_16x16x32_bf16 v[220:223], v[156:159], v[44:47], v[220:223]
v_mfma_f32_16x16x32_bf16 v[176:179], v[160:163], v[48:51], v[176:179]
ds_read_b128 v[168:171], v9 offset:27456
ds_read_b128 v[172:175], v9 offset:27712
ds_read_b64_tr_b16 v[44:45], v28 offset:8192
ds_read_b64_tr_b16 v[46:47], v28 offset:8448
v_mfma_f32_16x16x32_bf16 v[180:183], v[164:167], v[48:51], v[180:183]
s_waitcnt lgkmcnt(6)
v_mfma_f32_16x16x16_bf16 v[240:243], v[4:5], v[6:7], 0
v_mfma_f32_16x16x16_bf16 v[248:251], v[4:5], v[6:7], 0
v_mfma_f32_16x16x32_bf16 v[184:187], v[160:163], v[52:55], v[184:187]
ds_read_b64_tr_b16 v[48:49], v30 offset:8192
ds_read_b64_tr_b16 v[50:51], v30 offset:8448
v_mfma_f32_16x16x32_bf16 v[188:191], v[164:167], v[52:55], v[188:191]
v_and_b32 v6, 0x3f80, v63
v_mfma_f32_16x16x32_bf16 v[208:211], v[160:163], v[36:39], v[208:211]
ds_read_b64_tr_b16 v[52:53], v32 offset:8192
ds_read_b64_tr_b16 v[54:55], v32 offset:8448
v_mfma_f32_16x16x32_bf16 v[212:215], v[164:167], v[36:39], v[212:215]
s_waitcnt lgkmcnt(4)
v_mfma_f32_16x16x16_bf16 v[244:247], v[4:5], v[6:7], 0
v_mfma_f32_16x16x16_bf16 v[252:255], v[4:5], v[6:7], 0
v_mfma_f32_16x16x32_bf16 v[216:219], v[160:163], v[40:43], v[216:219]
ds_read_b64_tr_b16 v[36:37], v34 offset:8192
ds_read_b64_tr_b16 v[38:39], v34 offset:8448
v_mfma_f32_16x16x32_bf16 v[220:223], v[164:167], v[40:43], v[220:223]
v_mfma_f32_16x16x32_bf16 v[176:179], v[168:171], v[44:47], v[176:179]
s_barrier
ds_read_b64_tr_b16 v[40:41], v28 offset:16384
ds_read_b64_tr_b16 v[42:43], v28 offset:16640
v_mfma_f32_16x16x32_bf16 v[180:183], v[172:175], v[44:47], v[180:183]
s_waitcnt lgkmcnt(4)
v_mfma_f32_16x16x32_bf16 v[184:187], v[168:171], v[48:51], v[184:187]
ds_read_b64_tr_b16 v[44:45], v30 offset:16384
ds_read_b64_tr_b16 v[46:47], v30 offset:16640
v_mfma_f32_16x16x32_bf16 v[188:191], v[172:175], v[48:51], v[188:191]
v_mfma_f32_16x16x32_bf16 v[208:211], v[168:171], v[52:55], v[208:211]
ds_read_b64_tr_b16 v[48:49], v32 offset:16384
ds_read_b64_tr_b16 v[50:51], v32 offset:16640
v_mfma_f32_16x16x32_bf16 v[212:215], v[172:175], v[52:55], v[212:215]
s_waitcnt lgkmcnt(4)
v_mfma_f32_16x16x32_bf16 v[216:219], v[168:171], v[36:39], v[216:219]
ds_read_b64_tr_b16 v[52:53], v34 offset:16384
ds_read_b64_tr_b16 v[54:55], v34 offset:16640
v_mfma_f32_16x16x32_bf16 v[220:223], v[172:175], v[36:39], v[220:223]
v_mfma_f32_16x16x32_bf16 v[192:195], v[64:67], v[40:43], 0
ds_read_b64_tr_b16 v[36:37], v28 offset:24576
ds_read_b64_tr_b16 v[38:39], v28 offset:24832
v_mfma_f32_16x16x32_bf16 v[196:199], v[68:71], v[40:43], 0
s_waitcnt lgkmcnt(4)
v_mfma_f32_16x16x32_bf16 v[200:203], v[64:67], v[44:47], 0
ds_read_b64_tr_b16 v[40:41], v30 offset:24576
ds_read_b64_tr_b16 v[42:43], v30 offset:24832
v_mfma_f32_16x16x32_bf16 v[204:207], v[68:71], v[44:47], 0
v_mul_f32 v56, s56, v176
v_mul_f32 v57, s56, v177
v_mul_f32 v58, s56, v178
v_mfma_f32_16x16x32_bf16 v[224:227], v[64:67], v[48:51], 0
ds_read_b64_tr_b16 v[44:45], v32 offset:24576
ds_read_b64_tr_b16 v[46:47], v32 offset:24832
v_mfma_f32_16x16x32_bf16 v[228:231], v[68:71], v[48:51], 0
s_waitcnt lgkmcnt(4)
v_mul_f32 v59, s56, v179
v_exp_f32 v56, v56 clamp
v_mfma_f32_16x16x32_bf16 v[232:235], v[64:67], v[52:55], 0
ds_read_b64_tr_b16 v[48:49], v34 offset:24576
ds_read_b64_tr_b16 v[50:51], v34 offset:24832
v_mfma_f32_16x16x32_bf16 v[236:239], v[68:71], v[52:55], 0
v_max_f32 v176, s57, v176
v_exp_f32 v57, v57 clamp
v_mfma_f32_16x16x32_bf16 v[192:195], v[72:75], v[36:39], v[192:195]
s_barrier
ds_read_b64_tr_b16 v[52:53], v28 offset:32768
ds_read_b64_tr_b16 v[54:55], v28 offset:33024
v_mfma_f32_16x16x32_bf16 v[196:199], v[76:79], v[36:39], v[196:199]
s_waitcnt lgkmcnt(4)
v_max_f32 v177, s57, v177
v_exp_f32 v58, v58 clamp
v_mfma_f32_16x16x32_bf16 v[200:203], v[72:75], v[40:43], v[200:203]
ds_read_b64_tr_b16 v[36:37], v30 offset:32768
ds_read_b64_tr_b16 v[38:39], v30 offset:33024
v_mfma_f32_16x16x32_bf16 v[204:207], v[76:79], v[40:43], v[204:207]
v_max_f32 v178, s57, v178
v_exp_f32 v59, v59 clamp
v_mfma_f32_16x16x32_bf16 v[224:227], v[72:75], v[44:47], v[224:227]
ds_read_b64_tr_b16 v[40:41], v32 offset:32768
ds_read_b64_tr_b16 v[42:43], v32 offset:33024
v_mfma_f32_16x16x32_bf16 v[228:231], v[76:79], v[44:47], v[228:231]
s_waitcnt lgkmcnt(4)
v_max_f32 v179, s57, v179
v_add_f32 v176, v176, v56
v_add_f32 v177, v177, v57
v_mfma_f32_16x16x32_bf16 v[232:235], v[72:75], v[48:51], v[232:235]
ds_read_b64_tr_b16 v[44:45], v34 offset:32768
ds_read_b64_tr_b16 v[46:47], v34 offset:33024
v_mfma_f32_16x16x32_bf16 v[236:239], v[76:79], v[48:51], v[236:239]
v_add_f32 v178, v178, v58
v_add_f32 v179, v179, v59
v_cvt_pk_bf16_f32 v176, v176, v177
v_mfma_f32_16x16x32_bf16 v[192:195], v[80:83], v[52:55], v[192:195]
ds_read_b64_tr_b16 v[48:49], v28 offset:40960
ds_read_b64_tr_b16 v[50:51], v28 offset:41216
v_mfma_f32_16x16x32_bf16 v[196:199], v[84:87], v[52:55], v[196:199]
s_waitcnt lgkmcnt(4)
v_cvt_pk_bf16_f32 v177, v178, v179
v_mul_f32 v56, s56, v180
v_mul_f32 v57, s56, v181
v_mfma_f32_16x16x32_bf16 v[200:203], v[80:83], v[36:39], v[200:203]
ds_read_b64_tr_b16 v[52:53], v30 offset:40960
ds_read_b64_tr_b16 v[54:55], v30 offset:41216
v_mfma_f32_16x16x32_bf16 v[204:207], v[84:87], v[36:39], v[204:207]
v_mul_f32 v58, s56, v182
v_mul_f32 v59, s56, v183
v_exp_f32 v56, v56 clamp
v_mfma_f32_16x16x32_bf16 v[224:227], v[80:83], v[40:43], v[224:227]
ds_read_b64_tr_b16 v[36:37], v32 offset:40960
ds_read_b64_tr_b16 v[38:39], v32 offset:41216
v_mfma_f32_16x16x32_bf16 v[228:231], v[84:87], v[40:43], v[228:231]
s_waitcnt lgkmcnt(4)
v_max_f32 v180, s57, v180
v_exp_f32 v57, v57 clamp
v_mfma_f32_16x16x32_bf16 v[232:235], v[80:83], v[44:47], v[232:235]
ds_read_b64_tr_b16 v[40:41], v34 offset:40960
ds_read_b64_tr_b16 v[42:43], v34 offset:41216
v_mfma_f32_16x16x32_bf16 v[236:239], v[84:87], v[44:47], v[236:239]
v_max_f32 v181, s57, v181
v_exp_f32 v58, v58 clamp
v_mfma_f32_16x16x32_bf16 v[192:195], v[88:91], v[48:51], v[192:195]
s_barrier
ds_read_b64_tr_b16 v[44:45], v28 offset:49152
ds_read_b64_tr_b16 v[46:47], v28 offset:49408
v_mfma_f32_16x16x32_bf16 v[196:199], v[92:95], v[48:51], v[196:199]
s_waitcnt lgkmcnt(4)
v_max_f32 v182, s57, v182
v_exp_f32 v59, v59 clamp
v_mfma_f32_16x16x32_bf16 v[200:203], v[88:91], v[52:55], v[200:203]
ds_read_b64_tr_b16 v[48:49], v30 offset:49152
ds_read_b64_tr_b16 v[50:51], v30 offset:49408
v_mfma_f32_16x16x32_bf16 v[204:207], v[92:95], v[52:55], v[204:207]
v_max_f32 v183, s57, v183
v_add_f32 v180, v180, v56
v_add_f32 v181, v181, v57
v_mfma_f32_16x16x32_bf16 v[224:227], v[88:91], v[36:39], v[224:227]
ds_read_b64_tr_b16 v[52:53], v32 offset:49152
ds_read_b64_tr_b16 v[54:55], v32 offset:49408
v_mfma_f32_16x16x32_bf16 v[228:231], v[92:95], v[36:39], v[228:231]
s_waitcnt lgkmcnt(4)
v_add_f32 v182, v182, v58
v_add_f32 v183, v183, v59
v_cvt_pk_bf16_f32 v178, v180, v181
v_mfma_f32_16x16x32_bf16 v[232:235], v[88:91], v[40:43], v[232:235]
ds_read_b64_tr_b16 v[36:37], v34 offset:49152
ds_read_b64_tr_b16 v[38:39], v34 offset:49408
v_mfma_f32_16x16x32_bf16 v[236:239], v[92:95], v[40:43], v[236:239]
v_cvt_pk_bf16_f32 v179, v182, v183
v_mul_f32 v56, s56, v184
v_mul_f32 v57, s56, v185
v_mfma_f32_16x16x32_bf16 v[192:195], v[96:99], v[44:47], v[192:195]
ds_read_b64_tr_b16 v[40:41], v28 offset:57344
ds_read_b64_tr_b16 v[42:43], v28 offset:57600
v_mfma_f32_16x16x32_bf16 v[196:199], v[100:103], v[44:47], v[196:199]
s_waitcnt lgkmcnt(4)
v_mul_f32 v58, s56, v186
v_mul_f32 v59, s56, v187
v_exp_f32 v56, v56 clamp
v_mfma_f32_16x16x32_bf16 v[200:203], v[96:99], v[48:51], v[200:203]
ds_read_b64_tr_b16 v[44:45], v30 offset:57344
ds_read_b64_tr_b16 v[46:47], v30 offset:57600
v_mfma_f32_16x16x32_bf16 v[204:207], v[100:103], v[48:51], v[204:207]
v_max_f32 v184, s57, v184
v_exp_f32 v57, v57 clamp
v_mfma_f32_16x16x32_bf16 v[224:227], v[96:99], v[52:55], v[224:227]
ds_read_b64_tr_b16 v[48:49], v32 offset:57344
ds_read_b64_tr_b16 v[50:51], v32 offset:57600
v_mfma_f32_16x16x32_bf16 v[228:231], v[100:103], v[52:55], v[228:231]
s_waitcnt lgkmcnt(4)
v_max_f32 v185, s57, v185
v_exp_f32 v58, v58 clamp
v_mfma_f32_16x16x32_bf16 v[232:235], v[96:99], v[36:39], v[232:235]
ds_read_b64_tr_b16 v[52:53], v34 offset:57344
ds_read_b64_tr_b16 v[54:55], v34 offset:57600
v_mfma_f32_16x16x32_bf16 v[236:239], v[100:103], v[36:39], v[236:239]
v_max_f32 v186, s57, v186
v_exp_f32 v59, v59 clamp
v_mfma_f32_16x16x32_bf16 v[192:195], v[104:107], v[40:43], v[192:195]
s_barrier
ds_read_b64_tr_b16 v[36:37], v29 offset:0
ds_read_b64_tr_b16 v[38:39], v29 offset:256
v_mfma_f32_16x16x32_bf16 v[196:199], v[108:111], v[40:43], v[196:199]
s_waitcnt lgkmcnt(4)
v_max_f32 v187, s57, v187
v_add_f32 v184, v184, v56
v_add_f32 v185, v185, v57
v_mfma_f32_16x16x32_bf16 v[200:203], v[104:107], v[44:47], v[200:203]
ds_read_b64_tr_b16 v[40:41], v31 offset:0
ds_read_b64_tr_b16 v[42:43], v31 offset:256
v_mfma_f32_16x16x32_bf16 v[204:207], v[108:111], v[44:47], v[204:207]
v_add_f32 v186, v186, v58
v_add_f32 v187, v187, v59
v_cvt_pk_bf16_f32 v180, v184, v185
v_mfma_f32_16x16x32_bf16 v[224:227], v[104:107], v[48:51], v[224:227]
ds_read_b64_tr_b16 v[44:45], v33 offset:0
ds_read_b64_tr_b16 v[46:47], v33 offset:256
v_mfma_f32_16x16x32_bf16 v[228:231], v[108:111], v[48:51], v[228:231]
s_waitcnt lgkmcnt(4)
v_cvt_pk_bf16_f32 v181, v186, v187
v_mul_f32 v56, s56, v188
v_mul_f32 v57, s56, v189
v_mfma_f32_16x16x32_bf16 v[232:235], v[104:107], v[52:55], v[232:235]
ds_read_b64_tr_b16 v[48:49], v35 offset:0
ds_read_b64_tr_b16 v[50:51], v35 offset:256
v_mfma_f32_16x16x32_bf16 v[236:239], v[108:111], v[52:55], v[236:239]
v_mul_f32 v58, s56, v190
v_mul_f32 v59, s56, v191
v_exp_f32 v56, v56 clamp
v_mfma_f32_16x16x32_bf16 v[192:195], v[112:115], v[36:39], v[192:195]
ds_read_b64_tr_b16 v[52:53], v29 offset:8192
ds_read_b64_tr_b16 v[54:55], v29 offset:8448
v_mfma_f32_16x16x32_bf16 v[196:199], v[116:119], v[36:39], v[196:199]
s_waitcnt lgkmcnt(4)
v_max_f32 v188, s57, v188
v_exp_f32 v57, v57 clamp
v_mfma_f32_16x16x32_bf16 v[200:203], v[112:115], v[40:43], v[200:203]
ds_read_b64_tr_b16 v[36:37], v31 offset:8192
ds_read_b64_tr_b16 v[38:39], v31 offset:8448
v_mfma_f32_16x16x32_bf16 v[204:207], v[116:119], v[40:43], v[204:207]
v_max_f32 v189, s57, v189
v_exp_f32 v58, v58 clamp
v_mfma_f32_16x16x32_bf16 v[224:227], v[112:115], v[44:47], v[224:227]
ds_read_b64_tr_b16 v[40:41], v33 offset:8192
ds_read_b64_tr_b16 v[42:43], v33 offset:8448
v_mfma_f32_16x16x32_bf16 v[228:231], v[116:119], v[44:47], v[228:231]
s_waitcnt lgkmcnt(4)
v_max_f32 v190, s57, v190
v_exp_f32 v59, v59 clamp
v_mfma_f32_16x16x32_bf16 v[232:235], v[112:115], v[48:51], v[232:235]
ds_read_b64_tr_b16 v[44:45], v35 offset:8192
ds_read_b64_tr_b16 v[46:47], v35 offset:8448
v_mfma_f32_16x16x32_bf16 v[236:239], v[116:119], v[48:51], v[236:239]
v_max_f32 v191, s57, v191
v_add_f32 v188, v188, v56
v_add_f32 v189, v189, v57
v_mfma_f32_16x16x32_bf16 v[192:195], v[120:123], v[52:55], v[192:195]
s_barrier
ds_read_b64_tr_b16 v[48:49], v29 offset:16384
ds_read_b64_tr_b16 v[50:51], v29 offset:16640
v_mfma_f32_16x16x32_bf16 v[196:199], v[124:127], v[52:55], v[196:199]
s_waitcnt lgkmcnt(4)
v_add_f32 v190, v190, v58
v_add_f32 v191, v191, v59
v_cvt_pk_bf16_f32 v182, v188, v189
v_mfma_f32_16x16x32_bf16 v[200:203], v[120:123], v[36:39], v[200:203]
ds_read_b64_tr_b16 v[52:53], v31 offset:16384
ds_read_b64_tr_b16 v[54:55], v31 offset:16640
v_mfma_f32_16x16x32_bf16 v[204:207], v[124:127], v[36:39], v[204:207]
v_cvt_pk_bf16_f32 v183, v190, v191
v_mul_f32 v56, s56, v208
v_mul_f32 v57, s56, v209
v_mfma_f32_16x16x32_bf16 v[224:227], v[120:123], v[40:43], v[224:227]
ds_read_b64_tr_b16 v[36:37], v33 offset:16384
ds_read_b64_tr_b16 v[38:39], v33 offset:16640
v_mfma_f32_16x16x32_bf16 v[228:231], v[124:127], v[40:43], v[228:231]
s_waitcnt lgkmcnt(4)
v_mul_f32 v58, s56, v210
v_mul_f32 v59, s56, v211
v_exp_f32 v56, v56 clamp
v_mfma_f32_16x16x32_bf16 v[232:235], v[120:123], v[44:47], v[232:235]
ds_read_b64_tr_b16 v[40:41], v35 offset:16384
ds_read_b64_tr_b16 v[42:43], v35 offset:16640
v_mfma_f32_16x16x32_bf16 v[236:239], v[124:127], v[44:47], v[236:239]
v_max_f32 v208, s57, v208
v_exp_f32 v57, v57 clamp
v_mfma_f32_16x16x32_bf16 v[192:195], v[128:131], v[48:51], v[192:195]
ds_read_b64_tr_b16 v[44:45], v29 offset:24576
ds_read_b64_tr_b16 v[46:47], v29 offset:24832
v_mfma_f32_16x16x32_bf16 v[196:199], v[132:135], v[48:51], v[196:199]
s_waitcnt lgkmcnt(4)
v_max_f32 v209, s57, v209
v_exp_f32 v58, v58 clamp
v_mfma_f32_16x16x32_bf16 v[200:203], v[128:131], v[52:55], v[200:203]
ds_read_b64_tr_b16 v[48:49], v31 offset:24576
ds_read_b64_tr_b16 v[50:51], v31 offset:24832
v_mfma_f32_16x16x32_bf16 v[204:207], v[132:135], v[52:55], v[204:207]
v_max_f32 v210, s57, v210
v_exp_f32 v59, v59 clamp
v_mfma_f32_16x16x32_bf16 v[224:227], v[128:131], v[36:39], v[224:227]
ds_read_b64_tr_b16 v[52:53], v33 offset:24576
ds_read_b64_tr_b16 v[54:55], v33 offset:24832
v_mfma_f32_16x16x32_bf16 v[228:231], v[132:135], v[36:39], v[228:231]
s_waitcnt lgkmcnt(4)
v_max_f32 v211, s57, v211
v_add_f32 v208, v208, v56
v_add_f32 v209, v209, v57
v_mfma_f32_16x16x32_bf16 v[232:235], v[128:131], v[40:43], v[232:235]
ds_read_b64_tr_b16 v[36:37], v35 offset:24576
ds_read_b64_tr_b16 v[38:39], v35 offset:24832
v_mfma_f32_16x16x32_bf16 v[236:239], v[132:135], v[40:43], v[236:239]
v_add_f32 v210, v210, v58
v_add_f32 v211, v211, v59
v_cvt_pk_bf16_f32 v208, v208, v209
v_mfma_f32_16x16x32_bf16 v[192:195], v[136:139], v[44:47], v[192:195]
s_barrier
ds_read_b64_tr_b16 v[40:41], v28 offset:0
ds_read_b64_tr_b16 v[42:43], v28 offset:256
v_mfma_f32_16x16x32_bf16 v[196:199], v[140:143], v[44:47], v[196:199]
s_waitcnt lgkmcnt(4)
v_cvt_pk_bf16_f32 v209, v210, v211
v_mul_f32 v56, s56, v212
v_mul_f32 v57, s56, v213
v_mfma_f32_16x16x32_bf16 v[200:203], v[136:139], v[48:51], v[200:203]
ds_read_b64_tr_b16 v[44:45], v30 offset:0
ds_read_b64_tr_b16 v[46:47], v30 offset:256
v_mfma_f32_16x16x32_bf16 v[204:207], v[140:143], v[48:51], v[204:207]
v_mul_f32 v58, s56, v214
v_mul_f32 v59, s56, v215
v_exp_f32 v56, v56 clamp
v_mfma_f32_16x16x32_bf16 v[224:227], v[136:139], v[52:55], v[224:227]
ds_read_b64_tr_b16 v[48:49], v32 offset:0
ds_read_b64_tr_b16 v[50:51], v32 offset:256
v_mfma_f32_16x16x32_bf16 v[228:231], v[140:143], v[52:55], v[228:231]
s_waitcnt lgkmcnt(4)
v_max_f32 v212, s57, v212
v_exp_f32 v57, v57 clamp
v_mfma_f32_16x16x32_bf16 v[232:235], v[136:139], v[36:39], v[232:235]
ds_read_b64_tr_b16 v[52:53], v34 offset:0
ds_read_b64_tr_b16 v[54:55], v34 offset:256
v_mfma_f32_16x16x32_bf16 v[236:239], v[140:143], v[36:39], v[236:239]
v_max_f32 v213, s57, v213
v_exp_f32 v58, v58 clamp
v_mfma_f32_16x16x32_bf16 v[192:195], v[144:147], v[40:43], v[192:195]
ds_read_b64_tr_b16 v[36:37], v28 offset:8192
ds_read_b64_tr_b16 v[38:39], v28 offset:8448
v_mfma_f32_16x16x32_bf16 v[196:199], v[148:151], v[40:43], v[196:199]
s_waitcnt lgkmcnt(4)
v_max_f32 v214, s57, v214
v_exp_f32 v59, v59 clamp
v_mfma_f32_16x16x32_bf16 v[200:203], v[144:147], v[44:47], v[200:203]
ds_read_b64_tr_b16 v[40:41], v30 offset:8192
ds_read_b64_tr_b16 v[42:43], v30 offset:8448
v_mfma_f32_16x16x32_bf16 v[204:207], v[148:151], v[44:47], v[204:207]
v_max_f32 v215, s57, v215
v_add_f32 v212, v212, v56
v_add_f32 v213, v213, v57
v_mfma_f32_16x16x32_bf16 v[224:227], v[144:147], v[48:51], v[224:227]
ds_read_b64_tr_b16 v[44:45], v32 offset:8192
ds_read_b64_tr_b16 v[46:47], v32 offset:8448
v_mfma_f32_16x16x32_bf16 v[228:231], v[148:151], v[48:51], v[228:231]
s_waitcnt lgkmcnt(4)
v_add_f32 v214, v214, v58
v_add_f32 v215, v215, v59
v_cvt_pk_bf16_f32 v210, v212, v213
v_mfma_f32_16x16x32_bf16 v[232:235], v[144:147], v[52:55], v[232:235]
ds_read_b64_tr_b16 v[48:49], v34 offset:8192
ds_read_b64_tr_b16 v[50:51], v34 offset:8448
v_mfma_f32_16x16x32_bf16 v[236:239], v[148:151], v[52:55], v[236:239]
v_cvt_pk_bf16_f32 v211, v214, v215
v_mul_f32 v56, s56, v216
v_mul_f32 v57, s56, v217
v_mfma_f32_16x16x32_bf16 v[192:195], v[152:155], v[36:39], v[192:195]
s_barrier
ds_read_b64_tr_b16 v[52:53], v28 offset:16384
ds_read_b64_tr_b16 v[54:55], v28 offset:16640
v_mfma_f32_16x16x32_bf16 v[196:199], v[156:159], v[36:39], v[196:199]
s_waitcnt lgkmcnt(4)
v_mul_f32 v58, s56, v218
v_mul_f32 v59, s56, v219
v_exp_f32 v56, v56 clamp
v_mfma_f32_16x16x32_bf16 v[200:203], v[152:155], v[40:43], v[200:203]
ds_read_b64_tr_b16 v[36:37], v30 offset:16384
ds_read_b64_tr_b16 v[38:39], v30 offset:16640
v_mfma_f32_16x16x32_bf16 v[204:207], v[156:159], v[40:43], v[204:207]
v_max_f32 v216, s57, v216
v_exp_f32 v57, v57 clamp
v_mfma_f32_16x16x32_bf16 v[224:227], v[152:155], v[44:47], v[224:227]
ds_read_b64_tr_b16 v[40:41], v32 offset:16384
ds_read_b64_tr_b16 v[42:43], v32 offset:16640
v_mfma_f32_16x16x32_bf16 v[228:231], v[156:159], v[44:47], v[228:231]
s_waitcnt lgkmcnt(4)
v_max_f32 v217, s57, v217
v_exp_f32 v58, v58 clamp
v_mfma_f32_16x16x32_bf16 v[232:235], v[152:155], v[48:51], v[232:235]
ds_read_b64_tr_b16 v[44:45], v34 offset:16384
ds_read_b64_tr_b16 v[46:47], v34 offset:16640
v_mfma_f32_16x16x32_bf16 v[236:239], v[156:159], v[48:51], v[236:239]
v_max_f32 v218, s57, v218
v_exp_f32 v59, v59 clamp
v_mfma_f32_16x16x32_bf16 v[192:195], v[160:163], v[52:55], v[192:195]
ds_read_b64_tr_b16 v[48:49], v28 offset:24576
ds_read_b64_tr_b16 v[50:51], v28 offset:24832
v_mfma_f32_16x16x32_bf16 v[196:199], v[164:167], v[52:55], v[196:199]
s_waitcnt lgkmcnt(4)
v_max_f32 v219, s57, v219
v_add_f32 v216, v216, v56
v_add_f32 v217, v217, v57
v_mfma_f32_16x16x32_bf16 v[200:203], v[160:163], v[36:39], v[200:203]
ds_read_b64_tr_b16 v[52:53], v30 offset:24576
ds_read_b64_tr_b16 v[54:55], v30 offset:24832
v_mfma_f32_16x16x32_bf16 v[204:207], v[164:167], v[36:39], v[204:207]
v_add_f32 v218, v218, v58
v_add_f32 v219, v219, v59
v_cvt_pk_bf16_f32 v212, v216, v217
v_mfma_f32_16x16x32_bf16 v[224:227], v[160:163], v[40:43], v[224:227]
ds_read_b64_tr_b16 v[36:37], v32 offset:24576
ds_read_b64_tr_b16 v[38:39], v32 offset:24832
v_mfma_f32_16x16x32_bf16 v[228:231], v[164:167], v[40:43], v[228:231]
s_waitcnt lgkmcnt(4)
v_cvt_pk_bf16_f32 v213, v218, v219
v_mul_f32 v56, s56, v220
v_mul_f32 v57, s56, v221
v_mfma_f32_16x16x32_bf16 v[232:235], v[160:163], v[44:47], v[232:235]
ds_read_b64_tr_b16 v[40:41], v34 offset:24576
ds_read_b64_tr_b16 v[42:43], v34 offset:24832
v_mfma_f32_16x16x32_bf16 v[236:239], v[164:167], v[44:47], v[236:239]
v_mul_f32 v58, s56, v222
v_mul_f32 v59, s56, v223
v_exp_f32 v56, v56 clamp
v_mfma_f32_16x16x32_bf16 v[192:195], v[168:171], v[48:51], v[192:195]
s_barrier
ds_read_b64_tr_b16 v[44:45], v14 offset:32768
ds_read_b64_tr_b16 v[46:47], v14 offset:33024
v_mfma_f32_16x16x32_bf16 v[196:199], v[172:175], v[48:51], v[196:199]
s_waitcnt lgkmcnt(4)
v_max_f32 v220, s57, v220
v_exp_f32 v57, v57 clamp
v_mfma_f32_16x16x32_bf16 v[200:203], v[168:171], v[52:55], v[200:203]
ds_read_b64_tr_b16 v[48:49], v16 offset:32768
ds_read_b64_tr_b16 v[50:51], v16 offset:33024
v_mfma_f32_16x16x32_bf16 v[204:207], v[172:175], v[52:55], v[204:207]
v_max_f32 v221, s57, v221
v_exp_f32 v58, v58 clamp
v_mfma_f32_16x16x32_bf16 v[224:227], v[168:171], v[36:39], v[224:227]
ds_read_b64_tr_b16 v[52:53], v14 offset:36864
ds_read_b64_tr_b16 v[54:55], v14 offset:37120
v_mfma_f32_16x16x32_bf16 v[228:231], v[172:175], v[36:39], v[228:231]
s_waitcnt lgkmcnt(4)
v_max_f32 v222, s57, v222
v_exp_f32 v59, v59 clamp
v_mfma_f32_16x16x32_bf16 v[232:235], v[168:171], v[40:43], v[232:235]
ds_read_b64_tr_b16 v[36:37], v16 offset:36864
ds_read_b64_tr_b16 v[38:39], v16 offset:37120
v_mfma_f32_16x16x32_bf16 v[236:239], v[172:175], v[40:43], v[236:239]
v_max_f32 v223, s57, v223
v_add_f32 v220, v220, v56
v_add_f32 v221, v221, v57
v_add_f32 v222, v222, v58
v_add_f32 v223, v223, v59
v_cvt_pk_bf16_f32 v214, v220, v221
v_cvt_pk_bf16_f32 v215, v222, v223
s_barrier
v_cvt_pk_bf16_f32 v184, v192, v193
v_cvt_pk_bf16_f32 v185, v194, v195
v_cvt_pk_bf16_f32 v186, v196, v197
v_cvt_pk_bf16_f32 v187, v198, v199
v_cvt_pk_bf16_f32 v188, v200, v201
v_cvt_pk_bf16_f32 v189, v202, v203
v_cvt_pk_bf16_f32 v190, v204, v205
v_cvt_pk_bf16_f32 v191, v206, v207
v_bfi_b32 v188, v25, v188, v27
v_bfi_b32 v189, v25, v189, v27
v_bfi_b32 v190, v25, v190, v27
v_bfi_b32 v191, v25, v191, v27
v_mfma_f32_16x16x32_bf16 v[192:195], v[176:179], v[184:187], 0
v_mfma_f32_16x16x32_bf16 v[196:199], v[180:183], v[184:187], 0
v_mfma_f32_16x16x32_bf16 v[200:203], v[176:179], v[188:191], 0
v_mfma_f32_16x16x32_bf16 v[204:207], v[180:183], v[188:191], 0
v_cvt_pk_bf16_f32 v216, v224, v225
v_cvt_pk_bf16_f32 v217, v226, v227
v_cvt_pk_bf16_f32 v218, v228, v229
v_cvt_pk_bf16_f32 v219, v230, v231
v_cvt_pk_bf16_f32 v220, v232, v233
v_cvt_pk_bf16_f32 v221, v234, v235
v_cvt_pk_bf16_f32 v222, v236, v237
v_cvt_pk_bf16_f32 v223, v238, v239
v_bfi_b32 v220, v25, v220, v27
v_bfi_b32 v221, v25, v221, v27
v_bfi_b32 v222, v25, v222, v27
v_bfi_b32 v223, v25, v223, v27
v_mfma_f32_16x16x32_bf16 v[224:227], v[208:211], v[216:219], 0
v_mfma_f32_16x16x32_bf16 v[228:231], v[212:215], v[216:219], 0
v_mfma_f32_16x16x32_bf16 v[232:235], v[208:211], v[220:223], 0
v_mfma_f32_16x16x32_bf16 v[236:239], v[212:215], v[220:223], 0
v_cvt_pk_bf16_f32 v192, v192, v193
v_cvt_pk_bf16_f32 v193, v194, v195
v_cvt_pk_bf16_f32 v194, v196, v197
v_cvt_pk_bf16_f32 v195, v198, v199
v_cvt_pk_bf16_f32 v196, v200, v201
v_cvt_pk_bf16_f32 v197, v202, v203
v_cvt_pk_bf16_f32 v198, v204, v205
v_cvt_pk_bf16_f32 v199, v206, v207
v_mov_b32 v200, v195
v_mov_b32 v201, v195
v_and_or_b32 v202, v195, s58, v26
v_lshl_or_b32 v195, v195, 16, v26
v_mov_b32 v204, v199
v_mov_b32 v205, v199
v_and_or_b32 v206, v199, s58, v26
v_lshl_or_b32 v199, v199, 16, v26
v_permlane16_swap_b32 v200, v201
v_permlane32_swap_b32 v195, v202
v_bfi_b32 v194, v61, v200, v194
buffer_store_dwordx4 v[192:195], v20, s[36:39], s59 offen offset:0 sc1
v_permlane16_swap_b32 v204, v205
v_permlane32_swap_b32 v199, v206
v_bfi_b32 v198, v61, v204, v198
buffer_store_dwordx4 v[196:199], v20, s[36:39], s59 offen offset:256 sc1
v_mfma_f32_16x16x32_bf16 v[240:243], v[44:47], v[64:67], v[240:243]
ds_read_b64_tr_b16 v[40:41], v14 offset:40960
ds_read_b64_tr_b16 v[42:43], v14 offset:41216
v_mfma_f32_16x16x32_bf16 v[248:251], v[44:47], v[68:71], v[248:251]
s_waitcnt lgkmcnt(4)
v_mfma_f32_16x16x32_bf16 v[244:247], v[48:51], v[64:67], v[244:247]
ds_read_b64_tr_b16 v[44:45], v16 offset:40960
ds_read_b64_tr_b16 v[46:47], v16 offset:41216
v_mfma_f32_16x16x32_bf16 v[252:255], v[48:51], v[68:71], v[252:255]
v_mfma_f32_16x16x32_bf16 v[240:243], v[52:55], v[72:75], v[240:243]
ds_read_b64_tr_b16 v[48:49], v14 offset:45056
ds_read_b64_tr_b16 v[50:51], v14 offset:45312
v_mfma_f32_16x16x32_bf16 v[248:251], v[52:55], v[76:79], v[248:251]
s_waitcnt lgkmcnt(4)
v_cvt_pk_bf16_f32 v224, v224, v225
v_cvt_pk_bf16_f32 v225, v226, v227
v_cvt_pk_bf16_f32 v226, v228, v229
v_cvt_pk_bf16_f32 v227, v230, v231
v_mfma_f32_16x16x32_bf16 v[244:247], v[36:39], v[72:75], v[244:247]
ds_read_b64_tr_b16 v[52:53], v16 offset:45056
ds_read_b64_tr_b16 v[54:55], v16 offset:45312
v_mfma_f32_16x16x32_bf16 v[252:255], v[36:39], v[76:79], v[252:255]
v_cvt_pk_bf16_f32 v228, v232, v233
v_cvt_pk_bf16_f32 v229, v234, v235
v_cvt_pk_bf16_f32 v230, v236, v237
v_cvt_pk_bf16_f32 v231, v238, v239
v_mfma_f32_16x16x32_bf16 v[240:243], v[40:43], v[80:83], v[240:243]
s_barrier
ds_read_b64_tr_b16 v[36:37], v14 offset:49152
ds_read_b64_tr_b16 v[38:39], v14 offset:49408
v_mfma_f32_16x16x32_bf16 v[248:251], v[40:43], v[84:87], v[248:251]
s_waitcnt lgkmcnt(4)
v_mov_b32 v232, v227
v_mov_b32 v233, v227
v_and_or_b32 v234, v227, s58, v26
v_lshl_or_b32 v227, v227, 16, v26
v_mfma_f32_16x16x32_bf16 v[244:247], v[44:47], v[80:83], v[244:247]
ds_read_b64_tr_b16 v[40:41], v16 offset:49152
ds_read_b64_tr_b16 v[42:43], v16 offset:49408
v_mfma_f32_16x16x32_bf16 v[252:255], v[44:47], v[84:87], v[252:255]
v_mov_b32 v236, v231
v_mov_b32 v237, v231
v_and_or_b32 v238, v231, s58, v26
v_lshl_or_b32 v231, v231, 16, v26
v_mfma_f32_16x16x32_bf16 v[240:243], v[48:51], v[88:91], v[240:243]
ds_read_b64_tr_b16 v[44:45], v14 offset:53248
ds_read_b64_tr_b16 v[46:47], v14 offset:53504
v_mfma_f32_16x16x32_bf16 v[248:251], v[48:51], v[92:95], v[248:251]
s_waitcnt lgkmcnt(4)
v_permlane16_swap_b32 v232, v233
v_permlane32_swap_b32 v227, v234
v_bfi_b32 v226, v61, v232, v226
buffer_store_dwordx4 v[224:227], v20, s[36:39], s60 offen offset:0 sc1
v_mfma_f32_16x16x32_bf16 v[244:247], v[52:55], v[88:91], v[244:247]
ds_read_b64_tr_b16 v[48:49], v16 offset:53248
ds_read_b64_tr_b16 v[50:51], v16 offset:53504
v_mfma_f32_16x16x32_bf16 v[252:255], v[52:55], v[92:95], v[252:255]
v_permlane16_swap_b32 v236, v237
v_permlane32_swap_b32 v231, v238
v_bfi_b32 v230, v61, v236, v230
buffer_store_dwordx4 v[228:231], v20, s[36:39], s60 offen offset:256 sc1
v_mfma_f32_16x16x32_bf16 v[240:243], v[36:39], v[96:99], v[240:243]
ds_read_b64_tr_b16 v[52:53], v14 offset:57344
ds_read_b64_tr_b16 v[54:55], v14 offset:57600
v_mfma_f32_16x16x32_bf16 v[248:251], v[36:39], v[100:103], v[248:251]
s_waitcnt lgkmcnt(4)
v_mov_b32 v7, 0
v_and_b32 v6, 1.0, v62
v_mfma_f32_16x16x32_bf16 v[244:247], v[40:43], v[96:99], v[244:247]
ds_read_b64_tr_b16 v[36:37], v16 offset:57344
ds_read_b64_tr_b16 v[38:39], v16 offset:57600
v_mfma_f32_16x16x32_bf16 v[252:255], v[40:43], v[100:103], v[252:255]
v_mfma_f32_16x16x16_bf16 v[208:211], v[4:5], v[6:7], 0
v_mfma_f32_16x16x16_bf16 v[216:219], v[4:5], v[6:7], 0
v_and_b32 v6, 1.0, v63
v_mfma_f32_16x16x32_bf16 v[240:243], v[44:47], v[104:107], v[240:243]
ds_read_b64_tr_b16 v[40:41], v14 offset:61440
ds_read_b64_tr_b16 v[42:43], v14 offset:61696
v_mfma_f32_16x16x32_bf16 v[248:251], v[44:47], v[108:111], v[248:251]
s_waitcnt lgkmcnt(4)
v_mfma_f32_16x16x16_bf16 v[212:215], v[4:5], v[6:7], 0
v_mfma_f32_16x16x16_bf16 v[220:223], v[4:5], v[6:7], 0
v_mfma_f32_16x16x32_bf16 v[244:247], v[48:51], v[104:107], v[244:247]
ds_read_b64_tr_b16 v[44:45], v16 offset:61440
ds_read_b64_tr_b16 v[46:47], v16 offset:61696
v_mfma_f32_16x16x32_bf16 v[252:255], v[48:51], v[108:111], v[252:255]
s_lshl_b32 s44, s31, 12
s_sub_u32 s45, 4096, s44
v_mfma_f32_16x16x32_bf16 v[240:243], v[52:55], v[112:115], v[240:243]
s_barrier
ds_read_b64_tr_b16 v[48:49], v15 offset:0
ds_read_b64_tr_b16 v[50:51], v15 offset:256
v_mfma_f32_16x16x32_bf16 v[248:251], v[52:55], v[116:119], v[248:251]
s_waitcnt lgkmcnt(4)
v_add_u32 v28, s44, v14
v_add_u32 v29, s44, v15
v_mfma_f32_16x16x32_bf16 v[244:247], v[36:39], v[112:115], v[244:247]
ds_read_b64_tr_b16 v[52:53], v17 offset:0
ds_read_b64_tr_b16 v[54:55], v17 offset:256
v_mfma_f32_16x16x32_bf16 v[252:255], v[36:39], v[116:119], v[252:255]
v_add_u32 v30, s44, v16
v_add_u32 v31, s44, v17
v_mfma_f32_16x16x32_bf16 v[240:243], v[40:43], v[120:123], v[240:243]
ds_read_b64_tr_b16 v[36:37], v15 offset:4096
ds_read_b64_tr_b16 v[38:39], v15 offset:4352
v_mfma_f32_16x16x32_bf16 v[248:251], v[40:43], v[124:127], v[248:251]
s_waitcnt lgkmcnt(4)
v_add_u32 v32, s45, v14
v_add_u32 v33, s45, v15
v_mfma_f32_16x16x32_bf16 v[244:247], v[44:47], v[120:123], v[244:247]
ds_read_b64_tr_b16 v[40:41], v17 offset:4096
ds_read_b64_tr_b16 v[42:43], v17 offset:4352
v_mfma_f32_16x16x32_bf16 v[252:255], v[44:47], v[124:127], v[252:255]
v_add_u32 v34, s45, v16
v_add_u32 v35, s45, v17
v_mfma_f32_16x16x32_bf16 v[240:243], v[48:51], v[128:131], v[240:243]
ds_read_b64_tr_b16 v[44:45], v15 offset:8192
ds_read_b64_tr_b16 v[46:47], v15 offset:8448
v_mfma_f32_16x16x32_bf16 v[248:251], v[48:51], v[132:135], v[248:251]
s_waitcnt lgkmcnt(4)
v_subrev_u32 v12, 0x10000, v28
v_subrev_u32 v18, 0x10000, v30
v_mfma_f32_16x16x32_bf16 v[244:247], v[52:55], v[128:131], v[244:247]
ds_read_b64_tr_b16 v[48:49], v17 offset:8192
ds_read_b64_tr_b16 v[50:51], v17 offset:8448
v_mfma_f32_16x16x32_bf16 v[252:255], v[52:55], v[132:135], v[252:255]
v_subrev_u32 v19, 0x10000, v32
v_subrev_u32 v60, 0x10000, v34
v_mfma_f32_16x16x32_bf16 v[240:243], v[36:39], v[136:139], v[240:243]
ds_read_b64_tr_b16 v[52:53], v15 offset:12288
ds_read_b64_tr_b16 v[54:55], v15 offset:12544
v_mfma_f32_16x16x32_bf16 v[248:251], v[36:39], v[140:143], v[248:251]
s_waitcnt lgkmcnt(4)
v_mfma_f32_16x16x32_bf16 v[244:247], v[40:43], v[136:139], v[244:247]
ds_read_b64_tr_b16 v[36:37], v17 offset:12288
ds_read_b64_tr_b16 v[38:39], v17 offset:12544
v_mfma_f32_16x16x32_bf16 v[252:255], v[40:43], v[140:143], v[252:255]
v_mfma_f32_16x16x32_bf16 v[240:243], v[44:47], v[144:147], v[240:243]
s_barrier
ds_read_b64_tr_b16 v[40:41], v15 offset:16384
ds_read_b64_tr_b16 v[42:43], v15 offset:16640
v_mfma_f32_16x16x32_bf16 v[248:251], v[44:47], v[148:151], v[248:251]
s_waitcnt lgkmcnt(4)
v_mfma_f32_16x16x32_bf16 v[244:247], v[48:51], v[144:147], v[244:247]
ds_read_b64_tr_b16 v[44:45], v17 offset:16384
ds_read_b64_tr_b16 v[46:47], v17 offset:16640
v_mfma_f32_16x16x32_bf16 v[252:255], v[48:51], v[148:151], v[252:255]
v_mfma_f32_16x16x32_bf16 v[240:243], v[52:55], v[152:155], v[240:243]
ds_read_b64_tr_b16 v[48:49], v15 offset:20480
ds_read_b64_tr_b16 v[50:51], v15 offset:20736
v_mfma_f32_16x16x32_bf16 v[248:251], v[52:55], v[156:159], v[248:251]
s_waitcnt lgkmcnt(4)
v_mfma_f32_16x16x32_bf16 v[244:247], v[36:39], v[152:155], v[244:247]
ds_read_b64_tr_b16 v[52:53], v17 offset:20480
ds_read_b64_tr_b16 v[54:55], v17 offset:20736
v_mfma_f32_16x16x32_bf16 v[252:255], v[36:39], v[156:159], v[252:255]
v_mfma_f32_16x16x32_bf16 v[240:243], v[40:43], v[160:163], v[240:243]
ds_read_b64_tr_b16 v[36:37], v15 offset:24576
ds_read_b64_tr_b16 v[38:39], v15 offset:24832
v_mfma_f32_16x16x32_bf16 v[248:251], v[40:43], v[164:167], v[248:251]
s_waitcnt lgkmcnt(4)
v_mfma_f32_16x16x32_bf16 v[244:247], v[44:47], v[160:163], v[244:247]
ds_read_b64_tr_b16 v[40:41], v17 offset:24576
ds_read_b64_tr_b16 v[42:43], v17 offset:24832
v_mfma_f32_16x16x32_bf16 v[252:255], v[44:47], v[164:167], v[252:255]
v_mfma_f32_16x16x32_bf16 v[240:243], v[48:51], v[168:171], v[240:243]
ds_read_b64_tr_b16 v[44:45], v15 offset:28672
ds_read_b64_tr_b16 v[46:47], v15 offset:28928
v_mfma_f32_16x16x32_bf16 v[248:251], v[48:51], v[172:175], v[248:251]
s_waitcnt lgkmcnt(4)
v_mfma_f32_16x16x32_bf16 v[244:247], v[52:55], v[168:171], v[244:247]
ds_read_b64_tr_b16 v[48:49], v17 offset:28672
ds_read_b64_tr_b16 v[50:51], v17 offset:28928
v_mfma_f32_16x16x32_bf16 v[252:255], v[52:55], v[172:175], v[252:255]
v_mfma_f32_16x16x32_bf16 v[208:211], v[36:39], v[64:67], v[208:211]
s_barrier
ds_read_b64_tr_b16 v[52:53], v14 offset:0
ds_read_b64_tr_b16 v[54:55], v14 offset:256
v_mfma_f32_16x16x32_bf16 v[216:219], v[36:39], v[68:71], v[216:219]
s_waitcnt lgkmcnt(4)
v_mfma_f32_16x16x32_bf16 v[212:215], v[40:43], v[64:67], v[212:215]
ds_read_b64_tr_b16 v[36:37], v16 offset:0
ds_read_b64_tr_b16 v[38:39], v16 offset:256
v_mfma_f32_16x16x32_bf16 v[220:223], v[40:43], v[68:71], v[220:223]
v_mul_f32 v240, v240, abs(v240)
v_mul_f32 v241, v241, abs(v241)
v_mfma_f32_16x16x32_bf16 v[208:211], v[44:47], v[72:75], v[208:211]
ds_read_b64_tr_b16 v[40:41], v14 offset:4096
ds_read_b64_tr_b16 v[42:43], v14 offset:4352
v_mfma_f32_16x16x32_bf16 v[216:219], v[44:47], v[76:79], v[216:219]
s_waitcnt lgkmcnt(4)
v_mul_f32 v242, v242, abs(v242)
v_mul_f32 v243, v243, abs(v243)
v_mfma_f32_16x16x32_bf16 v[212:215], v[48:51], v[72:75], v[212:215]
ds_read_b64_tr_b16 v[44:45], v16 offset:4096
ds_read_b64_tr_b16 v[46:47], v16 offset:4352
v_mfma_f32_16x16x32_bf16 v[220:223], v[48:51], v[76:79], v[220:223]
v_mul_f32 v244, v244, abs(v244)
v_mul_f32 v245, v245, abs(v245)
v_mfma_f32_16x16x32_bf16 v[208:211], v[52:55], v[80:83], v[208:211]
ds_read_b64_tr_b16 v[48:49], v14 offset:8192
ds_read_b64_tr_b16 v[50:51], v14 offset:8448
v_mfma_f32_16x16x32_bf16 v[216:219], v[52:55], v[84:87], v[216:219]
s_waitcnt lgkmcnt(4)
v_mul_f32 v246, v246, abs(v246)
v_mul_f32 v247, v247, abs(v247)
v_mfma_f32_16x16x32_bf16 v[212:215], v[36:39], v[80:83], v[212:215]
ds_read_b64_tr_b16 v[52:53], v16 offset:8192
ds_read_b64_tr_b16 v[54:55], v16 offset:8448
v_mfma_f32_16x16x32_bf16 v[220:223], v[36:39], v[84:87], v[220:223]
v_cvt_pk_bf16_f32 v176, v240, v241
v_cvt_pk_bf16_f32 v177, v242, v243
v_mfma_f32_16x16x32_bf16 v[208:211], v[40:43], v[88:91], v[208:211]
ds_read_b64_tr_b16 v[36:37], v14 offset:12288
ds_read_b64_tr_b16 v[38:39], v14 offset:12544
v_mfma_f32_16x16x32_bf16 v[216:219], v[40:43], v[92:95], v[216:219]
s_waitcnt lgkmcnt(4)
v_cvt_pk_bf16_f32 v178, v244, v245
v_cvt_pk_bf16_f32 v179, v246, v247
v_mfma_f32_16x16x32_bf16 v[212:215], v[44:47], v[88:91], v[212:215]
ds_read_b64_tr_b16 v[40:41], v16 offset:12288
ds_read_b64_tr_b16 v[42:43], v16 offset:12544
v_mfma_f32_16x16x32_bf16 v[220:223], v[44:47], v[92:95], v[220:223]
v_pk_max_i16 v176, v176, 0
v_pk_max_i16 v177, v177, 0
v_mfma_f32_16x16x32_bf16 v[208:211], v[48:51], v[96:99], v[208:211]
s_barrier
ds_read_b64_tr_b16 v[44:45], v14 offset:16384
ds_read_b64_tr_b16 v[46:47], v14 offset:16640
v_mfma_f32_16x16x32_bf16 v[216:219], v[48:51], v[100:103], v[216:219]
s_waitcnt lgkmcnt(4)
v_pk_max_i16 v178, v178, 0
v_pk_max_i16 v179, v179, 0
v_mfma_f32_16x16x32_bf16 v[212:215], v[52:55], v[96:99], v[212:215]
ds_read_b64_tr_b16 v[48:49], v16 offset:16384
ds_read_b64_tr_b16 v[50:51], v16 offset:16640
v_mfma_f32_16x16x32_bf16 v[220:223], v[52:55], v[100:103], v[220:223]
v_mul_f32 v248, v248, abs(v248)
v_mul_f32 v249, v249, abs(v249)
v_mfma_f32_16x16x32_bf16 v[208:211], v[36:39], v[104:107], v[208:211]
ds_read_b64_tr_b16 v[52:53], v14 offset:20480
ds_read_b64_tr_b16 v[54:55], v14 offset:20736
v_mfma_f32_16x16x32_bf16 v[216:219], v[36:39], v[108:111], v[216:219]
s_waitcnt lgkmcnt(4)
v_mul_f32 v250, v250, abs(v250)
v_mul_f32 v251, v251, abs(v251)
v_mfma_f32_16x16x32_bf16 v[212:215], v[40:43], v[104:107], v[212:215]
ds_read_b64_tr_b16 v[36:37], v16 offset:20480
ds_read_b64_tr_b16 v[38:39], v16 offset:20736
v_mfma_f32_16x16x32_bf16 v[220:223], v[40:43], v[108:111], v[220:223]
v_mul_f32 v252, v252, abs(v252)
v_mul_f32 v253, v253, abs(v253)
v_mfma_f32_16x16x32_bf16 v[208:211], v[44:47], v[112:115], v[208:211]
ds_read_b64_tr_b16 v[40:41], v14 offset:24576
ds_read_b64_tr_b16 v[42:43], v14 offset:24832
v_mfma_f32_16x16x32_bf16 v[216:219], v[44:47], v[116:119], v[216:219]
s_waitcnt lgkmcnt(4)
v_mul_f32 v254, v254, abs(v254)
v_mul_f32 v255, v255, abs(v255)
v_mfma_f32_16x16x32_bf16 v[212:215], v[48:51], v[112:115], v[212:215]
ds_read_b64_tr_b16 v[44:45], v16 offset:24576
ds_read_b64_tr_b16 v[46:47], v16 offset:24832
v_mfma_f32_16x16x32_bf16 v[220:223], v[48:51], v[116:119], v[220:223]
v_cvt_pk_bf16_f32 v180, v248, v249
v_cvt_pk_bf16_f32 v181, v250, v251
v_mfma_f32_16x16x32_bf16 v[208:211], v[52:55], v[120:123], v[208:211]
ds_read_b64_tr_b16 v[48:49], v14 offset:28672
ds_read_b64_tr_b16 v[50:51], v14 offset:28928
v_mfma_f32_16x16x32_bf16 v[216:219], v[52:55], v[124:127], v[216:219]
s_waitcnt lgkmcnt(4)
v_cvt_pk_bf16_f32 v182, v252, v253
v_cvt_pk_bf16_f32 v183, v254, v255
v_mfma_f32_16x16x32_bf16 v[212:215], v[36:39], v[120:123], v[212:215]
ds_read_b64_tr_b16 v[52:53], v16 offset:28672
ds_read_b64_tr_b16 v[54:55], v16 offset:28928
v_mfma_f32_16x16x32_bf16 v[220:223], v[36:39], v[124:127], v[220:223]
v_pk_max_i16 v180, v180, 0
v_pk_max_i16 v181, v181, 0
v_mfma_f32_16x16x32_bf16 v[208:211], v[40:43], v[128:131], v[208:211]
s_barrier
ds_read_b64_tr_b16 v[36:37], v14 offset:32768
ds_read_b64_tr_b16 v[38:39], v14 offset:33024
v_mfma_f32_16x16x32_bf16 v[216:219], v[40:43], v[132:135], v[216:219]
s_waitcnt lgkmcnt(4)
v_pk_max_i16 v182, v182, 0
v_pk_max_i16 v183, v183, 0
v_mfma_f32_16x16x32_bf16 v[212:215], v[44:47], v[128:131], v[212:215]
ds_read_b64_tr_b16 v[40:41], v16 offset:32768
ds_read_b64_tr_b16 v[42:43], v16 offset:33024
v_mfma_f32_16x16x32_bf16 v[220:223], v[44:47], v[132:135], v[220:223]
v_mov_b32 v6, 0
v_and_b32 v7, 0x3f80, v62
v_mfma_f32_16x16x32_bf16 v[208:211], v[48:51], v[136:139], v[208:211]
ds_read_b64_tr_b16 v[44:45], v14 offset:36864
ds_read_b64_tr_b16 v[46:47], v14 offset:37120
v_mfma_f32_16x16x32_bf16 v[216:219], v[48:51], v[140:143], v[216:219]
s_waitcnt lgkmcnt(4)
v_mfma_f32_16x16x32_bf16 v[212:215], v[52:55], v[136:139], v[212:215]
ds_read_b64_tr_b16 v[48:49], v16 offset:36864
ds_read_b64_tr_b16 v[50:51], v16 offset:37120
v_mfma_f32_16x16x32_bf16 v[220:223], v[52:55], v[140:143], v[220:223]
v_mfma_f32_16x16x16_bf16 v[240:243], v[4:5], v[6:7], 0
v_mfma_f32_16x16x16_bf16 v[248:251], v[4:5], v[6:7], 0
v_mfma_f32_16x16x32_bf16 v[208:211], v[36:39], v[144:147], v[208:211]
ds_read_b64_tr_b16 v[52:53], v14 offset:40960
ds_read_b64_tr_b16 v[54:55], v14 offset:41216
v_mfma_f32_16x16x32_bf16 v[216:219], v[36:39], v[148:151], v[216:219]
s_waitcnt lgkmcnt(4)
v_and_b32 v7, 0x3f80, v63
v_mfma_f32_16x16x32_bf16 v[212:215], v[40:43], v[144:147], v[212:215]
ds_read_b64_tr_b16 v[36:37], v16 offset:40960
ds_read_b64_tr_b16 v[38:39], v16 offset:41216
v_mfma_f32_16x16x32_bf16 v[220:223], v[40:43], v[148:151], v[220:223]
v_mfma_f32_16x16x16_bf16 v[244:247], v[4:5], v[6:7], 0
v_mfma_f32_16x16x16_bf16 v[252:255], v[4:5], v[6:7], 0
v_mfma_f32_16x16x32_bf16 v[208:211], v[44:47], v[152:155], v[208:211]
ds_read_b64_tr_b16 v[40:41], v14 offset:45056
ds_read_b64_tr_b16 v[42:43], v14 offset:45312
v_mfma_f32_16x16x32_bf16 v[216:219], v[44:47], v[156:159], v[216:219]
s_waitcnt lgkmcnt(4)
v_mfma_f32_16x16x32_bf16 v[212:215], v[48:51], v[152:155], v[212:215]
ds_read_b64_tr_b16 v[44:45], v16 offset:45056
ds_read_b64_tr_b16 v[46:47], v16 offset:45312
v_mfma_f32_16x16x32_bf16 v[220:223], v[48:51], v[156:159], v[220:223]
v_mfma_f32_16x16x32_bf16 v[208:211], v[52:55], v[160:163], v[208:211]
s_barrier
ds_read_b64_tr_b16 v[48:49], v14 offset:49152
ds_read_b64_tr_b16 v[50:51], v14 offset:49408
v_mfma_f32_16x16x32_bf16 v[216:219], v[52:55], v[164:167], v[216:219]
s_waitcnt lgkmcnt(4)
v_mfma_f32_16x16x32_bf16 v[212:215], v[36:39], v[160:163], v[212:215]
ds_read_b64_tr_b16 v[52:53], v16 offset:49152
ds_read_b64_tr_b16 v[54:55], v16 offset:49408
v_mfma_f32_16x16x32_bf16 v[220:223], v[36:39], v[164:167], v[220:223]
v_mfma_f32_16x16x32_bf16 v[208:211], v[40:43], v[168:171], v[208:211]
ds_read_b64_tr_b16 v[36:37], v14 offset:53248
ds_read_b64_tr_b16 v[38:39], v14 offset:53504
v_mfma_f32_16x16x32_bf16 v[216:219], v[40:43], v[172:175], v[216:219]
s_waitcnt lgkmcnt(4)
v_mfma_f32_16x16x32_bf16 v[212:215], v[44:47], v[168:171], v[212:215]
ds_read_b64_tr_b16 v[40:41], v16 offset:53248
ds_read_b64_tr_b16 v[42:43], v16 offset:53504
v_mfma_f32_16x16x32_bf16 v[220:223], v[44:47], v[172:175], v[220:223]
v_mfma_f32_16x16x32_bf16 v[240:243], v[48:51], v[64:67], v[240:243]
ds_read_b64_tr_b16 v[44:45], v14 offset:57344
ds_read_b64_tr_b16 v[46:47], v14 offset:57600
v_mfma_f32_16x16x32_bf16 v[248:251], v[48:51], v[68:71], v[248:251]
s_waitcnt lgkmcnt(4)
v_mfma_f32_16x16x32_bf16 v[244:247], v[52:55], v[64:67], v[244:247]
ds_read_b64_tr_b16 v[48:49], v16 offset:57344
ds_read_b64_tr_b16 v[50:51], v16 offset:57600
v_mfma_f32_16x16x32_bf16 v[252:255], v[52:55], v[68:71], v[252:255]
v_mul_f32 v208, v208, abs(v208)
v_mul_f32 v209, v209, abs(v209)
v_mfma_f32_16x16x32_bf16 v[240:243], v[36:39], v[72:75], v[240:243]
ds_read_b64_tr_b16 v[52:53], v14 offset:61440
ds_read_b64_tr_b16 v[54:55], v14 offset:61696
v_mfma_f32_16x16x32_bf16 v[248:251], v[36:39], v[76:79], v[248:251]
s_waitcnt lgkmcnt(4)
v_mul_f32 v210, v210, abs(v210)
v_mul_f32 v211, v211, abs(v211)
v_mfma_f32_16x16x32_bf16 v[244:247], v[40:43], v[72:75], v[244:247]
ds_read_b64_tr_b16 v[36:37], v16 offset:61440
ds_read_b64_tr_b16 v[38:39], v16 offset:61696
v_mfma_f32_16x16x32_bf16 v[252:255], v[40:43], v[76:79], v[252:255]
v_mul_f32 v212, v212, abs(v212)
v_mul_f32 v213, v213, abs(v213)
v_mfma_f32_16x16x32_bf16 v[240:243], v[44:47], v[80:83], v[240:243]
s_barrier
ds_read_b64_tr_b16 v[40:41], v15 offset:0
ds_read_b64_tr_b16 v[42:43], v15 offset:256
v_mfma_f32_16x16x32_bf16 v[248:251], v[44:47], v[84:87], v[248:251]
s_waitcnt lgkmcnt(4)
v_mul_f32 v214, v214, abs(v214)
v_mul_f32 v215, v215, abs(v215)
v_mfma_f32_16x16x32_bf16 v[244:247], v[48:51], v[80:83], v[244:247]
ds_read_b64_tr_b16 v[44:45], v17 offset:0
ds_read_b64_tr_b16 v[46:47], v17 offset:256
v_mfma_f32_16x16x32_bf16 v[252:255], v[48:51], v[84:87], v[252:255]
v_cvt_pk_bf16_f32 v184, v208, v209
v_cvt_pk_bf16_f32 v185, v210, v211
v_mfma_f32_16x16x32_bf16 v[240:243], v[52:55], v[88:91], v[240:243]
ds_read_b64_tr_b16 v[48:49], v15 offset:4096
ds_read_b64_tr_b16 v[50:51], v15 offset:4352
v_mfma_f32_16x16x32_bf16 v[248:251], v[52:55], v[92:95], v[248:251]
s_waitcnt lgkmcnt(4)
v_cvt_pk_bf16_f32 v186, v212, v213
v_cvt_pk_bf16_f32 v187, v214, v215
v_mfma_f32_16x16x32_bf16 v[244:247], v[36:39], v[88:91], v[244:247]
ds_read_b64_tr_b16 v[52:53], v17 offset:4096
ds_read_b64_tr_b16 v[54:55], v17 offset:4352
v_mfma_f32_16x16x32_bf16 v[252:255], v[36:39], v[92:95], v[252:255]
v_pk_max_i16 v184, v184, 0
v_pk_max_i16 v185, v185, 0
v_mfma_f32_16x16x32_bf16 v[240:243], v[40:43], v[96:99], v[240:243]
ds_read_b64_tr_b16 v[36:37], v15 offset:8192
ds_read_b64_tr_b16 v[38:39], v15 offset:8448
v_mfma_f32_16x16x32_bf16 v[248:251], v[40:43], v[100:103], v[248:251]
s_waitcnt lgkmcnt(4)
v_pk_max_i16 v186, v186, 0
v_pk_max_i16 v187, v187, 0
v_mfma_f32_16x16x32_bf16 v[244:247], v[44:47], v[96:99], v[244:247]
ds_read_b64_tr_b16 v[40:41], v17 offset:8192
ds_read_b64_tr_b16 v[42:43], v17 offset:8448
v_mfma_f32_16x16x32_bf16 v[252:255], v[44:47], v[100:103], v[252:255]
v_mul_f32 v216, v216, abs(v216)
v_mul_f32 v217, v217, abs(v217)
v_mfma_f32_16x16x32_bf16 v[240:243], v[48:51], v[104:107], v[240:243]
ds_read_b64_tr_b16 v[44:45], v15 offset:12288
ds_read_b64_tr_b16 v[46:47], v15 offset:12544
v_mfma_f32_16x16x32_bf16 v[248:251], v[48:51], v[108:111], v[248:251]
s_waitcnt lgkmcnt(4)
v_mul_f32 v218, v218, abs(v218)
v_mul_f32 v219, v219, abs(v219)
v_mfma_f32_16x16x32_bf16 v[244:247], v[52:55], v[104:107], v[244:247]
ds_read_b64_tr_b16 v[48:49], v17 offset:12288
ds_read_b64_tr_b16 v[50:51], v17 offset:12544
v_mfma_f32_16x16x32_bf16 v[252:255], v[52:55], v[108:111], v[252:255]
v_mul_f32 v220, v220, abs(v220)
v_mul_f32 v221, v221, abs(v221)
v_mfma_f32_16x16x32_bf16 v[240:243], v[36:39], v[112:115], v[240:243]
s_barrier
ds_read_b64_tr_b16 v[52:53], v15 offset:16384
ds_read_b64_tr_b16 v[54:55], v15 offset:16640
v_mfma_f32_16x16x32_bf16 v[248:251], v[36:39], v[116:119], v[248:251]
s_waitcnt lgkmcnt(4)
v_mul_f32 v222, v222, abs(v222)
v_mul_f32 v223, v223, abs(v223)
v_mfma_f32_16x16x32_bf16 v[244:247], v[40:43], v[112:115], v[244:247]
ds_read_b64_tr_b16 v[36:37], v17 offset:16384
ds_read_b64_tr_b16 v[38:39], v17 offset:16640
v_mfma_f32_16x16x32_bf16 v[252:255], v[40:43], v[116:119], v[252:255]
v_cvt_pk_bf16_f32 v188, v216, v217
v_cvt_pk_bf16_f32 v189, v218, v219
v_mfma_f32_16x16x32_bf16 v[240:243], v[44:47], v[120:123], v[240:243]
ds_read_b64_tr_b16 v[40:41], v15 offset:20480
ds_read_b64_tr_b16 v[42:43], v15 offset:20736
v_mfma_f32_16x16x32_bf16 v[248:251], v[44:47], v[124:127], v[248:251]
s_waitcnt lgkmcnt(4)
v_cvt_pk_bf16_f32 v190, v220, v221
v_cvt_pk_bf16_f32 v191, v222, v223
v_mfma_f32_16x16x32_bf16 v[244:247], v[48:51], v[120:123], v[244:247]
ds_read_b64_tr_b16 v[44:45], v17 offset:20480
ds_read_b64_tr_b16 v[46:47], v17 offset:20736
v_mfma_f32_16x16x32_bf16 v[252:255], v[48:51], v[124:127], v[252:255]
v_pk_max_i16 v188, v188, 0
v_pk_max_i16 v189, v189, 0
v_mfma_f32_16x16x32_bf16 v[240:243], v[52:55], v[128:131], v[240:243]
ds_read_b64_tr_b16 v[48:49], v15 offset:24576
ds_read_b64_tr_b16 v[50:51], v15 offset:24832
v_mfma_f32_16x16x32_bf16 v[248:251], v[52:55], v[132:135], v[248:251]
s_waitcnt lgkmcnt(4)
v_pk_max_i16 v190, v190, 0
v_pk_max_i16 v191, v191, 0
v_mfma_f32_16x16x32_bf16 v[244:247], v[36:39], v[128:131], v[244:247]
ds_read_b64_tr_b16 v[52:53], v17 offset:24576
ds_read_b64_tr_b16 v[54:55], v17 offset:24832
v_mfma_f32_16x16x32_bf16 v[252:255], v[36:39], v[132:135], v[252:255]
v_mov_b32 v6, 0
v_and_b32 v7, 1.0, v62
v_mfma_f32_16x16x32_bf16 v[240:243], v[40:43], v[136:139], v[240:243]
ds_read_b64_tr_b16 v[36:37], v15 offset:28672
ds_read_b64_tr_b16 v[38:39], v15 offset:28928
v_mfma_f32_16x16x32_bf16 v[248:251], v[40:43], v[140:143], v[248:251]
s_waitcnt lgkmcnt(4)
v_mfma_f32_16x16x32_bf16 v[244:247], v[44:47], v[136:139], v[244:247]
ds_read_b64_tr_b16 v[40:41], v17 offset:28672
ds_read_b64_tr_b16 v[42:43], v17 offset:28928
v_mfma_f32_16x16x32_bf16 v[252:255], v[44:47], v[140:143], v[252:255]
v_mfma_f32_16x16x16_bf16 v[208:211], v[4:5], v[6:7], 0
v_mfma_f32_16x16x16_bf16 v[216:219], v[4:5], v[6:7], 0
v_mfma_f32_16x16x32_bf16 v[240:243], v[48:51], v[144:147], v[240:243]
s_barrier
ds_read_b64_tr_b16 v[44:45], v14 offset:0
ds_read_b64_tr_b16 v[46:47], v14 offset:256
v_mfma_f32_16x16x32_bf16 v[248:251], v[48:51], v[148:151], v[248:251]
s_waitcnt lgkmcnt(4)
v_and_b32 v7, 1.0, v63
v_mfma_f32_16x16x32_bf16 v[244:247], v[52:55], v[144:147], v[244:247]
ds_read_b64_tr_b16 v[48:49], v16 offset:0
ds_read_b64_tr_b16 v[50:51], v16 offset:256
v_mfma_f32_16x16x32_bf16 v[252:255], v[52:55], v[148:151], v[252:255]
v_mfma_f32_16x16x16_bf16 v[212:215], v[4:5], v[6:7], 0
v_mfma_f32_16x16x16_bf16 v[220:223], v[4:5], v[6:7], 0
v_mfma_f32_16x16x32_bf16 v[240:243], v[36:39], v[152:155], v[240:243]
ds_read_b64_tr_b16 v[52:53], v14 offset:4096
ds_read_b64_tr_b16 v[54:55], v14 offset:4352
v_mfma_f32_16x16x32_bf16 v[248:251], v[36:39], v[156:159], v[248:251]
s_waitcnt lgkmcnt(4)
v_mfma_f32_16x16x32_bf16 v[244:247], v[40:43], v[152:155], v[244:247]
ds_read_b64_tr_b16 v[36:37], v16 offset:4096
ds_read_b64_tr_b16 v[38:39], v16 offset:4352
v_mfma_f32_16x16x32_bf16 v[252:255], v[40:43], v[156:159], v[252:255]
v_mfma_f32_16x16x32_bf16 v[240:243], v[44:47], v[160:163], v[240:243]
ds_read_b64_tr_b16 v[40:41], v14 offset:8192
ds_read_b64_tr_b16 v[42:43], v14 offset:8448
v_mfma_f32_16x16x32_bf16 v[248:251], v[44:47], v[164:167], v[248:251]
s_waitcnt lgkmcnt(4)
v_mfma_f32_16x16x32_bf16 v[244:247], v[48:51], v[160:163], v[244:247]
ds_read_b64_tr_b16 v[44:45], v16 offset:8192
ds_read_b64_tr_b16 v[46:47], v16 offset:8448
v_mfma_f32_16x16x32_bf16 v[252:255], v[48:51], v[164:167], v[252:255]
v_mfma_f32_16x16x32_bf16 v[240:243], v[52:55], v[168:171], v[240:243]
ds_read_b64_tr_b16 v[48:49], v14 offset:12288
ds_read_b64_tr_b16 v[50:51], v14 offset:12544
v_mfma_f32_16x16x32_bf16 v[248:251], v[52:55], v[172:175], v[248:251]
s_waitcnt lgkmcnt(4)
v_mfma_f32_16x16x32_bf16 v[244:247], v[36:39], v[168:171], v[244:247]
ds_read_b64_tr_b16 v[52:53], v16 offset:12288
ds_read_b64_tr_b16 v[54:55], v16 offset:12544
v_mfma_f32_16x16x32_bf16 v[252:255], v[36:39], v[172:175], v[252:255]
v_mfma_f32_16x16x32_bf16 v[208:211], v[40:43], v[64:67], v[208:211]
s_barrier
ds_read_b64_tr_b16 v[36:37], v14 offset:16384
ds_read_b64_tr_b16 v[38:39], v14 offset:16640
v_mfma_f32_16x16x32_bf16 v[216:219], v[40:43], v[68:71], v[216:219]
s_waitcnt lgkmcnt(4)
v_mfma_f32_16x16x32_bf16 v[212:215], v[44:47], v[64:67], v[212:215]
ds_read_b64_tr_b16 v[40:41], v16 offset:16384
ds_read_b64_tr_b16 v[42:43], v16 offset:16640
v_mfma_f32_16x16x32_bf16 v[220:223], v[44:47], v[68:71], v[220:223]
v_mul_f32 v240, v240, abs(v240)
v_mul_f32 v241, v241, abs(v241)
v_mfma_f32_16x16x32_bf16 v[208:211], v[48:51], v[72:75], v[208:211]
ds_read_b64_tr_b16 v[44:45], v14 offset:20480
ds_read_b64_tr_b16 v[46:47], v14 offset:20736
v_mfma_f32_16x16x32_bf16 v[216:219], v[48:51], v[76:79], v[216:219]
s_waitcnt lgkmcnt(4)
v_mul_f32 v242, v242, abs(v242)
v_mul_f32 v243, v243, abs(v243)
v_mfma_f32_16x16x32_bf16 v[212:215], v[52:55], v[72:75], v[212:215]
ds_read_b64_tr_b16 v[48:49], v16 offset:20480
ds_read_b64_tr_b16 v[50:51], v16 offset:20736
v_mfma_f32_16x16x32_bf16 v[220:223], v[52:55], v[76:79], v[220:223]
v_mul_f32 v244, v244, abs(v244)
v_mul_f32 v245, v245, abs(v245)
v_mfma_f32_16x16x32_bf16 v[208:211], v[36:39], v[80:83], v[208:211]
ds_read_b64_tr_b16 v[52:53], v14 offset:24576
ds_read_b64_tr_b16 v[54:55], v14 offset:24832
v_mfma_f32_16x16x32_bf16 v[216:219], v[36:39], v[84:87], v[216:219]
s_waitcnt lgkmcnt(4)
v_mul_f32 v246, v246, abs(v246)
v_mul_f32 v247, v247, abs(v247)
v_mfma_f32_16x16x32_bf16 v[212:215], v[40:43], v[80:83], v[212:215]
ds_read_b64_tr_b16 v[36:37], v16 offset:24576
ds_read_b64_tr_b16 v[38:39], v16 offset:24832
v_mfma_f32_16x16x32_bf16 v[220:223], v[40:43], v[84:87], v[220:223]
v_cvt_pk_bf16_f32 v192, v240, v241
v_cvt_pk_bf16_f32 v193, v242, v243
v_mfma_f32_16x16x32_bf16 v[208:211], v[44:47], v[88:91], v[208:211]
ds_read_b64_tr_b16 v[40:41], v14 offset:28672
ds_read_b64_tr_b16 v[42:43], v14 offset:28928
v_mfma_f32_16x16x32_bf16 v[216:219], v[44:47], v[92:95], v[216:219]
s_waitcnt lgkmcnt(4)
v_cvt_pk_bf16_f32 v194, v244, v245
v_cvt_pk_bf16_f32 v195, v246, v247
v_mfma_f32_16x16x32_bf16 v[212:215], v[48:51], v[88:91], v[212:215]
ds_read_b64_tr_b16 v[44:45], v16 offset:28672
ds_read_b64_tr_b16 v[46:47], v16 offset:28928
v_mfma_f32_16x16x32_bf16 v[220:223], v[48:51], v[92:95], v[220:223]
v_pk_max_i16 v192, v192, 0
v_pk_max_i16 v193, v193, 0
v_mfma_f32_16x16x32_bf16 v[208:211], v[52:55], v[96:99], v[208:211]
s_barrier
ds_read_b64_tr_b16 v[48:49], v14 offset:32768
ds_read_b64_tr_b16 v[50:51], v14 offset:33024
v_mfma_f32_16x16x32_bf16 v[216:219], v[52:55], v[100:103], v[216:219]
s_waitcnt lgkmcnt(4)
v_pk_max_i16 v194, v194, 0
v_pk_max_i16 v195, v195, 0
v_mfma_f32_16x16x32_bf16 v[212:215], v[36:39], v[96:99], v[212:215]
ds_read_b64_tr_b16 v[52:53], v16 offset:32768
ds_read_b64_tr_b16 v[54:55], v16 offset:33024
v_mfma_f32_16x16x32_bf16 v[220:223], v[36:39], v[100:103], v[220:223]
v_mul_f32 v248, v248, abs(v248)
v_mul_f32 v249, v249, abs(v249)
v_mfma_f32_16x16x32_bf16 v[208:211], v[40:43], v[104:107], v[208:211]
ds_read_b64_tr_b16 v[36:37], v14 offset:36864
ds_read_b64_tr_b16 v[38:39], v14 offset:37120
v_mfma_f32_16x16x32_bf16 v[216:219], v[40:43], v[108:111], v[216:219]
s_waitcnt lgkmcnt(4)
v_mul_f32 v250, v250, abs(v250)
v_mul_f32 v251, v251, abs(v251)
v_mfma_f32_16x16x32_bf16 v[212:215], v[44:47], v[104:107], v[212:215]
ds_read_b64_tr_b16 v[40:41], v16 offset:36864
ds_read_b64_tr_b16 v[42:43], v16 offset:37120
v_mfma_f32_16x16x32_bf16 v[220:223], v[44:47], v[108:111], v[220:223]
v_mul_f32 v252, v252, abs(v252)
v_mul_f32 v253, v253, abs(v253)
v_mfma_f32_16x16x32_bf16 v[208:211], v[48:51], v[112:115], v[208:211]
ds_read_b64_tr_b16 v[44:45], v14 offset:40960
ds_read_b64_tr_b16 v[46:47], v14 offset:41216
v_mfma_f32_16x16x32_bf16 v[216:219], v[48:51], v[116:119], v[216:219]
s_waitcnt lgkmcnt(4)
v_mul_f32 v254, v254, abs(v254)
v_mul_f32 v255, v255, abs(v255)
v_mfma_f32_16x16x32_bf16 v[212:215], v[52:55], v[112:115], v[212:215]
ds_read_b64_tr_b16 v[48:49], v16 offset:40960
ds_read_b64_tr_b16 v[50:51], v16 offset:41216
v_mfma_f32_16x16x32_bf16 v[220:223], v[52:55], v[116:119], v[220:223]
v_cvt_pk_bf16_f32 v196, v248, v249
v_cvt_pk_bf16_f32 v197, v250, v251
v_mfma_f32_16x16x32_bf16 v[208:211], v[36:39], v[120:123], v[208:211]
ds_read_b64_tr_b16 v[52:53], v14 offset:45056
ds_read_b64_tr_b16 v[54:55], v14 offset:45312
v_mfma_f32_16x16x32_bf16 v[216:219], v[36:39], v[124:127], v[216:219]
s_waitcnt lgkmcnt(4)
v_cvt_pk_bf16_f32 v198, v252, v253
v_cvt_pk_bf16_f32 v199, v254, v255
v_mfma_f32_16x16x32_bf16 v[212:215], v[40:43], v[120:123], v[212:215]
ds_read_b64_tr_b16 v[36:37], v16 offset:45056
ds_read_b64_tr_b16 v[38:39], v16 offset:45312
v_mfma_f32_16x16x32_bf16 v[220:223], v[40:43], v[124:127], v[220:223]
v_pk_max_i16 v196, v196, 0
v_pk_max_i16 v197, v197, 0
v_mfma_f32_16x16x32_bf16 v[208:211], v[44:47], v[128:131], v[208:211]
s_barrier
ds_read_b64_tr_b16 v[40:41], v14 offset:49152
ds_read_b64_tr_b16 v[42:43], v14 offset:49408
v_mfma_f32_16x16x32_bf16 v[216:219], v[44:47], v[132:135], v[216:219]
s_waitcnt lgkmcnt(4)
v_pk_max_i16 v198, v198, 0
v_pk_max_i16 v199, v199, 0
v_mfma_f32_16x16x32_bf16 v[212:215], v[48:51], v[128:131], v[212:215]
ds_read_b64_tr_b16 v[44:45], v16 offset:49152
ds_read_b64_tr_b16 v[46:47], v16 offset:49408
v_mfma_f32_16x16x32_bf16 v[220:223], v[48:51], v[132:135], v[220:223]
v_mfma_f32_16x16x32_bf16 v[208:211], v[52:55], v[136:139], v[208:211]
ds_read_b64_tr_b16 v[48:49], v14 offset:53248
ds_read_b64_tr_b16 v[50:51], v14 offset:53504
v_mfma_f32_16x16x32_bf16 v[216:219], v[52:55], v[140:143], v[216:219]
s_waitcnt lgkmcnt(4)
v_mfma_f32_16x16x32_bf16 v[212:215], v[36:39], v[136:139], v[212:215]
ds_read_b64_tr_b16 v[52:53], v16 offset:53248
ds_read_b64_tr_b16 v[54:55], v16 offset:53504
v_mfma_f32_16x16x32_bf16 v[220:223], v[36:39], v[140:143], v[220:223]
v_mfma_f32_16x16x32_bf16 v[208:211], v[40:43], v[144:147], v[208:211]
ds_read_b64_tr_b16 v[36:37], v14 offset:57344
ds_read_b64_tr_b16 v[38:39], v14 offset:57600
v_mfma_f32_16x16x32_bf16 v[216:219], v[40:43], v[148:151], v[216:219]
s_waitcnt lgkmcnt(4)
v_mfma_f32_16x16x32_bf16 v[212:215], v[44:47], v[144:147], v[212:215]
ds_read_b64_tr_b16 v[40:41], v16 offset:57344
ds_read_b64_tr_b16 v[42:43], v16 offset:57600
v_mfma_f32_16x16x32_bf16 v[220:223], v[44:47], v[148:151], v[220:223]
v_mfma_f32_16x16x32_bf16 v[208:211], v[48:51], v[152:155], v[208:211]
ds_read_b64_tr_b16 v[44:45], v14 offset:61440
ds_read_b64_tr_b16 v[46:47], v14 offset:61696
v_mfma_f32_16x16x32_bf16 v[216:219], v[48:51], v[156:159], v[216:219]
s_waitcnt lgkmcnt(4)
v_mfma_f32_16x16x32_bf16 v[212:215], v[52:55], v[152:155], v[212:215]
ds_read_b64_tr_b16 v[48:49], v16 offset:61440
ds_read_b64_tr_b16 v[50:51], v16 offset:61696
v_mfma_f32_16x16x32_bf16 v[220:223], v[52:55], v[156:159], v[220:223]
v_mfma_f32_16x16x32_bf16 v[208:211], v[36:39], v[160:163], v[208:211]
s_barrier
ds_read_b64_tr_b16 v[52:53], v29 offset:0
ds_read_b64_tr_b16 v[54:55], v29 offset:256
v_mfma_f32_16x16x32_bf16 v[216:219], v[36:39], v[164:167], v[216:219]
s_waitcnt lgkmcnt(4)
v_mfma_f32_16x16x32_bf16 v[212:215], v[40:43], v[160:163], v[212:215]
ds_read_b64_tr_b16 v[36:37], v31 offset:0
ds_read_b64_tr_b16 v[38:39], v31 offset:256
v_mfma_f32_16x16x32_bf16 v[220:223], v[40:43], v[164:167], v[220:223]
v_mfma_f32_16x16x32_bf16 v[208:211], v[44:47], v[168:171], v[208:211]
ds_read_b64_tr_b16 v[40:41], v29 offset:8192
ds_read_b64_tr_b16 v[42:43], v29 offset:8448
v_mfma_f32_16x16x32_bf16 v[216:219], v[44:47], v[172:175], v[216:219]
s_waitcnt lgkmcnt(4)
v_mfma_f32_16x16x32_bf16 v[212:215], v[48:51], v[168:171], v[212:215]
ds_read_b64_tr_b16 v[44:45], v31 offset:8192
ds_read_b64_tr_b16 v[46:47], v31 offset:8448
v_mfma_f32_16x16x32_bf16 v[220:223], v[48:51], v[172:175], v[220:223]
v_mfma_f32_16x16x32_bf16 v[240:243], v[52:55], v[176:179], 0
s_barrier
ds_read_b64_tr_b16 v[48:49], v29 offset:16384
ds_read_b64_tr_b16 v[50:51], v29 offset:16640
v_mfma_f32_16x16x32_bf16 v[248:251], v[52:55], v[180:183], 0
s_waitcnt lgkmcnt(4)
v_mfma_f32_16x16x32_bf16 v[244:247], v[36:39], v[176:179], 0
ds_read_b64_tr_b16 v[52:53], v31 offset:16384
ds_read_b64_tr_b16 v[54:55], v31 offset:16640
v_mfma_f32_16x16x32_bf16 v[252:255], v[36:39], v[180:183], 0
v_mul_f32 v208, v208, abs(v208)
v_mul_f32 v209, v209, abs(v209)
v_mul_f32 v210, v210, abs(v210)
v_mul_f32 v211, v211, abs(v211)
v_mul_f32 v212, v212, abs(v212)
v_mul_f32 v213, v213, abs(v213)
v_mul_f32 v214, v214, abs(v214)
v_mul_f32 v215, v215, abs(v215)
v_mfma_f32_16x16x32_bf16 v[240:243], v[40:43], v[184:187], v[240:243]
ds_read_b64_tr_b16 v[36:37], v29 offset:24576
ds_read_b64_tr_b16 v[38:39], v29 offset:24832
v_mfma_f32_16x16x32_bf16 v[248:251], v[40:43], v[188:191], v[248:251]
s_waitcnt lgkmcnt(4)
v_cvt_pk_bf16_f32 v200, v208, v209
v_cvt_pk_bf16_f32 v201, v210, v211
v_cvt_pk_bf16_f32 v202, v212, v213
v_cvt_pk_bf16_f32 v203, v214, v215
v_pk_max_i16 v200, v200, 0
v_pk_max_i16 v201, v201, 0
v_pk_max_i16 v202, v202, 0
v_pk_max_i16 v203, v203, 0
v_mfma_f32_16x16x32_bf16 v[244:247], v[44:47], v[184:187], v[244:247]
ds_read_b64_tr_b16 v[40:41], v31 offset:24576
ds_read_b64_tr_b16 v[42:43], v31 offset:24832
v_mfma_f32_16x16x32_bf16 v[252:255], v[44:47], v[188:191], v[252:255]
v_mul_f32 v216, v216, abs(v216)
v_mul_f32 v217, v217, abs(v217)
v_mul_f32 v218, v218, abs(v218)
v_mul_f32 v219, v219, abs(v219)
v_mul_f32 v220, v220, abs(v220)
v_mul_f32 v221, v221, abs(v221)
v_mul_f32 v222, v222, abs(v222)
v_mul_f32 v223, v223, abs(v223)
v_mfma_f32_16x16x32_bf16 v[240:243], v[48:51], v[192:195], v[240:243]
s_barrier
ds_read_b64_tr_b16 v[44:45], v28 offset:0
ds_read_b64_tr_b16 v[46:47], v28 offset:256
v_mfma_f32_16x16x32_bf16 v[248:251], v[48:51], v[196:199], v[248:251]
s_waitcnt lgkmcnt(4)
v_cvt_pk_bf16_f32 v204, v216, v217
v_cvt_pk_bf16_f32 v205, v218, v219
v_cvt_pk_bf16_f32 v206, v220, v221
v_cvt_pk_bf16_f32 v207, v222, v223
v_pk_max_i16 v204, v204, 0
v_pk_max_i16 v205, v205, 0
v_pk_max_i16 v206, v206, 0
v_pk_max_i16 v207, v207, 0
v_mfma_f32_16x16x32_bf16 v[244:247], v[52:55], v[192:195], v[244:247]
ds_read_b64_tr_b16 v[48:49], v30 offset:0
ds_read_b64_tr_b16 v[50:51], v30 offset:256
v_mfma_f32_16x16x32_bf16 v[252:255], v[52:55], v[196:199], v[252:255]
s_mov_b32 s40, 757275152
s_mov_b32 s41, 984630
s_mov_b32 s42, 1430467104
s_mov_b32 s43, 1508966
s_cmp_eq_u32 s4, 6
s_cselect_b32 s40, 285737008, s40
s_cselect_b32 s41, 3089949, s41
s_cselect_b32 s42, 554696800, s42
v_mfma_f32_16x16x32_bf16 v[224:227], v[36:39], v[176:179], 0
ds_read_b64_tr_b16 v[52:53], v28 offset:8192
ds_read_b64_tr_b16 v[54:55], v28 offset:8448
v_mfma_f32_16x16x32_bf16 v[232:235], v[36:39], v[180:183], 0
s_waitcnt lgkmcnt(4)
s_cselect_b32 s43, 5719605, s43
s_bfe_u32 s48, s40, 0x80000
s_lshl_b32 s48, s48, 13
s_bfe_u32 s8, s42, 0x80000
s_lshl_b32 s8, s8, 3
s_bfe_u32 s49, s40, 0x80008
s_lshl_b32 s49, s49, 13
s_bfe_u32 s9, s42, 0x80008
v_mfma_f32_16x16x32_bf16 v[228:231], v[40:43], v[176:179], 0
ds_read_b64_tr_b16 v[36:37], v30 offset:8192
ds_read_b64_tr_b16 v[38:39], v30 offset:8448
v_mfma_f32_16x16x32_bf16 v[236:239], v[40:43], v[180:183], 0
s_lshl_b32 s9, s9, 3
s_bfe_u32 s50, s40, 0x80010
s_lshl_b32 s50, s50, 13
s_bfe_u32 s10, s42, 0x80010
s_lshl_b32 s10, s10, 3
s_bfe_u32 s51, s40, 0x80018
s_lshl_b32 s51, s51, 13
s_bfe_u32 s11, s42, 0x80018
v_mfma_f32_16x16x32_bf16 v[224:227], v[44:47], v[184:187], v[224:227]
s_barrier
ds_read_b64_tr_b16 v[40:41], v28 offset:16384
ds_read_b64_tr_b16 v[42:43], v28 offset:16640
v_mfma_f32_16x16x32_bf16 v[232:235], v[44:47], v[188:191], v[232:235]
s_waitcnt lgkmcnt(4)
s_lshl_b32 s11, s11, 3
s_bfe_u32 s52, s41, 0x80000
s_lshl_b32 s52, s52, 13
s_bfe_u32 s12, s43, 0x80000
s_lshl_b32 s12, s12, 3
s_bfe_u32 s53, s41, 0x80008
s_lshl_b32 s53, s53, 13
s_bfe_u32 s13, s43, 0x80008
v_mfma_f32_16x16x32_bf16 v[228:231], v[48:51], v[184:187], v[228:231]
ds_read_b64_tr_b16 v[44:45], v30 offset:16384
ds_read_b64_tr_b16 v[46:47], v30 offset:16640
v_mfma_f32_16x16x32_bf16 v[236:239], v[48:51], v[188:191], v[236:239]
s_lshl_b32 s13, s13, 3
s_bfe_u32 s54, s41, 0x80010
s_lshl_b32 s54, s54, 13
s_bfe_u32 s14, s43, 0x80010
s_lshl_b32 s14, s14, 3
s_mul_i32 s59, s5, 458752
s_lshl_b32 s60, s3, 11
s_add_u32 s59, s59, s60
v_mfma_f32_16x16x32_bf16 v[224:227], v[52:55], v[192:195], v[224:227]
ds_read_b64_tr_b16 v[48:49], v28 offset:24576
ds_read_b64_tr_b16 v[50:51], v28 offset:24832
v_mfma_f32_16x16x32_bf16 v[232:235], v[52:55], v[196:199], v[232:235]
s_waitcnt lgkmcnt(4)
s_add_u32 s59, s59, 6291456
v_add_u32 v24, s59, v20
v_and_b32 v13, 31, v0
v_mul_u32_u24 v13, 0x9e3a, v13
v_or_b32 v13, 1, v13
s_mul_i32 s59, s5, 896
s_lshl_b32 s60, s3, 15
s_add_u32 s59, s59, s60
v_mfma_f32_16x16x32_bf16 v[228:231], v[36:39], v[192:195], v[228:231]
ds_read_b64_tr_b16 v[52:53], v30 offset:24576
ds_read_b64_tr_b16 v[54:55], v30 offset:24832
v_mfma_f32_16x16x32_bf16 v[236:239], v[36:39], v[196:199], v[236:239]
s_add_u32 s59, s59, 23068672
v_subrev_u32 v21, 63, v0
v_and_b32 v21, 2147483648, v21
v_or_b32 v21, s59, v21
ds_write_b128 v11, v[176:179] offset:0
ds_write_b128 v11, v[180:183] offset:1024
ds_write_b128 v11, v[184:187] offset:4096
ds_write_b128 v11, v[188:191] offset:5120
ds_write_b128 v11, v[192:195] offset:8192
ds_write_b128 v11, v[196:199] offset:9216
ds_write_b128 v11, v[200:203] offset:12288
ds_write_b128 v11, v[204:207] offset:13312
v_mfma_f32_16x16x32_bf16 v[240:243], v[40:43], v[200:203], v[240:243]
v_mfma_f32_16x16x32_bf16 v[248:251], v[40:43], v[204:207], v[248:251]
s_waitcnt lgkmcnt(10)
v_mfma_f32_16x16x32_bf16 v[244:247], v[44:47], v[200:203], v[244:247]
v_mfma_f32_16x16x32_bf16 v[252:255], v[44:47], v[204:207], v[252:255]
v_mfma_f32_16x16x32_bf16 v[224:227], v[48:51], v[200:203], v[224:227]
v_mfma_f32_16x16x32_bf16 v[232:235], v[48:51], v[204:207], v[232:235]
s_waitcnt lgkmcnt(8)
v_mfma_f32_16x16x32_bf16 v[228:231], v[52:55], v[200:203], v[228:231]
v_mfma_f32_16x16x32_bf16 v[236:239], v[52:55], v[204:207], v[236:239]
s_waitcnt lgkmcnt(0)
s_barrier
ds_read_b128 v[64:67], v10 offset:0
ds_read_b128 v[68:71], v10 offset:1024
ds_read_b64_tr_b16 v[36:37], v33 offset:0
ds_read_b64_tr_b16 v[38:39], v33 offset:256
ds_read_b64_tr_b16 v[40:41], v35 offset:0
ds_read_b64_tr_b16 v[42:43], v35 offset:256
ds_read_b128 v[72:75], v10 offset:4096
ds_read_b128 v[76:79], v10 offset:5120
ds_read_b64_tr_b16 v[44:45], v33 offset:8192
ds_read_b64_tr_b16 v[46:47], v33 offset:8448
ds_read_b64_tr_b16 v[48:49], v35 offset:8192
ds_read_b64_tr_b16 v[50:51], v35 offset:8448
s_waitcnt lgkmcnt(8)
v_mfma_f32_16x16x32_bf16 v[240:243], v[36:39], v[64:67], v[240:243]
ds_read_b128 v[80:83], v10 offset:8192
ds_read_b128 v[84:87], v10 offset:9216
ds_read_b64_tr_b16 v[52:53], v33 offset:16384
ds_read_b64_tr_b16 v[54:55], v33 offset:16640
v_mfma_f32_16x16x32_bf16 v[248:251], v[36:39], v[68:71], v[248:251]
s_waitcnt lgkmcnt(6)
v_mfma_f32_16x16x32_bf16 v[244:247], v[40:43], v[64:67], v[244:247]
ds_read_b64_tr_b16 v[36:37], v35 offset:16384
ds_read_b64_tr_b16 v[38:39], v35 offset:16640
v_mfma_f32_16x16x32_bf16 v[252:255], v[40:43], v[68:71], v[252:255]
v_mfma_f32_16x16x32_bf16 v[240:243], v[44:47], v[72:75], v[240:243]
ds_read_b128 v[88:91], v10 offset:12288
ds_read_b128 v[92:95], v10 offset:13312
ds_read_b64_tr_b16 v[40:41], v32 offset:16384
ds_read_b64_tr_b16 v[42:43], v32 offset:16640
v_mfma_f32_16x16x32_bf16 v[248:251], v[44:47], v[76:79], v[248:251]
s_waitcnt lgkmcnt(6)
v_mfma_f32_16x16x32_bf16 v[244:247], v[48:51], v[72:75], v[244:247]
ds_read_b64_tr_b16 v[44:45], v34 offset:16384
ds_read_b64_tr_b16 v[46:47], v34 offset:16640
v_mfma_f32_16x16x32_bf16 v[252:255], v[48:51], v[76:79], v[252:255]
v_mfma_f32_16x16x32_bf16 v[240:243], v[52:55], v[80:83], v[240:243]
ds_read_b64_tr_b16 v[48:49], v33 offset:24576
ds_read_b64_tr_b16 v[50:51], v33 offset:24832
v_mfma_f32_16x16x32_bf16 v[248:251], v[52:55], v[84:87], v[248:251]
s_waitcnt lgkmcnt(4)
v_mfma_f32_16x16x32_bf16 v[244:247], v[36:39], v[80:83], v[244:247]
ds_read_b64_tr_b16 v[52:53], v35 offset:24576
ds_read_b64_tr_b16 v[54:55], v35 offset:24832
v_mfma_f32_16x16x32_bf16 v[252:255], v[36:39], v[84:87], v[252:255]
v_mfma_f32_16x16x32_bf16 v[240:243], v[40:43], v[88:91], v[240:243]
ds_read_b64_tr_b16 v[36:37], v32 offset:0
ds_read_b64_tr_b16 v[38:39], v32 offset:256
v_mfma_f32_16x16x32_bf16 v[248:251], v[40:43], v[92:95], v[248:251]
s_waitcnt lgkmcnt(4)
v_mfma_f32_16x16x32_bf16 v[244:247], v[44:47], v[88:91], v[244:247]
ds_read_b64_tr_b16 v[40:41], v34 offset:0
ds_read_b64_tr_b16 v[42:43], v34 offset:256
v_mfma_f32_16x16x32_bf16 v[252:255], v[44:47], v[92:95], v[252:255]
v_mfma_f32_16x16x32_bf16 v[224:227], v[48:51], v[64:67], v[224:227]
ds_read_b64_tr_b16 v[44:45], v32 offset:8192
ds_read_b64_tr_b16 v[46:47], v32 offset:8448
v_mfma_f32_16x16x32_bf16 v[232:235], v[48:51], v[68:71], v[232:235]
s_waitcnt lgkmcnt(4)
v_mfma_f32_16x16x32_bf16 v[228:231], v[52:55], v[64:67], v[228:231]
ds_read_b64_tr_b16 v[48:49], v34 offset:8192
ds_read_b64_tr_b16 v[50:51], v34 offset:8448
v_mfma_f32_16x16x32_bf16 v[236:239], v[52:55], v[68:71], v[236:239]
v_cvt_pk_bf16_f32 v240, v240, v241
v_cvt_pk_bf16_f32 v241, v242, v243
v_cvt_pk_bf16_f32 v242, v244, v245
v_mfma_f32_16x16x32_bf16 v[224:227], v[36:39], v[72:75], v[224:227]
ds_read_b64_tr_b16 v[52:53], v32 offset:24576
ds_read_b64_tr_b16 v[54:55], v32 offset:24832
v_mfma_f32_16x16x32_bf16 v[232:235], v[36:39], v[76:79], v[232:235]
s_waitcnt lgkmcnt(4)
v_cvt_pk_bf16_f32 v243, v246, v247
buffer_store_dwordx4 v[240:243], v24, s[36:39], s48 offen offset:0 sc1
v_cvt_pk_bf16_f32 v244, v248, v249
v_mfma_f32_16x16x32_bf16 v[228:231], v[40:43], v[72:75], v[228:231]
ds_read_b64_tr_b16 v[36:37], v34 offset:24576
ds_read_b64_tr_b16 v[38:39], v34 offset:24832
v_mfma_f32_16x16x32_bf16 v[236:239], v[40:43], v[76:79], v[236:239]
v_cvt_pk_bf16_f32 v245, v250, v251
v_cvt_pk_bf16_f32 v246, v252, v253
v_cvt_pk_bf16_f32 v247, v254, v255
v_mfma_f32_16x16x32_bf16 v[224:227], v[44:47], v[80:83], v[224:227]
s_barrier
ds_read_b64_tr_b16 v[40:41], v28 offset:32768
ds_read_b64_tr_b16 v[42:43], v28 offset:33024
v_mfma_f32_16x16x32_bf16 v[232:235], v[44:47], v[84:87], v[232:235]
s_waitcnt lgkmcnt(4)
v_add3_u32 v22, v240, v241, v242
v_add3_u32 v1, v243, v244, v245
v_add3_u32 v22, v22, v246, v247
v_mfma_f32_16x16x32_bf16 v[228:231], v[48:51], v[80:83], v[228:231]
ds_read_b64_tr_b16 v[44:45], v30 offset:32768
ds_read_b64_tr_b16 v[46:47], v30 offset:33024
v_mfma_f32_16x16x32_bf16 v[236:239], v[48:51], v[84:87], v[236:239]
v_add_u32 v22, v22, v1
v_mul_lo_u32 v22, v22, v13
buffer_store_dwordx4 v[244:247], v24, s[36:39], s48 offen offset:256 sc1
v_mfma_f32_16x16x32_bf16 v[224:227], v[52:55], v[88:91], v[224:227]
ds_read_b64_tr_b16 v[48:49], v32 offset:32768
ds_read_b64_tr_b16 v[50:51], v32 offset:33024
v_mfma_f32_16x16x32_bf16 v[232:235], v[52:55], v[92:95], v[232:235]
s_waitcnt lgkmcnt(4)
v_mfma_f32_16x16x32_bf16 v[228:231], v[36:39], v[88:91], v[228:231]
ds_read_b64_tr_b16 v[52:53], v34 offset:32768
ds_read_b64_tr_b16 v[54:55], v34 offset:33024
v_mfma_f32_16x16x32_bf16 v[236:239], v[36:39], v[92:95], v[236:239]
v_add_u32_dpp v22, v22, v22 row_ror:8 row_mask:0xf bank_mask:0xf
v_mfma_f32_16x16x32_bf16 v[208:211], v[40:43], v[176:179], 0
ds_read_b64_tr_b16 v[36:37], v28 offset:40960
ds_read_b64_tr_b16 v[38:39], v28 offset:41216
v_mfma_f32_16x16x32_bf16 v[216:219], v[40:43], v[180:183], 0
s_waitcnt lgkmcnt(4)
v_add_u32_dpp v22, v22, v22 row_ror:4 row_mask:0xf bank_mask:0xf
v_mfma_f32_16x16x32_bf16 v[212:215], v[44:47], v[176:179], 0
ds_read_b64_tr_b16 v[40:41], v30 offset:40960
ds_read_b64_tr_b16 v[42:43], v30 offset:41216
v_mfma_f32_16x16x32_bf16 v[220:223], v[44:47], v[180:183], 0
v_add_u32_dpp v22, v22, v22 row_ror:2 row_mask:0xf bank_mask:0xf
v_mfma_f32_16x16x32_bf16 v[208:211], v[48:51], v[64:67], v[208:211]
ds_read_b64_tr_b16 v[44:45], v32 offset:40960
ds_read_b64_tr_b16 v[46:47], v32 offset:41216
v_mfma_f32_16x16x32_bf16 v[216:219], v[48:51], v[68:71], v[216:219]
s_waitcnt lgkmcnt(4)
v_add_u32_dpp v22, v22, v22 row_ror:1 row_mask:0xf bank_mask:0xf
v_mfma_f32_16x16x32_bf16 v[212:215], v[52:55], v[64:67], v[212:215]
ds_read_b64_tr_b16 v[48:49], v34 offset:40960
ds_read_b64_tr_b16 v[50:51], v34 offset:41216
v_mfma_f32_16x16x32_bf16 v[220:223], v[52:55], v[68:71], v[220:223]
v_add_u32_dpp v22, v22, v22 row_bcast:15 row_mask:0xa bank_mask:0xf
v_mfma_f32_16x16x32_bf16 v[208:211], v[36:39], v[184:187], v[208:211]
s_barrier
ds_read_b64_tr_b16 v[52:53], v28 offset:49152
ds_read_b64_tr_b16 v[54:55], v28 offset:49408
v_mfma_f32_16x16x32_bf16 v[216:219], v[36:39], v[188:191], v[216:219]
s_waitcnt lgkmcnt(4)
v_add_u32_dpp v22, v22, v22 row_bcast:31 row_mask:0xc bank_mask:0xf
v_add_u32 v22, v22, v23
buffer_store_dwordx2 v[22:23], v21, s[36:39], s8 offen sc1
v_mfma_f32_16x16x32_bf16 v[212:215], v[40:43], v[184:187], v[212:215]
ds_read_b64_tr_b16 v[36:37], v30 offset:49152
ds_read_b64_tr_b16 v[38:39], v30 offset:49408
v_mfma_f32_16x16x32_bf16 v[220:223], v[40:43], v[188:191], v[220:223]
v_cvt_pk_bf16_f32 v224, v224, v225
v_cvt_pk_bf16_f32 v225, v226, v227
v_cvt_pk_bf16_f32 v226, v228, v229
v_mfma_f32_16x16x32_bf16 v[208:211], v[44:47], v[72:75], v[208:211]
ds_read_b64_tr_b16 v[40:41], v32 offset:49152
ds_read_b64_tr_b16 v[42:43], v32 offset:49408
v_mfma_f32_16x16x32_bf16 v[216:219], v[44:47], v[76:79], v[216:219]
s_waitcnt lgkmcnt(4)
v_cvt_pk_bf16_f32 v227, v230, v231
buffer_store_dwordx4 v[224:227], v24, s[36:39], s49 offen offset:0 sc1
v_cvt_pk_bf16_f32 v228, v232, v233
v_mfma_f32_16x16x32_bf16 v[212:215], v[48:51], v[72:75], v[212:215]
ds_read_b64_tr_b16 v[44:45], v34 offset:49152
ds_read_b64_tr_b16 v[46:47], v34 offset:49408
v_mfma_f32_16x16x32_bf16 v[220:223], v[48:51], v[76:79], v[220:223]
v_cvt_pk_bf16_f32 v229, v234, v235
v_cvt_pk_bf16_f32 v230, v236, v237
v_cvt_pk_bf16_f32 v231, v238, v239
v_mfma_f32_16x16x32_bf16 v[208:211], v[52:55], v[192:195], v[208:211]
ds_read_b64_tr_b16 v[48:49], v28 offset:57344
ds_read_b64_tr_b16 v[50:51], v28 offset:57600
v_mfma_f32_16x16x32_bf16 v[216:219], v[52:55], v[196:199], v[216:219]
s_waitcnt lgkmcnt(4)
v_add3_u32 v22, v224, v225, v226
v_add3_u32 v1, v227, v228, v229
v_add3_u32 v22, v22, v230, v231
v_mfma_f32_16x16x32_bf16 v[212:215], v[36:39], v[192:195], v[212:215]
ds_read_b64_tr_b16 v[52:53], v30 offset:57344
ds_read_b64_tr_b16 v[54:55], v30 offset:57600
v_mfma_f32_16x16x32_bf16 v[220:223], v[36:39], v[196:199], v[220:223]
v_add_u32 v22, v22, v1
v_mul_lo_u32 v22, v22, v13
buffer_store_dwordx4 v[228:231], v24, s[36:39], s49 offen offset:256 sc1
v_mfma_f32_16x16x32_bf16 v[208:211], v[40:43], v[80:83], v[208:211]
ds_read_b64_tr_b16 v[36:37], v32 offset:57344
ds_read_b64_tr_b16 v[38:39], v32 offset:57600
v_mfma_f32_16x16x32_bf16 v[216:219], v[40:43], v[84:87], v[216:219]
s_waitcnt lgkmcnt(4)
v_mfma_f32_16x16x32_bf16 v[212:215], v[44:47], v[80:83], v[212:215]
ds_read_b64_tr_b16 v[40:41], v34 offset:57344
ds_read_b64_tr_b16 v[42:43], v34 offset:57600
v_mfma_f32_16x16x32_bf16 v[220:223], v[44:47], v[84:87], v[220:223]
v_add_u32_dpp v22, v22, v22 row_ror:8 row_mask:0xf bank_mask:0xf
v_mfma_f32_16x16x32_bf16 v[208:211], v[48:51], v[200:203], v[208:211]
s_barrier
ds_read_b64_tr_b16 v[44:45], v12 offset:20480
ds_read_b64_tr_b16 v[46:47], v12 offset:20736
v_mfma_f32_16x16x32_bf16 v[216:219], v[48:51], v[204:207], v[216:219]
s_waitcnt lgkmcnt(4)
v_add_u32_dpp v22, v22, v22 row_ror:4 row_mask:0xf bank_mask:0xf
v_mfma_f32_16x16x32_bf16 v[212:215], v[52:55], v[200:203], v[212:215]
ds_read_b64_tr_b16 v[48:49], v18 offset:20480
ds_read_b64_tr_b16 v[50:51], v18 offset:20736
v_mfma_f32_16x16x32_bf16 v[220:223], v[52:55], v[204:207], v[220:223]
v_add_u32_dpp v22, v22, v22 row_ror:2 row_mask:0xf bank_mask:0xf
v_mfma_f32_16x16x32_bf16 v[208:211], v[36:39], v[88:91], v[208:211]
ds_read_b64_tr_b16 v[52:53], v19 offset:20480
ds_read_b64_tr_b16 v[54:55], v19 offset:20736
v_mfma_f32_16x16x32_bf16 v[216:219], v[36:39], v[92:95], v[216:219]
s_waitcnt lgkmcnt(4)
v_add_u32_dpp v22, v22, v22 row_ror:1 row_mask:0xf bank_mask:0xf
v_mfma_f32_16x16x32_bf16 v[212:215], v[40:43], v[88:91], v[212:215]
ds_read_b64_tr_b16 v[36:37], v60 offset:20480
ds_read_b64_tr_b16 v[38:39], v60 offset:20736
v_mfma_f32_16x16x32_bf16 v[220:223], v[40:43], v[92:95], v[220:223]
v_add_u32_dpp v22, v22, v22 row_bcast:15 row_mask:0xa bank_mask:0xf
s_nop 1
v_add_u32_dpp v22, v22, v22 row_bcast:31 row_mask:0xc bank_mask:0xf
v_add_u32 v22, v22, v23
buffer_store_dwordx2 v[22:23], v21, s[36:39], s9 offen sc1
v_mfma_f32_16x16x32_bf16 v[240:243], v[44:47], v[176:179], 0
ds_read_b64_tr_b16 v[40:41], v12 offset:51200
ds_read_b64_tr_b16 v[42:43], v12 offset:51456
v_mfma_f32_16x16x32_bf16 v[248:251], v[44:47], v[180:183], 0
s_waitcnt lgkmcnt(4)
v_mfma_f32_16x16x32_bf16 v[244:247], v[48:51], v[176:179], 0
ds_read_b64_tr_b16 v[44:45], v18 offset:51200
ds_read_b64_tr_b16 v[46:47], v18 offset:51456
v_mfma_f32_16x16x32_bf16 v[252:255], v[48:51], v[180:183], 0
v_cvt_pk_bf16_f32 v208, v208, v209
v_cvt_pk_bf16_f32 v209, v210, v211
v_mfma_f32_16x16x32_bf16 v[240:243], v[52:55], v[64:67], v[240:243]
ds_read_b64_tr_b16 v[48:49], v19 offset:51200
ds_read_b64_tr_b16 v[50:51], v19 offset:51456
v_mfma_f32_16x16x32_bf16 v[248:251], v[52:55], v[68:71], v[248:251]
s_waitcnt lgkmcnt(4)
v_cvt_pk_bf16_f32 v210, v212, v213
v_cvt_pk_bf16_f32 v211, v214, v215
v_mfma_f32_16x16x32_bf16 v[244:247], v[36:39], v[64:67], v[244:247]
ds_read_b64_tr_b16 v[52:53], v60 offset:51200
ds_read_b64_tr_b16 v[54:55], v60 offset:51456
v_mfma_f32_16x16x32_bf16 v[252:255], v[36:39], v[68:71], v[252:255]
buffer_store_dwordx4 v[208:211], v24, s[36:39], s50 offen offset:0 sc1
v_cvt_pk_bf16_f32 v212, v216, v217
v_mfma_f32_16x16x32_bf16 v[240:243], v[40:43], v[184:187], v[240:243]
s_barrier
ds_read_b64_tr_b16 v[36:37], v29 offset:0
ds_read_b64_tr_b16 v[38:39], v29 offset:256
v_mfma_f32_16x16x32_bf16 v[248:251], v[40:43], v[188:191], v[248:251]
s_waitcnt lgkmcnt(4)
v_cvt_pk_bf16_f32 v213, v218, v219
v_cvt_pk_bf16_f32 v214, v220, v221
v_mfma_f32_16x16x32_bf16 v[244:247], v[44:47], v[184:187], v[244:247]
ds_read_b64_tr_b16 v[40:41], v31 offset:0
ds_read_b64_tr_b16 v[42:43], v31 offset:256
v_mfma_f32_16x16x32_bf16 v[252:255], v[44:47], v[188:191], v[252:255]
v_cvt_pk_bf16_f32 v215, v222, v223
v_add3_u32 v22, v208, v209, v210
v_mfma_f32_16x16x32_bf16 v[240:243], v[48:51], v[72:75], v[240:243]
ds_read_b64_tr_b16 v[44:45], v33 offset:0
ds_read_b64_tr_b16 v[46:47], v33 offset:256
v_mfma_f32_16x16x32_bf16 v[248:251], v[48:51], v[76:79], v[248:251]
s_waitcnt lgkmcnt(4)
v_add3_u32 v1, v211, v212, v213
v_add3_u32 v22, v22, v214, v215
v_mfma_f32_16x16x32_bf16 v[244:247], v[52:55], v[72:75], v[244:247]
ds_read_b64_tr_b16 v[48:49], v35 offset:0
ds_read_b64_tr_b16 v[50:51], v35 offset:256
v_mfma_f32_16x16x32_bf16 v[252:255], v[52:55], v[76:79], v[252:255]
v_add_u32 v22, v22, v1
v_mul_lo_u32 v22, v22, v13
v_mfma_f32_16x16x32_bf16 v[240:243], v[36:39], v[192:195], v[240:243]
ds_read_b64_tr_b16 v[52:53], v29 offset:8192
ds_read_b64_tr_b16 v[54:55], v29 offset:8448
v_mfma_f32_16x16x32_bf16 v[248:251], v[36:39], v[196:199], v[248:251]
s_waitcnt lgkmcnt(4)
buffer_store_dwordx4 v[212:215], v24, s[36:39], s50 offen offset:256 sc1
v_mfma_f32_16x16x32_bf16 v[244:247], v[40:43], v[192:195], v[244:247]
ds_read_b64_tr_b16 v[36:37], v31 offset:8192
ds_read_b64_tr_b16 v[38:39], v31 offset:8448
v_mfma_f32_16x16x32_bf16 v[252:255], v[40:43], v[196:199], v[252:255]
v_add_u32_dpp v22, v22, v22 row_ror:8 row_mask:0xf bank_mask:0xf
v_mfma_f32_16x16x32_bf16 v[240:243], v[44:47], v[80:83], v[240:243]
ds_read_b64_tr_b16 v[40:41], v33 offset:8192
ds_read_b64_tr_b16 v[42:43], v33 offset:8448
v_mfma_f32_16x16x32_bf16 v[248:251], v[44:47], v[84:87], v[248:251]
s_waitcnt lgkmcnt(4)
v_add_u32_dpp v22, v22, v22 row_ror:4 row_mask:0xf bank_mask:0xf
v_mfma_f32_16x16x32_bf16 v[244:247], v[48:51], v[80:83], v[244:247]
ds_read_b64_tr_b16 v[44:45], v35 offset:8192
ds_read_b64_tr_b16 v[46:47], v35 offset:8448
v_mfma_f32_16x16x32_bf16 v[252:255], v[48:51], v[84:87], v[252:255]
v_add_u32_dpp v22, v22, v22 row_ror:2 row_mask:0xf bank_mask:0xf
v_mfma_f32_16x16x32_bf16 v[240:243], v[52:55], v[200:203], v[240:243]
s_barrier
ds_read_b64_tr_b16 v[48:49], v29 offset:16384
ds_read_b64_tr_b16 v[50:51], v29 offset:16640
v_mfma_f32_16x16x32_bf16 v[248:251], v[52:55], v[204:207], v[248:251]
s_waitcnt lgkmcnt(4)
v_add_u32_dpp v22, v22, v22 row_ror:1 row_mask:0xf bank_mask:0xf
v_mfma_f32_16x16x32_bf16 v[244:247], v[36:39], v[200:203], v[244:247]
ds_read_b64_tr_b16 v[52:53], v31 offset:16384
ds_read_b64_tr_b16 v[54:55], v31 offset:16640
v_mfma_f32_16x16x32_bf16 v[252:255], v[36:39], v[204:207], v[252:255]
v_add_u32_dpp v22, v22, v22 row_bcast:15 row_mask:0xa bank_mask:0xf
v_mfma_f32_16x16x32_bf16 v[240:243], v[40:43], v[88:91], v[240:243]
ds_read_b64_tr_b16 v[36:37], v33 offset:16384
ds_read_b64_tr_b16 v[38:39], v33 offset:16640
v_mfma_f32_16x16x32_bf16 v[248:251], v[40:43], v[92:95], v[248:251]
s_waitcnt lgkmcnt(4)
v_add_u32_dpp v22, v22, v22 row_bcast:31 row_mask:0xc bank_mask:0xf
v_add_u32 v22, v22, v23
v_mfma_f32_16x16x32_bf16 v[244:247], v[44:47], v[88:91], v[244:247]
ds_read_b64_tr_b16 v[40:41], v35 offset:16384
ds_read_b64_tr_b16 v[42:43], v35 offset:16640
v_mfma_f32_16x16x32_bf16 v[252:255], v[44:47], v[92:95], v[252:255]
buffer_store_dwordx2 v[22:23], v21, s[36:39], s10 offen sc1
v_mfma_f32_16x16x32_bf16 v[224:227], v[48:51], v[176:179], 0
ds_read_b64_tr_b16 v[44:45], v29 offset:24576
ds_read_b64_tr_b16 v[46:47], v29 offset:24832
v_mfma_f32_16x16x32_bf16 v[232:235], v[48:51], v[180:183], 0
s_waitcnt lgkmcnt(4)
v_mfma_f32_16x16x32_bf16 v[228:231], v[52:55], v[176:179], 0
ds_read_b64_tr_b16 v[48:49], v31 offset:24576
ds_read_b64_tr_b16 v[50:51], v31 offset:24832
v_mfma_f32_16x16x32_bf16 v[236:239], v[52:55], v[180:183], 0
v_cvt_pk_bf16_f32 v240, v240, v241
v_cvt_pk_bf16_f32 v241, v242, v243
v_cvt_pk_bf16_f32 v242, v244, v245
v_cvt_pk_bf16_f32 v243, v246, v247
v_mfma_f32_16x16x32_bf16 v[224:227], v[36:39], v[64:67], v[224:227]
ds_read_b64_tr_b16 v[52:53], v33 offset:24576
ds_read_b64_tr_b16 v[54:55], v33 offset:24832
v_mfma_f32_16x16x32_bf16 v[232:235], v[36:39], v[68:71], v[232:235]
s_waitcnt lgkmcnt(4)
buffer_store_dwordx4 v[240:243], v24, s[36:39], s51 offen offset:0 sc1
v_cvt_pk_bf16_f32 v244, v248, v249
v_cvt_pk_bf16_f32 v245, v250, v251
v_cvt_pk_bf16_f32 v246, v252, v253
v_mfma_f32_16x16x32_bf16 v[228:231], v[40:43], v[64:67], v[228:231]
ds_read_b64_tr_b16 v[36:37], v35 offset:24576
ds_read_b64_tr_b16 v[38:39], v35 offset:24832
v_mfma_f32_16x16x32_bf16 v[236:239], v[40:43], v[68:71], v[236:239]
v_cvt_pk_bf16_f32 v247, v254, v255
v_add3_u32 v22, v240, v241, v242
v_add3_u32 v1, v243, v244, v245
v_add3_u32 v22, v22, v246, v247
v_mfma_f32_16x16x32_bf16 v[224:227], v[44:47], v[184:187], v[224:227]
s_barrier
ds_read_b64_tr_b16 v[40:41], v28 offset:0
ds_read_b64_tr_b16 v[42:43], v28 offset:256
v_mfma_f32_16x16x32_bf16 v[232:235], v[44:47], v[188:191], v[232:235]
s_waitcnt lgkmcnt(4)
v_add_u32 v22, v22, v1
v_mul_lo_u32 v22, v22, v13
buffer_store_dwordx4 v[244:247], v24, s[36:39], s51 offen offset:256 sc1
v_mfma_f32_16x16x32_bf16 v[228:231], v[48:51], v[184:187], v[228:231]
ds_read_b64_tr_b16 v[44:45], v30 offset:0
ds_read_b64_tr_b16 v[46:47], v30 offset:256
v_mfma_f32_16x16x32_bf16 v[236:239], v[48:51], v[188:191], v[236:239]
v_add_u32_dpp v22, v22, v22 row_ror:8 row_mask:0xf bank_mask:0xf
s_nop 1
v_add_u32_dpp v22, v22, v22 row_ror:4 row_mask:0xf bank_mask:0xf
v_mfma_f32_16x16x32_bf16 v[224:227], v[52:55], v[72:75], v[224:227]
ds_read_b64_tr_b16 v[48:49], v32 offset:0
ds_read_b64_tr_b16 v[50:51], v32 offset:256
v_mfma_f32_16x16x32_bf16 v[232:235], v[52:55], v[76:79], v[232:235]
s_waitcnt lgkmcnt(4)
v_add_u32_dpp v22, v22, v22 row_ror:2 row_mask:0xf bank_mask:0xf
s_nop 1
v_add_u32_dpp v22, v22, v22 row_ror:1 row_mask:0xf bank_mask:0xf
v_mfma_f32_16x16x32_bf16 v[228:231], v[36:39], v[72:75], v[228:231]
ds_read_b64_tr_b16 v[52:53], v34 offset:0
ds_read_b64_tr_b16 v[54:55], v34 offset:256
v_mfma_f32_16x16x32_bf16 v[236:239], v[36:39], v[76:79], v[236:239]
v_add_u32_dpp v22, v22, v22 row_bcast:15 row_mask:0xa bank_mask:0xf
s_nop 1
v_add_u32_dpp v22, v22, v22 row_bcast:31 row_mask:0xc bank_mask:0xf
v_add_u32 v22, v22, v23
buffer_store_dwordx2 v[22:23], v21, s[36:39], s11 offen sc1
v_mfma_f32_16x16x32_bf16 v[224:227], v[40:43], v[192:195], v[224:227]
ds_read_b64_tr_b16 v[36:37], v28 offset:8192
ds_read_b64_tr_b16 v[38:39], v28 offset:8448
v_mfma_f32_16x16x32_bf16 v[232:235], v[40:43], v[196:199], v[232:235]
s_waitcnt lgkmcnt(4)
v_mfma_f32_16x16x32_bf16 v[228:231], v[44:47], v[192:195], v[228:231]
ds_read_b64_tr_b16 v[40:41], v30 offset:8192
ds_read_b64_tr_b16 v[42:43], v30 offset:8448
v_mfma_f32_16x16x32_bf16 v[236:239], v[44:47], v[196:199], v[236:239]
v_mfma_f32_16x16x32_bf16 v[224:227], v[48:51], v[80:83], v[224:227]
ds_read_b64_tr_b16 v[44:45], v32 offset:8192
ds_read_b64_tr_b16 v[46:47], v32 offset:8448
v_mfma_f32_16x16x32_bf16 v[232:235], v[48:51], v[84:87], v[232:235]
s_waitcnt lgkmcnt(4)
v_mfma_f32_16x16x32_bf16 v[228:231], v[52:55], v[80:83], v[228:231]
ds_read_b64_tr_b16 v[48:49], v34 offset:8192
ds_read_b64_tr_b16 v[50:51], v34 offset:8448
v_mfma_f32_16x16x32_bf16 v[236:239], v[52:55], v[84:87], v[236:239]
v_mfma_f32_16x16x32_bf16 v[224:227], v[36:39], v[200:203], v[224:227]
s_barrier
ds_read_b64_tr_b16 v[52:53], v28 offset:16384
ds_read_b64_tr_b16 v[54:55], v28 offset:16640
v_mfma_f32_16x16x32_bf16 v[232:235], v[36:39], v[204:207], v[232:235]
s_waitcnt lgkmcnt(4)
v_mfma_f32_16x16x32_bf16 v[228:231], v[40:43], v[200:203], v[228:231]
ds_read_b64_tr_b16 v[36:37], v30 offset:16384
ds_read_b64_tr_b16 v[38:39], v30 offset:16640
v_mfma_f32_16x16x32_bf16 v[236:239], v[40:43], v[204:207], v[236:239]
v_mfma_f32_16x16x32_bf16 v[224:227], v[44:47], v[88:91], v[224:227]
ds_read_b64_tr_b16 v[40:41], v32 offset:16384
ds_read_b64_tr_b16 v[42:43], v32 offset:16640
v_mfma_f32_16x16x32_bf16 v[232:235], v[44:47], v[92:95], v[232:235]
s_waitcnt lgkmcnt(4)
v_mfma_f32_16x16x32_bf16 v[228:231], v[48:51], v[88:91], v[228:231]
ds_read_b64_tr_b16 v[44:45], v34 offset:16384
ds_read_b64_tr_b16 v[46:47], v34 offset:16640
v_mfma_f32_16x16x32_bf16 v[236:239], v[48:51], v[92:95], v[236:239]
v_mfma_f32_16x16x32_bf16 v[208:211], v[52:55], v[176:179], 0
ds_read_b64_tr_b16 v[48:49], v28 offset:24576
ds_read_b64_tr_b16 v[50:51], v28 offset:24832
v_mfma_f32_16x16x32_bf16 v[216:219], v[52:55], v[180:183], 0
s_waitcnt lgkmcnt(4)
v_mfma_f32_16x16x32_bf16 v[212:215], v[36:39], v[176:179], 0
ds_read_b64_tr_b16 v[52:53], v30 offset:24576
ds_read_b64_tr_b16 v[54:55], v30 offset:24832
v_mfma_f32_16x16x32_bf16 v[220:223], v[36:39], v[180:183], 0
v_cvt_pk_bf16_f32 v224, v224, v225
v_cvt_pk_bf16_f32 v225, v226, v227
v_cvt_pk_bf16_f32 v226, v228, v229
v_cvt_pk_bf16_f32 v227, v230, v231
v_mfma_f32_16x16x32_bf16 v[208:211], v[40:43], v[64:67], v[208:211]
ds_read_b64_tr_b16 v[36:37], v32 offset:24576
ds_read_b64_tr_b16 v[38:39], v32 offset:24832
v_mfma_f32_16x16x32_bf16 v[216:219], v[40:43], v[68:71], v[216:219]
s_waitcnt lgkmcnt(4)
buffer_store_dwordx4 v[224:227], v24, s[36:39], s52 offen offset:0 sc1
v_cvt_pk_bf16_f32 v228, v232, v233
v_cvt_pk_bf16_f32 v229, v234, v235
v_cvt_pk_bf16_f32 v230, v236, v237
v_mfma_f32_16x16x32_bf16 v[212:215], v[44:47], v[64:67], v[212:215]
ds_read_b64_tr_b16 v[40:41], v34 offset:24576
ds_read_b64_tr_b16 v[42:43], v34 offset:24832
v_mfma_f32_16x16x32_bf16 v[220:223], v[44:47], v[68:71], v[220:223]
v_cvt_pk_bf16_f32 v231, v238, v239
v_add3_u32 v22, v224, v225, v226
v_add3_u32 v1, v227, v228, v229
v_add3_u32 v22, v22, v230, v231
v_mfma_f32_16x16x32_bf16 v[208:211], v[48:51], v[184:187], v[208:211]
s_barrier
ds_read_b64_tr_b16 v[44:45], v28 offset:32768
ds_read_b64_tr_b16 v[46:47], v28 offset:33024
v_mfma_f32_16x16x32_bf16 v[216:219], v[48:51], v[188:191], v[216:219]
s_waitcnt lgkmcnt(4)
v_add_u32 v22, v22, v1
v_mul_lo_u32 v22, v22, v13
buffer_store_dwordx4 v[228:231], v24, s[36:39], s52 offen offset:256 sc1
v_mfma_f32_16x16x32_bf16 v[212:215], v[52:55], v[184:187], v[212:215]
ds_read_b64_tr_b16 v[48:49], v30 offset:32768
ds_read_b64_tr_b16 v[50:51], v30 offset:33024
v_mfma_f32_16x16x32_bf16 v[220:223], v[52:55], v[188:191], v[220:223]
v_add_u32_dpp v22, v22, v22 row_ror:8 row_mask:0xf bank_mask:0xf
s_nop 1
v_add_u32_dpp v22, v22, v22 row_ror:4 row_mask:0xf bank_mask:0xf
v_mfma_f32_16x16x32_bf16 v[208:211], v[36:39], v[72:75], v[208:211]
ds_read_b64_tr_b16 v[52:53], v32 offset:32768
ds_read_b64_tr_b16 v[54:55], v32 offset:33024
v_mfma_f32_16x16x32_bf16 v[216:219], v[36:39], v[76:79], v[216:219]
s_waitcnt lgkmcnt(4)
v_add_u32_dpp v22, v22, v22 row_ror:2 row_mask:0xf bank_mask:0xf
s_nop 1
v_add_u32_dpp v22, v22, v22 row_ror:1 row_mask:0xf bank_mask:0xf
v_mfma_f32_16x16x32_bf16 v[212:215], v[40:43], v[72:75], v[212:215]
ds_read_b64_tr_b16 v[36:37], v34 offset:32768
ds_read_b64_tr_b16 v[38:39], v34 offset:33024
v_mfma_f32_16x16x32_bf16 v[220:223], v[40:43], v[76:79], v[220:223]
v_add_u32_dpp v22, v22, v22 row_bcast:15 row_mask:0xa bank_mask:0xf
s_nop 1
v_add_u32_dpp v22, v22, v22 row_bcast:31 row_mask:0xc bank_mask:0xf
v_add_u32 v22, v22, v23
buffer_store_dwordx2 v[22:23], v21, s[36:39], s12 offen sc1
v_mfma_f32_16x16x32_bf16 v[208:211], v[44:47], v[192:195], v[208:211]
ds_read_b64_tr_b16 v[40:41], v28 offset:40960
ds_read_b64_tr_b16 v[42:43], v28 offset:41216
v_mfma_f32_16x16x32_bf16 v[216:219], v[44:47], v[196:199], v[216:219]
s_waitcnt lgkmcnt(4)
v_mfma_f32_16x16x32_bf16 v[212:215], v[48:51], v[192:195], v[212:215]
ds_read_b64_tr_b16 v[44:45], v30 offset:40960
ds_read_b64_tr_b16 v[46:47], v30 offset:41216
v_mfma_f32_16x16x32_bf16 v[220:223], v[48:51], v[196:199], v[220:223]
v_mfma_f32_16x16x32_bf16 v[208:211], v[52:55], v[80:83], v[208:211]
ds_read_b64_tr_b16 v[48:49], v32 offset:40960
ds_read_b64_tr_b16 v[50:51], v32 offset:41216
v_mfma_f32_16x16x32_bf16 v[216:219], v[52:55], v[84:87], v[216:219]
s_waitcnt lgkmcnt(4)
v_mfma_f32_16x16x32_bf16 v[212:215], v[36:39], v[80:83], v[212:215]
ds_read_b64_tr_b16 v[52:53], v34 offset:40960
ds_read_b64_tr_b16 v[54:55], v34 offset:41216
v_mfma_f32_16x16x32_bf16 v[220:223], v[36:39], v[84:87], v[220:223]
v_mfma_f32_16x16x32_bf16 v[208:211], v[40:43], v[200:203], v[208:211]
s_barrier
ds_read_b64_tr_b16 v[36:37], v28 offset:49152
ds_read_b64_tr_b16 v[38:39], v28 offset:49408
v_mfma_f32_16x16x32_bf16 v[216:219], v[40:43], v[204:207], v[216:219]
s_waitcnt lgkmcnt(4)
v_mfma_f32_16x16x32_bf16 v[212:215], v[44:47], v[200:203], v[212:215]
ds_read_b64_tr_b16 v[40:41], v30 offset:49152
ds_read_b64_tr_b16 v[42:43], v30 offset:49408
v_mfma_f32_16x16x32_bf16 v[220:223], v[44:47], v[204:207], v[220:223]
v_mfma_f32_16x16x32_bf16 v[208:211], v[48:51], v[88:91], v[208:211]
ds_read_b64_tr_b16 v[44:45], v32 offset:49152
ds_read_b64_tr_b16 v[46:47], v32 offset:49408
v_mfma_f32_16x16x32_bf16 v[216:219], v[48:51], v[92:95], v[216:219]
s_waitcnt lgkmcnt(4)
v_mfma_f32_16x16x32_bf16 v[212:215], v[52:55], v[88:91], v[212:215]
ds_read_b64_tr_b16 v[48:49], v34 offset:49152
ds_read_b64_tr_b16 v[50:51], v34 offset:49408
v_mfma_f32_16x16x32_bf16 v[220:223], v[52:55], v[92:95], v[220:223]
v_mfma_f32_16x16x32_bf16 v[240:243], v[36:39], v[176:179], 0
ds_read_b64_tr_b16 v[52:53], v28 offset:57344
ds_read_b64_tr_b16 v[54:55], v28 offset:57600
v_mfma_f32_16x16x32_bf16 v[248:251], v[36:39], v[180:183], 0
s_waitcnt lgkmcnt(4)
v_mfma_f32_16x16x32_bf16 v[244:247], v[40:43], v[176:179], 0
ds_read_b64_tr_b16 v[36:37], v30 offset:57344
ds_read_b64_tr_b16 v[38:39], v30 offset:57600
v_mfma_f32_16x16x32_bf16 v[252:255], v[40:43], v[180:183], 0
v_cvt_pk_bf16_f32 v208, v208, v209
v_cvt_pk_bf16_f32 v209, v210, v211
v_cvt_pk_bf16_f32 v210, v212, v213
v_cvt_pk_bf16_f32 v211, v214, v215
v_mfma_f32_16x16x32_bf16 v[240:243], v[44:47], v[64:67], v[240:243]
ds_read_b64_tr_b16 v[40:41], v32 offset:57344
ds_read_b64_tr_b16 v[42:43], v32 offset:57600
v_mfma_f32_16x16x32_bf16 v[248:251], v[44:47], v[68:71], v[248:251]
s_waitcnt lgkmcnt(4)
buffer_store_dwordx4 v[208:211], v24, s[36:39], s53 offen offset:0 sc1
v_cvt_pk_bf16_f32 v212, v216, v217
v_cvt_pk_bf16_f32 v213, v218, v219
v_cvt_pk_bf16_f32 v214, v220, v221
v_mfma_f32_16x16x32_bf16 v[244:247], v[48:51], v[64:67], v[244:247]
ds_read_b64_tr_b16 v[44:45], v34 offset:57344
ds_read_b64_tr_b16 v[46:47], v34 offset:57600
v_mfma_f32_16x16x32_bf16 v[252:255], v[48:51], v[68:71], v[252:255]
v_cvt_pk_bf16_f32 v215, v222, v223
v_add3_u32 v22, v208, v209, v210
v_add3_u32 v1, v211, v212, v213
v_add3_u32 v22, v22, v214, v215
v_mfma_f32_16x16x32_bf16 v[240:243], v[52:55], v[184:187], v[240:243]
s_barrier
ds_read_b64_tr_b16 v[48:49], v29 offset:0
ds_read_b64_tr_b16 v[50:51], v29 offset:256
v_mfma_f32_16x16x32_bf16 v[248:251], v[52:55], v[188:191], v[248:251]
s_waitcnt lgkmcnt(4)
v_add_u32 v22, v22, v1
v_mul_lo_u32 v22, v22, v13
buffer_store_dwordx4 v[212:215], v24, s[36:39], s53 offen offset:256 sc1
v_mfma_f32_16x16x32_bf16 v[244:247], v[36:39], v[184:187], v[244:247]
ds_read_b64_tr_b16 v[52:53], v31 offset:0
ds_read_b64_tr_b16 v[54:55], v31 offset:256
v_mfma_f32_16x16x32_bf16 v[252:255], v[36:39], v[188:191], v[252:255]
v_add_u32_dpp v22, v22, v22 row_ror:8 row_mask:0xf bank_mask:0xf
s_nop 1
v_add_u32_dpp v22, v22, v22 row_ror:4 row_mask:0xf bank_mask:0xf
v_mfma_f32_16x16x32_bf16 v[240:243], v[40:43], v[72:75], v[240:243]
ds_read_b64_tr_b16 v[36:37], v33 offset:0
ds_read_b64_tr_b16 v[38:39], v33 offset:256
v_mfma_f32_16x16x32_bf16 v[248:251], v[40:43], v[76:79], v[248:251]
s_waitcnt lgkmcnt(4)
v_add_u32_dpp v22, v22, v22 row_ror:2 row_mask:0xf bank_mask:0xf
s_nop 1
v_add_u32_dpp v22, v22, v22 row_ror:1 row_mask:0xf bank_mask:0xf
v_mfma_f32_16x16x32_bf16 v[244:247], v[44:47], v[72:75], v[244:247]
ds_read_b64_tr_b16 v[40:41], v35 offset:0
ds_read_b64_tr_b16 v[42:43], v35 offset:256
v_mfma_f32_16x16x32_bf16 v[252:255], v[44:47], v[76:79], v[252:255]
v_add_u32_dpp v22, v22, v22 row_bcast:15 row_mask:0xa bank_mask:0xf
s_nop 1
v_add_u32_dpp v22, v22, v22 row_bcast:31 row_mask:0xc bank_mask:0xf
v_add_u32 v22, v22, v23
buffer_store_dwordx2 v[22:23], v21, s[36:39], s13 offen sc1
v_mfma_f32_16x16x32_bf16 v[240:243], v[48:51], v[192:195], v[240:243]
ds_read_b64_tr_b16 v[44:45], v29 offset:8192
ds_read_b64_tr_b16 v[46:47], v29 offset:8448
v_mfma_f32_16x16x32_bf16 v[248:251], v[48:51], v[196:199], v[248:251]
s_waitcnt lgkmcnt(4)
s_barrier
v_mfma_f32_16x16x32_bf16 v[244:247], v[52:55], v[192:195], v[244:247]
ds_read_b64_tr_b16 v[48:49], v31 offset:8192
ds_read_b64_tr_b16 v[50:51], v31 offset:8448
v_mfma_f32_16x16x32_bf16 v[252:255], v[52:55], v[196:199], v[252:255]
v_mfma_f32_16x16x32_bf16 v[240:243], v[36:39], v[80:83], v[240:243]
ds_read_b64_tr_b16 v[52:53], v33 offset:8192
ds_read_b64_tr_b16 v[54:55], v33 offset:8448
v_mfma_f32_16x16x32_bf16 v[248:251], v[36:39], v[84:87], v[248:251]
s_waitcnt lgkmcnt(4)
v_mfma_f32_16x16x32_bf16 v[244:247], v[40:43], v[80:83], v[244:247]
ds_read_b64_tr_b16 v[36:37], v35 offset:8192
ds_read_b64_tr_b16 v[38:39], v35 offset:8448
v_mfma_f32_16x16x32_bf16 v[252:255], v[40:43], v[84:87], v[252:255]
v_mfma_f32_16x16x32_bf16 v[240:243], v[44:47], v[200:203], v[240:243]
v_mfma_f32_16x16x32_bf16 v[248:251], v[44:47], v[204:207], v[248:251]
s_waitcnt lgkmcnt(2)
v_mfma_f32_16x16x32_bf16 v[244:247], v[48:51], v[200:203], v[244:247]
v_mfma_f32_16x16x32_bf16 v[252:255], v[48:51], v[204:207], v[252:255]
v_mfma_f32_16x16x32_bf16 v[240:243], v[52:55], v[88:91], v[240:243]
v_mfma_f32_16x16x32_bf16 v[248:251], v[52:55], v[92:95], v[248:251]
s_waitcnt lgkmcnt(0)
v_mfma_f32_16x16x32_bf16 v[244:247], v[36:39], v[88:91], v[244:247]
v_mfma_f32_16x16x32_bf16 v[252:255], v[36:39], v[92:95], v[252:255]
s_mul_i32 s59, s30, 30720
s_lshl_b32 s60, s31, 12
s_add_u32 s59, s59, s60
s_add_u32 s59, s59, 20480
v_and_b32 v2, 32, v0
v_lshl_add_u32 v2, v2, 5, v20
v_add_u32 v2, s59, v2
s_lshl_b32 s59, s3, 8
v_lshl_add_u32 v3, v0, 2, s59
ds_write_b128 v2, v[240:243] offset:0
ds_write_b128 v2, v[244:247] offset:1024
ds_write_b128 v2, v[248:251] offset:256
ds_write_b128 v2, v[252:255] offset:1280
ds_write_b32 v3, v27
s_endpgm
.p2align 6
gather_N:
gN_top:
s_mov_b32 s31, 1
s_mov_b32 s27, 0xffff0000
s_waitcnt vmcnt(0)
ds_read2_b64 v[128:131], v38 offset0:0 offset1:4
ds_read2_b64 v[132:135], v38 offset0:2 offset1:6
s_cmp_lg_u32 s9, s26
s_cbranch_scc1 gN_wait0
gN_go0:
buffer_load_dwordx4 v[64:67], v39, s[36:39], s50 offen offset:0 sc1
buffer_load_dwordx4 v[68:71], v39, s[36:39], s50 offen offset:1024 sc1
s_waitcnt lgkmcnt(0)
s_load_dwordx16 s[8:23], s[48:49], 0 glc
v_lshlrev_b32 v16, 16, v128
v_and_b32 v17, s27, v128
v_lshlrev_b32 v18, 16, v129
v_and_b32 v19, s27, v129
v_lshlrev_b32 v20, 16, v130
v_and_b32 v21, s27, v130
v_lshlrev_b32 v22, 16, v131
v_and_b32 v23, s27, v131
v_lshlrev_b32 v24, 16, v132
v_and_b32 v25, s27, v132
v_lshlrev_b32 v26, 16, v133
v_and_b32 v27, s27, v133
v_lshlrev_b32 v28, 16, v134
v_and_b32 v29, s27, v134
v_lshlrev_b32 v30, 16, v135
v_and_b32 v31, s27, v135
s_mov_b32 s31, 0
s_cmp_lg_u32 s11, s26
s_cbranch_scc1 gN_wait1
gN_go1:
buffer_load_dwordx4 v[72:75], v39, s[36:39], s51 offen offset:0 sc1
buffer_load_dwordx4 v[76:79], v39, s[36:39], s51 offen offset:1024 sc1
s_cmp_lg_u32 s13, s26
s_cbranch_scc1 gN_wait2
gN_go2:
buffer_load_dwordx4 v[80:83], v39, s[36:39], s52 offen offset:0 sc1
buffer_load_dwordx4 v[84:87], v39, s[36:39], s52 offen offset:1024 sc1
v_dot2c_f32_bf16 v16, v136, v35
v_dot2c_f32_bf16 v17, v136, v15
v_dot2c_f32_bf16 v18, v137, v35
v_dot2c_f32_bf16 v19, v137, v15
v_dot2c_f32_bf16 v20, v138, v35
v_dot2c_f32_bf16 v21, v138, v15
v_dot2c_f32_bf16 v22, v139, v35
v_dot2c_f32_bf16 v23, v139, v15
v_dot2c_f32_bf16 v24, v140, v35
v_dot2c_f32_bf16 v25, v140, v15
v_dot2c_f32_bf16 v26, v141, v35
v_dot2c_f32_bf16 v27, v141, v15
v_dot2c_f32_bf16 v28, v142, v35
v_dot2c_f32_bf16 v29, v142, v15
v_dot2c_f32_bf16 v30, v143, v35
v_dot2c_f32_bf16 v31, v143, v15
s_cmp_lg_u32 s15, s26
s_cbranch_scc1 gN_wait3
gN_go3:
buffer_load_dwordx4 v[88:91], v39, s[36:39], s53 offen offset:0 sc1
buffer_load_dwordx4 v[92:95], v39, s[36:39], s53 offen offset:1024 sc1
s_waitcnt vmcnt(7)
v_add3_u32 v32, v32, v64, v65
v_add3_u32 v32, v32, v66, v67
s_waitcnt vmcnt(6)
v_add3_u32 v32, v32, v68, v69
v_add3_u32 v32, v32, v70, v71
v_dot2c_f32_bf16 v16, v64, v35
v_dot2c_f32_bf16 v17, v64, v15
v_dot2c_f32_bf16 v18, v65, v35
v_dot2c_f32_bf16 v19, v65, v15
v_dot2c_f32_bf16 v20, v66, v35
v_dot2c_f32_bf16 v21, v66, v15
v_dot2c_f32_bf16 v22, v67, v35
v_dot2c_f32_bf16 v23, v67, v15
v_dot2c_f32_bf16 v24, v68, v35
v_dot2c_f32_bf16 v25, v68, v15
v_dot2c_f32_bf16 v26, v69, v35
v_dot2c_f32_bf16 v27, v69, v15
v_dot2c_f32_bf16 v28, v70, v35
v_dot2c_f32_bf16 v29, v70, v15
v_dot2c_f32_bf16 v30, v71, v35
v_dot2c_f32_bf16 v31, v71, v15
s_cmp_lg_u32 s17, s26
s_cbranch_scc1 gN_wait4
gN_go4:
buffer_load_dwordx4 v[96:99], v39, s[36:39], s54 offen offset:0 sc1
buffer_load_dwordx4 v[100:103], v39, s[36:39], s54 offen offset:1024 sc1
s_waitcnt vmcnt(7)
v_add3_u32 v32, v32, v72, v73
v_add3_u32 v32, v32, v74, v75
s_waitcnt vmcnt(6)
v_add3_u32 v32, v32, v76, v77
v_add3_u32 v32, v32, v78, v79
v_dot2c_f32_bf16 v16, v72, v35
v_dot2c_f32_bf16 v17, v72, v15
v_dot2c_f32_bf16 v18, v73, v35
v_dot2c_f32_bf16 v19, v73, v15
v_dot2c_f32_bf16 v20, v74, v35
v_dot2c_f32_bf16 v21, v74, v15
v_dot2c_f32_bf16 v22, v75, v35
v_dot2c_f32_bf16 v23, v75, v15
v_dot2c_f32_bf16 v24, v76, v35
v_dot2c_f32_bf16 v25, v76, v15
v_dot2c_f32_bf16 v26, v77, v35
v_dot2c_f32_bf16 v27, v77, v15
v_dot2c_f32_bf16 v28, v78, v35
v_dot2c_f32_bf16 v29, v78, v15
v_dot2c_f32_bf16 v30, v79, v35
v_dot2c_f32_bf16 v31, v79, v15
s_cmp_lg_u32 s19, s26
s_cbranch_scc1 gN_wait5
gN_go5:
buffer_load_dwordx4 v[104:107], v39, s[36:39], s55 offen offset:0 sc1
buffer_load_dwordx4 v[108:111], v39, s[36:39], s55 offen offset:1024 sc1
s_waitcnt vmcnt(7)
v_add3_u32 v32, v32, v80, v81
v_add3_u32 v32, v32, v82, v83
s_waitcnt vmcnt(6)
v_add3_u32 v32, v32, v84, v85
v_add3_u32 v32, v32, v86, v87
v_dot2c_f32_bf16 v16, v80, v35
v_dot2c_f32_bf16 v17, v80, v15
v_dot2c_f32_bf16 v18, v81, v35
v_dot2c_f32_bf16 v19, v81, v15
v_dot2c_f32_bf16 v20, v82, v35
v_dot2c_f32_bf16 v21, v82, v15
v_dot2c_f32_bf16 v22, v83, v35
v_dot2c_f32_bf16 v23, v83, v15
v_dot2c_f32_bf16 v24, v84, v35
v_dot2c_f32_bf16 v25, v84, v15
v_dot2c_f32_bf16 v26, v85, v35
v_dot2c_f32_bf16 v27, v85, v15
v_dot2c_f32_bf16 v28, v86, v35
v_dot2c_f32_bf16 v29, v86, v15
v_dot2c_f32_bf16 v30, v87, v35
v_dot2c_f32_bf16 v31, v87, v15
s_cmp_lg_u32 s21, s26
s_cbranch_scc1 gN_wait6
gN_go6:
buffer_load_dwordx4 v[112:115], v39, s[36:39], s56 offen offset:0 sc1
buffer_load_dwordx4 v[116:119], v39, s[36:39], s56 offen offset:1024 sc1
s_mul_i32 s30, s26, 7
s_sub_u32 s30, s30, s8
s_sub_u32 s30, s30, s10
s_sub_u32 s30, s30, s12
s_sub_u32 s30, s30, s14
s_sub_u32 s30, s30, s16
s_sub_u32 s30, s30, s18
s_sub_u32 s30, s30, s20
s_cmp_lg_u32 s31, 0
s_cbranch_scc1 gN_sum
gN_ownw:
ds_read_b32 v160, v42
s_sub_u32 s63, s63, 1
s_cmp_le_i32 s63, 0
s_waitcnt lgkmcnt(0)
s_cbranch_scc1 gN_redo
v_cmp_eq_u32 vcc, 0, v160
s_cbranch_vccnz gN_ownw
gN_redo:
ds_read_b128 v[160:163], v33 offset:0
ds_read_b128 v[164:167], v33 offset:1024
ds_read_b128 v[168:171], v33 offset:2048
ds_read_b128 v[172:175], v33 offset:3072
s_waitcnt lgkmcnt(0)
v_add_f32 v16, v16, v160
v_add_f32 v17, v17, v161
v_add_f32 v18, v18, v162
v_add_f32 v19, v19, v163
v_add_f32 v20, v20, v164
v_add_f32 v21, v21, v165
v_add_f32 v22, v22, v166
v_add_f32 v23, v23, v167
v_add_f32 v24, v24, v168
v_add_f32 v25, v25, v169
v_add_f32 v26, v26, v170
v_add_f32 v27, v27, v171
v_add_f32 v28, v28, v172
v_add_f32 v29, v29, v173
v_add_f32 v30, v30, v174
v_add_f32 v31, v31, v175
gN_sum:
s_waitcnt vmcnt(7)
v_add3_u32 v32, v32, v88, v89
v_add3_u32 v32, v32, v90, v91
s_waitcnt vmcnt(6)
v_add3_u32 v32, v32, v92, v93
v_add3_u32 v32, v32, v94, v95
v_dot2c_f32_bf16 v16, v88, v35
v_dot2c_f32_bf16 v17, v88, v15
v_dot2c_f32_bf16 v18, v89, v35
v_dot2c_f32_bf16 v19, v89, v15
v_dot2c_f32_bf16 v20, v90, v35
v_dot2c_f32_bf16 v21, v90, v15
v_dot2c_f32_bf16 v22, v91, v35
v_dot2c_f32_bf16 v23, v91, v15
v_dot2c_f32_bf16 v24, v92, v35
v_dot2c_f32_bf16 v25, v92, v15
v_dot2c_f32_bf16 v26, v93, v35
v_dot2c_f32_bf16 v27, v93, v15
v_dot2c_f32_bf16 v28, v94, v35
v_dot2c_f32_bf16 v29, v94, v15
v_dot2c_f32_bf16 v30, v95, v35
v_dot2c_f32_bf16 v31, v95, v15
s_waitcnt vmcnt(5)
v_add3_u32 v32, v32, v96, v97
v_add3_u32 v32, v32, v98, v99
s_waitcnt vmcnt(4)
v_add3_u32 v32, v32, v100, v101
v_add3_u32 v32, v32, v102, v103
v_dot2c_f32_bf16 v16, v96, v35
v_dot2c_f32_bf16 v17, v96, v15
v_dot2c_f32_bf16 v18, v97, v35
v_dot2c_f32_bf16 v19, v97, v15
v_dot2c_f32_bf16 v20, v98, v35
v_dot2c_f32_bf16 v21, v98, v15
v_dot2c_f32_bf16 v22, v99, v35
v_dot2c_f32_bf16 v23, v99, v15
v_dot2c_f32_bf16 v24, v100, v35
v_dot2c_f32_bf16 v25, v100, v15
v_dot2c_f32_bf16 v26, v101, v35
v_dot2c_f32_bf16 v27, v101, v15
v_dot2c_f32_bf16 v28, v102, v35
v_dot2c_f32_bf16 v29, v102, v15
v_dot2c_f32_bf16 v30, v103, v35
v_dot2c_f32_bf16 v31, v103, v15
s_waitcnt vmcnt(3)
v_add3_u32 v32, v32, v104, v105
v_add3_u32 v32, v32, v106, v107
s_waitcnt vmcnt(2)
v_add3_u32 v32, v32, v108, v109
v_add3_u32 v32, v32, v110, v111
v_dot2c_f32_bf16 v16, v104, v35
v_dot2c_f32_bf16 v17, v104, v15
v_dot2c_f32_bf16 v18, v105, v35
v_dot2c_f32_bf16 v19, v105, v15
v_dot2c_f32_bf16 v20, v106, v35
v_dot2c_f32_bf16 v21, v106, v15
v_dot2c_f32_bf16 v22, v107, v35
v_dot2c_f32_bf16 v23, v107, v15
v_dot2c_f32_bf16 v24, v108, v35
v_dot2c_f32_bf16 v25, v108, v15
v_dot2c_f32_bf16 v26, v109, v35
v_dot2c_f32_bf16 v27, v109, v15
v_dot2c_f32_bf16 v28, v110, v35
v_dot2c_f32_bf16 v29, v110, v15
v_dot2c_f32_bf16 v30, v111, v35
v_dot2c_f32_bf16 v31, v111, v15
s_waitcnt vmcnt(0)
v_add3_u32 v32, v32, v112, v113
v_add3_u32 v32, v32, v114, v115
v_add3_u32 v32, v32, v116, v117
v_add3_u32 v32, v32, v118, v119
v_mul_lo_u32 v32, v32, v43
v_dot2c_f32_bf16 v16, v112, v35
v_dot2c_f32_bf16 v17, v112, v15
v_add_u32_dpp v32, v32, v32 row_ror:8 row_mask:0xf bank_mask:0xf
v_dot2c_f32_bf16 v18, v113, v35
v_dot2c_f32_bf16 v19, v113, v15
v_add_u32_dpp v32, v32, v32 row_ror:4 row_mask:0xf bank_mask:0xf
v_dot2c_f32_bf16 v20, v114, v35
v_dot2c_f32_bf16 v21, v114, v15
v_add_u32_dpp v32, v32, v32 row_ror:2 row_mask:0xf bank_mask:0xf
v_dot2c_f32_bf16 v22, v115, v35
v_dot2c_f32_bf16 v23, v115, v15
v_add_u32_dpp v32, v32, v32 row_ror:1 row_mask:0xf bank_mask:0xf
v_dot2c_f32_bf16 v24, v116, v35
v_dot2c_f32_bf16 v25, v116, v15
v_add_u32_dpp v32, v32, v32 row_bcast:15 row_mask:0xa bank_mask:0xf
v_dot2c_f32_bf16 v26, v117, v35
v_dot2c_f32_bf16 v27, v117, v15
v_add_u32_dpp v32, v32, v32 row_bcast:31 row_mask:0xc bank_mask:0xf
v_dot2c_f32_bf16 v28, v118, v35
v_dot2c_f32_bf16 v29, v118, v15
v_readlane_b32 s59, v32, 63
v_dot2c_f32_bf16 v30, v119, v35
v_dot2c_f32_bf16 v31, v119, v15
s_add_u32 s59, s59, s30
s_cmp_lg_u32 s59, 0
s_cbranch_scc1 gN_fail
gN_done:
s_waitcnt lgkmcnt(0)
v_cvt_pk_bf16_f32 v16, v16, v17
v_cvt_pk_bf16_f32 v17, v18, v19
v_cvt_pk_bf16_f32 v18, v20, v21
v_cvt_pk_bf16_f32 v19, v22, v23
ds_write2_b64 v40, v[16:17], v[18:19] offset0:0 offset1:4
v_cvt_pk_bf16_f32 v20, v24, v25
v_cvt_pk_bf16_f32 v21, v26, v27
v_cvt_pk_bf16_f32 v22, v28, v29
v_cvt_pk_bf16_f32 v23, v30, v31
ds_write2_b64 v40, v[20:21], v[22:23] offset0:2 offset1:6
ds_read_b128 v[24:27], v41 offset:0
ds_read_b128 v[28:31], v41 offset:1280
s_waitcnt lgkmcnt(1)
buffer_store_dwordx4 v[24:27], v36, s[44:47], s60 offen
s_waitcnt lgkmcnt(0)
buffer_store_dwordx4 v[28:31], v36, s[44:47], s57 offen
s_lshl_b32 s59, s5, 3
s_add_u32 s59, s59, s4
s_lshl_b32 s59, s59, 3
s_add_u32 s59, s59, s3
s_cmp_lg_u32 s59, 23
s_cbranch_scc1 gN_exit
s_mov_b64 exec, 1
buffer_store_dword v34, v39, s[36:39], 0 offen offset:12 sc1
s_mov_b64 exec, -1
gN_exit:
s_endpgm
gN_fail:
s_sub_u32 s63, s63, 64
s_cmp_le_i32 s63, 0
s_cbranch_scc1 gN_done
s_waitcnt lgkmcnt(0)
s_load_dwordx16 s[8:23], s[48:49], 0 glc
v_mov_b32 v32, 0
s_waitcnt lgkmcnt(0)
s_branch gN_top
gN_idle:
s_cmp_lg_u32 s31, 0
s_cbranch_scc1 gN_idle2
ds_read_b32 v160, v42
s_waitcnt lgkmcnt(0)
v_cmp_eq_u32 vcc, 0, v160
s_cbranch_vccnz gN_idle2
s_mov_b32 s31, 1
ds_read_b128 v[160:163], v33 offset:0
ds_read_b128 v[164:167], v33 offset:1024
ds_read_b128 v[168:171], v33 offset:2048
ds_read_b128 v[172:175], v33 offset:3072
s_waitcnt lgkmcnt(0)
s_load_dwordx16 s[8:23], s[48:49], 0 glc
v_add_f32 v16, v16, v160
v_add_f32 v17, v17, v161
v_add_f32 v18, v18, v162
v_add_f32 v19, v19, v163
v_add_f32 v20, v20, v164
v_add_f32 v21, v21, v165
v_add_f32 v22, v22, v166
v_add_f32 v23, v23, v167
v_add_f32 v24, v24, v168
v_add_f32 v25, v25, v169
v_add_f32 v26, v26, v170
v_add_f32 v27, v27, v171
v_add_f32 v28, v28, v172
v_add_f32 v29, v29, v173
v_add_f32 v30, v30, v174
v_add_f32 v31, v31, v175
s_setpc_b64 s[58:59]
gN_idle2:
s_load_dwordx16 s[8:23], s[48:49], 0 glc
s_setpc_b64 s[58:59]
gN_wait0:
s_waitcnt lgkmcnt(0)
s_cmp_eq_u32 s9, s26
s_cbranch_scc1 gN_go0
s_sub_u32 s63, s63, 1
s_cmp_le_i32 s63, 0
s_cbranch_scc1 gN_go0
s_call_b64 s[58:59], gN_idle
s_branch gN_wait0
gN_wait1:
s_waitcnt lgkmcnt(0)
s_cmp_eq_u32 s11, s26
s_cbranch_scc1 gN_go1
s_sub_u32 s63, s63, 1
s_cmp_le_i32 s63, 0
s_cbranch_scc1 gN_go1
s_call_b64 s[58:59], gN_idle
s_branch gN_wait1
gN_wait2:
s_waitcnt lgkmcnt(0)
s_cmp_eq_u32 s13, s26
s_cbranch_scc1 gN_go2
s_sub_u32 s63, s63, 1
s_cmp_le_i32 s63, 0
s_cbranch_scc1 gN_go2
s_call_b64 s[58:59], gN_idle
s_branch gN_wait2
gN_wait3:
s_waitcnt lgkmcnt(0)
s_cmp_eq_u32 s15, s26
s_cbranch_scc1 gN_go3
s_sub_u32 s63, s63, 1
s_cmp_le_i32 s63, 0
s_cbranch_scc1 gN_go3
s_call_b64 s[58:59], gN_idle
s_branch gN_wait3
gN_wait4:
s_waitcnt lgkmcnt(0)
s_cmp_eq_u32 s17, s26
s_cbranch_scc1 gN_go4
s_sub_u32 s63, s63, 1
s_cmp_le_i32 s63, 0
s_cbranch_scc1 gN_go4
s_call_b64 s[58:59], gN_idle
s_branch gN_wait4
gN_wait5:
s_waitcnt lgkmcnt(0)
s_cmp_eq_u32 s19, s26
s_cbranch_scc1 gN_go5
s_sub_u32 s63, s63, 1
s_cmp_le_i32 s63, 0
s_cbranch_scc1 gN_go5
s_call_b64 s[58:59], gN_idle
s_branch gN_wait5
gN_wait6:
s_waitcnt lgkmcnt(0)
s_cmp_eq_u32 s21, s26
s_cbranch_scc1 gN_go6
s_sub_u32 s63, s63, 1
s_cmp_le_i32 s63, 0
s_cbranch_scc1 gN_go6
s_call_b64 s[58:59], gN_idle
s_branch gN_wait6
role_N_end:
.p2align 7
role_E_start:
.p2align 6
proto_E:
s_sub_u32 s30, s3, 6
s_mov_b32 s31, 0
s_barrier
s_mov_b32 s52, s28
s_and_b32 s53, s29, 0xffff
s_mov_b32 s54, 67108864
s_mov_b32 s55, 0x20000
s_waitcnt lgkmcnt(0)
s_add_u32 s14, s14, 1
s_cmp_gt_u32 s4, 3
s_subb_u32 s60, s4, 0
s_mul_i32 s61, s5, 7
s_add_u32 s60, s60, s61
s_lshl_b32 s61, s3, 8
s_add_u32 s60, s60, s61
s_lshl_b32 s60, s60, 7
s_add_u32 s60, s60, 22937600
s_load_dword s26, s[28:29], s60 glc
s_barrier
pE_tk2:
s_cmp_ge_u32 s31, 1
s_cbranch_scc1 pE_tk2x
s_barrier
s_add_u32 s31, s31, 1
s_branch pE_tk2
pE_tk2x:
s_lshr_b32 s59, s4, 1
s_lshl_b32 s59, s59, 1
s_add_u32 s59, s59, s30
s_lshl_b32 s59, s59, 5
s_add_u32 s61, s59, s5
s_lshl_b32 s61, s61, 7
s_lshr_b32 s59, s61, 11
s_lshl_b32 s59, s59, 17
s_and_b32 s58, s61, 2047
s_add_u32 s59, s59, s58
s_add_u32 s59, s59, 1048576
s_add_u32 s60, s59, 65536
s_add_u32 s61, s61, 5242880
v_lshrrev_b32 v20, 3, v0
v_lshlrev_b32 v20, 11, v20
v_and_b32 v33, 7, v0
v_lshl_add_u32 v20, v33, 4, v20
v_lshlrev_b32 v13, 4, v0
s_and_b32 s58, s14, 0xffff
v_mov_b32 v12, s58
s_mov_b32 s58, 0xffff0000
v_mov_b32 v28, 0x3f80
v_mov_b32 v29, 1.0
v_add_u32 v21, 16384, v20
v_add_u32 v22, 16384, v21
v_add_u32 v23, 16384, v22
v_add_u32 v24, 16384, v23
v_add_u32 v25, 16384, v24
v_add_u32 v26, 16384, v25
v_add_u32 v27, 16384, v26
pE_tk4:
s_cmp_ge_u32 s31, 21
s_cbranch_scc1 pE_tk4x
s_barrier
s_add_u32 s31, s31, 1
s_branch pE_tk4
pE_tk4x:
pE_l1_5:
buffer_load_dwordx4 v[64:67], v20, s[52:55], s59 offen sc1
buffer_load_dwordx4 v[68:71], v21, s[52:55], s59 offen sc1
buffer_load_dwordx4 v[72:75], v22, s[52:55], s59 offen sc1
buffer_load_dwordx4 v[76:79], v23, s[52:55], s59 offen sc1
buffer_load_dwordx4 v[80:83], v24, s[52:55], s59 offen sc1
buffer_load_dwordx4 v[84:87], v25, s[52:55], s59 offen sc1
buffer_load_dwordx4 v[88:91], v26, s[52:55], s59 offen sc1
buffer_load_dwordx4 v[92:95], v27, s[52:55], s59 offen sc1
s_cmp_ge_u32 s31, 29
s_cbranch_scc1 pE_tk6
s_barrier
s_add_u32 s31, s31, 1
pE_tk6:
s_waitcnt vmcnt(7)
v_lshlrev_b32 v128, 16, v64
v_lshlrev_b32 v129, 16, v65
v_lshlrev_b32 v130, 16, v66
v_and_b32 v132, s58, v64
v_and_b32 v133, s58, v65
v_and_b32 v134, s58, v66
v_and_b32 v135, s58, v67
v_mov_b32 v131, 0
v_xor_b32 v3, v67, v12
s_waitcnt vmcnt(6)
v_xor_b32 v10, v71, v12
v_or_b32 v3, v3, v10
v_and_b32 v71, s58, v71
v_add_f32 v135, v135, v71
v_dot2c_f32_bf16 v128, v68, v28
v_dot2c_f32_bf16 v132, v68, v29
v_dot2c_f32_bf16 v129, v69, v28
v_dot2c_f32_bf16 v133, v69, v29
v_dot2c_f32_bf16 v130, v70, v28
v_dot2c_f32_bf16 v134, v70, v29
s_waitcnt vmcnt(5)
v_xor_b32 v10, v75, v12
v_or_b32 v3, v3, v10
v_and_b32 v75, s58, v75
v_add_f32 v135, v135, v75
v_dot2c_f32_bf16 v128, v72, v28
v_dot2c_f32_bf16 v132, v72, v29
v_dot2c_f32_bf16 v129, v73, v28
v_dot2c_f32_bf16 v133, v73, v29
v_dot2c_f32_bf16 v130, v74, v28
v_dot2c_f32_bf16 v134, v74, v29
s_waitcnt vmcnt(4)
v_xor_b32 v10, v79, v12
v_or_b32 v3, v3, v10
v_and_b32 v79, s58, v79
v_add_f32 v135, v135, v79
v_dot2c_f32_bf16 v128, v76, v28
v_dot2c_f32_bf16 v132, v76, v29
v_dot2c_f32_bf16 v129, v77, v28
v_dot2c_f32_bf16 v133, v77, v29
v_dot2c_f32_bf16 v130, v78, v28
v_dot2c_f32_bf16 v134, v78, v29
s_waitcnt vmcnt(3)
v_xor_b32 v10, v83, v12
v_or_b32 v3, v3, v10
v_and_b32 v83, s58, v83
v_add_f32 v135, v135, v83
v_dot2c_f32_bf16 v128, v80, v28
v_dot2c_f32_bf16 v132, v80, v29
v_dot2c_f32_bf16 v129, v81, v28
v_dot2c_f32_bf16 v133, v81, v29
v_dot2c_f32_bf16 v130, v82, v28
v_dot2c_f32_bf16 v134, v82, v29
s_waitcnt vmcnt(2)
v_xor_b32 v10, v87, v12
v_or_b32 v3, v3, v10
v_and_b32 v87, s58, v87
v_add_f32 v135, v135, v87
v_dot2c_f32_bf16 v128, v84, v28
v_dot2c_f32_bf16 v132, v84, v29
v_dot2c_f32_bf16 v129, v85, v28
v_dot2c_f32_bf16 v133, v85, v29
v_dot2c_f32_bf16 v130, v86, v28
v_dot2c_f32_bf16 v134, v86, v29
s_waitcnt vmcnt(1)
v_xor_b32 v10, v91, v12
v_or_b32 v3, v3, v10
v_and_b32 v91, s58, v91
v_add_f32 v135, v135, v91
v_dot2c_f32_bf16 v128, v88, v28
v_dot2c_f32_bf16 v132, v88, v29
v_dot2c_f32_bf16 v129, v89, v28
v_dot2c_f32_bf16 v133, v89, v29
v_dot2c_f32_bf16 v130, v90, v28
v_dot2c_f32_bf16 v134, v90, v29
s_waitcnt vmcnt(0)
v_xor_b32 v10, v95, v12
v_or_b32 v3, v3, v10
v_and_b32 v95, s58, v95
v_add_f32 v135, v135, v95
v_dot2c_f32_bf16 v128, v92, v28
v_dot2c_f32_bf16 v132, v92, v29
v_dot2c_f32_bf16 v129, v93, v28
v_dot2c_f32_bf16 v133, v93, v29
v_dot2c_f32_bf16 v130, v94, v28
v_dot2c_f32_bf16 v134, v94, v29
v_and_b32 v3, 0xffff, v3
v_cmp_ne_u32 vcc, 0, v3
v_permlane16_swap_b32 v128, v129
v_permlane16_swap_b32 v130, v131
v_permlane16_swap_b32 v132, v133
v_permlane16_swap_b32 v134, v135
s_cbranch_vccz pE_giveup7
s_sub_u32 s63, s63, 1
s_cmp_gt_i32 s63, 0
s_cbranch_scc1 pE_l1_5
pE_giveup7:
v_add_f32 v128, v128, v129
v_add_f32 v130, v130, v131
v_add_f32 v132, v132, v133
v_add_f32 v134, v134, v135
v_permlane32_swap_b32 v128, v130
s_nop 0
v_permlane32_swap_b32 v132, v134
v_add_f32 v128, v128, v130
v_add_f32 v132, v132, v134
s_nop 0
v_add_f32_dpp v128, v128, v128 row_ror:8 row_mask:0xf bank_mask:0xf
v_add_f32_dpp v132, v132, v132 row_ror:8 row_mask:0xf bank_mask:0xf
v_cvt_pk_bf16_f32 v64, v128, v132
v_cvt_pk_bf16_f32 v65, v128, v132
s_nop 1
v_permlane16_swap_b32 v64, v65
v_mov_b32 v66, v64
v_mov_b32 v67, v65
s_nop 0
v_permlane32_swap_b32 v64, v66
v_permlane32_swap_b32 v65, v67
v_and_or_b32 v67, v67, s58, v12
s_mov_b64 exec, 0xff
buffer_store_dwordx4 v[64:67], v13, s[52:55], s61 offen sc1
s_mov_b64 exec, -1
pE_nol13:
s_and_b32 s59, s4, 1
s_lshl_b32 s59, s59, 1
s_add_u32 s59, s59, s30
s_lshl_b32 s60, s59, 9
s_and_b32 s61, s5, 7
s_mul_i32 s61, s61, 2304
s_add_u32 s60, s60, s61
s_add_u32 s60, s60, 5324800
s_lshl_b32 s59, s59, 13
s_add_u32 s59, s59, 5242880
s_mul_i32 s61, s30, 30720
s_add_u32 s61, s61, 12288
v_lshlrev_b32 v3, 4, v0
s_add_u32 s48, s28, s60
s_addc_u32 s49, s29, 0
s_and_b32 s50, s14, 0xff
s_mul_i32 s50, s50, 0x01010101
s_mov_b32 s51, s50
pE_tk8:
s_cmp_ge_u32 s31, 28
s_cbranch_scc1 pE_tk8x
s_barrier
s_add_u32 s31, s31, 1
s_branch pE_tk8
pE_tk8x:
s_add_u32 m0, s61, 0
s_add_u32 s58, s59, 0
buffer_load_dwordx4 v3, s[52:55], s58 offen offset:0 sc1 lds
buffer_load_dwordx4 v3, s[52:55], s58 offen offset:1024 sc1 lds
buffer_load_dwordx4 v3, s[52:55], s58 offen offset:2048 sc1 lds
buffer_load_dwordx4 v3, s[52:55], s58 offen offset:3072 sc1 lds
s_add_u32 m0, s61, 4096
s_add_u32 s58, s59, 4096
buffer_load_dwordx4 v3, s[52:55], s58 offen offset:0 sc1 lds
buffer_load_dwordx4 v3, s[52:55], s58 offen offset:1024 sc1 lds
buffer_load_dwordx4 v3, s[52:55], s58 offen offset:2048 sc1 lds
buffer_load_dwordx4 v3, s[52:55], s58 offen offset:3072 sc1 lds
pE_tk9:
s_cmp_ge_u32 s31, 29
s_cbranch_scc1 pE_tk9x
s_barrier
s_add_u32 s31, s31, 1
s_branch pE_tk9
pE_tk9x:
s_waitcnt vmcnt(0)
s_cmp_eq_u32 s30, 0
s_mov_b32 s59, 36
s_cselect_b32 s59, 31, s59
pE_tk10:
s_cmp_ge_u32 s31, s59
s_cbranch_scc1 pE_tk10x
s_barrier
s_add_u32 s31, s31, 1
s_branch pE_tk10
pE_tk10x:
s_waitcnt vmcnt(0)
s_mov_b32 s32, s8
s_and_b32 s33, s9, 0xffff
s_mov_b32 s34, 1835008
s_mov_b32 s35, 0x20000
s_mov_b32 s36, s28
s_and_b32 s37, s29, 0xffff
s_mov_b32 s38, 67108864
s_mov_b32 s39, 0x20000
s_mov_b64 s[0:1], s[22:23]
s_sub_u32 s57, s3, 4
s_cmp_gt_u32 s4, 3
s_subb_u32 s58, s4, 0
s_mul_i32 s61, s5, 7
s_add_u32 s61, s61, s58
s_lshl_b32 s60, s57, 8
s_add_u32 s60, s60, s61
s_lshl_b32 s60, s60, 7
s_add_u32 s60, s60, 23068672
s_add_u32 s48, s28, s60
s_addc_u32 s49, s29, 0
s_waitcnt lgkmcnt(0)
s_mov_b32 s26, s14
s_load_dwordx16 s[8:23], s[48:49], 0 glc
s_lshl_b32 s61, s61, 5
s_add_u32 s61, s61, s57
s_lshl_b32 s61, s61, 11
s_mul_i32 s60, s5, 0
s_add_u32 s61, s61, s60
s_add_u32 s61, s61, 6291456
s_lshl_b32 s58, s58, 7
s_and_b32 s60, s57, 1
s_lshl_b32 s60, s60, 6
s_add_u32 s58, s58, s60
s_lshr_b32 s27, s57, 1
s_lshl_b32 s60, s5, 1
s_add_u32 s60, s60, s27
s_mul_i32 s60, s60, 28672
s_add_u32 s60, s60, s58
v_lshrrev_b32 v41, 2, v0
v_and_b32 v39, 3, v0
v_mul_u32_u24 v36, 896, v41
v_lshl_add_u32 v36, v39, 4, v36
v_mul_u32_u24 v41, 80, v41
v_lshl_add_u32 v41, v39, 4, v41
v_bfe_u32 v37, v0, 5, 1
v_lshlrev_b32 v37, 3, v37
v_and_b32 v39, 31, v0
v_lshl_add_u32 v38, v39, 6, v37
v_lshl_add_u32 v40, v39, 4, v38
v_lshlrev_b32 v39, 4, v0
s_mul_i32 s27, s27, 30720
s_and_b32 s57, s57, 1
s_lshl_b32 s57, s57, 11
s_add_u32 s27, s27, s57
s_add_u32 s57, s57, s27
s_add_u32 s57, s57, 20480
s_add_u32 s27, s27, 28672
v_add_u32 v33, s57, v39
v_add_u32 v40, s57, v40
v_add_u32 v41, s57, v41
v_add_u32 v38, s27, v38
v_and_b32 v43, 15, v0
v_lshl_add_u32 v43, v37, 1, v43
v_mul_u32_u24 v43, 0x9e3a, v43
v_or_b32 v43, 1, v43
v_mov_b32 v34, s26
s_cmp_lg_u32 s30, 0
s_cbranch_scc1 pE_mp11x
s_cmp_eq_u32 s4, 3
s_cselect_b32 s56, 0, 0x7f
s_sub_u32 s52, s61, 4096
v_lshlrev_b32 v2, 7, v0
pE_mp11:
s_cmp_ge_u32 s31, 39
s_cbranch_scc1 pE_mp11x
s_barrier
s_add_u32 s31, s31, 1
s_mov_b32 s57, 0
s_cmp_eq_u32 s23, s26
s_addc_u32 s57, s57, s57
s_cmp_eq_u32 s21, s26
s_addc_u32 s57, s57, s57
s_cmp_eq_u32 s19, s26
s_addc_u32 s57, s57, s57
s_cmp_eq_u32 s17, s26
s_addc_u32 s57, s57, s57
s_cmp_eq_u32 s15, s26
s_addc_u32 s57, s57, s57
s_cmp_eq_u32 s13, s26
s_addc_u32 s57, s57, s57
s_cmp_eq_u32 s11, s26
s_addc_u32 s57, s57, s57
s_cmp_eq_u32 s9, s26
s_addc_u32 s57, s57, s57
s_and_b32 s57, s57, s56
s_cbranch_scc0 pE_mp11n
s_ff1_i32_b32 s59, s57
s_bitset0_b32 s56, s59
s_lshl_b32 s59, s59, 13
s_add_u32 s59, s59, s52
buffer_load_dword v3, v2, s[36:39], s59 offen sc1
pE_mp11n:
s_getreg_b32 s59, hwreg(HW_REG_IB_STS, 8, 4)
s_cmp_gt_u32 s59, 0
s_cbranch_scc1 pE_mp11
s_cmp_ge_u32 s31, 38
s_cbranch_scc1 pE_mp11
s_load_dwordx16 s[8:23], s[48:49], 0 glc
s_branch pE_mp11
pE_mp11x:
pE_tk12:
s_cmp_ge_u32 s31, 40
s_cbranch_scc1 pE_tk12x
s_barrier
s_add_u32 s31, s31, 1
s_branch pE_tk12
pE_tk12x:
s_mov_b32 s40, s0
s_and_b32 s41, s1, 0xffff
s_mov_b32 s42, 896
s_mov_b32 s43, 0x20000
s_mov_b32 s44, s24
s_and_b32 s45, s25, 0xffff
s_mov_b32 s46, 1835008
s_mov_b32 s47, 0x20000
s_add_u32 s57, s60, 14336
s_add_u32 m0, s27, 0
s_nop 0
buffer_load_dwordx4 v36, s[32:35], s60 offen lds
buffer_load_dwordx2 v[136:137], v37, s[40:43], s58 offen offset:0
buffer_load_dwordx2 v[138:139], v37, s[40:43], s58 offen offset:32
s_add_u32 m0, s27, 1024
s_nop 0
buffer_load_dwordx4 v36, s[32:35], s57 offen lds
buffer_load_dwordx2 v[140:141], v37, s[40:43], s58 offen offset:16
buffer_load_dwordx2 v[142:143], v37, s[40:43], s58 offen offset:48
s_load_dwordx16 s[8:23], s[48:49], 0 glc
s_add_u32 s50, s61, 0
s_add_u32 s51, s61, 8192
s_add_u32 s52, s61, 16384
s_add_u32 s53, s61, 24576
s_add_u32 s54, s61, 32768
s_add_u32 s55, s61, 40960
s_add_u32 s56, s61, 49152
v_mov_b32 v35, 0x3f80
v_mov_b32 v15, 1.0
v_mov_b32 v32, 0
pE_tk13:
s_cmp_ge_u32 s31, 43
s_cbranch_scc1 pE_tk13x
s_barrier
s_add_u32 s31, s31, 1
s_branch pE_tk13
pE_tk13x:
s_branch gather_E
.p2align 6
load_E:
s_mul_i32 s49, s4, 56
s_lshr_b32 s49, s49, 6
s_lshl_b32 s49, s49, 7
s_and_b32 s48, s4, 1
s_mul_i32 s59, s48, 200704
s_mul_i32 s48, s48, 384
s_add_u32 s44, s12, s59
s_addc_u32 s45, s13, 0
s_and_b32 s45, s45, 0xffff
s_sub_u32 s46, 401408, s59
s_mov_b32 s47, 0x20000
s_lshl_b32 s60, s4, 2
s_sub_u32 s60, s60, 2
s_max_i32 s60, s60, 0
s_lshl_b32 s59, s60, 7
s_add_u32 s36, s16, s59
s_addc_u32 s37, s17, 0
s_and_b32 s37, s37, 0xffff
s_sub_u32 s38, 1605632, s59
s_mov_b32 s39, 0x20000
s_mul_i32 s59, s60, 57344
s_add_u32 s40, s20, s59
s_addc_u32 s41, s21, 0
s_and_b32 s41, s41, 0xffff
s_sub_u32 s42, 1605632, s59
s_mov_b32 s43, 0x20000
s_add_u32 s7, s4, 1
s_cmp_gt_u32 s4, 3
s_cselect_b32 s7, s4, s7
s_cmp_eq_u32 s4, 3
s_cselect_b32 s7, 3, s7
s_cmp_eq_u32 s4, 0
s_mov_b32 s50, 0
s_cselect_b32 s50, 768, s50
s_mov_b32 s51, 128
s_cselect_b32 s51, 640, s51
s_mov_b32 s52, 256
s_cselect_b32 s52, 512, s52
s_mov_b32 s53, 384
s_cselect_b32 s53, 384, s53
s_mov_b32 s54, 512
s_cselect_b32 s54, 256, s54
s_mov_b32 s55, 640
s_cselect_b32 s55, 128, s55
s_mov_b32 s56, 768
s_cselect_b32 s56, 0, s56
s_sub_u32 s30, s3, 4
s_lshl_b32 s31, s30, 11
s_lshl_b32 s59, s30, 4
v_bfe_u32 v12, v0, 2, 3
v_add_u32 v12, s59, v12
v_lshrrev_b32 v13, 5, v0
v_lshlrev_b32 v13, 6, v13
v_and_b32 v14, 3, v0
v_lshl_add_u32 v13, v14, 4, v13
v_mul_u32_u24 v2, 2688, v12
v_add_u32 v2, v2, v13
v_mul_u32_u24 v3, 3584, v12
v_add_u32 v3, v3, v13
v_mul_u32_u24 v4, 896, v12
v_add_u32 v4, v4, v13
s_lshl_b32 s61, s6, 1
s_add_u32 s61, s61, s30
s_mul_i32 s60, s61, 14
v_and_b32 v17, 15, v0
v_min_u32 v17, 13, v17
v_add_u32 v17, s60, v17
v_mul_u32_u24 v17, 3584, v17
v_lshrrev_b32 v9, 4, v0
v_min_u32 v9, 1, v9
v_lshl_add_u32 v17, v9, 7, v17
s_barrier
buffer_load_dword v49, v17, s[36:39], 0 offen
s_waitcnt lgkmcnt(0)
s_add_u32 s14, s14, 1
s_mul_i32 s60, s61, 14
v_and_b32 v18, 15, v0
v_min_u32 v18, 13, v18
v_add_u32 v18, s60, v18
v_mul_u32_u24 v18, 2688, v18
v_lshrrev_b32 v9, 4, v0
v_min_u32 v9, 3, v9
v_lshl_add_u32 v18, v9, 7, v18
v_add_u32 v18, s48, v18
s_mul_i32 s60, s61, 4
v_and_b32 v19, 7, v0
v_min_u32 v19, 3, v19
v_add_u32 v19, s60, v19
v_mul_u32_u24 v19, 896, v19
v_mov_b32 v9, s50
v_mov_b32 v10, s51
v_cmp_le_u32 vcc, 8, v0
s_nop 1
v_cndmask_b32 v9, v9, v10, vcc
v_mov_b32 v10, s52
v_cmp_le_u32 vcc, 16, v0
s_nop 1
v_cndmask_b32 v9, v9, v10, vcc
v_mov_b32 v10, s53
v_cmp_le_u32 vcc, 24, v0
s_nop 1
v_cndmask_b32 v9, v9, v10, vcc
v_mov_b32 v10, s54
v_cmp_le_u32 vcc, 32, v0
s_nop 1
v_cndmask_b32 v9, v9, v10, vcc
v_mov_b32 v10, s55
v_cmp_le_u32 vcc, 40, v0
s_nop 1
v_cndmask_b32 v9, v9, v10, vcc
v_mov_b32 v10, s56
v_cmp_le_u32 vcc, 48, v0
s_nop 1
v_cndmask_b32 v9, v9, v10, vcc
v_add_u32 v19, v9, v19
s_mul_i32 s60, s61, 7
v_and_b32 v20, 7, v0
v_min_u32 v20, 6, v20
v_add_u32 v20, s60, v20
v_mul_u32_u24 v20, 896, v20
v_mov_b32 v9, s50
v_mov_b32 v10, s51
v_cmp_le_u32 vcc, 8, v0
s_nop 1
v_cndmask_b32 v9, v9, v10, vcc
v_mov_b32 v10, s52
v_cmp_le_u32 vcc, 16, v0
s_nop 1
v_cndmask_b32 v9, v9, v10, vcc
v_mov_b32 v10, s53
v_cmp_le_u32 vcc, 24, v0
s_nop 1
v_cndmask_b32 v9, v9, v10, vcc
v_mov_b32 v10, s54
v_cmp_le_u32 vcc, 32, v0
s_nop 1
v_cndmask_b32 v9, v9, v10, vcc
v_mov_b32 v10, s55
v_cmp_le_u32 vcc, 40, v0
s_nop 1
v_cndmask_b32 v9, v9, v10, vcc
v_mov_b32 v10, s56
v_cmp_le_u32 vcc, 48, v0
s_nop 1
v_cndmask_b32 v9, v9, v10, vcc
v_add_u32 v20, v9, v20
s_cmp_gt_u32 s4, 3
s_subb_u32 s60, s4, 0
s_mul_i32 s61, s5, 7
s_add_u32 s60, s60, s61
s_lshl_b32 s61, s3, 8
s_add_u32 s60, s60, s61
s_lshl_b32 s60, s60, 7
s_add_u32 s60, s60, 22937600
s_load_dword s26, s[28:29], s60 glc
s_barrier
s_add_u32 m0, s31, 65536
s_mov_b32 s59, 0
buffer_load_dwordx4 v3, s[36:39], s59 offen  lds
s_add_u32 m0, s31, 66560
s_mov_b32 s59, 28672
buffer_load_dwordx4 v3, s[36:39], s59 offen  lds
s_add_u32 m0, s31, 69632
s_mov_b32 s59, 114688
buffer_load_dwordx4 v3, s[36:39], s59 offen  lds
s_add_u32 m0, s31, 70656
s_mov_b32 s59, 143360
buffer_load_dwordx4 v3, s[36:39], s59 offen  lds
s_add_u32 m0, s31, 73728
s_mov_b32 s59, 229376
buffer_load_dwordx4 v3, s[36:39], s59 offen  lds
s_add_u32 m0, s31, 74752
s_mov_b32 s59, 258048
buffer_load_dwordx4 v3, s[36:39], s59 offen  lds
s_add_u32 m0, s31, 77824
s_mov_b32 s59, 344064
buffer_load_dwordx4 v3, s[36:39], s59 offen  lds
s_add_u32 m0, s31, 78848
s_mov_b32 s59, 372736
buffer_load_dwordx4 v3, s[36:39], s59 offen  lds
s_add_u32 m0, s31, 81920
s_mov_b32 s59, 458752
buffer_load_dwordx4 v3, s[36:39], s59 offen  lds
s_add_u32 m0, s31, 82944
s_mov_b32 s59, 487424
buffer_load_dwordx4 v3, s[36:39], s59 offen  lds
s_add_u32 m0, s31, 86016
s_mov_b32 s59, 573440
buffer_load_dwordx4 v3, s[36:39], s59 offen  lds
s_add_u32 m0, s31, 87040
s_mov_b32 s59, 602112
buffer_load_dwordx4 v3, s[36:39], s59 offen  lds
s_add_u32 m0, s31, 90112
s_mov_b32 s59, 688128
buffer_load_dwordx4 v3, s[36:39], s59 offen  lds
s_add_u32 m0, s31, 91136
s_mov_b32 s59, 716800
buffer_load_dwordx4 v3, s[36:39], s59 offen  lds
s_add_u32 m0, s31, 94208
s_mov_b32 s59, 802816
buffer_load_dwordx4 v3, s[36:39], s59 offen  lds
s_add_u32 m0, s31, 95232
s_mov_b32 s59, 831488
buffer_load_dwordx4 v3, s[36:39], s59 offen  lds
s_add_u32 m0, s31, 98304
s_mov_b32 s59, 917504
buffer_load_dwordx4 v3, s[36:39], s59 offen  lds
s_add_u32 m0, s31, 99328
s_mov_b32 s59, 946176
buffer_load_dwordx4 v3, s[36:39], s59 offen  lds
s_add_u32 m0, s31, 102400
s_mov_b32 s59, 1032192
buffer_load_dwordx4 v3, s[36:39], s59 offen  lds
s_add_u32 m0, s31, 103424
s_mov_b32 s59, 1060864
buffer_load_dwordx4 v3, s[36:39], s59 offen  lds
s_add_u32 m0, s31, 106496
s_mov_b32 s59, 1146880
buffer_load_dwordx4 v3, s[36:39], s59 offen  lds
s_add_u32 m0, s31, 107520
s_mov_b32 s59, 1175552
buffer_load_dwordx4 v3, s[36:39], s59 offen  lds
buffer_load_dword v50, v18, s[32:35], 0 offen
s_waitcnt vmcnt(15)
s_barrier
s_add_u32 m0, s31, 110592
s_mov_b32 s59, 1261568
buffer_load_dwordx4 v3, s[36:39], s59 offen  lds
s_add_u32 m0, s31, 111616
s_mov_b32 s59, 1290240
buffer_load_dwordx4 v3, s[36:39], s59 offen  lds
s_add_u32 m0, s31, 114688
s_mov_b32 s59, 1376256
buffer_load_dwordx4 v3, s[36:39], s59 offen  lds
s_add_u32 m0, s31, 115712
s_mov_b32 s59, 1404928
buffer_load_dwordx4 v3, s[36:39], s59 offen  lds
s_add_u32 m0, s31, 118784
s_mov_b32 s59, 1490944
buffer_load_dwordx4 v3, s[36:39], s59 offen  lds
s_add_u32 m0, s31, 119808
s_mov_b32 s59, 1519616
buffer_load_dwordx4 v3, s[36:39], s59 offen  lds
s_add_u32 m0, s31, 122880
s_mov_b32 s59, 128
buffer_load_dwordx4 v3, s[36:39], s59 offen  lds
s_add_u32 m0, s31, 123904
s_mov_b32 s59, 28800
buffer_load_dwordx4 v3, s[36:39], s59 offen  lds
s_waitcnt vmcnt(15)
s_barrier
s_add_u32 m0, s31, 126976
s_mov_b32 s59, 114816
buffer_load_dwordx4 v3, s[36:39], s59 offen  lds
s_add_u32 m0, s31, 128000
s_mov_b32 s59, 143488
buffer_load_dwordx4 v3, s[36:39], s59 offen  lds
s_add_u32 m0, s31, 131072
s_mov_b32 s59, 229504
buffer_load_dwordx4 v3, s[36:39], s59 offen  lds
s_add_u32 m0, s31, 132096
s_mov_b32 s59, 258176
buffer_load_dwordx4 v3, s[36:39], s59 offen  lds
s_add_u32 m0, s31, 135168
s_mov_b32 s59, 344192
buffer_load_dwordx4 v3, s[36:39], s59 offen  lds
s_add_u32 m0, s31, 136192
s_mov_b32 s59, 372864
buffer_load_dwordx4 v3, s[36:39], s59 offen  lds
s_add_u32 m0, s31, 139264
s_mov_b32 s59, 458880
buffer_load_dwordx4 v3, s[36:39], s59 offen  lds
s_add_u32 m0, s31, 140288
s_mov_b32 s59, 487552
buffer_load_dwordx4 v3, s[36:39], s59 offen  lds
s_waitcnt vmcnt(14)
s_barrier
s_add_u32 m0, s31, 143360
s_mov_b32 s59, 573568
buffer_load_dwordx4 v3, s[36:39], s59 offen  lds
s_add_u32 m0, s31, 144384
s_mov_b32 s59, 602240
buffer_load_dwordx4 v3, s[36:39], s59 offen  lds
s_add_u32 m0, s31, 147456
s_mov_b32 s59, 688256
buffer_load_dwordx4 v3, s[36:39], s59 offen  lds
s_add_u32 m0, s31, 148480
s_mov_b32 s59, 716928
buffer_load_dwordx4 v3, s[36:39], s59 offen  lds
s_add_u32 m0, s31, 151552
s_mov_b32 s59, 802944
buffer_load_dwordx4 v3, s[36:39], s59 offen  lds
s_add_u32 m0, s31, 152576
s_mov_b32 s59, 831616
buffer_load_dwordx4 v3, s[36:39], s59 offen  lds
s_add_u32 m0, s31, 155648
s_mov_b32 s59, 917632
buffer_load_dwordx4 v3, s[36:39], s59 offen  lds
s_add_u32 m0, s31, 156672
s_mov_b32 s59, 946304
buffer_load_dwordx4 v3, s[36:39], s59 offen  lds
s_waitcnt vmcnt(14)
s_barrier
s_add_u32 m0, s31, 159744
s_mov_b32 s59, 1032320
buffer_load_dwordx4 v3, s[36:39], s59 offen  lds
s_add_u32 m0, s31, 160768
s_mov_b32 s59, 1060992
buffer_load_dwordx4 v3, s[36:39], s59 offen  lds
s_add_u32 m0, s31, 65536
s_mov_b32 s59, 1147008
buffer_load_dwordx4 v3, s[36:39], s59 offen  lds
s_add_u32 m0, s31, 66560
s_mov_b32 s59, 1175680
buffer_load_dwordx4 v3, s[36:39], s59 offen  lds
s_add_u32 m0, s31, 69632
s_mov_b32 s59, 1261696
buffer_load_dwordx4 v3, s[36:39], s59 offen  lds
s_add_u32 m0, s31, 70656
s_mov_b32 s59, 1290368
buffer_load_dwordx4 v3, s[36:39], s59 offen  lds
s_add_u32 m0, s31, 73728
s_mov_b32 s59, 1376384
buffer_load_dwordx4 v3, s[36:39], s59 offen  lds
s_add_u32 m0, s31, 74752
s_mov_b32 s59, 1405056
buffer_load_dwordx4 v3, s[36:39], s59 offen  lds
s_waitcnt vmcnt(14)
s_barrier
s_add_u32 m0, s31, 77824
s_mov_b32 s59, 1491072
buffer_load_dwordx4 v3, s[36:39], s59 offen  lds
s_add_u32 m0, s31, 78848
s_mov_b32 s59, 1519744
buffer_load_dwordx4 v3, s[36:39], s59 offen  lds
s_add_u32 m0, s31, 81920
s_add_u32 s59, s48, 0
buffer_load_dwordx4 v2, s[32:35], s59 offen  lds
s_add_u32 m0, s31, 82944
s_add_u32 s59, s48, 21504
buffer_load_dwordx4 v2, s[32:35], s59 offen  lds
s_add_u32 m0, s31, 86016
s_add_u32 s59, s48, 128
buffer_load_dwordx4 v2, s[32:35], s59 offen  lds
s_add_u32 m0, s31, 87040
s_add_u32 s59, s48, 21632
buffer_load_dwordx4 v2, s[32:35], s59 offen  lds
s_add_u32 m0, s31, 90112
s_add_u32 s59, s48, 256
buffer_load_dwordx4 v2, s[32:35], s59 offen  lds
s_add_u32 m0, s31, 91136
s_add_u32 s59, s48, 21760
buffer_load_dwordx4 v2, s[32:35], s59 offen  lds
s_waitcnt vmcnt(14)
s_barrier
s_add_u32 m0, s31, 94208
s_add_u32 s59, s48, 384
buffer_load_dwordx4 v2, s[32:35], s59 offen  lds
s_add_u32 m0, s31, 95232
s_add_u32 s59, s48, 21888
buffer_load_dwordx4 v2, s[32:35], s59 offen  lds
s_add_u32 m0, s31, 98304
s_add_u32 s59, s48, 86016
buffer_load_dwordx4 v2, s[32:35], s59 offen  lds
s_add_u32 m0, s31, 99328
s_add_u32 s59, s48, 107520
buffer_load_dwordx4 v2, s[32:35], s59 offen  lds
s_add_u32 m0, s31, 102400
s_add_u32 s59, s48, 86144
buffer_load_dwordx4 v2, s[32:35], s59 offen  lds
s_add_u32 m0, s31, 103424
s_add_u32 s59, s48, 107648
buffer_load_dwordx4 v2, s[32:35], s59 offen  lds
s_add_u32 m0, s31, 106496
s_add_u32 s59, s48, 86272
buffer_load_dwordx4 v2, s[32:35], s59 offen  lds
s_add_u32 m0, s31, 107520
s_add_u32 s59, s48, 107776
buffer_load_dwordx4 v2, s[32:35], s59 offen  lds
s_waitcnt vmcnt(14)
s_barrier
s_add_u32 m0, s31, 110592
s_add_u32 s59, s48, 86400
buffer_load_dwordx4 v2, s[32:35], s59 offen  lds
s_add_u32 m0, s31, 111616
s_add_u32 s59, s48, 107904
buffer_load_dwordx4 v2, s[32:35], s59 offen  lds
s_add_u32 m0, s31, 114688
s_add_u32 s59, s48, 172032
buffer_load_dwordx4 v2, s[32:35], s59 offen  lds
s_add_u32 m0, s31, 115712
s_add_u32 s59, s48, 193536
buffer_load_dwordx4 v2, s[32:35], s59 offen  lds
s_add_u32 m0, s31, 118784
s_add_u32 s59, s48, 172160
buffer_load_dwordx4 v2, s[32:35], s59 offen  lds
s_add_u32 m0, s31, 119808
s_add_u32 s59, s48, 193664
buffer_load_dwordx4 v2, s[32:35], s59 offen  lds
s_add_u32 m0, s31, 122880
s_add_u32 s59, s48, 172288
buffer_load_dwordx4 v2, s[32:35], s59 offen  lds
s_add_u32 m0, s31, 123904
s_add_u32 s59, s48, 193792
buffer_load_dwordx4 v2, s[32:35], s59 offen  lds
s_waitcnt vmcnt(14)
s_barrier
s_add_u32 m0, s31, 126976
s_add_u32 s59, s48, 172416
buffer_load_dwordx4 v2, s[32:35], s59 offen  lds
s_add_u32 m0, s31, 128000
s_add_u32 s59, s48, 193920
buffer_load_dwordx4 v2, s[32:35], s59 offen  lds
s_add_u32 m0, s31, 131072
s_add_u32 s59, s48, 258048
buffer_load_dwordx4 v2, s[32:35], s59 offen  lds
s_add_u32 m0, s31, 132096
s_add_u32 s59, s48, 279552
buffer_load_dwordx4 v2, s[32:35], s59 offen  lds
s_add_u32 m0, s31, 135168
s_add_u32 s59, s48, 258176
buffer_load_dwordx4 v2, s[32:35], s59 offen  lds
s_add_u32 m0, s31, 136192
s_add_u32 s59, s48, 279680
buffer_load_dwordx4 v2, s[32:35], s59 offen  lds
s_add_u32 m0, s31, 139264
s_add_u32 s59, s48, 258304
buffer_load_dwordx4 v2, s[32:35], s59 offen  lds
s_add_u32 m0, s31, 140288
s_add_u32 s59, s48, 279808
buffer_load_dwordx4 v2, s[32:35], s59 offen  lds
s_waitcnt vmcnt(14)
s_barrier
s_add_u32 m0, s31, 143360
s_add_u32 s59, s48, 258432
buffer_load_dwordx4 v2, s[32:35], s59 offen  lds
s_add_u32 m0, s31, 144384
s_add_u32 s59, s48, 279936
buffer_load_dwordx4 v2, s[32:35], s59 offen  lds
s_add_u32 m0, s31, 147456
s_add_u32 s59, s48, 344064
buffer_load_dwordx4 v2, s[32:35], s59 offen  lds
s_add_u32 m0, s31, 148480
s_add_u32 s59, s48, 365568
buffer_load_dwordx4 v2, s[32:35], s59 offen  lds
s_add_u32 m0, s31, 151552
s_add_u32 s59, s48, 344192
buffer_load_dwordx4 v2, s[32:35], s59 offen  lds
s_add_u32 m0, s31, 152576
s_add_u32 s59, s48, 365696
buffer_load_dwordx4 v2, s[32:35], s59 offen  lds
s_add_u32 m0, s31, 155648
s_add_u32 s59, s48, 344320
buffer_load_dwordx4 v2, s[32:35], s59 offen  lds
s_add_u32 m0, s31, 156672
s_add_u32 s59, s48, 365824
buffer_load_dwordx4 v2, s[32:35], s59 offen  lds
s_waitcnt vmcnt(14)
s_barrier
s_add_u32 m0, s31, 159744
s_add_u32 s59, s48, 344448
buffer_load_dwordx4 v2, s[32:35], s59 offen  lds
s_add_u32 m0, s31, 160768
s_add_u32 s59, s48, 365952
buffer_load_dwordx4 v2, s[32:35], s59 offen  lds
s_add_u32 m0, s31, 65536
s_add_u32 s59, s48, 430080
buffer_load_dwordx4 v2, s[32:35], s59 offen  lds
s_add_u32 m0, s31, 66560
s_add_u32 s59, s48, 451584
buffer_load_dwordx4 v2, s[32:35], s59 offen  lds
s_add_u32 m0, s31, 69632
s_add_u32 s59, s48, 430208
buffer_load_dwordx4 v2, s[32:35], s59 offen  lds
s_add_u32 m0, s31, 70656
s_add_u32 s59, s48, 451712
buffer_load_dwordx4 v2, s[32:35], s59 offen  lds
s_add_u32 m0, s31, 73728
s_add_u32 s59, s48, 430336
buffer_load_dwordx4 v2, s[32:35], s59 offen  lds
s_add_u32 m0, s31, 74752
s_add_u32 s59, s48, 451840
buffer_load_dwordx4 v2, s[32:35], s59 offen  lds
s_waitcnt vmcnt(14)
s_barrier
s_add_u32 m0, s31, 77824
s_add_u32 s59, s48, 430464
buffer_load_dwordx4 v2, s[32:35], s59 offen  lds
s_add_u32 m0, s31, 78848
s_add_u32 s59, s48, 451968
buffer_load_dwordx4 v2, s[32:35], s59 offen  lds
s_add_u32 m0, s31, 81920
s_add_u32 s59, s48, 516096
buffer_load_dwordx4 v2, s[32:35], s59 offen  lds
s_add_u32 m0, s31, 82944
s_add_u32 s59, s48, 537600
buffer_load_dwordx4 v2, s[32:35], s59 offen  lds
s_add_u32 m0, s31, 86016
s_add_u32 s59, s48, 516224
buffer_load_dwordx4 v2, s[32:35], s59 offen  lds
s_add_u32 m0, s31, 87040
s_add_u32 s59, s48, 537728
buffer_load_dwordx4 v2, s[32:35], s59 offen  lds
s_add_u32 m0, s31, 90112
s_add_u32 s59, s48, 516352
buffer_load_dwordx4 v2, s[32:35], s59 offen  lds
s_add_u32 m0, s31, 91136
s_add_u32 s59, s48, 537856
buffer_load_dwordx4 v2, s[32:35], s59 offen  lds
s_waitcnt vmcnt(14)
s_barrier
s_add_u32 m0, s31, 94208
s_add_u32 s59, s48, 516480
buffer_load_dwordx4 v2, s[32:35], s59 offen  lds
s_add_u32 m0, s31, 95232
s_add_u32 s59, s48, 537984
buffer_load_dwordx4 v2, s[32:35], s59 offen  lds
s_add_u32 m0, s31, 98304
s_add_u32 s59, s48, 602112
buffer_load_dwordx4 v2, s[32:35], s59 offen  lds
s_add_u32 m0, s31, 99328
s_add_u32 s59, s48, 623616
buffer_load_dwordx4 v2, s[32:35], s59 offen  lds
s_add_u32 m0, s31, 102400
s_add_u32 s59, s48, 602240
buffer_load_dwordx4 v2, s[32:35], s59 offen  lds
s_add_u32 m0, s31, 103424
s_add_u32 s59, s48, 623744
buffer_load_dwordx4 v2, s[32:35], s59 offen  lds
s_add_u32 m0, s31, 106496
s_add_u32 s59, s48, 602368
buffer_load_dwordx4 v2, s[32:35], s59 offen  lds
s_add_u32 m0, s31, 107520
s_add_u32 s59, s48, 623872
buffer_load_dwordx4 v2, s[32:35], s59 offen  lds
s_waitcnt vmcnt(14)
s_barrier
s_add_u32 m0, s31, 110592
s_add_u32 s59, s48, 602496
buffer_load_dwordx4 v2, s[32:35], s59 offen  lds
s_add_u32 m0, s31, 111616
s_add_u32 s59, s48, 624000
buffer_load_dwordx4 v2, s[32:35], s59 offen  lds
s_add_u32 m0, s31, 114688
s_add_u32 s59, s48, 688128
buffer_load_dwordx4 v2, s[32:35], s59 offen  lds
s_add_u32 m0, s31, 115712
s_add_u32 s59, s48, 709632
buffer_load_dwordx4 v2, s[32:35], s59 offen  lds
s_add_u32 m0, s31, 118784
s_add_u32 s59, s48, 688256
buffer_load_dwordx4 v2, s[32:35], s59 offen  lds
s_add_u32 m0, s31, 119808
s_add_u32 s59, s48, 709760
buffer_load_dwordx4 v2, s[32:35], s59 offen  lds
s_add_u32 m0, s31, 122880
s_add_u32 s59, s48, 688384
buffer_load_dwordx4 v2, s[32:35], s59 offen  lds
s_add_u32 m0, s31, 123904
s_add_u32 s59, s48, 709888
buffer_load_dwordx4 v2, s[32:35], s59 offen  lds
buffer_load_dword v51, v19, s[40:43], 0 offen
s_waitcnt vmcnt(15)
s_barrier
s_add_u32 m0, s31, 126976
s_add_u32 s59, s48, 688512
buffer_load_dwordx4 v2, s[32:35], s59 offen  lds
s_add_u32 m0, s31, 128000
s_add_u32 s59, s48, 710016
buffer_load_dwordx4 v2, s[32:35], s59 offen  lds
s_add_u32 m0, s31, 131072
s_add_u32 s59, s48, 774144
buffer_load_dwordx4 v2, s[32:35], s59 offen  lds
s_add_u32 m0, s31, 132096
s_add_u32 s59, s48, 795648
buffer_load_dwordx4 v2, s[32:35], s59 offen  lds
s_add_u32 m0, s31, 135168
s_add_u32 s59, s48, 774272
buffer_load_dwordx4 v2, s[32:35], s59 offen  lds
s_add_u32 m0, s31, 136192
s_add_u32 s59, s48, 795776
buffer_load_dwordx4 v2, s[32:35], s59 offen  lds
s_add_u32 m0, s31, 139264
s_add_u32 s59, s48, 774400
buffer_load_dwordx4 v2, s[32:35], s59 offen  lds
s_add_u32 m0, s31, 140288
s_add_u32 s59, s48, 795904
buffer_load_dwordx4 v2, s[32:35], s59 offen  lds
s_add_u32 m0, s31, 143360
s_add_u32 s59, s48, 774528
buffer_load_dwordx4 v2, s[32:35], s59 offen  lds
s_add_u32 m0, s31, 144384
s_add_u32 s59, s48, 796032
buffer_load_dwordx4 v2, s[32:35], s59 offen  lds
s_add_u32 m0, s31, 147456
s_add_u32 s59, s48, 860160
buffer_load_dwordx4 v2, s[32:35], s59 offen  lds
s_add_u32 m0, s31, 148480
s_add_u32 s59, s48, 881664
buffer_load_dwordx4 v2, s[32:35], s59 offen  lds
s_add_u32 m0, s31, 151552
s_add_u32 s59, s48, 860288
buffer_load_dwordx4 v2, s[32:35], s59 offen  lds
s_add_u32 m0, s31, 152576
s_add_u32 s59, s48, 881792
buffer_load_dwordx4 v2, s[32:35], s59 offen  lds
s_waitcnt vmcnt(21)
s_barrier
s_add_u32 m0, s31, 155648
s_add_u32 s59, s48, 860416
buffer_load_dwordx4 v2, s[32:35], s59 offen  lds
s_add_u32 m0, s31, 156672
s_add_u32 s59, s48, 881920
buffer_load_dwordx4 v2, s[32:35], s59 offen  lds
s_add_u32 m0, s31, 159744
s_add_u32 s59, s48, 860544
buffer_load_dwordx4 v2, s[32:35], s59 offen  lds
s_add_u32 m0, s31, 160768
s_add_u32 s59, s48, 882048
buffer_load_dwordx4 v2, s[32:35], s59 offen  lds
s_add_u32 m0, s31, 65536
s_add_u32 s59, s48, 946176
buffer_load_dwordx4 v2, s[32:35], s59 offen  lds
s_add_u32 m0, s31, 66560
s_add_u32 s59, s48, 967680
buffer_load_dwordx4 v2, s[32:35], s59 offen  lds
s_add_u32 m0, s31, 69632
s_add_u32 s59, s48, 946304
buffer_load_dwordx4 v2, s[32:35], s59 offen  lds
s_add_u32 m0, s31, 70656
s_add_u32 s59, s48, 967808
buffer_load_dwordx4 v2, s[32:35], s59 offen  lds
s_waitcnt vmcnt(20)
s_barrier
s_add_u32 m0, s31, 73728
s_add_u32 s59, s48, 946432
buffer_load_dwordx4 v2, s[32:35], s59 offen  lds
s_add_u32 m0, s31, 74752
s_add_u32 s59, s48, 967936
buffer_load_dwordx4 v2, s[32:35], s59 offen  lds
s_add_u32 m0, s31, 77824
s_add_u32 s59, s48, 946560
buffer_load_dwordx4 v2, s[32:35], s59 offen  lds
s_add_u32 m0, s31, 78848
s_add_u32 s59, s48, 968064
buffer_load_dwordx4 v2, s[32:35], s59 offen  lds
s_add_u32 m0, s31, 81920
s_add_u32 s59, s48, 1032192
buffer_load_dwordx4 v2, s[32:35], s59 offen  lds
s_add_u32 m0, s31, 82944
s_add_u32 s59, s48, 1053696
buffer_load_dwordx4 v2, s[32:35], s59 offen  lds
s_waitcnt vmcnt(18)
s_barrier
s_add_u32 m0, s31, 86016
s_add_u32 s59, s48, 1032320
buffer_load_dwordx4 v2, s[32:35], s59 offen  lds
s_add_u32 m0, s31, 87040
s_add_u32 s59, s48, 1053824
buffer_load_dwordx4 v2, s[32:35], s59 offen  lds
s_add_u32 m0, s31, 90112
s_add_u32 s59, s48, 1032448
buffer_load_dwordx4 v2, s[32:35], s59 offen  lds
s_add_u32 m0, s31, 91136
s_add_u32 s59, s48, 1053952
buffer_load_dwordx4 v2, s[32:35], s59 offen  lds
s_add_u32 m0, s31, 94208
s_add_u32 s59, s48, 1032576
buffer_load_dwordx4 v2, s[32:35], s59 offen  lds
s_add_u32 m0, s31, 95232
s_add_u32 s59, s48, 1054080
buffer_load_dwordx4 v2, s[32:35], s59 offen  lds
s_add_u32 m0, s31, 98304
s_add_u32 s59, s48, 1118208
buffer_load_dwordx4 v2, s[32:35], s59 offen  lds
s_add_u32 m0, s31, 99328
s_add_u32 s59, s48, 1139712
buffer_load_dwordx4 v2, s[32:35], s59 offen  lds
s_waitcnt vmcnt(18)
s_barrier
s_add_u32 m0, s31, 102400
s_add_u32 s59, s48, 1118336
buffer_load_dwordx4 v2, s[32:35], s59 offen  lds
s_add_u32 m0, s31, 103424
s_add_u32 s59, s48, 1139840
buffer_load_dwordx4 v2, s[32:35], s59 offen  lds
s_add_u32 m0, s31, 106496
s_add_u32 s59, s48, 1118464
buffer_load_dwordx4 v2, s[32:35], s59 offen  lds
s_add_u32 m0, s31, 107520
s_add_u32 s59, s48, 1139968
buffer_load_dwordx4 v2, s[32:35], s59 offen  lds
s_add_u32 m0, s31, 110592
s_add_u32 s59, s48, 1118592
buffer_load_dwordx4 v2, s[32:35], s59 offen  lds
s_add_u32 m0, s31, 111616
s_add_u32 s59, s48, 1140096
buffer_load_dwordx4 v2, s[32:35], s59 offen  lds
s_add_u32 m0, s31, 114688
s_add_u32 s59, s50, 0
buffer_load_dwordx4 v4, s[40:43], s59 offen  lds
s_add_u32 m0, s31, 115712
s_add_u32 s59, s50, 7168
buffer_load_dwordx4 v4, s[40:43], s59 offen  lds
s_waitcnt vmcnt(18)
s_barrier
s_add_u32 m0, s31, 118784
s_add_u32 s59, s51, 0
buffer_load_dwordx4 v4, s[40:43], s59 offen  lds
s_add_u32 m0, s31, 119808
s_add_u32 s59, s51, 7168
buffer_load_dwordx4 v4, s[40:43], s59 offen  lds
s_add_u32 m0, s31, 122880
s_add_u32 s59, s52, 0
buffer_load_dwordx4 v4, s[40:43], s59 offen  lds
s_add_u32 m0, s31, 123904
s_add_u32 s59, s52, 7168
buffer_load_dwordx4 v4, s[40:43], s59 offen  lds
s_add_u32 m0, s31, 126976
s_add_u32 s59, s53, 0
buffer_load_dwordx4 v4, s[40:43], s59 offen  lds
s_add_u32 m0, s31, 128000
s_add_u32 s59, s53, 7168
buffer_load_dwordx4 v4, s[40:43], s59 offen  lds
s_add_u32 m0, s31, 131072
s_add_u32 s59, s54, 0
buffer_load_dwordx4 v4, s[40:43], s59 offen  lds
s_add_u32 m0, s31, 132096
s_add_u32 s59, s54, 7168
buffer_load_dwordx4 v4, s[40:43], s59 offen  lds
s_waitcnt vmcnt(18)
s_barrier
s_add_u32 m0, s31, 135168
s_add_u32 s59, s55, 0
buffer_load_dwordx4 v4, s[40:43], s59 offen  lds
s_add_u32 m0, s31, 136192
s_add_u32 s59, s55, 7168
buffer_load_dwordx4 v4, s[40:43], s59 offen  lds
s_add_u32 m0, s31, 139264
s_add_u32 s59, s56, 0
buffer_load_dwordx4 v4, s[40:43], s59 offen  lds
s_add_u32 m0, s31, 140288
s_add_u32 s59, s56, 7168
buffer_load_dwordx4 v4, s[40:43], s59 offen  lds
s_add_u32 m0, s31, 143360
s_add_u32 s59, s50, 28672
buffer_load_dwordx4 v4, s[40:43], s59 offen  lds
s_add_u32 m0, s31, 144384
s_add_u32 s59, s50, 35840
buffer_load_dwordx4 v4, s[40:43], s59 offen  lds
s_add_u32 m0, s31, 147456
s_add_u32 s59, s51, 28672
buffer_load_dwordx4 v4, s[40:43], s59 offen  lds
s_add_u32 m0, s31, 148480
s_add_u32 s59, s51, 35840
buffer_load_dwordx4 v4, s[40:43], s59 offen  lds
s_waitcnt vmcnt(18)
s_barrier
s_add_u32 m0, s31, 151552
s_add_u32 s59, s52, 28672
buffer_load_dwordx4 v4, s[40:43], s59 offen  lds
s_add_u32 m0, s31, 152576
s_add_u32 s59, s52, 35840
buffer_load_dwordx4 v4, s[40:43], s59 offen  lds
s_add_u32 m0, s31, 155648
s_add_u32 s59, s53, 28672
buffer_load_dwordx4 v4, s[40:43], s59 offen  lds
s_add_u32 m0, s31, 156672
s_add_u32 s59, s53, 35840
buffer_load_dwordx4 v4, s[40:43], s59 offen  lds
s_add_u32 m0, s31, 159744
s_add_u32 s59, s54, 28672
buffer_load_dwordx4 v4, s[40:43], s59 offen  lds
s_add_u32 m0, s31, 160768
s_add_u32 s59, s54, 35840
buffer_load_dwordx4 v4, s[40:43], s59 offen  lds
buffer_load_dword v52, v20, s[44:47], 0 offen
s_waitcnt vmcnt(17)
s_barrier
s_add_u32 m0, s31, 65536
s_add_u32 s59, s55, 28672
buffer_load_dwordx4 v4, s[40:43], s59 offen  lds
s_add_u32 m0, s31, 66560
s_add_u32 s59, s55, 35840
buffer_load_dwordx4 v4, s[40:43], s59 offen  lds
s_add_u32 m0, s31, 69632
s_add_u32 s59, s56, 28672
buffer_load_dwordx4 v4, s[40:43], s59 offen  lds
s_add_u32 m0, s31, 70656
s_add_u32 s59, s56, 35840
buffer_load_dwordx4 v4, s[40:43], s59 offen  lds
s_add_u32 m0, s31, 73728
s_add_u32 s59, s50, 57344
buffer_load_dwordx4 v4, s[40:43], s59 offen  lds
s_add_u32 m0, s31, 74752
s_add_u32 s59, s50, 64512
buffer_load_dwordx4 v4, s[40:43], s59 offen  lds
s_add_u32 m0, s31, 77824
s_add_u32 s59, s51, 57344
buffer_load_dwordx4 v4, s[40:43], s59 offen  lds
s_add_u32 m0, s31, 78848
s_add_u32 s59, s51, 64512
buffer_load_dwordx4 v4, s[40:43], s59 offen  lds
s_add_u32 m0, s31, 81920
s_add_u32 s59, s52, 57344
buffer_load_dwordx4 v4, s[40:43], s59 offen  lds
s_add_u32 m0, s31, 82944
s_add_u32 s59, s52, 64512
buffer_load_dwordx4 v4, s[40:43], s59 offen  lds
s_waitcnt vmcnt(19)
s_barrier
s_add_u32 m0, s31, 86016
s_add_u32 s59, s53, 57344
buffer_load_dwordx4 v4, s[40:43], s59 offen  lds
s_add_u32 m0, s31, 87040
s_add_u32 s59, s53, 64512
buffer_load_dwordx4 v4, s[40:43], s59 offen  lds
s_add_u32 m0, s31, 90112
s_add_u32 s59, s54, 57344
buffer_load_dwordx4 v4, s[40:43], s59 offen  lds
s_add_u32 m0, s31, 91136
s_add_u32 s59, s54, 64512
buffer_load_dwordx4 v4, s[40:43], s59 offen  lds
s_add_u32 m0, s31, 94208
s_add_u32 s59, s55, 57344
buffer_load_dwordx4 v4, s[40:43], s59 offen  lds
s_add_u32 m0, s31, 95232
s_add_u32 s59, s55, 64512
buffer_load_dwordx4 v4, s[40:43], s59 offen  lds
s_add_u32 m0, s31, 98304
s_add_u32 s59, s56, 57344
buffer_load_dwordx4 v4, s[40:43], s59 offen  lds
s_add_u32 m0, s31, 99328
s_add_u32 s59, s56, 64512
buffer_load_dwordx4 v4, s[40:43], s59 offen  lds
s_add_u32 m0, s31, 102400
s_add_u32 s59, s50, 86016
buffer_load_dwordx4 v4, s[40:43], s59 offen  lds
s_add_u32 m0, s31, 103424
s_add_u32 s59, s50, 93184
buffer_load_dwordx4 v4, s[40:43], s59 offen  lds
s_waitcnt vmcnt(21)
s_barrier
s_add_u32 m0, s31, 106496
s_add_u32 s59, s51, 86016
buffer_load_dwordx4 v4, s[40:43], s59 offen  lds
s_add_u32 m0, s31, 107520
s_add_u32 s59, s51, 93184
buffer_load_dwordx4 v4, s[40:43], s59 offen  lds
s_add_u32 m0, s31, 110592
s_add_u32 s59, s52, 86016
buffer_load_dwordx4 v4, s[40:43], s59 offen  lds
s_add_u32 m0, s31, 111616
s_add_u32 s59, s52, 93184
buffer_load_dwordx4 v4, s[40:43], s59 offen  lds
s_add_u32 m0, s31, 114688
s_add_u32 s59, s53, 86016
buffer_load_dwordx4 v4, s[40:43], s59 offen  lds
s_add_u32 m0, s31, 115712
s_add_u32 s59, s53, 93184
buffer_load_dwordx4 v4, s[40:43], s59 offen  lds
s_add_u32 m0, s31, 118784
s_add_u32 s59, s54, 86016
buffer_load_dwordx4 v4, s[40:43], s59 offen  lds
s_add_u32 m0, s31, 119808
s_add_u32 s59, s54, 93184
buffer_load_dwordx4 v4, s[40:43], s59 offen  lds
s_add_u32 m0, s31, 122880
s_add_u32 s59, s55, 86016
buffer_load_dwordx4 v4, s[40:43], s59 offen  lds
s_add_u32 m0, s31, 123904
s_add_u32 s59, s55, 93184
buffer_load_dwordx4 v4, s[40:43], s59 offen  lds
s_waitcnt vmcnt(22)
s_barrier
s_add_u32 m0, s31, 126976
s_add_u32 s59, s56, 86016
buffer_load_dwordx4 v4, s[40:43], s59 offen  lds
s_add_u32 m0, s31, 128000
s_add_u32 s59, s56, 93184
buffer_load_dwordx4 v4, s[40:43], s59 offen  lds
s_add_u32 m0, s31, 131072
s_add_u32 s59, s50, 0
buffer_load_dwordx4 v4, s[44:47], s59 offen  lds
s_add_u32 m0, s31, 132096
s_add_u32 s59, s50, 7168
buffer_load_dwordx4 v4, s[44:47], s59 offen  lds
s_add_u32 m0, s31, 135168
s_add_u32 s59, s50, 28672
buffer_load_dwordx4 v4, s[44:47], s59 offen  lds
s_add_u32 m0, s31, 136192
s_add_u32 s59, s50, 35840
buffer_load_dwordx4 v4, s[44:47], s59 offen  lds
s_add_u32 m0, s31, 139264
s_add_u32 s59, s50, 57344
buffer_load_dwordx4 v4, s[44:47], s59 offen  lds
s_add_u32 m0, s31, 140288
s_add_u32 s59, s50, 64512
buffer_load_dwordx4 v4, s[44:47], s59 offen  lds
s_add_u32 m0, s31, 143360
s_add_u32 s59, s50, 86016
buffer_load_dwordx4 v4, s[44:47], s59 offen  lds
s_add_u32 m0, s31, 144384
s_add_u32 s59, s50, 93184
buffer_load_dwordx4 v4, s[44:47], s59 offen  lds
s_waitcnt vmcnt(24)
s_barrier
s_add_u32 m0, s31, 147456
s_add_u32 s59, s50, 114688
buffer_load_dwordx4 v4, s[44:47], s59 offen  lds
s_add_u32 m0, s31, 148480
s_add_u32 s59, s50, 121856
buffer_load_dwordx4 v4, s[44:47], s59 offen  lds
s_add_u32 m0, s31, 151552
s_add_u32 s59, s50, 143360
buffer_load_dwordx4 v4, s[44:47], s59 offen  lds
s_add_u32 m0, s31, 152576
s_add_u32 s59, s50, 150528
buffer_load_dwordx4 v4, s[44:47], s59 offen  lds
s_add_u32 m0, s31, 155648
s_add_u32 s59, s50, 172032
buffer_load_dwordx4 v4, s[44:47], s59 offen  lds
s_add_u32 m0, s31, 156672
s_add_u32 s59, s50, 179200
buffer_load_dwordx4 v4, s[44:47], s59 offen  lds
s_add_u32 m0, s31, 159744
s_add_u32 s59, s51, 0
buffer_load_dwordx4 v4, s[44:47], s59 offen  lds
s_add_u32 m0, s31, 160768
s_add_u32 s59, s51, 7168
buffer_load_dwordx4 v4, s[44:47], s59 offen  lds
s_add_u32 m0, s31, 65536
s_add_u32 s59, s51, 28672
buffer_load_dwordx4 v4, s[44:47], s59 offen  lds
s_add_u32 m0, s31, 66560
s_add_u32 s59, s51, 35840
buffer_load_dwordx4 v4, s[44:47], s59 offen  lds
s_waitcnt vmcnt(26)
s_barrier
s_add_u32 m0, s31, 69632
s_add_u32 s59, s51, 57344
buffer_load_dwordx4 v4, s[44:47], s59 offen  lds
s_add_u32 m0, s31, 70656
s_add_u32 s59, s51, 64512
buffer_load_dwordx4 v4, s[44:47], s59 offen  lds
s_add_u32 m0, s31, 73728
s_add_u32 s59, s51, 86016
buffer_load_dwordx4 v4, s[44:47], s59 offen  lds
s_add_u32 m0, s31, 74752
s_add_u32 s59, s51, 93184
buffer_load_dwordx4 v4, s[44:47], s59 offen  lds
s_add_u32 m0, s31, 77824
s_add_u32 s59, s51, 114688
buffer_load_dwordx4 v4, s[44:47], s59 offen  lds
s_add_u32 m0, s31, 78848
s_add_u32 s59, s51, 121856
buffer_load_dwordx4 v4, s[44:47], s59 offen  lds
s_add_u32 m0, s31, 81920
s_add_u32 s59, s51, 143360
buffer_load_dwordx4 v4, s[44:47], s59 offen  lds
s_add_u32 m0, s31, 82944
s_add_u32 s59, s51, 150528
buffer_load_dwordx4 v4, s[44:47], s59 offen  lds
s_add_u32 m0, s31, 86016
s_add_u32 s59, s51, 172032
buffer_load_dwordx4 v4, s[44:47], s59 offen  lds
s_add_u32 m0, s31, 87040
s_add_u32 s59, s51, 179200
buffer_load_dwordx4 v4, s[44:47], s59 offen  lds
s_waitcnt vmcnt(28)
s_barrier
s_add_u32 m0, s31, 90112
s_add_u32 s59, s52, 0
buffer_load_dwordx4 v4, s[44:47], s59 offen  lds
s_add_u32 m0, s31, 91136
s_add_u32 s59, s52, 7168
buffer_load_dwordx4 v4, s[44:47], s59 offen  lds
s_add_u32 m0, s31, 94208
s_add_u32 s59, s52, 28672
buffer_load_dwordx4 v4, s[44:47], s59 offen  lds
s_add_u32 m0, s31, 95232
s_add_u32 s59, s52, 35840
buffer_load_dwordx4 v4, s[44:47], s59 offen  lds
s_add_u32 m0, s31, 98304
s_add_u32 s59, s52, 57344
buffer_load_dwordx4 v4, s[44:47], s59 offen  lds
s_add_u32 m0, s31, 99328
s_add_u32 s59, s52, 64512
buffer_load_dwordx4 v4, s[44:47], s59 offen  lds
s_add_u32 m0, s31, 102400
s_add_u32 s59, s52, 86016
buffer_load_dwordx4 v4, s[44:47], s59 offen  lds
s_add_u32 m0, s31, 103424
s_add_u32 s59, s52, 93184
buffer_load_dwordx4 v4, s[44:47], s59 offen  lds
s_waitcnt vmcnt(36)
s_barrier
s_add_u32 m0, s31, 106496
s_add_u32 s59, s52, 114688
buffer_load_dwordx4 v4, s[44:47], s59 offen  lds
s_add_u32 m0, s31, 107520
s_add_u32 s59, s52, 121856
buffer_load_dwordx4 v4, s[44:47], s59 offen  lds
s_add_u32 m0, s31, 110592
s_add_u32 s59, s52, 143360
buffer_load_dwordx4 v4, s[44:47], s59 offen  lds
s_add_u32 m0, s31, 111616
s_add_u32 s59, s52, 150528
buffer_load_dwordx4 v4, s[44:47], s59 offen  lds
s_add_u32 m0, s31, 114688
s_add_u32 s59, s52, 172032
buffer_load_dwordx4 v4, s[44:47], s59 offen  lds
s_add_u32 m0, s31, 115712
s_add_u32 s59, s52, 179200
buffer_load_dwordx4 v4, s[44:47], s59 offen  lds
s_add_u32 m0, s31, 118784
s_add_u32 s59, s53, 0
buffer_load_dwordx4 v4, s[44:47], s59 offen  lds
s_add_u32 m0, s31, 119808
s_add_u32 s59, s53, 7168
buffer_load_dwordx4 v4, s[44:47], s59 offen  lds
s_add_u32 m0, s31, 122880
s_add_u32 s59, s53, 28672
buffer_load_dwordx4 v4, s[44:47], s59 offen  lds
s_add_u32 m0, s31, 123904
s_add_u32 s59, s53, 35840
buffer_load_dwordx4 v4, s[44:47], s59 offen  lds
s_add_u32 m0, s31, 126976
s_add_u32 s59, s53, 57344
buffer_load_dwordx4 v4, s[44:47], s59 offen  lds
s_add_u32 m0, s31, 128000
s_add_u32 s59, s53, 64512
buffer_load_dwordx4 v4, s[44:47], s59 offen  lds
s_add_u32 m0, s31, 4096
s_add_u32 s59, s53, 86016
buffer_load_dwordx4 v4, s[44:47], s59 offen  lds
s_add_u32 m0, s31, 5120
s_add_u32 s59, s53, 93184
buffer_load_dwordx4 v4, s[44:47], s59 offen  lds
s_add_u32 m0, s31, 34816
s_add_u32 s59, s53, 114688
buffer_load_dwordx4 v4, s[44:47], s59 offen  lds
s_add_u32 m0, s31, 35840
s_add_u32 s59, s53, 121856
buffer_load_dwordx4 v4, s[44:47], s59 offen  lds
s_add_u32 m0, s31, 8192
s_add_u32 s59, s53, 143360
buffer_load_dwordx4 v4, s[44:47], s59 offen  lds
s_add_u32 m0, s31, 9216
s_add_u32 s59, s53, 150528
buffer_load_dwordx4 v4, s[44:47], s59 offen  lds
s_add_u32 m0, s31, 38912
s_add_u32 s59, s53, 172032
buffer_load_dwordx4 v4, s[44:47], s59 offen  lds
s_add_u32 m0, s31, 39936
s_add_u32 s59, s53, 179200
buffer_load_dwordx4 v4, s[44:47], s59 offen  lds
s_waitcnt vmcnt(56)
s_barrier
s_waitcnt vmcnt(48)
s_barrier
s_add_u32 m0, s31, 12288
s_add_u32 s59, s54, 0
buffer_load_dwordx4 v4, s[44:47], s59 offen  lds
s_add_u32 m0, s31, 13312
s_add_u32 s59, s54, 7168
buffer_load_dwordx4 v4, s[44:47], s59 offen  lds
s_add_u32 m0, s31, 43008
s_add_u32 s59, s54, 28672
buffer_load_dwordx4 v4, s[44:47], s59 offen  lds
s_add_u32 m0, s31, 44032
s_add_u32 s59, s54, 35840
buffer_load_dwordx4 v4, s[44:47], s59 offen  lds
s_add_u32 m0, s31, 16384
s_add_u32 s59, s54, 57344
buffer_load_dwordx4 v4, s[44:47], s59 offen  lds
s_add_u32 m0, s31, 17408
s_add_u32 s59, s54, 64512
buffer_load_dwordx4 v4, s[44:47], s59 offen  lds
s_add_u32 m0, s31, 47104
s_add_u32 s59, s54, 86016
buffer_load_dwordx4 v4, s[44:47], s59 offen  lds
s_add_u32 m0, s31, 48128
s_add_u32 s59, s54, 93184
buffer_load_dwordx4 v4, s[44:47], s59 offen  lds
s_waitcnt vmcnt(48)
s_barrier
s_add_u32 m0, s31, 131072
s_add_u32 s59, s54, 114688
buffer_load_dwordx4 v4, s[44:47], s59 offen  lds
s_add_u32 m0, s31, 132096
s_add_u32 s59, s54, 121856
buffer_load_dwordx4 v4, s[44:47], s59 offen  lds
s_add_u32 m0, s31, 135168
s_add_u32 s59, s54, 143360
buffer_load_dwordx4 v4, s[44:47], s59 offen  lds
s_add_u32 m0, s31, 136192
s_add_u32 s59, s54, 150528
buffer_load_dwordx4 v4, s[44:47], s59 offen  lds
s_waitcnt vmcnt(44)
s_barrier
s_add_u32 m0, s31, 139264
s_add_u32 s59, s54, 172032
buffer_load_dwordx4 v4, s[44:47], s59 offen  lds
s_add_u32 m0, s31, 140288
s_add_u32 s59, s54, 179200
buffer_load_dwordx4 v4, s[44:47], s59 offen  lds
s_add_u32 m0, s31, 143360
s_add_u32 s59, s55, 0
buffer_load_dwordx4 v4, s[44:47], s59 offen  lds
s_add_u32 m0, s31, 144384
s_add_u32 s59, s55, 7168
buffer_load_dwordx4 v4, s[44:47], s59 offen  lds
s_add_u32 m0, s31, 147456
s_add_u32 s59, s55, 28672
buffer_load_dwordx4 v4, s[44:47], s59 offen  lds
s_add_u32 m0, s31, 148480
s_add_u32 s59, s55, 35840
buffer_load_dwordx4 v4, s[44:47], s59 offen  lds
s_add_u32 m0, s31, 151552
s_add_u32 s59, s55, 57344
buffer_load_dwordx4 v4, s[44:47], s59 offen  lds
s_add_u32 m0, s31, 152576
s_add_u32 s59, s55, 64512
buffer_load_dwordx4 v4, s[44:47], s59 offen  lds
s_waitcnt vmcnt(44)
s_barrier
s_add_u32 m0, s31, 155648
s_add_u32 s59, s55, 86016
buffer_load_dwordx4 v4, s[44:47], s59 offen  lds
s_add_u32 m0, s31, 156672
s_add_u32 s59, s55, 93184
buffer_load_dwordx4 v4, s[44:47], s59 offen  lds
s_add_u32 m0, s31, 159744
s_add_u32 s59, s55, 114688
buffer_load_dwordx4 v4, s[44:47], s59 offen  lds
s_add_u32 m0, s31, 160768
s_add_u32 s59, s55, 121856
buffer_load_dwordx4 v4, s[44:47], s59 offen  lds
s_add_u32 m0, s31, 65536
s_add_u32 s59, s55, 143360
buffer_load_dwordx4 v4, s[44:47], s59 offen  lds
s_add_u32 m0, s31, 66560
s_add_u32 s59, s55, 150528
buffer_load_dwordx4 v4, s[44:47], s59 offen  lds
s_add_u32 m0, s31, 69632
s_add_u32 s59, s55, 172032
buffer_load_dwordx4 v4, s[44:47], s59 offen  lds
s_add_u32 m0, s31, 70656
s_add_u32 s59, s55, 179200
buffer_load_dwordx4 v4, s[44:47], s59 offen  lds
s_waitcnt vmcnt(44)
s_barrier
s_add_u32 m0, s31, 73728
s_add_u32 s59, s56, 0
buffer_load_dwordx4 v4, s[44:47], s59 offen  lds
s_add_u32 m0, s31, 74752
s_add_u32 s59, s56, 7168
buffer_load_dwordx4 v4, s[44:47], s59 offen  lds
s_add_u32 m0, s31, 77824
s_add_u32 s59, s56, 28672
buffer_load_dwordx4 v4, s[44:47], s59 offen  lds
s_add_u32 m0, s31, 78848
s_add_u32 s59, s56, 35840
buffer_load_dwordx4 v4, s[44:47], s59 offen  lds
s_add_u32 m0, s31, 81920
s_add_u32 s59, s56, 57344
buffer_load_dwordx4 v4, s[44:47], s59 offen  lds
s_add_u32 m0, s31, 82944
s_add_u32 s59, s56, 64512
buffer_load_dwordx4 v4, s[44:47], s59 offen  lds
s_add_u32 m0, s31, 86016
s_add_u32 s59, s56, 86016
buffer_load_dwordx4 v4, s[44:47], s59 offen  lds
s_add_u32 m0, s31, 87040
s_add_u32 s59, s56, 93184
buffer_load_dwordx4 v4, s[44:47], s59 offen  lds
s_waitcnt vmcnt(44)
s_barrier
s_add_u32 m0, s31, 90112
s_add_u32 s59, s56, 114688
buffer_load_dwordx4 v4, s[44:47], s59 offen  lds
s_add_u32 m0, s31, 91136
s_add_u32 s59, s56, 121856
buffer_load_dwordx4 v4, s[44:47], s59 offen  lds
s_add_u32 m0, s31, 94208
s_add_u32 s59, s56, 143360
buffer_load_dwordx4 v4, s[44:47], s59 offen  lds
s_add_u32 m0, s31, 95232
s_add_u32 s59, s56, 150528
buffer_load_dwordx4 v4, s[44:47], s59 offen  lds
s_add_u32 m0, s31, 98304
s_add_u32 s59, s56, 172032
buffer_load_dwordx4 v4, s[44:47], s59 offen  lds
s_add_u32 m0, s31, 99328
s_add_u32 s59, s56, 179200
buffer_load_dwordx4 v4, s[44:47], s59 offen  lds
s_mov_b32 s32, s8
s_and_b32 s33, s9, 0xffff
s_mov_b32 s34, 1835008
s_mov_b32 s35, 0x20000
s_mov_b32 s36, s28
s_and_b32 s37, s29, 0xffff
s_mov_b32 s38, 67108864
s_mov_b32 s39, 0x20000
s_mov_b64 s[0:1], s[22:23]
s_sub_u32 s57, s3, 4
s_cmp_gt_u32 s4, 3
s_subb_u32 s58, s4, 0
s_mul_i32 s61, s5, 7
s_add_u32 s61, s61, s58
s_lshl_b32 s60, s57, 8
s_add_u32 s60, s60, s61
s_lshl_b32 s60, s60, 7
s_add_u32 s60, s60, 23068672
s_add_u32 s48, s28, s60
s_addc_u32 s49, s29, 0
s_waitcnt lgkmcnt(0)
s_mov_b32 s26, s14
s_load_dwordx16 s[8:23], s[48:49], 0 glc
s_lshl_b32 s61, s61, 5
s_add_u32 s61, s61, s57
s_lshl_b32 s61, s61, 11
s_mul_i32 s60, s5, 0
s_add_u32 s61, s61, s60
s_add_u32 s61, s61, 6291456
s_lshl_b32 s58, s58, 7
s_and_b32 s60, s57, 1
s_lshl_b32 s60, s60, 6
s_add_u32 s58, s58, s60
s_lshr_b32 s27, s57, 1
s_lshl_b32 s60, s5, 1
s_add_u32 s60, s60, s27
s_mul_i32 s60, s60, 28672
s_add_u32 s60, s60, s58
v_lshrrev_b32 v41, 2, v0
v_and_b32 v39, 3, v0
v_mul_u32_u24 v36, 896, v41
v_lshl_add_u32 v36, v39, 4, v36
v_mul_u32_u24 v41, 80, v41
v_lshl_add_u32 v41, v39, 4, v41
v_bfe_u32 v37, v0, 5, 1
v_lshlrev_b32 v37, 3, v37
v_and_b32 v39, 31, v0
v_lshl_add_u32 v38, v39, 6, v37
v_lshl_add_u32 v40, v39, 4, v38
v_lshlrev_b32 v39, 4, v0
s_mul_i32 s27, s27, 30720
s_and_b32 s57, s57, 1
s_lshl_b32 s57, s57, 11
s_add_u32 s27, s27, s57
s_add_u32 s57, s57, s27
s_add_u32 s57, s57, 20480
s_add_u32 s27, s27, 28672
v_add_u32 v33, s57, v39
v_add_u32 v40, s57, v40
v_add_u32 v41, s57, v41
v_add_u32 v38, s27, v38
v_and_b32 v43, 15, v0
v_lshl_add_u32 v43, v37, 1, v43
v_mul_u32_u24 v43, 0x9e3a, v43
v_or_b32 v43, 1, v43
v_mov_b32 v34, s26
s_waitcnt vmcnt(42)
s_barrier
s_mov_b32 s40, s0
s_and_b32 s41, s1, 0xffff
s_mov_b32 s42, 896
s_mov_b32 s43, 0x20000
s_mov_b32 s44, s24
s_and_b32 s45, s25, 0xffff
s_mov_b32 s46, 1835008
s_mov_b32 s47, 0x20000
s_add_u32 s57, s60, 14336
s_add_u32 m0, s27, 0
s_nop 0
buffer_load_dwordx4 v36, s[32:35], s60 offen lds
buffer_load_dwordx2 v[136:137], v37, s[40:43], s58 offen offset:0
buffer_load_dwordx2 v[138:139], v37, s[40:43], s58 offen offset:32
s_add_u32 m0, s27, 1024
s_nop 0
buffer_load_dwordx4 v36, s[32:35], s57 offen lds
buffer_load_dwordx2 v[140:141], v37, s[40:43], s58 offen offset:16
buffer_load_dwordx2 v[142:143], v37, s[40:43], s58 offen offset:48
s_load_dwordx16 s[8:23], s[48:49], 0 glc
s_add_u32 s50, s61, 0
s_add_u32 s51, s61, 8192
s_add_u32 s52, s61, 16384
s_add_u32 s53, s61, 24576
s_add_u32 s54, s61, 32768
s_add_u32 s55, s61, 40960
s_add_u32 s56, s61, 49152
v_mov_b32 v35, 0x3f80
v_mov_b32 v15, 1.0
v_mov_b32 v32, 0
s_waitcnt vmcnt(40)
s_barrier
s_waitcnt vmcnt(32)
s_barrier
s_waitcnt vmcnt(24)
s_barrier
s_waitcnt vmcnt(16)
s_barrier
s_load_dwordx16 s[8:23], s[48:49], 0 glc
s_waitcnt vmcnt(6)
s_barrier
s_waitcnt vmcnt(6)
s_barrier
s_branch gather_E
.p2align 6
comp_E:
s_add_u32 s45, s45, 28
v_add_u32 v60, s45, v3
v_cmp_le_u32 vcc, s44, v60
v_subrev_u32 v61, 32, v60
s_nop 0
v_cndmask_b32 v60, v60, v61, vcc
v_lshrrev_b32 v1, 6, v60
v_lshl_add_u32 v32, v1, 12, v2
v_bfe_u32 v1, v60, 5, 1
v_lshl_add_u32 v32, v1, 9, v32
v_and_b32 v1, 31, v60
v_lshl_add_u32 v32, v1, 1, v32
v_add_u32 v33, 0x10000, v32
s_add_u32 s45, s45, 28
v_add_u32 v60, s45, v3
v_cmp_le_u32 vcc, s44, v60
v_subrev_u32 v61, 32, v60
s_nop 0
v_cndmask_b32 v60, v60, v61, vcc
v_lshrrev_b32 v1, 6, v60
v_lshl_add_u32 v34, v1, 12, v2
v_bfe_u32 v1, v60, 5, 1
v_lshl_add_u32 v34, v1, 9, v34
v_and_b32 v1, 31, v60
v_lshl_add_u32 v34, v1, 1, v34
v_add_u32 v35, 0x10000, v34
v_lshrrev_b32 v1, 5, v0
s_mul_i32 s60, s31, 7168
v_mul_u32_u24 v19, 24, v1
v_sub_u32 v19, v9, v19
v_add_u32 v19, s60, v19
v_mul_u32_u24 v18, 496, v1
s_waitcnt lgkmcnt(0)
s_barrier
ds_read_b128 v[64:67], v9 offset:0
ds_read_b64_tr_b16 v[36:37], v14 offset:0
ds_read_b64_tr_b16 v[38:39], v14 offset:256
ds_read_b128 v[68:71], v9 offset:1056
ds_read_b64_tr_b16 v[40:41], v14 offset:2048
ds_read_b64_tr_b16 v[42:43], v14 offset:2304
ds_read_b128 v[72:75], v9 offset:2112
ds_read_b64_tr_b16 v[44:45], v14 offset:4096
ds_read_b64_tr_b16 v[46:47], v14 offset:4352
ds_read_b128 v[76:79], v9 offset:3168
ds_read_b64_tr_b16 v[48:49], v14 offset:6144
ds_read_b64_tr_b16 v[50:51], v14 offset:6400
s_waitcnt lgkmcnt(9)
v_mfma_f32_32x32x16_bf16 v[208:223], v[36:39], v[64:67], 0
ds_read_b128 v[80:83], v9 offset:4224
ds_read_b64_tr_b16 v[52:53], v14 offset:8192
ds_read_b64_tr_b16 v[54:55], v14 offset:8448
s_waitcnt lgkmcnt(6)
v_mfma_f32_32x32x16_bf16 v[208:223], v[40:43], v[68:71], v[208:223]
ds_read_b128 v[84:87], v9 offset:5280
ds_read_b64_tr_b16 v[36:37], v14 offset:10240
ds_read_b64_tr_b16 v[38:39], v14 offset:10496
v_sub_u32 v18, v19, v18
s_mov_b32 s56, 0x3fb8aa3b
v_mfma_f32_32x32x16_bf16 v[208:223], v[44:47], v[72:75], v[208:223]
ds_read_b128 v[88:91], v9 offset:6336
ds_read_b64_tr_b16 v[40:41], v14 offset:12288
ds_read_b64_tr_b16 v[42:43], v14 offset:12544
s_waitcnt lgkmcnt(6)
s_mov_b32 s57, 0x358637bd
s_mov_b32 s36, s28
v_mfma_f32_32x32x16_bf16 v[208:223], v[48:51], v[76:79], v[208:223]
ds_read_b128 v[92:95], v9 offset:7392
ds_read_b64_tr_b16 v[44:45], v14 offset:14336
ds_read_b64_tr_b16 v[46:47], v14 offset:14592
s_and_b32 s37, s29, 0xffff
s_mov_b32 s38, 67108864
v_mfma_f32_32x32x16_bf16 v[208:223], v[52:55], v[80:83], v[208:223]
s_barrier
ds_read_b128 v[96:99], v9 offset:8448
ds_read_b64_tr_b16 v[48:49], v14 offset:16384
ds_read_b64_tr_b16 v[50:51], v14 offset:16640
s_waitcnt lgkmcnt(6)
s_mov_b32 s39, 0x20000
v_mfma_f32_32x32x16_bf16 v[208:223], v[36:39], v[84:87], v[208:223]
ds_read_b128 v[100:103], v9 offset:9504
ds_read_b64_tr_b16 v[52:53], v14 offset:18432
ds_read_b64_tr_b16 v[54:55], v14 offset:18688
v_mfma_f32_32x32x16_bf16 v[208:223], v[40:43], v[88:91], v[208:223]
ds_read_b128 v[104:107], v9 offset:10560
ds_read_b64_tr_b16 v[36:37], v14 offset:20480
ds_read_b64_tr_b16 v[38:39], v14 offset:20736
s_waitcnt lgkmcnt(6)
v_mfma_f32_32x32x16_bf16 v[208:223], v[44:47], v[92:95], v[208:223]
ds_read_b128 v[108:111], v9 offset:11616
ds_read_b64_tr_b16 v[40:41], v14 offset:22528
ds_read_b64_tr_b16 v[42:43], v14 offset:22784
v_mfma_f32_32x32x16_bf16 v[208:223], v[48:51], v[96:99], v[208:223]
ds_read_b128 v[112:115], v9 offset:12672
ds_read_b64_tr_b16 v[44:45], v14 offset:24576
ds_read_b64_tr_b16 v[46:47], v14 offset:24832
s_waitcnt lgkmcnt(6)
v_mfma_f32_32x32x16_bf16 v[208:223], v[52:55], v[100:103], v[208:223]
ds_read_b128 v[116:119], v9 offset:13728
ds_read_b64_tr_b16 v[48:49], v14 offset:26624
ds_read_b64_tr_b16 v[50:51], v14 offset:26880
v_mfma_f32_32x32x16_bf16 v[208:223], v[36:39], v[104:107], v[208:223]
ds_read_b128 v[120:123], v9 offset:14784
ds_read_b64_tr_b16 v[52:53], v14 offset:28672
ds_read_b64_tr_b16 v[54:55], v14 offset:28928
s_waitcnt lgkmcnt(6)
v_mfma_f32_32x32x16_bf16 v[208:223], v[40:43], v[108:111], v[208:223]
ds_read_b128 v[124:127], v9 offset:15840
ds_read_b64_tr_b16 v[36:37], v14 offset:30720
ds_read_b64_tr_b16 v[38:39], v14 offset:30976
v_mfma_f32_32x32x16_bf16 v[208:223], v[44:47], v[112:115], v[208:223]
s_barrier
ds_read_b128 v[128:131], v9 offset:16896
ds_read_b64_tr_b16 v[40:41], v14 offset:32768
ds_read_b64_tr_b16 v[42:43], v14 offset:33024
s_waitcnt lgkmcnt(6)
v_mfma_f32_32x32x16_bf16 v[208:223], v[48:51], v[116:119], v[208:223]
ds_read_b128 v[132:135], v9 offset:17952
ds_read_b64_tr_b16 v[44:45], v14 offset:34816
ds_read_b64_tr_b16 v[46:47], v14 offset:35072
v_mfma_f32_32x32x16_bf16 v[208:223], v[52:55], v[120:123], v[208:223]
ds_read_b128 v[136:139], v9 offset:19008
ds_read_b64_tr_b16 v[48:49], v14 offset:36864
ds_read_b64_tr_b16 v[50:51], v14 offset:37120
s_waitcnt lgkmcnt(6)
v_mfma_f32_32x32x16_bf16 v[208:223], v[36:39], v[124:127], v[208:223]
ds_read_b128 v[140:143], v9 offset:20064
ds_read_b64_tr_b16 v[52:53], v14 offset:38912
ds_read_b64_tr_b16 v[54:55], v14 offset:39168
s_waitcnt vmcnt(2)
v_lshl_or_b32 v4, v57, 16, v56
v_mov_b32 v5, 0
v_mfma_f32_32x32x16_bf16 v[208:223], v[40:43], v[128:131], v[208:223]
ds_read_b128 v[144:147], v9 offset:21120
ds_read_b64_tr_b16 v[36:37], v14 offset:40960
ds_read_b64_tr_b16 v[38:39], v14 offset:41216
s_waitcnt lgkmcnt(6)
v_mfma_f32_32x32x16_bf16 v[208:223], v[44:47], v[132:135], v[208:223]
ds_read_b128 v[148:151], v9 offset:22176
ds_read_b64_tr_b16 v[40:41], v14 offset:43008
ds_read_b64_tr_b16 v[42:43], v14 offset:43264
v_mov_b32 v6, 1.0
v_mov_b32 v7, 0
v_mfma_f32_32x32x16_bf16 v[208:223], v[48:51], v[136:139], v[208:223]
ds_read_b128 v[152:155], v9 offset:23232
ds_read_b64_tr_b16 v[44:45], v14 offset:45056
ds_read_b64_tr_b16 v[46:47], v14 offset:45312
s_waitcnt lgkmcnt(6)
v_mfma_f32_32x32x16_bf16 v[208:223], v[52:55], v[140:143], v[208:223]
ds_read_b128 v[156:159], v9 offset:24288
ds_read_b64_tr_b16 v[48:49], v14 offset:47104
ds_read_b64_tr_b16 v[50:51], v14 offset:47360
v_mfma_f32_32x32x8bf16_1k v[240:255], v[4:5], v[6:7], 0
v_mfma_f32_32x32x16_bf16 v[208:223], v[36:39], v[144:147], v[208:223]
s_barrier
ds_read_b128 v[160:163], v9 offset:25344
ds_read_b64_tr_b16 v[52:53], v14 offset:49152
ds_read_b64_tr_b16 v[54:55], v14 offset:49408
s_waitcnt lgkmcnt(6)
v_mfma_f32_32x32x16_bf16 v[208:223], v[40:43], v[148:151], v[208:223]
ds_read_b128 v[164:167], v9 offset:26400
ds_read_b64_tr_b16 v[36:37], v14 offset:51200
ds_read_b64_tr_b16 v[38:39], v14 offset:51456
v_mfma_f32_32x32x16_bf16 v[208:223], v[44:47], v[152:155], v[208:223]
ds_read_b128 v[168:171], v9 offset:27456
ds_read_b64_tr_b16 v[40:41], v14 offset:53248
ds_read_b64_tr_b16 v[42:43], v14 offset:53504
s_waitcnt lgkmcnt(6)
v_mfma_f32_32x32x16_bf16 v[208:223], v[48:51], v[156:159], v[208:223]
ds_read_b128 v[172:175], v9 offset:28512
ds_read_b64_tr_b16 v[44:45], v14 offset:55296
ds_read_b64_tr_b16 v[46:47], v14 offset:55552
v_mfma_f32_32x32x16_bf16 v[208:223], v[52:55], v[160:163], v[208:223]
ds_read_b64_tr_b16 v[48:49], v14 offset:57344
ds_read_b64_tr_b16 v[50:51], v14 offset:57600
s_waitcnt lgkmcnt(5)
v_mfma_f32_32x32x16_bf16 v[208:223], v[36:39], v[164:167], v[208:223]
ds_read_b64_tr_b16 v[52:53], v14 offset:59392
ds_read_b64_tr_b16 v[54:55], v14 offset:59648
v_mfma_f32_32x32x16_bf16 v[208:223], v[40:43], v[168:171], v[208:223]
ds_read_b64_tr_b16 v[36:37], v14 offset:61440
ds_read_b64_tr_b16 v[38:39], v14 offset:61696
s_waitcnt lgkmcnt(4)
v_mfma_f32_32x32x16_bf16 v[208:223], v[44:47], v[172:175], v[208:223]
ds_read_b64_tr_b16 v[40:41], v14 offset:63488
ds_read_b64_tr_b16 v[42:43], v14 offset:63744
v_mfma_f32_32x32x16_bf16 v[240:255], v[48:51], v[64:67], v[240:255]
s_barrier
ds_read_b64_tr_b16 v[44:45], v15 offset:0
ds_read_b64_tr_b16 v[46:47], v15 offset:256
s_waitcnt lgkmcnt(4)
v_mfma_f32_32x32x16_bf16 v[240:255], v[52:55], v[68:71], v[240:255]
ds_read_b64_tr_b16 v[48:49], v15 offset:2048
ds_read_b64_tr_b16 v[50:51], v15 offset:2304
v_mfma_f32_32x32x16_bf16 v[240:255], v[36:39], v[72:75], v[240:255]
ds_read_b64_tr_b16 v[52:53], v15 offset:4096
ds_read_b64_tr_b16 v[54:55], v15 offset:4352
s_waitcnt lgkmcnt(4)
v_mov_b32 v6, 0x3f80
v_mov_b32 v7, 0
v_mfma_f32_32x32x16_bf16 v[240:255], v[40:43], v[76:79], v[240:255]
ds_read_b64_tr_b16 v[36:37], v15 offset:6144
ds_read_b64_tr_b16 v[38:39], v15 offset:6400
v_mfma_f32_32x32x16_bf16 v[240:255], v[44:47], v[80:83], v[240:255]
ds_read_b64_tr_b16 v[40:41], v15 offset:8192
ds_read_b64_tr_b16 v[42:43], v15 offset:8448
s_waitcnt lgkmcnt(4)
v_mfma_f32_32x32x8bf16_1k v[208:223], v[4:5], v[6:7], v[208:223]
v_mfma_f32_32x32x16_bf16 v[240:255], v[48:51], v[84:87], v[240:255]
ds_read_b64_tr_b16 v[44:45], v15 offset:10240
ds_read_b64_tr_b16 v[46:47], v15 offset:10496
v_mfma_f32_32x32x16_bf16 v[240:255], v[52:55], v[88:91], v[240:255]
ds_read_b64_tr_b16 v[48:49], v15 offset:12288
ds_read_b64_tr_b16 v[50:51], v15 offset:12544
s_waitcnt lgkmcnt(4)
v_mfma_f32_32x32x16_bf16 v[240:255], v[36:39], v[92:95], v[240:255]
ds_read_b64_tr_b16 v[52:53], v15 offset:14336
ds_read_b64_tr_b16 v[54:55], v15 offset:14592
v_mfma_f32_32x32x16_bf16 v[240:255], v[40:43], v[96:99], v[240:255]
s_barrier
ds_read_b64_tr_b16 v[36:37], v15 offset:16384
ds_read_b64_tr_b16 v[38:39], v15 offset:16640
s_waitcnt lgkmcnt(4)
v_mfma_f32_32x32x16_bf16 v[240:255], v[44:47], v[100:103], v[240:255]
ds_read_b64_tr_b16 v[40:41], v15 offset:18432
ds_read_b64_tr_b16 v[42:43], v15 offset:18688
v_mfma_f32_32x32x16_bf16 v[240:255], v[48:51], v[104:107], v[240:255]
ds_read_b64_tr_b16 v[44:45], v15 offset:20480
ds_read_b64_tr_b16 v[46:47], v15 offset:20736
s_waitcnt lgkmcnt(4)
v_mul_f32 v208, v208, abs(v208)
v_mul_f32 v209, v209, abs(v209)
v_mfma_f32_32x32x16_bf16 v[240:255], v[52:55], v[108:111], v[240:255]
ds_read_b64_tr_b16 v[48:49], v15 offset:22528
ds_read_b64_tr_b16 v[50:51], v15 offset:22784
v_mul_f32 v210, v210, abs(v210)
v_mul_f32 v211, v211, abs(v211)
v_mfma_f32_32x32x16_bf16 v[240:255], v[36:39], v[112:115], v[240:255]
ds_read_b64_tr_b16 v[52:53], v15 offset:24576
ds_read_b64_tr_b16 v[54:55], v15 offset:24832
s_waitcnt lgkmcnt(4)
v_mul_f32 v212, v212, abs(v212)
v_mul_f32 v213, v213, abs(v213)
v_mfma_f32_32x32x16_bf16 v[240:255], v[40:43], v[116:119], v[240:255]
ds_read_b64_tr_b16 v[36:37], v15 offset:26624
ds_read_b64_tr_b16 v[38:39], v15 offset:26880
v_mul_f32 v214, v214, abs(v214)
v_mul_f32 v215, v215, abs(v215)
v_mfma_f32_32x32x16_bf16 v[240:255], v[44:47], v[120:123], v[240:255]
ds_read_b64_tr_b16 v[40:41], v15 offset:28672
ds_read_b64_tr_b16 v[42:43], v15 offset:28928
s_waitcnt lgkmcnt(4)
v_cvt_pk_bf16_f32 v56, v208, v209
v_cvt_pk_bf16_f32 v57, v210, v211
v_mfma_f32_32x32x16_bf16 v[240:255], v[48:51], v[124:127], v[240:255]
ds_read_b64_tr_b16 v[44:45], v15 offset:30720
ds_read_b64_tr_b16 v[46:47], v15 offset:30976
s_waitcnt vmcnt(1)
v_cvt_pk_bf16_f32 v58, v212, v213
s_waitcnt vmcnt(0)
v_cvt_pk_bf16_f32 v59, v214, v215
v_mfma_f32_32x32x16_bf16 v[240:255], v[52:55], v[128:131], v[240:255]
s_barrier
ds_read_b64_tr_b16 v[48:49], v14 offset:0
ds_read_b64_tr_b16 v[50:51], v14 offset:256
s_waitcnt lgkmcnt(4)
v_pk_max_i16 v56, v56, 0
v_pk_max_i16 v57, v57, 0
v_mfma_f32_32x32x16_bf16 v[240:255], v[36:39], v[132:135], v[240:255]
ds_read_b64_tr_b16 v[52:53], v14 offset:2048
ds_read_b64_tr_b16 v[54:55], v14 offset:2304
v_pk_max_i16 v58, v58, 0
v_pk_max_i16 v59, v59, 0
v_mfma_f32_32x32x16_bf16 v[240:255], v[40:43], v[136:139], v[240:255]
ds_read_b64_tr_b16 v[36:37], v14 offset:4096
ds_read_b64_tr_b16 v[38:39], v14 offset:4352
s_waitcnt lgkmcnt(4)
v_mul_f32 v216, v216, abs(v216)
v_mul_f32 v217, v217, abs(v217)
v_mfma_f32_32x32x16_bf16 v[240:255], v[44:47], v[140:143], v[240:255]
ds_read_b64_tr_b16 v[40:41], v14 offset:6144
ds_read_b64_tr_b16 v[42:43], v14 offset:6400
v_mul_f32 v218, v218, abs(v218)
v_mul_f32 v219, v219, abs(v219)
v_mfma_f32_32x32x16_bf16 v[240:255], v[48:51], v[144:147], v[240:255]
ds_read_b64_tr_b16 v[44:45], v14 offset:8192
ds_read_b64_tr_b16 v[46:47], v14 offset:8448
s_waitcnt lgkmcnt(4)
v_mul_f32 v220, v220, abs(v220)
v_mul_f32 v221, v221, abs(v221)
v_mfma_f32_32x32x16_bf16 v[240:255], v[52:55], v[148:151], v[240:255]
ds_read_b64_tr_b16 v[48:49], v14 offset:10240
ds_read_b64_tr_b16 v[50:51], v14 offset:10496
v_mul_f32 v222, v222, abs(v222)
v_mul_f32 v223, v223, abs(v223)
v_mfma_f32_32x32x16_bf16 v[240:255], v[36:39], v[152:155], v[240:255]
ds_read_b64_tr_b16 v[52:53], v14 offset:12288
ds_read_b64_tr_b16 v[54:55], v14 offset:12544
s_waitcnt lgkmcnt(4)
v_cvt_pk_bf16_f32 v60, v216, v217
v_cvt_pk_bf16_f32 v61, v218, v219
v_mfma_f32_32x32x16_bf16 v[240:255], v[40:43], v[156:159], v[240:255]
ds_read_b64_tr_b16 v[36:37], v14 offset:14336
ds_read_b64_tr_b16 v[38:39], v14 offset:14592
v_cvt_pk_bf16_f32 v62, v220, v221
v_cvt_pk_bf16_f32 v63, v222, v223
v_mfma_f32_32x32x16_bf16 v[240:255], v[44:47], v[160:163], v[240:255]
s_barrier
ds_read_b64_tr_b16 v[40:41], v28 offset:16384
ds_read_b64_tr_b16 v[42:43], v28 offset:16640
s_waitcnt lgkmcnt(4)
v_pk_max_i16 v60, v60, 0
v_pk_max_i16 v61, v61, 0
v_mfma_f32_32x32x16_bf16 v[240:255], v[48:51], v[164:167], v[240:255]
ds_read_b64_tr_b16 v[44:45], v30 offset:16384
ds_read_b64_tr_b16 v[46:47], v30 offset:16640
v_pk_max_i16 v62, v62, 0
v_pk_max_i16 v63, v63, 0
v_mfma_f32_32x32x16_bf16 v[240:255], v[52:55], v[168:171], v[240:255]
ds_read_b64_tr_b16 v[48:49], v32 offset:16384
ds_read_b64_tr_b16 v[50:51], v32 offset:16640
s_waitcnt lgkmcnt(4)
v_mfma_f32_32x32x16_bf16 v[240:255], v[36:39], v[172:175], v[240:255]
ds_read_b64_tr_b16 v[52:53], v34 offset:16384
ds_read_b64_tr_b16 v[54:55], v34 offset:16640
v_mfma_f32_32x32x16_bf16 v[176:191], v[40:43], v[64:67], 0
ds_read_b64_tr_b16 v[36:37], v28 offset:18432
ds_read_b64_tr_b16 v[38:39], v28 offset:18688
s_waitcnt lgkmcnt(4)
v_mfma_f32_32x32x16_bf16 v[192:207], v[44:47], v[64:67], 0
ds_read_b64_tr_b16 v[40:41], v30 offset:18432
ds_read_b64_tr_b16 v[42:43], v30 offset:18688
s_nop 2
v_mul_f32 v240, v240, abs(v240)
v_mfma_f32_32x32x16_bf16 v[208:223], v[48:51], v[64:67], 0
ds_read_b64_tr_b16 v[44:45], v32 offset:18432
ds_read_b64_tr_b16 v[46:47], v32 offset:18688
s_waitcnt lgkmcnt(4)
v_mul_f32 v241, v241, abs(v241)
v_mfma_f32_32x32x16_bf16 v[224:239], v[52:55], v[64:67], 0
ds_read_b64_tr_b16 v[48:49], v34 offset:18432
ds_read_b64_tr_b16 v[50:51], v34 offset:18688
v_mul_f32 v242, v242, abs(v242)
v_mfma_f32_32x32x16_bf16 v[176:191], v[36:39], v[68:71], v[176:191]
s_barrier
ds_read_b64_tr_b16 v[52:53], v28 offset:32768
ds_read_b64_tr_b16 v[54:55], v28 offset:33024
s_waitcnt lgkmcnt(4)
v_mul_f32 v243, v243, abs(v243)
v_mfma_f32_32x32x16_bf16 v[192:207], v[40:43], v[68:71], v[192:207]
ds_read_b64_tr_b16 v[36:37], v30 offset:32768
ds_read_b64_tr_b16 v[38:39], v30 offset:33024
v_mul_f32 v244, v244, abs(v244)
v_mfma_f32_32x32x16_bf16 v[208:223], v[44:47], v[68:71], v[208:223]
ds_read_b64_tr_b16 v[40:41], v32 offset:32768
ds_read_b64_tr_b16 v[42:43], v32 offset:33024
s_waitcnt lgkmcnt(4)
v_mul_f32 v245, v245, abs(v245)
v_mfma_f32_32x32x16_bf16 v[224:239], v[48:51], v[68:71], v[224:239]
ds_read_b64_tr_b16 v[44:45], v34 offset:32768
ds_read_b64_tr_b16 v[46:47], v34 offset:33024
v_mul_f32 v246, v246, abs(v246)
v_mfma_f32_32x32x16_bf16 v[176:191], v[52:55], v[72:75], v[176:191]
ds_read_b64_tr_b16 v[48:49], v28 offset:34816
ds_read_b64_tr_b16 v[50:51], v28 offset:35072
s_waitcnt lgkmcnt(4)
v_mul_f32 v247, v247, abs(v247)
v_mfma_f32_32x32x16_bf16 v[192:207], v[36:39], v[72:75], v[192:207]
ds_read_b64_tr_b16 v[52:53], v30 offset:34816
ds_read_b64_tr_b16 v[54:55], v30 offset:35072
v_cvt_pk_bf16_f32 v240, v240, v241
v_mfma_f32_32x32x16_bf16 v[208:223], v[40:43], v[72:75], v[208:223]
ds_read_b64_tr_b16 v[36:37], v32 offset:34816
ds_read_b64_tr_b16 v[38:39], v32 offset:35072
s_waitcnt lgkmcnt(4)
v_cvt_pk_bf16_f32 v241, v242, v243
v_mfma_f32_32x32x16_bf16 v[224:239], v[44:47], v[72:75], v[224:239]
ds_read_b64_tr_b16 v[40:41], v34 offset:34816
ds_read_b64_tr_b16 v[42:43], v34 offset:35072
v_cvt_pk_bf16_f32 v242, v244, v245
v_mfma_f32_32x32x16_bf16 v[176:191], v[48:51], v[76:79], v[176:191]
s_barrier
ds_read_b64_tr_b16 v[44:45], v28 offset:49152
ds_read_b64_tr_b16 v[46:47], v28 offset:49408
s_waitcnt lgkmcnt(4)
v_cvt_pk_bf16_f32 v243, v246, v247
v_mfma_f32_32x32x16_bf16 v[192:207], v[52:55], v[76:79], v[192:207]
ds_read_b64_tr_b16 v[48:49], v30 offset:49152
ds_read_b64_tr_b16 v[50:51], v30 offset:49408
v_pk_max_i16 v240, v240, 0
v_mfma_f32_32x32x16_bf16 v[208:223], v[36:39], v[76:79], v[208:223]
ds_read_b64_tr_b16 v[52:53], v32 offset:49152
ds_read_b64_tr_b16 v[54:55], v32 offset:49408
s_waitcnt lgkmcnt(4)
v_pk_max_i16 v241, v241, 0
v_mfma_f32_32x32x16_bf16 v[224:239], v[40:43], v[76:79], v[224:239]
ds_read_b64_tr_b16 v[36:37], v34 offset:49152
ds_read_b64_tr_b16 v[38:39], v34 offset:49408
v_pk_max_i16 v242, v242, 0
v_mfma_f32_32x32x16_bf16 v[176:191], v[44:47], v[80:83], v[176:191]
ds_read_b64_tr_b16 v[40:41], v28 offset:51200
ds_read_b64_tr_b16 v[42:43], v28 offset:51456
s_waitcnt lgkmcnt(4)
v_pk_max_i16 v243, v243, 0
v_mfma_f32_32x32x16_bf16 v[192:207], v[48:51], v[80:83], v[192:207]
ds_read_b64_tr_b16 v[44:45], v30 offset:51200
ds_read_b64_tr_b16 v[46:47], v30 offset:51456
v_mul_f32 v248, v248, abs(v248)
v_mfma_f32_32x32x16_bf16 v[208:223], v[52:55], v[80:83], v[208:223]
ds_read_b64_tr_b16 v[48:49], v32 offset:51200
ds_read_b64_tr_b16 v[50:51], v32 offset:51456
s_waitcnt lgkmcnt(4)
v_mul_f32 v249, v249, abs(v249)
v_mfma_f32_32x32x16_bf16 v[224:239], v[36:39], v[80:83], v[224:239]
ds_read_b64_tr_b16 v[52:53], v34 offset:51200
ds_read_b64_tr_b16 v[54:55], v34 offset:51456
v_mul_f32 v250, v250, abs(v250)
v_mfma_f32_32x32x16_bf16 v[176:191], v[40:43], v[84:87], v[176:191]
s_barrier
ds_read_b64_tr_b16 v[36:37], v29 offset:0
ds_read_b64_tr_b16 v[38:39], v29 offset:256
s_waitcnt lgkmcnt(4)
v_mul_f32 v251, v251, abs(v251)
v_mfma_f32_32x32x16_bf16 v[192:207], v[44:47], v[84:87], v[192:207]
ds_read_b64_tr_b16 v[40:41], v31 offset:0
ds_read_b64_tr_b16 v[42:43], v31 offset:256
v_mul_f32 v252, v252, abs(v252)
v_mfma_f32_32x32x16_bf16 v[208:223], v[48:51], v[84:87], v[208:223]
ds_read_b64_tr_b16 v[44:45], v33 offset:0
ds_read_b64_tr_b16 v[46:47], v33 offset:256
s_waitcnt lgkmcnt(4)
v_mul_f32 v253, v253, abs(v253)
v_mfma_f32_32x32x16_bf16 v[224:239], v[52:55], v[84:87], v[224:239]
ds_read_b64_tr_b16 v[48:49], v35 offset:0
ds_read_b64_tr_b16 v[50:51], v35 offset:256
v_mul_f32 v254, v254, abs(v254)
v_mfma_f32_32x32x16_bf16 v[176:191], v[36:39], v[88:91], v[176:191]
ds_read_b64_tr_b16 v[52:53], v29 offset:2048
ds_read_b64_tr_b16 v[54:55], v29 offset:2304
s_waitcnt lgkmcnt(4)
v_mul_f32 v255, v255, abs(v255)
v_mfma_f32_32x32x16_bf16 v[192:207], v[40:43], v[88:91], v[192:207]
ds_read_b64_tr_b16 v[36:37], v31 offset:2048
ds_read_b64_tr_b16 v[38:39], v31 offset:2304
v_cvt_pk_bf16_f32 v244, v248, v249
v_mfma_f32_32x32x16_bf16 v[208:223], v[44:47], v[88:91], v[208:223]
ds_read_b64_tr_b16 v[40:41], v33 offset:2048
ds_read_b64_tr_b16 v[42:43], v33 offset:2304
s_waitcnt lgkmcnt(4)
v_cvt_pk_bf16_f32 v245, v250, v251
v_mfma_f32_32x32x16_bf16 v[224:239], v[48:51], v[88:91], v[224:239]
ds_read_b64_tr_b16 v[44:45], v35 offset:2048
ds_read_b64_tr_b16 v[46:47], v35 offset:2304
v_cvt_pk_bf16_f32 v246, v252, v253
v_mfma_f32_32x32x16_bf16 v[176:191], v[52:55], v[92:95], v[176:191]
s_barrier
ds_read_b64_tr_b16 v[48:49], v29 offset:16384
ds_read_b64_tr_b16 v[50:51], v29 offset:16640
s_waitcnt lgkmcnt(4)
v_cvt_pk_bf16_f32 v247, v254, v255
v_mfma_f32_32x32x16_bf16 v[192:207], v[36:39], v[92:95], v[192:207]
ds_read_b64_tr_b16 v[52:53], v31 offset:16384
ds_read_b64_tr_b16 v[54:55], v31 offset:16640
v_pk_max_i16 v244, v244, 0
v_mfma_f32_32x32x16_bf16 v[208:223], v[40:43], v[92:95], v[208:223]
ds_read_b64_tr_b16 v[36:37], v33 offset:16384
ds_read_b64_tr_b16 v[38:39], v33 offset:16640
s_waitcnt lgkmcnt(4)
v_pk_max_i16 v245, v245, 0
v_mfma_f32_32x32x16_bf16 v[224:239], v[44:47], v[92:95], v[224:239]
ds_read_b64_tr_b16 v[40:41], v35 offset:16384
ds_read_b64_tr_b16 v[42:43], v35 offset:16640
v_pk_max_i16 v246, v246, 0
v_mfma_f32_32x32x16_bf16 v[176:191], v[48:51], v[96:99], v[176:191]
ds_read_b64_tr_b16 v[44:45], v29 offset:18432
ds_read_b64_tr_b16 v[46:47], v29 offset:18688
s_waitcnt lgkmcnt(4)
v_pk_max_i16 v247, v247, 0
v_mfma_f32_32x32x16_bf16 v[192:207], v[52:55], v[96:99], v[192:207]
ds_read_b64_tr_b16 v[48:49], v31 offset:18432
ds_read_b64_tr_b16 v[50:51], v31 offset:18688
v_mfma_f32_32x32x16_bf16 v[208:223], v[36:39], v[96:99], v[208:223]
ds_read_b64_tr_b16 v[52:53], v33 offset:18432
ds_read_b64_tr_b16 v[54:55], v33 offset:18688
s_waitcnt lgkmcnt(4)
v_mfma_f32_32x32x16_bf16 v[224:239], v[40:43], v[96:99], v[224:239]
ds_read_b64_tr_b16 v[36:37], v35 offset:18432
ds_read_b64_tr_b16 v[38:39], v35 offset:18688
v_mfma_f32_32x32x16_bf16 v[176:191], v[44:47], v[100:103], v[176:191]
s_barrier
ds_read_b64_tr_b16 v[40:41], v28 offset:0
ds_read_b64_tr_b16 v[42:43], v28 offset:256
s_waitcnt lgkmcnt(4)
v_mfma_f32_32x32x16_bf16 v[192:207], v[48:51], v[100:103], v[192:207]
ds_read_b64_tr_b16 v[44:45], v30 offset:0
ds_read_b64_tr_b16 v[46:47], v30 offset:256
v_mfma_f32_32x32x16_bf16 v[208:223], v[52:55], v[100:103], v[208:223]
ds_read_b64_tr_b16 v[48:49], v32 offset:0
ds_read_b64_tr_b16 v[50:51], v32 offset:256
s_waitcnt lgkmcnt(4)
v_mfma_f32_32x32x16_bf16 v[224:239], v[36:39], v[100:103], v[224:239]
ds_read_b64_tr_b16 v[52:53], v34 offset:0
ds_read_b64_tr_b16 v[54:55], v34 offset:256
v_mfma_f32_32x32x16_bf16 v[176:191], v[40:43], v[104:107], v[176:191]
ds_read_b64_tr_b16 v[36:37], v28 offset:2048
ds_read_b64_tr_b16 v[38:39], v28 offset:2304
s_waitcnt lgkmcnt(4)
v_mfma_f32_32x32x16_bf16 v[192:207], v[44:47], v[104:107], v[192:207]
ds_read_b64_tr_b16 v[40:41], v30 offset:2048
ds_read_b64_tr_b16 v[42:43], v30 offset:2304
v_mfma_f32_32x32x16_bf16 v[208:223], v[48:51], v[104:107], v[208:223]
ds_read_b64_tr_b16 v[44:45], v32 offset:2048
ds_read_b64_tr_b16 v[46:47], v32 offset:2304
s_waitcnt lgkmcnt(4)
v_mfma_f32_32x32x16_bf16 v[224:239], v[52:55], v[104:107], v[224:239]
ds_read_b64_tr_b16 v[48:49], v34 offset:2048
ds_read_b64_tr_b16 v[50:51], v34 offset:2304
v_mfma_f32_32x32x16_bf16 v[176:191], v[36:39], v[108:111], v[176:191]
s_barrier
ds_read_b64_tr_b16 v[52:53], v28 offset:16384
ds_read_b64_tr_b16 v[54:55], v28 offset:16640
s_waitcnt lgkmcnt(4)
v_mfma_f32_32x32x16_bf16 v[192:207], v[40:43], v[108:111], v[192:207]
ds_read_b64_tr_b16 v[36:37], v30 offset:16384
ds_read_b64_tr_b16 v[38:39], v30 offset:16640
v_mfma_f32_32x32x16_bf16 v[208:223], v[44:47], v[108:111], v[208:223]
ds_read_b64_tr_b16 v[40:41], v32 offset:16384
ds_read_b64_tr_b16 v[42:43], v32 offset:16640
s_waitcnt lgkmcnt(4)
v_mfma_f32_32x32x16_bf16 v[224:239], v[48:51], v[108:111], v[224:239]
ds_read_b64_tr_b16 v[44:45], v34 offset:16384
ds_read_b64_tr_b16 v[46:47], v34 offset:16640
ds_write_b128 v11, v[56:59] offset:0
ds_write_b128 v11, v[60:63] offset:1024
ds_write_b128 v11, v[240:243] offset:4096
ds_write_b128 v11, v[244:247] offset:5120
v_mfma_f32_32x32x16_bf16 v[176:191], v[52:55], v[112:115], v[176:191]
ds_read_b64_tr_b16 v[48:49], v28 offset:18432
ds_read_b64_tr_b16 v[50:51], v28 offset:18688
s_waitcnt lgkmcnt(8)
v_mfma_f32_32x32x16_bf16 v[192:207], v[36:39], v[112:115], v[192:207]
ds_read_b64_tr_b16 v[52:53], v30 offset:18432
ds_read_b64_tr_b16 v[54:55], v30 offset:18688
v_mfma_f32_32x32x16_bf16 v[208:223], v[40:43], v[112:115], v[208:223]
ds_read_b64_tr_b16 v[36:37], v32 offset:18432
ds_read_b64_tr_b16 v[38:39], v32 offset:18688
s_waitcnt lgkmcnt(4)
v_mfma_f32_32x32x16_bf16 v[224:239], v[44:47], v[112:115], v[224:239]
ds_read_b64_tr_b16 v[40:41], v34 offset:18432
ds_read_b64_tr_b16 v[42:43], v34 offset:18688
v_mfma_f32_32x32x16_bf16 v[176:191], v[48:51], v[116:119], v[176:191]
s_barrier
ds_read_b64_tr_b16 v[44:45], v28 offset:32768
ds_read_b64_tr_b16 v[46:47], v28 offset:33024
s_waitcnt lgkmcnt(4)
s_mov_b32 s40, 455355442
v_mfma_f32_32x32x16_bf16 v[192:207], v[52:55], v[116:119], v[192:207]
ds_read_b64_tr_b16 v[48:49], v30 offset:32768
ds_read_b64_tr_b16 v[50:51], v30 offset:33024
s_mov_b32 s41, 462356
v_mfma_f32_32x32x16_bf16 v[208:223], v[36:39], v[116:119], v[208:223]
ds_read_b64_tr_b16 v[52:53], v32 offset:32768
ds_read_b64_tr_b16 v[54:55], v32 offset:33024
s_waitcnt lgkmcnt(4)
s_mov_b32 s42, 860116066
v_mfma_f32_32x32x16_bf16 v[224:239], v[40:43], v[116:119], v[224:239]
ds_read_b64_tr_b16 v[36:37], v34 offset:32768
ds_read_b64_tr_b16 v[38:39], v34 offset:33024
s_mov_b32 s43, 464420
v_mfma_f32_32x32x16_bf16 v[176:191], v[44:47], v[120:123], v[176:191]
ds_read_b64_tr_b16 v[40:41], v28 offset:34816
ds_read_b64_tr_b16 v[42:43], v28 offset:35072
s_waitcnt lgkmcnt(4)
s_cmp_eq_u32 s4, 7
v_mfma_f32_32x32x16_bf16 v[192:207], v[48:51], v[120:123], v[192:207]
ds_read_b64_tr_b16 v[44:45], v30 offset:34816
ds_read_b64_tr_b16 v[46:47], v30 offset:35072
s_cselect_b32 s40, 470944001, s40
v_mfma_f32_32x32x16_bf16 v[208:223], v[52:55], v[120:123], v[208:223]
ds_read_b64_tr_b16 v[48:49], v32 offset:34816
ds_read_b64_tr_b16 v[50:51], v32 offset:35072
s_waitcnt lgkmcnt(4)
s_cselect_b32 s41, 3616293, s41
v_mfma_f32_32x32x16_bf16 v[224:239], v[36:39], v[120:123], v[224:239]
ds_read_b64_tr_b16 v[52:53], v34 offset:34816
ds_read_b64_tr_b16 v[54:55], v34 offset:35072
s_cselect_b32 s42, 874647809, s42
v_mfma_f32_32x32x16_bf16 v[176:191], v[40:43], v[124:127], v[176:191]
s_barrier
ds_read_b64_tr_b16 v[36:37], v28 offset:49152
ds_read_b64_tr_b16 v[38:39], v28 offset:49408
s_waitcnt lgkmcnt(4)
s_cselect_b32 s43, 6772293, s43
v_mfma_f32_32x32x16_bf16 v[192:207], v[44:47], v[124:127], v[192:207]
ds_read_b64_tr_b16 v[40:41], v30 offset:49152
ds_read_b64_tr_b16 v[42:43], v30 offset:49408
s_bfe_u32 s48, s40, 0x80000
v_mfma_f32_32x32x16_bf16 v[208:223], v[48:51], v[124:127], v[208:223]
ds_read_b64_tr_b16 v[44:45], v32 offset:49152
ds_read_b64_tr_b16 v[46:47], v32 offset:49408
s_waitcnt lgkmcnt(4)
s_lshl_b32 s48, s48, 13
v_mfma_f32_32x32x16_bf16 v[224:239], v[52:55], v[124:127], v[224:239]
ds_read_b64_tr_b16 v[48:49], v34 offset:49152
ds_read_b64_tr_b16 v[50:51], v34 offset:49408
s_bfe_u32 s8, s42, 0x80000
v_mfma_f32_32x32x16_bf16 v[176:191], v[36:39], v[128:131], v[176:191]
ds_read_b64_tr_b16 v[52:53], v28 offset:51200
ds_read_b64_tr_b16 v[54:55], v28 offset:51456
s_waitcnt lgkmcnt(4)
s_lshl_b32 s8, s8, 3
v_mfma_f32_32x32x16_bf16 v[192:207], v[40:43], v[128:131], v[192:207]
ds_read_b64_tr_b16 v[36:37], v30 offset:51200
ds_read_b64_tr_b16 v[38:39], v30 offset:51456
s_bfe_u32 s49, s40, 0x80008
v_mfma_f32_32x32x16_bf16 v[208:223], v[44:47], v[128:131], v[208:223]
ds_read_b64_tr_b16 v[40:41], v32 offset:51200
ds_read_b64_tr_b16 v[42:43], v32 offset:51456
s_waitcnt lgkmcnt(4)
s_lshl_b32 s49, s49, 13
v_mfma_f32_32x32x16_bf16 v[224:239], v[48:51], v[128:131], v[224:239]
ds_read_b64_tr_b16 v[44:45], v34 offset:51200
ds_read_b64_tr_b16 v[46:47], v34 offset:51456
s_bfe_u32 s9, s42, 0x80008
v_mfma_f32_32x32x16_bf16 v[176:191], v[52:55], v[132:135], v[176:191]
s_barrier
ds_read_b64_tr_b16 v[48:49], v29 offset:0
ds_read_b64_tr_b16 v[50:51], v29 offset:256
s_waitcnt lgkmcnt(4)
s_lshl_b32 s9, s9, 3
v_mfma_f32_32x32x16_bf16 v[192:207], v[36:39], v[132:135], v[192:207]
ds_read_b64_tr_b16 v[52:53], v31 offset:0
ds_read_b64_tr_b16 v[54:55], v31 offset:256
s_bfe_u32 s50, s40, 0x80010
v_mfma_f32_32x32x16_bf16 v[208:223], v[40:43], v[132:135], v[208:223]
ds_read_b64_tr_b16 v[36:37], v33 offset:0
ds_read_b64_tr_b16 v[38:39], v33 offset:256
s_waitcnt lgkmcnt(4)
s_lshl_b32 s50, s50, 13
v_mfma_f32_32x32x16_bf16 v[224:239], v[44:47], v[132:135], v[224:239]
ds_read_b64_tr_b16 v[40:41], v35 offset:0
ds_read_b64_tr_b16 v[42:43], v35 offset:256
s_bfe_u32 s10, s42, 0x80010
v_mfma_f32_32x32x16_bf16 v[176:191], v[48:51], v[136:139], v[176:191]
ds_read_b64_tr_b16 v[44:45], v29 offset:2048
ds_read_b64_tr_b16 v[46:47], v29 offset:2304
s_waitcnt lgkmcnt(4)
s_lshl_b32 s10, s10, 3
v_mfma_f32_32x32x16_bf16 v[192:207], v[52:55], v[136:139], v[192:207]
ds_read_b64_tr_b16 v[48:49], v31 offset:2048
ds_read_b64_tr_b16 v[50:51], v31 offset:2304
s_bfe_u32 s51, s40, 0x80018
v_mfma_f32_32x32x16_bf16 v[208:223], v[36:39], v[136:139], v[208:223]
ds_read_b64_tr_b16 v[52:53], v33 offset:2048
ds_read_b64_tr_b16 v[54:55], v33 offset:2304
s_waitcnt lgkmcnt(4)
s_lshl_b32 s51, s51, 13
v_mfma_f32_32x32x16_bf16 v[224:239], v[40:43], v[136:139], v[224:239]
ds_read_b64_tr_b16 v[36:37], v35 offset:2048
ds_read_b64_tr_b16 v[38:39], v35 offset:2304
s_bfe_u32 s11, s42, 0x80018
v_mfma_f32_32x32x16_bf16 v[176:191], v[44:47], v[140:143], v[176:191]
s_barrier
ds_read_b64_tr_b16 v[40:41], v29 offset:16384
ds_read_b64_tr_b16 v[42:43], v29 offset:16640
s_waitcnt lgkmcnt(4)
s_lshl_b32 s11, s11, 3
v_mfma_f32_32x32x16_bf16 v[192:207], v[48:51], v[140:143], v[192:207]
ds_read_b64_tr_b16 v[44:45], v31 offset:16384
ds_read_b64_tr_b16 v[46:47], v31 offset:16640
s_bfe_u32 s52, s41, 0x80000
v_mfma_f32_32x32x16_bf16 v[208:223], v[52:55], v[140:143], v[208:223]
ds_read_b64_tr_b16 v[48:49], v33 offset:16384
ds_read_b64_tr_b16 v[50:51], v33 offset:16640
s_waitcnt lgkmcnt(4)
s_lshl_b32 s52, s52, 13
v_mfma_f32_32x32x16_bf16 v[224:239], v[36:39], v[140:143], v[224:239]
ds_read_b64_tr_b16 v[52:53], v35 offset:16384
ds_read_b64_tr_b16 v[54:55], v35 offset:16640
s_bfe_u32 s12, s43, 0x80000
v_mfma_f32_32x32x16_bf16 v[176:191], v[40:43], v[144:147], v[176:191]
ds_read_b64_tr_b16 v[36:37], v29 offset:18432
ds_read_b64_tr_b16 v[38:39], v29 offset:18688
s_waitcnt lgkmcnt(4)
s_lshl_b32 s12, s12, 3
v_mfma_f32_32x32x16_bf16 v[192:207], v[44:47], v[144:147], v[192:207]
ds_read_b64_tr_b16 v[40:41], v31 offset:18432
ds_read_b64_tr_b16 v[42:43], v31 offset:18688
s_bfe_u32 s53, s41, 0x80008
v_mfma_f32_32x32x16_bf16 v[208:223], v[48:51], v[144:147], v[208:223]
ds_read_b64_tr_b16 v[44:45], v33 offset:18432
ds_read_b64_tr_b16 v[46:47], v33 offset:18688
s_waitcnt lgkmcnt(4)
s_lshl_b32 s53, s53, 13
v_mfma_f32_32x32x16_bf16 v[224:239], v[52:55], v[144:147], v[224:239]
ds_read_b64_tr_b16 v[48:49], v35 offset:18432
ds_read_b64_tr_b16 v[50:51], v35 offset:18688
s_bfe_u32 s13, s43, 0x80008
v_mfma_f32_32x32x16_bf16 v[176:191], v[36:39], v[148:151], v[176:191]
s_barrier
ds_read_b64_tr_b16 v[52:53], v28 offset:0
ds_read_b64_tr_b16 v[54:55], v28 offset:256
s_waitcnt lgkmcnt(4)
s_lshl_b32 s13, s13, 3
v_mfma_f32_32x32x16_bf16 v[192:207], v[40:43], v[148:151], v[192:207]
ds_read_b64_tr_b16 v[36:37], v30 offset:0
ds_read_b64_tr_b16 v[38:39], v30 offset:256
s_bfe_u32 s54, s41, 0x80010
v_mfma_f32_32x32x16_bf16 v[208:223], v[44:47], v[148:151], v[208:223]
ds_read_b64_tr_b16 v[40:41], v32 offset:0
ds_read_b64_tr_b16 v[42:43], v32 offset:256
s_waitcnt lgkmcnt(4)
s_lshl_b32 s54, s54, 13
v_mfma_f32_32x32x16_bf16 v[224:239], v[48:51], v[148:151], v[224:239]
ds_read_b64_tr_b16 v[44:45], v34 offset:0
ds_read_b64_tr_b16 v[46:47], v34 offset:256
s_bfe_u32 s14, s43, 0x80010
v_mfma_f32_32x32x16_bf16 v[176:191], v[52:55], v[152:155], v[176:191]
ds_read_b64_tr_b16 v[48:49], v28 offset:2048
ds_read_b64_tr_b16 v[50:51], v28 offset:2304
s_waitcnt lgkmcnt(4)
s_lshl_b32 s14, s14, 3
v_mfma_f32_32x32x16_bf16 v[192:207], v[36:39], v[152:155], v[192:207]
ds_read_b64_tr_b16 v[52:53], v30 offset:2048
ds_read_b64_tr_b16 v[54:55], v30 offset:2304
s_mul_i32 s59, s5, 458752
v_mfma_f32_32x32x16_bf16 v[208:223], v[40:43], v[152:155], v[208:223]
ds_read_b64_tr_b16 v[36:37], v32 offset:2048
ds_read_b64_tr_b16 v[38:39], v32 offset:2304
s_waitcnt lgkmcnt(4)
s_lshl_b32 s60, s3, 11
v_mfma_f32_32x32x16_bf16 v[224:239], v[44:47], v[152:155], v[224:239]
ds_read_b64_tr_b16 v[40:41], v34 offset:2048
ds_read_b64_tr_b16 v[42:43], v34 offset:2304
s_add_u32 s59, s59, s60
v_mfma_f32_32x32x16_bf16 v[176:191], v[48:51], v[156:159], v[176:191]
s_barrier
ds_read_b64_tr_b16 v[44:45], v28 offset:16384
ds_read_b64_tr_b16 v[46:47], v28 offset:16640
s_waitcnt lgkmcnt(4)
s_add_u32 s59, s59, 6291456
v_mfma_f32_32x32x16_bf16 v[192:207], v[52:55], v[156:159], v[192:207]
ds_read_b64_tr_b16 v[48:49], v30 offset:16384
ds_read_b64_tr_b16 v[50:51], v30 offset:16640
v_add_u32 v24, s59, v20
v_mfma_f32_32x32x16_bf16 v[208:223], v[36:39], v[156:159], v[208:223]
ds_read_b64_tr_b16 v[52:53], v32 offset:16384
ds_read_b64_tr_b16 v[54:55], v32 offset:16640
s_waitcnt lgkmcnt(4)
v_bfe_u32 v1, v0, 5, 1
v_mfma_f32_32x32x16_bf16 v[224:239], v[40:43], v[156:159], v[224:239]
ds_read_b64_tr_b16 v[36:37], v34 offset:16384
ds_read_b64_tr_b16 v[38:39], v34 offset:16640
v_and_b32 v13, 15, v0
v_mfma_f32_32x32x16_bf16 v[176:191], v[44:47], v[160:163], v[176:191]
ds_read_b64_tr_b16 v[40:41], v28 offset:18432
ds_read_b64_tr_b16 v[42:43], v28 offset:18688
s_waitcnt lgkmcnt(4)
v_lshl_add_u32 v13, v1, 4, v13
v_mfma_f32_32x32x16_bf16 v[192:207], v[48:51], v[160:163], v[192:207]
ds_read_b64_tr_b16 v[44:45], v30 offset:18432
ds_read_b64_tr_b16 v[46:47], v30 offset:18688
v_mul_u32_u24 v13, 0x9e3a, v13
v_mfma_f32_32x32x16_bf16 v[208:223], v[52:55], v[160:163], v[208:223]
ds_read_b64_tr_b16 v[48:49], v32 offset:18432
ds_read_b64_tr_b16 v[50:51], v32 offset:18688
s_waitcnt lgkmcnt(4)
v_or_b32 v13, 1, v13
v_mfma_f32_32x32x16_bf16 v[224:239], v[36:39], v[160:163], v[224:239]
ds_read_b64_tr_b16 v[52:53], v34 offset:18432
ds_read_b64_tr_b16 v[54:55], v34 offset:18688
s_mul_i32 s59, s5, 896
v_mfma_f32_32x32x16_bf16 v[176:191], v[40:43], v[164:167], v[176:191]
s_barrier
ds_read_b64_tr_b16 v[36:37], v28 offset:32768
ds_read_b64_tr_b16 v[38:39], v28 offset:33024
s_waitcnt lgkmcnt(4)
s_lshl_b32 s60, s3, 15
v_mfma_f32_32x32x16_bf16 v[192:207], v[44:47], v[164:167], v[192:207]
ds_read_b64_tr_b16 v[40:41], v30 offset:32768
ds_read_b64_tr_b16 v[42:43], v30 offset:33024
s_add_u32 s59, s59, s60
v_mfma_f32_32x32x16_bf16 v[208:223], v[48:51], v[164:167], v[208:223]
ds_read_b64_tr_b16 v[44:45], v32 offset:32768
ds_read_b64_tr_b16 v[46:47], v32 offset:33024
s_waitcnt lgkmcnt(4)
s_add_u32 s59, s59, 23068672
v_mfma_f32_32x32x16_bf16 v[224:239], v[52:55], v[164:167], v[224:239]
ds_read_b64_tr_b16 v[48:49], v34 offset:32768
ds_read_b64_tr_b16 v[50:51], v34 offset:33024
v_subrev_u32 v21, 63, v0
v_mfma_f32_32x32x16_bf16 v[176:191], v[36:39], v[168:171], v[176:191]
ds_read_b64_tr_b16 v[52:53], v28 offset:34816
ds_read_b64_tr_b16 v[54:55], v28 offset:35072
s_waitcnt lgkmcnt(4)
v_and_b32 v21, 2147483648, v21
v_mfma_f32_32x32x16_bf16 v[192:207], v[40:43], v[168:171], v[192:207]
ds_read_b64_tr_b16 v[36:37], v30 offset:34816
ds_read_b64_tr_b16 v[38:39], v30 offset:35072
v_or_b32 v21, s59, v21
v_mfma_f32_32x32x16_bf16 v[208:223], v[44:47], v[168:171], v[208:223]
ds_read_b64_tr_b16 v[40:41], v32 offset:34816
ds_read_b64_tr_b16 v[42:43], v32 offset:35072
s_waitcnt lgkmcnt(4)
v_mfma_f32_32x32x16_bf16 v[224:239], v[48:51], v[168:171], v[224:239]
ds_read_b64_tr_b16 v[44:45], v34 offset:34816
ds_read_b64_tr_b16 v[46:47], v34 offset:35072
v_mfma_f32_32x32x16_bf16 v[176:191], v[52:55], v[172:175], v[176:191]
s_barrier
ds_read_b128 v[240:243], v10 offset:0
ds_read_b64_tr_b16 v[48:49], v16 offset:49152
ds_read_b64_tr_b16 v[50:51], v16 offset:49408
s_waitcnt lgkmcnt(5)
v_mfma_f32_32x32x16_bf16 v[192:207], v[36:39], v[172:175], v[192:207]
ds_read_b128 v[244:247], v10 offset:1024
ds_read_b64_tr_b16 v[52:53], v16 offset:51200
ds_read_b64_tr_b16 v[54:55], v16 offset:51456
v_mfma_f32_32x32x16_bf16 v[208:223], v[40:43], v[172:175], v[208:223]
ds_read_b64_tr_b16 v[36:37], v16 offset:53248
ds_read_b64_tr_b16 v[38:39], v16 offset:53504
s_waitcnt lgkmcnt(5)
v_mfma_f32_32x32x16_bf16 v[224:239], v[44:47], v[172:175], v[224:239]
ds_read_b64_tr_b16 v[40:41], v16 offset:55296
ds_read_b64_tr_b16 v[42:43], v16 offset:55552
v_mfma_f32_32x32x16_bf16 v[64:79], v[48:51], v[240:243], 0
ds_read_b64_tr_b16 v[44:45], v16 offset:57344
ds_read_b64_tr_b16 v[46:47], v16 offset:57600
s_waitcnt lgkmcnt(4)
v_mfma_f32_32x32x16_bf16 v[64:79], v[52:55], v[244:247], v[64:79]
ds_read_b64_tr_b16 v[48:49], v16 offset:59392
ds_read_b64_tr_b16 v[50:51], v16 offset:59648
v_mul_f32 v56, s56, v176
v_mul_f32 v57, s56, v177
v_mul_f32 v58, s56, v178
v_mul_f32 v59, s56, v179
v_mfma_f32_32x32x16_bf16 v[80:95], v[36:39], v[240:243], 0
ds_read_b64_tr_b16 v[52:53], v16 offset:61440
ds_read_b64_tr_b16 v[54:55], v16 offset:61696
s_waitcnt lgkmcnt(4)
v_exp_f32 v56, v56 clamp
v_max_f32 v176, s57, v176
v_exp_f32 v57, v57 clamp
v_mfma_f32_32x32x16_bf16 v[80:95], v[40:43], v[244:247], v[80:95]
ds_read_b64_tr_b16 v[36:37], v16 offset:63488
ds_read_b64_tr_b16 v[38:39], v16 offset:63744
v_max_f32 v177, s57, v177
v_exp_f32 v58, v58 clamp
v_max_f32 v178, s57, v178
v_mfma_f32_32x32x16_bf16 v[96:111], v[44:47], v[240:243], 0
s_barrier
ds_read_b64_tr_b16 v[40:41], v17 offset:0
ds_read_b64_tr_b16 v[42:43], v17 offset:256
s_waitcnt lgkmcnt(4)
v_exp_f32 v59, v59 clamp
v_max_f32 v179, s57, v179
v_add_f32 v176, v176, v56
v_mfma_f32_32x32x16_bf16 v[96:111], v[48:51], v[244:247], v[96:111]
ds_read_b64_tr_b16 v[44:45], v17 offset:2048
ds_read_b64_tr_b16 v[46:47], v17 offset:2304
v_add_f32 v177, v177, v57
v_add_f32 v178, v178, v58
v_add_f32 v179, v179, v59
v_cvt_pk_bf16_f32 v176, v176, v177
v_mfma_f32_32x32x16_bf16 v[112:127], v[52:55], v[240:243], 0
ds_read_b64_tr_b16 v[48:49], v17 offset:4096
ds_read_b64_tr_b16 v[50:51], v17 offset:4352
s_waitcnt lgkmcnt(4)
v_cvt_pk_bf16_f32 v177, v178, v179
v_mul_f32 v56, s56, v180
v_mul_f32 v57, s56, v181
v_mul_f32 v58, s56, v182
v_mfma_f32_32x32x16_bf16 v[112:127], v[36:39], v[244:247], v[112:127]
ds_read_b64_tr_b16 v[52:53], v17 offset:6144
ds_read_b64_tr_b16 v[54:55], v17 offset:6400
v_mul_f32 v59, s56, v183
v_exp_f32 v56, v56 clamp
v_max_f32 v180, s57, v180
v_mfma_f32_32x32x16_bf16 v[128:143], v[40:43], v[240:243], 0
ds_read_b64_tr_b16 v[36:37], v17 offset:8192
ds_read_b64_tr_b16 v[38:39], v17 offset:8448
s_waitcnt lgkmcnt(4)
v_exp_f32 v57, v57 clamp
v_max_f32 v181, s57, v181
v_exp_f32 v58, v58 clamp
v_mfma_f32_32x32x16_bf16 v[128:143], v[44:47], v[244:247], v[128:143]
ds_read_b64_tr_b16 v[40:41], v17 offset:10240
ds_read_b64_tr_b16 v[42:43], v17 offset:10496
v_max_f32 v182, s57, v182
v_exp_f32 v59, v59 clamp
v_max_f32 v183, s57, v183
v_mfma_f32_32x32x16_bf16 v[144:159], v[48:51], v[240:243], 0
ds_read_b128 v[248:251], v10 offset:2048
ds_read_b64_tr_b16 v[44:45], v17 offset:12288
ds_read_b64_tr_b16 v[46:47], v17 offset:12544
s_waitcnt lgkmcnt(5)
v_add_f32 v180, v180, v56
v_add_f32 v181, v181, v57
v_add_f32 v182, v182, v58
v_add_f32 v183, v183, v59
v_mfma_f32_32x32x16_bf16 v[144:159], v[52:55], v[244:247], v[144:159]
ds_read_b128 v[252:255], v10 offset:3072
ds_read_b64_tr_b16 v[48:49], v17 offset:14336
ds_read_b64_tr_b16 v[50:51], v17 offset:14592
v_cvt_pk_bf16_f32 v178, v180, v181
v_cvt_pk_bf16_f32 v179, v182, v183
v_mul_f32 v56, s56, v184
v_mul_f32 v57, s56, v185
v_mfma_f32_32x32x16_bf16 v[160:175], v[36:39], v[240:243], 0
s_barrier
ds_read_b64_tr_b16 v[52:53], v17 offset:16384
ds_read_b64_tr_b16 v[54:55], v17 offset:16640
s_waitcnt lgkmcnt(5)
v_mul_f32 v58, s56, v186
v_mul_f32 v59, s56, v187
v_exp_f32 v56, v56 clamp
v_mfma_f32_32x32x16_bf16 v[160:175], v[40:43], v[244:247], v[160:175]
ds_read_b64_tr_b16 v[36:37], v17 offset:18432
ds_read_b64_tr_b16 v[38:39], v17 offset:18688
v_max_f32 v184, s57, v184
v_exp_f32 v57, v57 clamp
v_max_f32 v185, s57, v185
v_mfma_f32_32x32x16_bf16 v[64:79], v[44:47], v[248:251], v[64:79]
ds_read_b64_tr_b16 v[40:41], v17 offset:20480
ds_read_b64_tr_b16 v[42:43], v17 offset:20736
s_waitcnt lgkmcnt(4)
v_exp_f32 v58, v58 clamp
v_max_f32 v186, s57, v186
v_exp_f32 v59, v59 clamp
v_mfma_f32_32x32x16_bf16 v[64:79], v[48:51], v[252:255], v[64:79]
ds_read_b64_tr_b16 v[44:45], v17 offset:22528
ds_read_b64_tr_b16 v[46:47], v17 offset:22784
v_max_f32 v187, s57, v187
v_add_f32 v184, v184, v56
v_add_f32 v185, v185, v57
v_add_f32 v186, v186, v58
v_mfma_f32_32x32x16_bf16 v[80:95], v[52:55], v[248:251], v[80:95]
ds_read_b64_tr_b16 v[48:49], v17 offset:24576
ds_read_b64_tr_b16 v[50:51], v17 offset:24832
s_waitcnt lgkmcnt(4)
v_add_f32 v187, v187, v59
v_cvt_pk_bf16_f32 v180, v184, v185
v_cvt_pk_bf16_f32 v181, v186, v187
v_mul_f32 v56, s56, v188
v_mfma_f32_32x32x16_bf16 v[80:95], v[36:39], v[252:255], v[80:95]
ds_read_b64_tr_b16 v[52:53], v17 offset:26624
ds_read_b64_tr_b16 v[54:55], v17 offset:26880
v_mul_f32 v57, s56, v189
v_mul_f32 v58, s56, v190
v_mul_f32 v59, s56, v191
v_exp_f32 v56, v56 clamp
v_mfma_f32_32x32x16_bf16 v[96:111], v[40:43], v[248:251], v[96:111]
ds_read_b64_tr_b16 v[36:37], v17 offset:28672
ds_read_b64_tr_b16 v[38:39], v17 offset:28928
s_waitcnt lgkmcnt(4)
v_max_f32 v188, s57, v188
v_exp_f32 v57, v57 clamp
v_max_f32 v189, s57, v189
v_mfma_f32_32x32x16_bf16 v[96:111], v[44:47], v[252:255], v[96:111]
ds_read_b64_tr_b16 v[40:41], v17 offset:30720
ds_read_b64_tr_b16 v[42:43], v17 offset:30976
v_exp_f32 v58, v58 clamp
v_max_f32 v190, s57, v190
v_exp_f32 v59, v59 clamp
v_mfma_f32_32x32x16_bf16 v[112:127], v[48:51], v[248:251], v[112:127]
s_barrier
ds_read_b64_tr_b16 v[44:45], v16 offset:0
ds_read_b64_tr_b16 v[46:47], v16 offset:256
s_waitcnt lgkmcnt(4)
v_max_f32 v191, s57, v191
v_add_f32 v188, v188, v56
v_add_f32 v189, v189, v57
v_add_f32 v190, v190, v58
v_mfma_f32_32x32x16_bf16 v[112:127], v[52:55], v[252:255], v[112:127]
ds_read_b64_tr_b16 v[48:49], v16 offset:2048
ds_read_b64_tr_b16 v[50:51], v16 offset:2304
v_add_f32 v191, v191, v59
v_cvt_pk_bf16_f32 v182, v188, v189
v_cvt_pk_bf16_f32 v183, v190, v191
v_mul_f32 v56, s56, v192
v_mfma_f32_32x32x16_bf16 v[128:143], v[36:39], v[248:251], v[128:143]
ds_read_b64_tr_b16 v[52:53], v16 offset:4096
ds_read_b64_tr_b16 v[54:55], v16 offset:4352
s_waitcnt lgkmcnt(4)
v_mul_f32 v57, s56, v193
v_mul_f32 v58, s56, v194
v_mul_f32 v59, s56, v195
v_exp_f32 v56, v56 clamp
v_mfma_f32_32x32x16_bf16 v[128:143], v[40:43], v[252:255], v[128:143]
ds_read_b64_tr_b16 v[36:37], v16 offset:6144
ds_read_b64_tr_b16 v[38:39], v16 offset:6400
v_max_f32 v192, s57, v192
v_exp_f32 v57, v57 clamp
v_max_f32 v193, s57, v193
v_mfma_f32_32x32x16_bf16 v[144:159], v[44:47], v[248:251], v[144:159]
ds_read_b128 v[240:243], v10 offset:4096
ds_read_b64_tr_b16 v[40:41], v16 offset:8192
ds_read_b64_tr_b16 v[42:43], v16 offset:8448
s_waitcnt lgkmcnt(5)
v_exp_f32 v58, v58 clamp
v_max_f32 v194, s57, v194
v_exp_f32 v59, v59 clamp
v_mfma_f32_32x32x16_bf16 v[144:159], v[48:51], v[252:255], v[144:159]
ds_read_b128 v[244:247], v10 offset:5120
ds_read_b64_tr_b16 v[44:45], v16 offset:10240
ds_read_b64_tr_b16 v[46:47], v16 offset:10496
v_max_f32 v195, s57, v195
v_add_f32 v192, v192, v56
v_add_f32 v193, v193, v57
v_add_f32 v194, v194, v58
v_mfma_f32_32x32x16_bf16 v[160:175], v[52:55], v[248:251], v[160:175]
ds_read_b64_tr_b16 v[48:49], v16 offset:12288
ds_read_b64_tr_b16 v[50:51], v16 offset:12544
s_waitcnt lgkmcnt(5)
v_add_f32 v195, v195, v59
v_cvt_pk_bf16_f32 v184, v192, v193
v_cvt_pk_bf16_f32 v185, v194, v195
v_mul_f32 v56, s56, v196
v_mfma_f32_32x32x16_bf16 v[160:175], v[36:39], v[252:255], v[160:175]
ds_read_b64_tr_b16 v[52:53], v16 offset:14336
ds_read_b64_tr_b16 v[54:55], v16 offset:14592
v_mul_f32 v57, s56, v197
v_mul_f32 v58, s56, v198
v_mul_f32 v59, s56, v199
v_exp_f32 v56, v56 clamp
v_mfma_f32_32x32x16_bf16 v[64:79], v[40:43], v[240:243], v[64:79]
s_barrier
ds_read_b64_tr_b16 v[36:37], v16 offset:16384
ds_read_b64_tr_b16 v[38:39], v16 offset:16640
s_waitcnt lgkmcnt(4)
v_max_f32 v196, s57, v196
v_exp_f32 v57, v57 clamp
v_max_f32 v197, s57, v197
v_mfma_f32_32x32x16_bf16 v[64:79], v[44:47], v[244:247], v[64:79]
ds_read_b64_tr_b16 v[40:41], v16 offset:18432
ds_read_b64_tr_b16 v[42:43], v16 offset:18688
v_exp_f32 v58, v58 clamp
v_max_f32 v198, s57, v198
v_exp_f32 v59, v59 clamp
v_mfma_f32_32x32x16_bf16 v[80:95], v[48:51], v[240:243], v[80:95]
ds_read_b64_tr_b16 v[44:45], v16 offset:20480
ds_read_b64_tr_b16 v[46:47], v16 offset:20736
s_waitcnt lgkmcnt(4)
v_max_f32 v199, s57, v199
v_add_f32 v196, v196, v56
v_add_f32 v197, v197, v57
v_add_f32 v198, v198, v58
v_mfma_f32_32x32x16_bf16 v[80:95], v[52:55], v[244:247], v[80:95]
ds_read_b64_tr_b16 v[48:49], v16 offset:22528
ds_read_b64_tr_b16 v[50:51], v16 offset:22784
v_add_f32 v199, v199, v59
v_cvt_pk_bf16_f32 v186, v196, v197
v_cvt_pk_bf16_f32 v187, v198, v199
v_mul_f32 v56, s56, v200
v_mfma_f32_32x32x16_bf16 v[96:111], v[36:39], v[240:243], v[96:111]
ds_read_b64_tr_b16 v[52:53], v16 offset:24576
ds_read_b64_tr_b16 v[54:55], v16 offset:24832
s_waitcnt lgkmcnt(4)
v_mul_f32 v57, s56, v201
v_mul_f32 v58, s56, v202
v_mul_f32 v59, s56, v203
v_exp_f32 v56, v56 clamp
v_mfma_f32_32x32x16_bf16 v[96:111], v[40:43], v[244:247], v[96:111]
ds_read_b64_tr_b16 v[36:37], v16 offset:26624
ds_read_b64_tr_b16 v[38:39], v16 offset:26880
v_max_f32 v200, s57, v200
v_exp_f32 v57, v57 clamp
v_max_f32 v201, s57, v201
v_mfma_f32_32x32x16_bf16 v[112:127], v[44:47], v[240:243], v[112:127]
ds_read_b64_tr_b16 v[40:41], v16 offset:28672
ds_read_b64_tr_b16 v[42:43], v16 offset:28928
s_waitcnt lgkmcnt(4)
v_exp_f32 v58, v58 clamp
v_max_f32 v202, s57, v202
v_exp_f32 v59, v59 clamp
v_mfma_f32_32x32x16_bf16 v[112:127], v[48:51], v[244:247], v[112:127]
ds_read_b64_tr_b16 v[44:45], v16 offset:30720
ds_read_b64_tr_b16 v[46:47], v16 offset:30976
v_max_f32 v203, s57, v203
v_add_f32 v200, v200, v56
v_add_f32 v201, v201, v57
v_add_f32 v202, v202, v58
v_mfma_f32_32x32x16_bf16 v[128:143], v[52:55], v[240:243], v[128:143]
s_barrier
ds_read_b64_tr_b16 v[48:49], v16 offset:32768
ds_read_b64_tr_b16 v[50:51], v16 offset:33024
s_waitcnt lgkmcnt(4)
v_add_f32 v203, v203, v59
v_cvt_pk_bf16_f32 v188, v200, v201
v_cvt_pk_bf16_f32 v189, v202, v203
v_mul_f32 v56, s56, v204
v_mfma_f32_32x32x16_bf16 v[128:143], v[36:39], v[244:247], v[128:143]
ds_read_b64_tr_b16 v[52:53], v16 offset:34816
ds_read_b64_tr_b16 v[54:55], v16 offset:35072
v_mul_f32 v57, s56, v205
v_mul_f32 v58, s56, v206
v_mul_f32 v59, s56, v207
v_exp_f32 v56, v56 clamp
v_mfma_f32_32x32x16_bf16 v[144:159], v[40:43], v[240:243], v[144:159]
ds_read_b128 v[248:251], v10 offset:6144
ds_read_b64_tr_b16 v[36:37], v16 offset:36864
ds_read_b64_tr_b16 v[38:39], v16 offset:37120
s_waitcnt lgkmcnt(5)
v_max_f32 v204, s57, v204
v_exp_f32 v57, v57 clamp
v_max_f32 v205, s57, v205
v_mfma_f32_32x32x16_bf16 v[144:159], v[44:47], v[244:247], v[144:159]
ds_read_b128 v[252:255], v10 offset:7168
ds_read_b64_tr_b16 v[40:41], v16 offset:38912
ds_read_b64_tr_b16 v[42:43], v16 offset:39168
v_exp_f32 v58, v58 clamp
v_max_f32 v206, s57, v206
v_exp_f32 v59, v59 clamp
v_mfma_f32_32x32x16_bf16 v[160:175], v[48:51], v[240:243], v[160:175]
ds_read_b64_tr_b16 v[44:45], v16 offset:40960
ds_read_b64_tr_b16 v[46:47], v16 offset:41216
s_waitcnt lgkmcnt(5)
v_max_f32 v207, s57, v207
v_add_f32 v204, v204, v56
v_add_f32 v205, v205, v57
v_add_f32 v206, v206, v58
v_mfma_f32_32x32x16_bf16 v[160:175], v[52:55], v[244:247], v[160:175]
ds_read_b64_tr_b16 v[48:49], v16 offset:43008
ds_read_b64_tr_b16 v[50:51], v16 offset:43264
v_add_f32 v207, v207, v59
v_cvt_pk_bf16_f32 v190, v204, v205
v_cvt_pk_bf16_f32 v191, v206, v207
v_mul_f32 v56, s56, v208
v_mfma_f32_32x32x16_bf16 v[64:79], v[36:39], v[248:251], v[64:79]
ds_read_b64_tr_b16 v[52:53], v16 offset:45056
ds_read_b64_tr_b16 v[54:55], v16 offset:45312
s_waitcnt lgkmcnt(4)
v_mul_f32 v57, s56, v209
v_mul_f32 v58, s56, v210
v_mul_f32 v59, s56, v211
v_exp_f32 v56, v56 clamp
v_mfma_f32_32x32x16_bf16 v[64:79], v[40:43], v[252:255], v[64:79]
ds_read_b64_tr_b16 v[36:37], v16 offset:47104
ds_read_b64_tr_b16 v[38:39], v16 offset:47360
v_max_f32 v208, s57, v208
v_exp_f32 v57, v57 clamp
v_max_f32 v209, s57, v209
v_mfma_f32_32x32x16_bf16 v[80:95], v[44:47], v[248:251], v[80:95]
s_barrier
ds_read_b64_tr_b16 v[40:41], v16 offset:49152
ds_read_b64_tr_b16 v[42:43], v16 offset:49408
s_waitcnt lgkmcnt(4)
v_exp_f32 v58, v58 clamp
v_max_f32 v210, s57, v210
v_exp_f32 v59, v59 clamp
v_mfma_f32_32x32x16_bf16 v[80:95], v[48:51], v[252:255], v[80:95]
ds_read_b64_tr_b16 v[44:45], v16 offset:51200
ds_read_b64_tr_b16 v[46:47], v16 offset:51456
v_max_f32 v211, s57, v211
v_add_f32 v208, v208, v56
v_add_f32 v209, v209, v57
v_add_f32 v210, v210, v58
v_mfma_f32_32x32x16_bf16 v[96:111], v[52:55], v[248:251], v[96:111]
ds_read_b64_tr_b16 v[48:49], v16 offset:53248
ds_read_b64_tr_b16 v[50:51], v16 offset:53504
s_waitcnt lgkmcnt(4)
v_add_f32 v211, v211, v59
v_cvt_pk_bf16_f32 v192, v208, v209
v_cvt_pk_bf16_f32 v193, v210, v211
v_mul_f32 v56, s56, v212
v_mfma_f32_32x32x16_bf16 v[96:111], v[36:39], v[252:255], v[96:111]
ds_read_b64_tr_b16 v[52:53], v16 offset:55296
ds_read_b64_tr_b16 v[54:55], v16 offset:55552
v_mul_f32 v57, s56, v213
v_mul_f32 v58, s56, v214
v_mul_f32 v59, s56, v215
v_exp_f32 v56, v56 clamp
v_mfma_f32_32x32x16_bf16 v[112:127], v[40:43], v[248:251], v[112:127]
ds_read_b64_tr_b16 v[36:37], v16 offset:57344
ds_read_b64_tr_b16 v[38:39], v16 offset:57600
s_waitcnt lgkmcnt(4)
v_max_f32 v212, s57, v212
v_exp_f32 v57, v57 clamp
v_max_f32 v213, s57, v213
v_mfma_f32_32x32x16_bf16 v[112:127], v[44:47], v[252:255], v[112:127]
ds_read_b64_tr_b16 v[40:41], v16 offset:59392
ds_read_b64_tr_b16 v[42:43], v16 offset:59648
v_exp_f32 v58, v58 clamp
v_max_f32 v214, s57, v214
v_exp_f32 v59, v59 clamp
v_mfma_f32_32x32x16_bf16 v[128:143], v[48:51], v[248:251], v[128:143]
ds_read_b64_tr_b16 v[44:45], v16 offset:61440
ds_read_b64_tr_b16 v[46:47], v16 offset:61696
s_waitcnt lgkmcnt(4)
v_max_f32 v215, s57, v215
v_add_f32 v212, v212, v56
v_add_f32 v213, v213, v57
v_add_f32 v214, v214, v58
v_mfma_f32_32x32x16_bf16 v[128:143], v[52:55], v[252:255], v[128:143]
ds_read_b64_tr_b16 v[48:49], v16 offset:63488
ds_read_b64_tr_b16 v[50:51], v16 offset:63744
v_add_f32 v215, v215, v59
v_cvt_pk_bf16_f32 v194, v212, v213
v_cvt_pk_bf16_f32 v195, v214, v215
v_mul_f32 v56, s56, v216
v_mfma_f32_32x32x16_bf16 v[144:159], v[36:39], v[248:251], v[144:159]
s_waitcnt lgkmcnt(2)
v_mul_f32 v57, s56, v217
v_mul_f32 v58, s56, v218
v_mul_f32 v59, s56, v219
v_exp_f32 v56, v56 clamp
v_mfma_f32_32x32x16_bf16 v[144:159], v[40:43], v[252:255], v[144:159]
v_max_f32 v216, s57, v216
v_exp_f32 v57, v57 clamp
v_max_f32 v217, s57, v217
v_mfma_f32_32x32x16_bf16 v[160:175], v[44:47], v[248:251], v[160:175]
s_waitcnt lgkmcnt(0)
v_exp_f32 v58, v58 clamp
v_max_f32 v218, s57, v218
v_exp_f32 v59, v59 clamp
v_mfma_f32_32x32x16_bf16 v[160:175], v[48:51], v[252:255], v[160:175]
v_max_f32 v219, s57, v219
v_add_f32 v216, v216, v56
v_add_f32 v217, v217, v57
v_add_f32 v218, v218, v58
s_barrier
v_add_f32 v219, v219, v59
v_cvt_pk_bf16_f32 v196, v216, v217
v_cvt_pk_bf16_f32 v197, v218, v219
v_mul_f32 v56, s56, v220
v_mul_f32 v57, s56, v221
v_mul_f32 v58, s56, v222
v_mul_f32 v59, s56, v223
v_exp_f32 v56, v56 clamp
v_max_f32 v220, s57, v220
v_exp_f32 v57, v57 clamp
v_max_f32 v221, s57, v221
v_exp_f32 v58, v58 clamp
v_max_f32 v222, s57, v222
v_exp_f32 v59, v59 clamp
v_max_f32 v223, s57, v223
v_add_f32 v220, v220, v56
v_add_f32 v221, v221, v57
v_add_f32 v222, v222, v58
v_add_f32 v223, v223, v59
v_cvt_pk_bf16_f32 v198, v220, v221
v_cvt_pk_bf16_f32 v199, v222, v223
v_mul_f32 v56, s56, v224
v_mul_f32 v57, s56, v225
v_mul_f32 v58, s56, v226
v_mul_f32 v59, s56, v227
v_exp_f32 v56, v56 clamp
v_max_f32 v224, s57, v224
v_exp_f32 v57, v57 clamp
v_max_f32 v225, s57, v225
v_exp_f32 v58, v58 clamp
v_max_f32 v226, s57, v226
v_exp_f32 v59, v59 clamp
v_max_f32 v227, s57, v227
v_add_f32 v224, v224, v56
v_add_f32 v225, v225, v57
v_add_f32 v226, v226, v58
v_add_f32 v227, v227, v59
v_cvt_pk_bf16_f32 v200, v224, v225
v_cvt_pk_bf16_f32 v201, v226, v227
v_mul_f32 v56, s56, v228
v_mul_f32 v57, s56, v229
v_mul_f32 v58, s56, v230
v_mul_f32 v59, s56, v231
v_exp_f32 v56, v56 clamp
v_max_f32 v228, s57, v228
v_exp_f32 v57, v57 clamp
v_max_f32 v229, s57, v229
v_exp_f32 v58, v58 clamp
v_max_f32 v230, s57, v230
v_exp_f32 v59, v59 clamp
v_max_f32 v231, s57, v231
v_add_f32 v228, v228, v56
v_add_f32 v229, v229, v57
v_add_f32 v230, v230, v58
v_add_f32 v231, v231, v59
v_cvt_pk_bf16_f32 v202, v228, v229
v_cvt_pk_bf16_f32 v203, v230, v231
v_mul_f32 v56, s56, v232
v_mul_f32 v57, s56, v233
v_mul_f32 v58, s56, v234
v_mul_f32 v59, s56, v235
v_exp_f32 v56, v56 clamp
v_max_f32 v232, s57, v232
v_exp_f32 v57, v57 clamp
v_max_f32 v233, s57, v233
v_exp_f32 v58, v58 clamp
v_max_f32 v234, s57, v234
v_exp_f32 v59, v59 clamp
v_max_f32 v235, s57, v235
v_add_f32 v232, v232, v56
v_add_f32 v233, v233, v57
v_add_f32 v234, v234, v58
v_add_f32 v235, v235, v59
v_cvt_pk_bf16_f32 v204, v232, v233
v_cvt_pk_bf16_f32 v205, v234, v235
v_mul_f32 v56, s56, v236
v_mul_f32 v57, s56, v237
v_mul_f32 v58, s56, v238
v_mul_f32 v59, s56, v239
v_exp_f32 v56, v56 clamp
v_max_f32 v236, s57, v236
v_exp_f32 v57, v57 clamp
v_max_f32 v237, s57, v237
v_exp_f32 v58, v58 clamp
v_max_f32 v238, s57, v238
v_exp_f32 v59, v59 clamp
v_max_f32 v239, s57, v239
v_add_f32 v236, v236, v56
v_add_f32 v237, v237, v57
v_add_f32 v238, v238, v58
v_add_f32 v239, v239, v59
v_cvt_pk_bf16_f32 v206, v236, v237
v_cvt_pk_bf16_f32 v207, v238, v239
s_and_b32 s59, s4, 1
s_lshl_b32 s59, s59, 1
s_add_u32 s59, s59, s31
s_lshl_b32 s59, s59, 13
s_add_u32 s59, s59, 5242880
s_add_u32 s60, s59, 4096
v_subrev_u32 v12, 0x10000, v16
s_mul_i32 s61, s31, 30720
s_add_u32 s61, s61, 12288
v_add_u32 v8, s61, v20
s_mov_b32 s61, 0x07060302
s_barrier
ds_read_b128 v[208:211], v8 offset:0
ds_read_b128 v[212:215], v8 offset:1024
ds_read_b128 v[216:219], v8 offset:2048
ds_read_b128 v[220:223], v8 offset:3072
ds_read_b128 v[224:227], v8 offset:4096
ds_read_b128 v[228:231], v8 offset:5120
ds_read_b128 v[232:235], v8 offset:6144
ds_read_b128 v[236:239], v8 offset:7168
cE_l2c2:
v_mov_b32 v1, 0
s_waitcnt lgkmcnt(7)
v_xor_b32 v2, v211, v26
s_waitcnt lgkmcnt(6)
v_xor_b32 v3, v215, v26
v_or3_b32 v1, v1, v2, v3
v_perm_b32 v211, v215, v211, s61
v_mov_b32 v215, 0
s_waitcnt lgkmcnt(5)
v_xor_b32 v2, v219, v26
s_waitcnt lgkmcnt(4)
v_xor_b32 v3, v223, v26
v_or3_b32 v1, v1, v2, v3
v_perm_b32 v219, v223, v219, s61
v_mov_b32 v223, 0
s_waitcnt lgkmcnt(3)
v_xor_b32 v2, v227, v26
s_waitcnt lgkmcnt(2)
v_xor_b32 v3, v231, v26
v_or3_b32 v1, v1, v2, v3
v_perm_b32 v227, v231, v227, s61
v_mov_b32 v231, 0
s_waitcnt lgkmcnt(1)
v_xor_b32 v2, v235, v26
s_waitcnt lgkmcnt(0)
v_xor_b32 v3, v239, v26
v_or3_b32 v1, v1, v2, v3
v_perm_b32 v235, v239, v235, s61
v_mov_b32 v239, 0
v_and_b32 v1, 0xffff, v1
v_cmp_ne_u32 vcc, 0, v1
v_permlane32_swap_b32 v214, v215
v_permlane32_swap_b32 v222, v223
v_permlane32_swap_b32 v230, v231
v_permlane32_swap_b32 v238, v239
s_cbranch_vccz cE_giveup3
s_sub_u32 s63, s63, 1
s_cmp_gt_i32 s63, 0
s_cbranch_scc1 cE_l2_1
cE_giveup3:
v_mfma_f32_32x32x16_bf16 v[240:255], v[208:211], v[176:179], 0
v_mfma_f32_32x32x16_bf16 v[240:255], v[212:215], v[180:183], v[240:255]
v_mfma_f32_32x32x16_bf16 v[36:51], v[216:219], v[184:187], 0
v_mfma_f32_32x32x16_bf16 v[36:51], v[220:223], v[188:191], v[36:51]
v_mfma_f32_32x32x16_bf16 v[208:223], v[224:227], v[192:195], 0
v_mfma_f32_32x32x16_bf16 v[208:223], v[228:231], v[196:199], v[208:223]
v_mfma_f32_32x32x16_bf16 v[176:191], v[232:235], v[200:203], 0
v_mfma_f32_32x32x16_bf16 v[176:191], v[236:239], v[204:207], v[176:191]
s_nop 5
v_mov_b32 v56, v252
v_mov_b32 v57, v252
v_mov_b32 v58, v48
v_mov_b32 v59, v48
v_mov_b32 v60, v220
v_mov_b32 v61, v220
v_mov_b32 v62, v188
v_mov_b32 v63, v188
v_permlane32_swap_b32 v57, v56
v_permlane32_swap_b32 v59, v58
v_permlane32_swap_b32 v61, v60
v_permlane32_swap_b32 v63, v62
v_add_f32 v56, s57, v56
v_add_f32 v58, s57, v58
v_add_f32 v60, s57, v60
v_add_f32 v62, s57, v62
v_rcp_f32 v56, v56
v_rcp_f32 v58, v58
v_rcp_f32 v60, v60
v_rcp_f32 v62, v62
v_pk_mul_f32 v[240:241], v[240:241], v[56:57] op_sel_hi:[1,0]
v_pk_mul_f32 v[242:243], v[242:243], v[56:57] op_sel_hi:[1,0]
v_cvt_pk_bf16_f32 v240, v240, v241
v_cvt_pk_bf16_f32 v241, v242, v243
ds_write_b64 v18, v[240:241] offset:16384
v_pk_mul_f32 v[36:37], v[36:37], v[58:59] op_sel_hi:[1,0]
v_pk_mul_f32 v[38:39], v[38:39], v[58:59] op_sel_hi:[1,0]
v_cvt_pk_bf16_f32 v36, v36, v37
v_cvt_pk_bf16_f32 v37, v38, v39
ds_write_b64 v19, v[36:37] offset:17928
v_pk_mul_f32 v[208:209], v[208:209], v[60:61] op_sel_hi:[1,0]
v_pk_mul_f32 v[210:211], v[210:211], v[60:61] op_sel_hi:[1,0]
v_cvt_pk_bf16_f32 v208, v208, v209
v_cvt_pk_bf16_f32 v209, v210, v211
ds_write_b64 v18, v[208:209] offset:19968
v_pk_mul_f32 v[176:177], v[176:177], v[62:63] op_sel_hi:[1,0]
v_pk_mul_f32 v[178:179], v[178:179], v[62:63] op_sel_hi:[1,0]
v_cvt_pk_bf16_f32 v176, v176, v177
v_cvt_pk_bf16_f32 v177, v178, v179
ds_write_b64 v19, v[176:177] offset:21512
v_pk_mul_f32 v[244:245], v[244:245], v[56:57] op_sel_hi:[1,0]
v_pk_mul_f32 v[246:247], v[246:247], v[56:57] op_sel_hi:[1,0]
v_cvt_pk_bf16_f32 v244, v244, v245
v_cvt_pk_bf16_f32 v245, v246, v247
ds_write_b64 v18, v[244:245] offset:16896
v_pk_mul_f32 v[40:41], v[40:41], v[58:59] op_sel_hi:[1,0]
v_pk_mul_f32 v[42:43], v[42:43], v[58:59] op_sel_hi:[1,0]
v_cvt_pk_bf16_f32 v40, v40, v41
v_cvt_pk_bf16_f32 v41, v42, v43
ds_write_b64 v19, v[40:41] offset:18440
v_pk_mul_f32 v[212:213], v[212:213], v[60:61] op_sel_hi:[1,0]
v_pk_mul_f32 v[214:215], v[214:215], v[60:61] op_sel_hi:[1,0]
v_cvt_pk_bf16_f32 v212, v212, v213
v_cvt_pk_bf16_f32 v213, v214, v215
ds_write_b64 v18, v[212:213] offset:20480
v_pk_mul_f32 v[180:181], v[180:181], v[62:63] op_sel_hi:[1,0]
v_pk_mul_f32 v[182:183], v[182:183], v[62:63] op_sel_hi:[1,0]
v_cvt_pk_bf16_f32 v180, v180, v181
v_cvt_pk_bf16_f32 v181, v182, v183
ds_write_b64 v19, v[180:181] offset:22024
v_pk_mul_f32 v[248:249], v[248:249], v[56:57] op_sel_hi:[1,0]
v_pk_mul_f32 v[250:251], v[250:251], v[56:57] op_sel_hi:[1,0]
v_cvt_pk_bf16_f32 v248, v248, v249
v_cvt_pk_bf16_f32 v249, v250, v251
ds_write_b64 v18, v[248:249] offset:17408
v_pk_mul_f32 v[44:45], v[44:45], v[58:59] op_sel_hi:[1,0]
v_pk_mul_f32 v[46:47], v[46:47], v[58:59] op_sel_hi:[1,0]
v_cvt_pk_bf16_f32 v44, v44, v45
v_cvt_pk_bf16_f32 v45, v46, v47
ds_write_b64 v19, v[44:45] offset:18952
v_pk_mul_f32 v[216:217], v[216:217], v[60:61] op_sel_hi:[1,0]
v_pk_mul_f32 v[218:219], v[218:219], v[60:61] op_sel_hi:[1,0]
v_cvt_pk_bf16_f32 v216, v216, v217
v_cvt_pk_bf16_f32 v217, v218, v219
ds_write_b64 v18, v[216:217] offset:20992
v_pk_mul_f32 v[184:185], v[184:185], v[62:63] op_sel_hi:[1,0]
v_pk_mul_f32 v[186:187], v[186:187], v[62:63] op_sel_hi:[1,0]
v_cvt_pk_bf16_f32 v184, v184, v185
v_cvt_pk_bf16_f32 v185, v186, v187
ds_write_b64 v19, v[184:185] offset:22536
s_mov_b32 exec_hi, 0
v_pk_mul_f32 v[252:253], v[252:253], v[56:57] op_sel_hi:[1,0]
v_pk_mul_f32 v[254:255], v[254:255], v[56:57] op_sel_hi:[1,0]
v_cvt_pk_bf16_f32 v252, v252, v253
v_cvt_pk_bf16_f32 v253, v254, v255
ds_write_b64 v18, v[252:253] offset:17920
v_pk_mul_f32 v[48:49], v[48:49], v[58:59] op_sel_hi:[1,0]
v_pk_mul_f32 v[50:51], v[50:51], v[58:59] op_sel_hi:[1,0]
v_cvt_pk_bf16_f32 v48, v48, v49
v_cvt_pk_bf16_f32 v49, v50, v51
ds_write_b64 v19, v[48:49] offset:19464
v_pk_mul_f32 v[220:221], v[220:221], v[60:61] op_sel_hi:[1,0]
v_pk_mul_f32 v[222:223], v[222:223], v[60:61] op_sel_hi:[1,0]
v_cvt_pk_bf16_f32 v220, v220, v221
v_cvt_pk_bf16_f32 v221, v222, v223
ds_write_b64 v18, v[220:221] offset:21504
v_pk_mul_f32 v[188:189], v[188:189], v[62:63] op_sel_hi:[1,0]
v_pk_mul_f32 v[190:191], v[190:191], v[62:63] op_sel_hi:[1,0]
v_cvt_pk_bf16_f32 v188, v188, v189
v_cvt_pk_bf16_f32 v189, v190, v191
ds_write_b64 v19, v[188:189] offset:23048
s_mov_b32 exec_hi, -1
s_waitcnt lgkmcnt(0)
s_barrier
ds_read_b128 v[176:179], v10 offset:16384
ds_read_b64_tr_b16 v[52:53], v17 offset:0
ds_read_b64_tr_b16 v[54:55], v17 offset:256
ds_read_b128 v[180:183], v10 offset:17408
ds_read_b64_tr_b16 v[36:37], v17 offset:2048
ds_read_b64_tr_b16 v[38:39], v17 offset:2304
ds_read_b128 v[184:187], v10 offset:18432
ds_read_b64_tr_b16 v[40:41], v17 offset:4096
ds_read_b64_tr_b16 v[42:43], v17 offset:4352
ds_read_b128 v[188:191], v10 offset:19456
ds_read_b64_tr_b16 v[44:45], v17 offset:6144
ds_read_b64_tr_b16 v[46:47], v17 offset:6400
s_waitcnt lgkmcnt(9)
v_mfma_f32_32x32x16_bf16 v[64:79], v[52:55], v[176:179], v[64:79]
ds_read_b128 v[192:195], v10 offset:20480
ds_read_b64_tr_b16 v[48:49], v17 offset:8192
ds_read_b64_tr_b16 v[50:51], v17 offset:8448
s_waitcnt lgkmcnt(6)
v_mfma_f32_32x32x16_bf16 v[64:79], v[36:39], v[180:183], v[64:79]
ds_read_b128 v[196:199], v10 offset:21504
ds_read_b64_tr_b16 v[52:53], v17 offset:10240
ds_read_b64_tr_b16 v[54:55], v17 offset:10496
v_mfma_f32_32x32x16_bf16 v[64:79], v[40:43], v[184:187], v[64:79]
ds_read_b128 v[200:203], v10 offset:22528
ds_read_b64_tr_b16 v[36:37], v17 offset:12288
ds_read_b64_tr_b16 v[38:39], v17 offset:12544
s_waitcnt lgkmcnt(6)
v_mfma_f32_32x32x16_bf16 v[64:79], v[44:47], v[188:191], v[64:79]
ds_read_b128 v[204:207], v10 offset:23552
ds_read_b64_tr_b16 v[40:41], v17 offset:14336
ds_read_b64_tr_b16 v[42:43], v17 offset:14592
v_mfma_f32_32x32x16_bf16 v[64:79], v[48:51], v[192:195], v[64:79]
s_barrier
ds_read_b128 v[208:211], v10 offset:24576
ds_read_b64_tr_b16 v[44:45], v17 offset:16384
ds_read_b64_tr_b16 v[46:47], v17 offset:16640
s_waitcnt lgkmcnt(6)
v_mfma_f32_32x32x16_bf16 v[64:79], v[52:55], v[196:199], v[64:79]
ds_read_b128 v[212:215], v10 offset:25600
ds_read_b64_tr_b16 v[48:49], v17 offset:18432
ds_read_b64_tr_b16 v[50:51], v17 offset:18688
v_mfma_f32_32x32x16_bf16 v[64:79], v[36:39], v[200:203], v[64:79]
ds_read_b128 v[216:219], v10 offset:26624
ds_read_b64_tr_b16 v[52:53], v17 offset:20480
ds_read_b64_tr_b16 v[54:55], v17 offset:20736
s_waitcnt lgkmcnt(6)
v_mfma_f32_32x32x16_bf16 v[64:79], v[40:43], v[204:207], v[64:79]
ds_read_b128 v[220:223], v10 offset:27648
ds_read_b64_tr_b16 v[36:37], v17 offset:22528
ds_read_b64_tr_b16 v[38:39], v17 offset:22784
v_mfma_f32_32x32x16_bf16 v[64:79], v[44:47], v[208:211], v[64:79]
ds_read_b128 v[224:227], v10 offset:28672
ds_read_b64_tr_b16 v[40:41], v17 offset:24576
ds_read_b64_tr_b16 v[42:43], v17 offset:24832
s_waitcnt lgkmcnt(6)
v_mfma_f32_32x32x16_bf16 v[64:79], v[48:51], v[212:215], v[64:79]
ds_read_b128 v[228:231], v10 offset:29696
ds_read_b64_tr_b16 v[44:45], v17 offset:26624
ds_read_b64_tr_b16 v[46:47], v17 offset:26880
v_mfma_f32_32x32x16_bf16 v[64:79], v[52:55], v[216:219], v[64:79]
ds_read_b64_tr_b16 v[48:49], v17 offset:28672
ds_read_b64_tr_b16 v[50:51], v17 offset:28928
s_waitcnt lgkmcnt(5)
v_mfma_f32_32x32x16_bf16 v[64:79], v[36:39], v[220:223], v[64:79]
ds_read_b64_tr_b16 v[52:53], v17 offset:30720
ds_read_b64_tr_b16 v[54:55], v17 offset:30976
v_mfma_f32_32x32x16_bf16 v[64:79], v[40:43], v[224:227], v[64:79]
s_barrier
ds_read_b64_tr_b16 v[36:37], v16 offset:0
ds_read_b64_tr_b16 v[38:39], v16 offset:256
s_waitcnt lgkmcnt(4)
v_mfma_f32_32x32x16_bf16 v[64:79], v[44:47], v[228:231], v[64:79]
ds_read_b64_tr_b16 v[40:41], v16 offset:2048
ds_read_b64_tr_b16 v[42:43], v16 offset:2304
v_mfma_f32_32x32x16_bf16 v[80:95], v[48:51], v[176:179], v[80:95]
ds_read_b64_tr_b16 v[44:45], v16 offset:4096
ds_read_b64_tr_b16 v[46:47], v16 offset:4352
s_waitcnt lgkmcnt(4)
v_mfma_f32_32x32x16_bf16 v[80:95], v[52:55], v[180:183], v[80:95]
ds_read_b64_tr_b16 v[48:49], v16 offset:6144
ds_read_b64_tr_b16 v[50:51], v16 offset:6400
s_nop 2
v_cvt_pk_bf16_f32 v64, v64, v65
v_cvt_pk_bf16_f32 v65, v66, v67
v_cvt_pk_bf16_f32 v66, v68, v69
v_mfma_f32_32x32x16_bf16 v[80:95], v[36:39], v[184:187], v[80:95]
ds_read_b64_tr_b16 v[52:53], v16 offset:8192
ds_read_b64_tr_b16 v[54:55], v16 offset:8448
s_waitcnt lgkmcnt(4)
v_cvt_pk_bf16_f32 v67, v70, v71
buffer_store_dwordx4 v[64:67], v24, s[36:39], s48 offen offset:0 sc1
v_cvt_pk_bf16_f32 v68, v72, v73
v_mfma_f32_32x32x16_bf16 v[80:95], v[40:43], v[188:191], v[80:95]
ds_read_b64_tr_b16 v[36:37], v16 offset:10240
ds_read_b64_tr_b16 v[38:39], v16 offset:10496
v_cvt_pk_bf16_f32 v69, v74, v75
v_cvt_pk_bf16_f32 v70, v76, v77
v_cvt_pk_bf16_f32 v71, v78, v79
v_mfma_f32_32x32x16_bf16 v[80:95], v[44:47], v[192:195], v[80:95]
ds_read_b64_tr_b16 v[40:41], v16 offset:12288
ds_read_b64_tr_b16 v[42:43], v16 offset:12544
s_waitcnt lgkmcnt(4)
v_add3_u32 v22, v64, v65, v66
v_add3_u32 v1, v67, v68, v69
v_add3_u32 v22, v22, v70, v71
v_mfma_f32_32x32x16_bf16 v[80:95], v[48:51], v[196:199], v[80:95]
ds_read_b64_tr_b16 v[44:45], v16 offset:14336
ds_read_b64_tr_b16 v[46:47], v16 offset:14592
v_add_u32 v22, v22, v1
v_mul_lo_u32 v22, v22, v13
buffer_store_dwordx4 v[68:71], v24, s[36:39], s48 offen offset:1024 sc1
v_mfma_f32_32x32x16_bf16 v[80:95], v[52:55], v[200:203], v[80:95]
s_barrier
ds_read_b64_tr_b16 v[48:49], v16 offset:16384
ds_read_b64_tr_b16 v[50:51], v16 offset:16640
s_waitcnt lgkmcnt(4)
v_mfma_f32_32x32x16_bf16 v[80:95], v[36:39], v[204:207], v[80:95]
ds_read_b64_tr_b16 v[52:53], v16 offset:18432
ds_read_b64_tr_b16 v[54:55], v16 offset:18688
v_add_u32_dpp v22, v22, v22 row_ror:8 row_mask:0xf bank_mask:0xf
v_mfma_f32_32x32x16_bf16 v[80:95], v[40:43], v[208:211], v[80:95]
ds_read_b64_tr_b16 v[36:37], v16 offset:20480
ds_read_b64_tr_b16 v[38:39], v16 offset:20736
s_waitcnt lgkmcnt(4)
v_add_u32_dpp v22, v22, v22 row_ror:4 row_mask:0xf bank_mask:0xf
v_mfma_f32_32x32x16_bf16 v[80:95], v[44:47], v[212:215], v[80:95]
ds_read_b64_tr_b16 v[40:41], v16 offset:22528
ds_read_b64_tr_b16 v[42:43], v16 offset:22784
v_add_u32_dpp v22, v22, v22 row_ror:2 row_mask:0xf bank_mask:0xf
v_mfma_f32_32x32x16_bf16 v[80:95], v[48:51], v[216:219], v[80:95]
ds_read_b64_tr_b16 v[44:45], v16 offset:24576
ds_read_b64_tr_b16 v[46:47], v16 offset:24832
s_waitcnt lgkmcnt(4)
v_add_u32_dpp v22, v22, v22 row_ror:1 row_mask:0xf bank_mask:0xf
v_mfma_f32_32x32x16_bf16 v[80:95], v[52:55], v[220:223], v[80:95]
ds_read_b64_tr_b16 v[48:49], v16 offset:26624
ds_read_b64_tr_b16 v[50:51], v16 offset:26880
v_add_u32_dpp v22, v22, v22 row_bcast:15 row_mask:0xa bank_mask:0xf
v_mfma_f32_32x32x16_bf16 v[80:95], v[36:39], v[224:227], v[80:95]
ds_read_b64_tr_b16 v[52:53], v16 offset:28672
ds_read_b64_tr_b16 v[54:55], v16 offset:28928
s_waitcnt lgkmcnt(4)
v_add_u32_dpp v22, v22, v22 row_bcast:31 row_mask:0xc bank_mask:0xf
v_add_u32 v22, v22, v23
buffer_store_dwordx2 v[22:23], v21, s[36:39], s8 offen sc1
v_mfma_f32_32x32x16_bf16 v[80:95], v[40:43], v[228:231], v[80:95]
ds_read_b64_tr_b16 v[36:37], v16 offset:30720
ds_read_b64_tr_b16 v[38:39], v16 offset:30976
v_mfma_f32_32x32x16_bf16 v[96:111], v[44:47], v[176:179], v[96:111]
s_barrier
ds_read_b64_tr_b16 v[40:41], v16 offset:32768
ds_read_b64_tr_b16 v[42:43], v16 offset:33024
s_waitcnt lgkmcnt(4)
v_mfma_f32_32x32x16_bf16 v[96:111], v[48:51], v[180:183], v[96:111]
ds_read_b64_tr_b16 v[44:45], v16 offset:34816
ds_read_b64_tr_b16 v[46:47], v16 offset:35072
s_nop 1
v_cvt_pk_bf16_f32 v80, v80, v81
v_cvt_pk_bf16_f32 v81, v82, v83
v_cvt_pk_bf16_f32 v82, v84, v85
v_mfma_f32_32x32x16_bf16 v[96:111], v[52:55], v[184:187], v[96:111]
ds_read_b64_tr_b16 v[48:49], v16 offset:36864
ds_read_b64_tr_b16 v[50:51], v16 offset:37120
s_waitcnt lgkmcnt(4)
v_cvt_pk_bf16_f32 v83, v86, v87
buffer_store_dwordx4 v[80:83], v24, s[36:39], s49 offen offset:0 sc1
v_cvt_pk_bf16_f32 v84, v88, v89
v_mfma_f32_32x32x16_bf16 v[96:111], v[36:39], v[188:191], v[96:111]
ds_read_b64_tr_b16 v[52:53], v16 offset:38912
ds_read_b64_tr_b16 v[54:55], v16 offset:39168
v_cvt_pk_bf16_f32 v85, v90, v91
v_cvt_pk_bf16_f32 v86, v92, v93
v_cvt_pk_bf16_f32 v87, v94, v95
v_mfma_f32_32x32x16_bf16 v[96:111], v[40:43], v[192:195], v[96:111]
ds_read_b64_tr_b16 v[36:37], v16 offset:40960
ds_read_b64_tr_b16 v[38:39], v16 offset:41216
s_waitcnt lgkmcnt(4)
v_add3_u32 v22, v80, v81, v82
v_add3_u32 v1, v83, v84, v85
v_add3_u32 v22, v22, v86, v87
v_mfma_f32_32x32x16_bf16 v[96:111], v[44:47], v[196:199], v[96:111]
ds_read_b64_tr_b16 v[40:41], v16 offset:43008
ds_read_b64_tr_b16 v[42:43], v16 offset:43264
v_add_u32 v22, v22, v1
v_mul_lo_u32 v22, v22, v13
buffer_store_dwordx4 v[84:87], v24, s[36:39], s49 offen offset:1024 sc1
v_mfma_f32_32x32x16_bf16 v[96:111], v[48:51], v[200:203], v[96:111]
ds_read_b64_tr_b16 v[44:45], v16 offset:45056
ds_read_b64_tr_b16 v[46:47], v16 offset:45312
s_waitcnt lgkmcnt(4)
v_mfma_f32_32x32x16_bf16 v[96:111], v[52:55], v[204:207], v[96:111]
ds_read_b64_tr_b16 v[48:49], v16 offset:47104
ds_read_b64_tr_b16 v[50:51], v16 offset:47360
v_add_u32_dpp v22, v22, v22 row_ror:8 row_mask:0xf bank_mask:0xf
v_mfma_f32_32x32x16_bf16 v[96:111], v[36:39], v[208:211], v[96:111]
s_barrier
ds_read_b64_tr_b16 v[52:53], v16 offset:49152
ds_read_b64_tr_b16 v[54:55], v16 offset:49408
s_waitcnt lgkmcnt(4)
v_add_u32_dpp v22, v22, v22 row_ror:4 row_mask:0xf bank_mask:0xf
v_mfma_f32_32x32x16_bf16 v[96:111], v[40:43], v[212:215], v[96:111]
ds_read_b64_tr_b16 v[36:37], v16 offset:51200
ds_read_b64_tr_b16 v[38:39], v16 offset:51456
v_add_u32_dpp v22, v22, v22 row_ror:2 row_mask:0xf bank_mask:0xf
v_mfma_f32_32x32x16_bf16 v[96:111], v[44:47], v[216:219], v[96:111]
ds_read_b64_tr_b16 v[40:41], v16 offset:53248
ds_read_b64_tr_b16 v[42:43], v16 offset:53504
s_waitcnt lgkmcnt(4)
v_add_u32_dpp v22, v22, v22 row_ror:1 row_mask:0xf bank_mask:0xf
v_mfma_f32_32x32x16_bf16 v[96:111], v[48:51], v[220:223], v[96:111]
ds_read_b64_tr_b16 v[44:45], v16 offset:55296
ds_read_b64_tr_b16 v[46:47], v16 offset:55552
v_add_u32_dpp v22, v22, v22 row_bcast:15 row_mask:0xa bank_mask:0xf
v_mfma_f32_32x32x16_bf16 v[96:111], v[52:55], v[224:227], v[96:111]
ds_read_b64_tr_b16 v[48:49], v16 offset:57344
ds_read_b64_tr_b16 v[50:51], v16 offset:57600
s_waitcnt lgkmcnt(4)
v_add_u32_dpp v22, v22, v22 row_bcast:31 row_mask:0xc bank_mask:0xf
v_add_u32 v22, v22, v23
buffer_store_dwordx2 v[22:23], v21, s[36:39], s9 offen sc1
v_mfma_f32_32x32x16_bf16 v[96:111], v[36:39], v[228:231], v[96:111]
ds_read_b64_tr_b16 v[52:53], v16 offset:59392
ds_read_b64_tr_b16 v[54:55], v16 offset:59648
v_mfma_f32_32x32x16_bf16 v[112:127], v[40:43], v[176:179], v[112:127]
ds_read_b64_tr_b16 v[36:37], v16 offset:61440
ds_read_b64_tr_b16 v[38:39], v16 offset:61696
s_waitcnt lgkmcnt(4)
v_mfma_f32_32x32x16_bf16 v[112:127], v[44:47], v[180:183], v[112:127]
ds_read_b64_tr_b16 v[40:41], v16 offset:63488
ds_read_b64_tr_b16 v[42:43], v16 offset:63744
s_nop 2
v_cvt_pk_bf16_f32 v96, v96, v97
v_cvt_pk_bf16_f32 v97, v98, v99
v_cvt_pk_bf16_f32 v98, v100, v101
v_mfma_f32_32x32x16_bf16 v[112:127], v[48:51], v[184:187], v[112:127]
s_barrier
ds_read_b64_tr_b16 v[44:45], v12 offset:4096
ds_read_b64_tr_b16 v[46:47], v12 offset:4352
s_waitcnt lgkmcnt(4)
v_cvt_pk_bf16_f32 v99, v102, v103
buffer_store_dwordx4 v[96:99], v24, s[36:39], s50 offen offset:0 sc1
v_cvt_pk_bf16_f32 v100, v104, v105
v_mfma_f32_32x32x16_bf16 v[112:127], v[52:55], v[188:191], v[112:127]
ds_read_b64_tr_b16 v[48:49], v12 offset:6144
ds_read_b64_tr_b16 v[50:51], v12 offset:6400
v_cvt_pk_bf16_f32 v101, v106, v107
v_cvt_pk_bf16_f32 v102, v108, v109
v_cvt_pk_bf16_f32 v103, v110, v111
v_mfma_f32_32x32x16_bf16 v[112:127], v[36:39], v[192:195], v[112:127]
ds_read_b64_tr_b16 v[52:53], v12 offset:34816
ds_read_b64_tr_b16 v[54:55], v12 offset:35072
s_waitcnt lgkmcnt(4)
v_add3_u32 v22, v96, v97, v98
v_add3_u32 v1, v99, v100, v101
v_add3_u32 v22, v22, v102, v103
v_mfma_f32_32x32x16_bf16 v[112:127], v[40:43], v[196:199], v[112:127]
ds_read_b64_tr_b16 v[36:37], v12 offset:36864
ds_read_b64_tr_b16 v[38:39], v12 offset:37120
v_add_u32 v22, v22, v1
v_mul_lo_u32 v22, v22, v13
buffer_store_dwordx4 v[100:103], v24, s[36:39], s50 offen offset:1024 sc1
v_mfma_f32_32x32x16_bf16 v[112:127], v[44:47], v[200:203], v[112:127]
ds_read_b64_tr_b16 v[40:41], v12 offset:8192
ds_read_b64_tr_b16 v[42:43], v12 offset:8448
s_waitcnt lgkmcnt(4)
v_mfma_f32_32x32x16_bf16 v[112:127], v[48:51], v[204:207], v[112:127]
ds_read_b64_tr_b16 v[44:45], v12 offset:10240
ds_read_b64_tr_b16 v[46:47], v12 offset:10496
v_add_u32_dpp v22, v22, v22 row_ror:8 row_mask:0xf bank_mask:0xf
v_mfma_f32_32x32x16_bf16 v[112:127], v[52:55], v[208:211], v[112:127]
ds_read_b64_tr_b16 v[48:49], v12 offset:38912
ds_read_b64_tr_b16 v[50:51], v12 offset:39168
s_waitcnt lgkmcnt(4)
v_add_u32_dpp v22, v22, v22 row_ror:4 row_mask:0xf bank_mask:0xf
v_mfma_f32_32x32x16_bf16 v[112:127], v[36:39], v[212:215], v[112:127]
ds_read_b64_tr_b16 v[52:53], v12 offset:40960
ds_read_b64_tr_b16 v[54:55], v12 offset:41216
v_add_u32_dpp v22, v22, v22 row_ror:2 row_mask:0xf bank_mask:0xf
v_mfma_f32_32x32x16_bf16 v[112:127], v[40:43], v[216:219], v[112:127]
s_barrier
ds_read_b64_tr_b16 v[36:37], v12 offset:12288
ds_read_b64_tr_b16 v[38:39], v12 offset:12544
s_waitcnt lgkmcnt(4)
v_add_u32_dpp v22, v22, v22 row_ror:1 row_mask:0xf bank_mask:0xf
v_mfma_f32_32x32x16_bf16 v[112:127], v[44:47], v[220:223], v[112:127]
ds_read_b64_tr_b16 v[40:41], v12 offset:14336
ds_read_b64_tr_b16 v[42:43], v12 offset:14592
v_add_u32_dpp v22, v22, v22 row_bcast:15 row_mask:0xa bank_mask:0xf
v_mfma_f32_32x32x16_bf16 v[112:127], v[48:51], v[224:227], v[112:127]
ds_read_b64_tr_b16 v[44:45], v12 offset:43008
ds_read_b64_tr_b16 v[46:47], v12 offset:43264
s_waitcnt lgkmcnt(4)
v_add_u32_dpp v22, v22, v22 row_bcast:31 row_mask:0xc bank_mask:0xf
v_add_u32 v22, v22, v23
buffer_store_dwordx2 v[22:23], v21, s[36:39], s10 offen sc1
v_mfma_f32_32x32x16_bf16 v[112:127], v[52:55], v[228:231], v[112:127]
ds_read_b64_tr_b16 v[48:49], v12 offset:45056
ds_read_b64_tr_b16 v[50:51], v12 offset:45312
v_mfma_f32_32x32x16_bf16 v[128:143], v[36:39], v[176:179], v[128:143]
ds_read_b64_tr_b16 v[52:53], v12 offset:16384
ds_read_b64_tr_b16 v[54:55], v12 offset:16640
s_waitcnt lgkmcnt(4)
v_mfma_f32_32x32x16_bf16 v[128:143], v[40:43], v[180:183], v[128:143]
ds_read_b64_tr_b16 v[36:37], v12 offset:18432
ds_read_b64_tr_b16 v[38:39], v12 offset:18688
s_nop 2
v_cvt_pk_bf16_f32 v112, v112, v113
v_cvt_pk_bf16_f32 v113, v114, v115
v_cvt_pk_bf16_f32 v114, v116, v117
v_cvt_pk_bf16_f32 v115, v118, v119
v_mfma_f32_32x32x16_bf16 v[128:143], v[44:47], v[184:187], v[128:143]
ds_read_b64_tr_b16 v[40:41], v12 offset:47104
ds_read_b64_tr_b16 v[42:43], v12 offset:47360
s_waitcnt lgkmcnt(4)
buffer_store_dwordx4 v[112:115], v24, s[36:39], s51 offen offset:0 sc1
v_cvt_pk_bf16_f32 v116, v120, v121
v_cvt_pk_bf16_f32 v117, v122, v123
v_cvt_pk_bf16_f32 v118, v124, v125
v_mfma_f32_32x32x16_bf16 v[128:143], v[48:51], v[188:191], v[128:143]
ds_read_b64_tr_b16 v[44:45], v12 offset:49152
ds_read_b64_tr_b16 v[46:47], v12 offset:49408
v_cvt_pk_bf16_f32 v119, v126, v127
v_add3_u32 v22, v112, v113, v114
v_add3_u32 v1, v115, v116, v117
v_add3_u32 v22, v22, v118, v119
v_mfma_f32_32x32x16_bf16 v[128:143], v[52:55], v[192:195], v[128:143]
s_barrier
ds_read_b64_tr_b16 v[48:49], v17 offset:0
ds_read_b64_tr_b16 v[50:51], v17 offset:256
s_waitcnt lgkmcnt(4)
v_add_u32 v22, v22, v1
v_mul_lo_u32 v22, v22, v13
buffer_store_dwordx4 v[116:119], v24, s[36:39], s51 offen offset:1024 sc1
v_mfma_f32_32x32x16_bf16 v[128:143], v[36:39], v[196:199], v[128:143]
ds_read_b64_tr_b16 v[52:53], v17 offset:2048
ds_read_b64_tr_b16 v[54:55], v17 offset:2304
v_add_u32_dpp v22, v22, v22 row_ror:8 row_mask:0xf bank_mask:0xf
s_nop 1
v_add_u32_dpp v22, v22, v22 row_ror:4 row_mask:0xf bank_mask:0xf
v_mfma_f32_32x32x16_bf16 v[128:143], v[40:43], v[200:203], v[128:143]
ds_read_b64_tr_b16 v[36:37], v17 offset:4096
ds_read_b64_tr_b16 v[38:39], v17 offset:4352
s_waitcnt lgkmcnt(4)
v_add_u32_dpp v22, v22, v22 row_ror:2 row_mask:0xf bank_mask:0xf
s_nop 1
v_add_u32_dpp v22, v22, v22 row_ror:1 row_mask:0xf bank_mask:0xf
v_mfma_f32_32x32x16_bf16 v[128:143], v[44:47], v[204:207], v[128:143]
ds_read_b64_tr_b16 v[40:41], v17 offset:6144
ds_read_b64_tr_b16 v[42:43], v17 offset:6400
v_add_u32_dpp v22, v22, v22 row_bcast:15 row_mask:0xa bank_mask:0xf
s_nop 1
v_add_u32_dpp v22, v22, v22 row_bcast:31 row_mask:0xc bank_mask:0xf
v_add_u32 v22, v22, v23
buffer_store_dwordx2 v[22:23], v21, s[36:39], s11 offen sc1
v_mfma_f32_32x32x16_bf16 v[128:143], v[48:51], v[208:211], v[128:143]
ds_read_b64_tr_b16 v[44:45], v17 offset:8192
ds_read_b64_tr_b16 v[46:47], v17 offset:8448
s_waitcnt lgkmcnt(4)
v_mfma_f32_32x32x16_bf16 v[128:143], v[52:55], v[212:215], v[128:143]
ds_read_b64_tr_b16 v[48:49], v17 offset:10240
ds_read_b64_tr_b16 v[50:51], v17 offset:10496
v_mfma_f32_32x32x16_bf16 v[128:143], v[36:39], v[216:219], v[128:143]
ds_read_b64_tr_b16 v[52:53], v17 offset:12288
ds_read_b64_tr_b16 v[54:55], v17 offset:12544
s_waitcnt lgkmcnt(4)
v_mfma_f32_32x32x16_bf16 v[128:143], v[40:43], v[220:223], v[128:143]
ds_read_b64_tr_b16 v[36:37], v17 offset:14336
ds_read_b64_tr_b16 v[38:39], v17 offset:14592
v_mfma_f32_32x32x16_bf16 v[128:143], v[44:47], v[224:227], v[128:143]
s_barrier
ds_read_b64_tr_b16 v[40:41], v17 offset:16384
ds_read_b64_tr_b16 v[42:43], v17 offset:16640
s_waitcnt lgkmcnt(4)
v_mfma_f32_32x32x16_bf16 v[128:143], v[48:51], v[228:231], v[128:143]
ds_read_b64_tr_b16 v[44:45], v17 offset:18432
ds_read_b64_tr_b16 v[46:47], v17 offset:18688
v_mfma_f32_32x32x16_bf16 v[144:159], v[52:55], v[176:179], v[144:159]
ds_read_b64_tr_b16 v[48:49], v17 offset:20480
ds_read_b64_tr_b16 v[50:51], v17 offset:20736
s_waitcnt lgkmcnt(4)
v_mfma_f32_32x32x16_bf16 v[144:159], v[36:39], v[180:183], v[144:159]
ds_read_b64_tr_b16 v[52:53], v17 offset:22528
ds_read_b64_tr_b16 v[54:55], v17 offset:22784
s_nop 2
v_cvt_pk_bf16_f32 v128, v128, v129
v_cvt_pk_bf16_f32 v129, v130, v131
v_cvt_pk_bf16_f32 v130, v132, v133
v_cvt_pk_bf16_f32 v131, v134, v135
v_mfma_f32_32x32x16_bf16 v[144:159], v[40:43], v[184:187], v[144:159]
ds_read_b64_tr_b16 v[36:37], v17 offset:24576
ds_read_b64_tr_b16 v[38:39], v17 offset:24832
s_waitcnt lgkmcnt(4)
buffer_store_dwordx4 v[128:131], v24, s[36:39], s52 offen offset:0 sc1
v_cvt_pk_bf16_f32 v132, v136, v137
v_cvt_pk_bf16_f32 v133, v138, v139
v_cvt_pk_bf16_f32 v134, v140, v141
v_mfma_f32_32x32x16_bf16 v[144:159], v[44:47], v[188:191], v[144:159]
ds_read_b64_tr_b16 v[40:41], v17 offset:26624
ds_read_b64_tr_b16 v[42:43], v17 offset:26880
v_cvt_pk_bf16_f32 v135, v142, v143
v_add3_u32 v22, v128, v129, v130
v_add3_u32 v1, v131, v132, v133
v_add3_u32 v22, v22, v134, v135
v_mfma_f32_32x32x16_bf16 v[144:159], v[48:51], v[192:195], v[144:159]
ds_read_b64_tr_b16 v[44:45], v17 offset:28672
ds_read_b64_tr_b16 v[46:47], v17 offset:28928
s_waitcnt lgkmcnt(4)
v_add_u32 v22, v22, v1
v_mul_lo_u32 v22, v22, v13
buffer_store_dwordx4 v[132:135], v24, s[36:39], s52 offen offset:1024 sc1
v_mfma_f32_32x32x16_bf16 v[144:159], v[52:55], v[196:199], v[144:159]
ds_read_b64_tr_b16 v[48:49], v17 offset:30720
ds_read_b64_tr_b16 v[50:51], v17 offset:30976
v_add_u32_dpp v22, v22, v22 row_ror:8 row_mask:0xf bank_mask:0xf
s_nop 1
v_add_u32_dpp v22, v22, v22 row_ror:4 row_mask:0xf bank_mask:0xf
v_mfma_f32_32x32x16_bf16 v[144:159], v[36:39], v[200:203], v[144:159]
s_barrier
ds_read_b64_tr_b16 v[52:53], v16 offset:0
ds_read_b64_tr_b16 v[54:55], v16 offset:256
s_waitcnt lgkmcnt(4)
v_add_u32_dpp v22, v22, v22 row_ror:2 row_mask:0xf bank_mask:0xf
s_nop 1
v_add_u32_dpp v22, v22, v22 row_ror:1 row_mask:0xf bank_mask:0xf
v_mfma_f32_32x32x16_bf16 v[144:159], v[40:43], v[204:207], v[144:159]
ds_read_b64_tr_b16 v[36:37], v16 offset:2048
ds_read_b64_tr_b16 v[38:39], v16 offset:2304
v_add_u32_dpp v22, v22, v22 row_bcast:15 row_mask:0xa bank_mask:0xf
s_nop 1
v_add_u32_dpp v22, v22, v22 row_bcast:31 row_mask:0xc bank_mask:0xf
v_add_u32 v22, v22, v23
buffer_store_dwordx2 v[22:23], v21, s[36:39], s12 offen sc1
v_mfma_f32_32x32x16_bf16 v[144:159], v[44:47], v[208:211], v[144:159]
ds_read_b64_tr_b16 v[40:41], v16 offset:4096
ds_read_b64_tr_b16 v[42:43], v16 offset:4352
s_waitcnt lgkmcnt(4)
v_mfma_f32_32x32x16_bf16 v[144:159], v[48:51], v[212:215], v[144:159]
ds_read_b64_tr_b16 v[44:45], v16 offset:6144
ds_read_b64_tr_b16 v[46:47], v16 offset:6400
v_mfma_f32_32x32x16_bf16 v[144:159], v[52:55], v[216:219], v[144:159]
ds_read_b64_tr_b16 v[48:49], v16 offset:8192
ds_read_b64_tr_b16 v[50:51], v16 offset:8448
s_waitcnt lgkmcnt(4)
v_mfma_f32_32x32x16_bf16 v[144:159], v[36:39], v[220:223], v[144:159]
ds_read_b64_tr_b16 v[52:53], v16 offset:10240
ds_read_b64_tr_b16 v[54:55], v16 offset:10496
v_mfma_f32_32x32x16_bf16 v[144:159], v[40:43], v[224:227], v[144:159]
ds_read_b64_tr_b16 v[36:37], v16 offset:12288
ds_read_b64_tr_b16 v[38:39], v16 offset:12544
s_waitcnt lgkmcnt(4)
v_mfma_f32_32x32x16_bf16 v[144:159], v[44:47], v[228:231], v[144:159]
ds_read_b64_tr_b16 v[40:41], v16 offset:14336
ds_read_b64_tr_b16 v[42:43], v16 offset:14592
v_mfma_f32_32x32x16_bf16 v[160:175], v[48:51], v[176:179], v[160:175]
s_barrier
ds_read_b64_tr_b16 v[44:45], v16 offset:16384
ds_read_b64_tr_b16 v[46:47], v16 offset:16640
s_waitcnt lgkmcnt(4)
v_mfma_f32_32x32x16_bf16 v[160:175], v[52:55], v[180:183], v[160:175]
ds_read_b64_tr_b16 v[48:49], v16 offset:18432
ds_read_b64_tr_b16 v[50:51], v16 offset:18688
s_nop 1
v_cvt_pk_bf16_f32 v144, v144, v145
v_cvt_pk_bf16_f32 v145, v146, v147
v_cvt_pk_bf16_f32 v146, v148, v149
v_cvt_pk_bf16_f32 v147, v150, v151
v_mfma_f32_32x32x16_bf16 v[160:175], v[36:39], v[184:187], v[160:175]
ds_read_b64_tr_b16 v[52:53], v16 offset:20480
ds_read_b64_tr_b16 v[54:55], v16 offset:20736
s_waitcnt lgkmcnt(4)
buffer_store_dwordx4 v[144:147], v24, s[36:39], s53 offen offset:0 sc1
v_cvt_pk_bf16_f32 v148, v152, v153
v_cvt_pk_bf16_f32 v149, v154, v155
v_cvt_pk_bf16_f32 v150, v156, v157
v_mfma_f32_32x32x16_bf16 v[160:175], v[40:43], v[188:191], v[160:175]
ds_read_b64_tr_b16 v[36:37], v16 offset:22528
ds_read_b64_tr_b16 v[38:39], v16 offset:22784
v_cvt_pk_bf16_f32 v151, v158, v159
v_add3_u32 v22, v144, v145, v146
v_add3_u32 v1, v147, v148, v149
v_add3_u32 v22, v22, v150, v151
v_mfma_f32_32x32x16_bf16 v[160:175], v[44:47], v[192:195], v[160:175]
ds_read_b64_tr_b16 v[40:41], v16 offset:24576
ds_read_b64_tr_b16 v[42:43], v16 offset:24832
s_waitcnt lgkmcnt(4)
v_add_u32 v22, v22, v1
v_mul_lo_u32 v22, v22, v13
buffer_store_dwordx4 v[148:151], v24, s[36:39], s53 offen offset:1024 sc1
v_mfma_f32_32x32x16_bf16 v[160:175], v[48:51], v[196:199], v[160:175]
ds_read_b64_tr_b16 v[44:45], v16 offset:26624
ds_read_b64_tr_b16 v[46:47], v16 offset:26880
v_add_u32_dpp v22, v22, v22 row_ror:8 row_mask:0xf bank_mask:0xf
s_nop 1
v_add_u32_dpp v22, v22, v22 row_ror:4 row_mask:0xf bank_mask:0xf
v_mfma_f32_32x32x16_bf16 v[160:175], v[52:55], v[200:203], v[160:175]
ds_read_b64_tr_b16 v[48:49], v16 offset:28672
ds_read_b64_tr_b16 v[50:51], v16 offset:28928
s_waitcnt lgkmcnt(4)
v_add_u32_dpp v22, v22, v22 row_ror:2 row_mask:0xf bank_mask:0xf
s_nop 1
v_add_u32_dpp v22, v22, v22 row_ror:1 row_mask:0xf bank_mask:0xf
v_mfma_f32_32x32x16_bf16 v[160:175], v[36:39], v[204:207], v[160:175]
ds_read_b64_tr_b16 v[52:53], v16 offset:30720
ds_read_b64_tr_b16 v[54:55], v16 offset:30976
v_add_u32_dpp v22, v22, v22 row_bcast:15 row_mask:0xa bank_mask:0xf
s_nop 1
v_add_u32_dpp v22, v22, v22 row_bcast:31 row_mask:0xc bank_mask:0xf
v_add_u32 v22, v22, v23
buffer_store_dwordx2 v[22:23], v21, s[36:39], s13 offen sc1
v_mfma_f32_32x32x16_bf16 v[160:175], v[40:43], v[208:211], v[160:175]
ds_read_b64_tr_b16 v[36:37], v16 offset:32768
ds_read_b64_tr_b16 v[38:39], v16 offset:33024
s_waitcnt lgkmcnt(4)
s_barrier
v_mfma_f32_32x32x16_bf16 v[160:175], v[44:47], v[212:215], v[160:175]
ds_read_b64_tr_b16 v[40:41], v16 offset:34816
ds_read_b64_tr_b16 v[42:43], v16 offset:35072
v_mfma_f32_32x32x16_bf16 v[160:175], v[48:51], v[216:219], v[160:175]
s_waitcnt lgkmcnt(2)
v_mfma_f32_32x32x16_bf16 v[160:175], v[52:55], v[220:223], v[160:175]
v_mfma_f32_32x32x16_bf16 v[160:175], v[36:39], v[224:227], v[160:175]
s_waitcnt lgkmcnt(0)
v_mfma_f32_32x32x16_bf16 v[160:175], v[40:43], v[228:231], v[160:175]
s_lshl_b32 s59, s31, 11
s_add_u32 s59, s59, 16384
v_add_u32 v2, s59, v11
s_lshl_b32 s59, s3, 8
v_lshl_add_u32 v3, v0, 2, s59
s_nop 6
ds_write_b128 v2, v[160:163] offset:0
ds_write_b128 v2, v[164:167] offset:1024
ds_write_b128 v2, v[168:171] offset:2048
ds_write_b128 v2, v[172:175] offset:3072
ds_write_b32 v3, v27
s_endpgm
cE_l2_1:
buffer_load_dwordx4 v[208:211], v20, s[36:39], s59 offen offset:0 sc1
buffer_load_dwordx4 v[212:215], v20, s[36:39], s59 offen offset:1024 sc1
buffer_load_dwordx4 v[216:219], v20, s[36:39], s59 offen offset:2048 sc1
buffer_load_dwordx4 v[220:223], v20, s[36:39], s59 offen offset:3072 sc1
buffer_load_dwordx4 v[224:227], v20, s[36:39], s60 offen offset:0 sc1
buffer_load_dwordx4 v[228:231], v20, s[36:39], s60 offen offset:1024 sc1
buffer_load_dwordx4 v[232:235], v20, s[36:39], s60 offen offset:2048 sc1
buffer_load_dwordx4 v[236:239], v20, s[36:39], s60 offen offset:3072 sc1
s_waitcnt vmcnt(0)
s_branch cE_l2c2
.p2align 6
gather_E:
gE_top:
s_mov_b32 s31, 1
s_mov_b32 s27, 0xffff0000
s_waitcnt vmcnt(0)
ds_read2_b64 v[128:131], v38 offset0:0 offset1:4
ds_read2_b64 v[132:135], v38 offset0:2 offset1:6
s_cmp_lg_u32 s9, s26
s_cbranch_scc1 gE_wait0
gE_go0:
buffer_load_dwordx4 v[64:67], v39, s[36:39], s50 offen offset:0 sc1
buffer_load_dwordx4 v[68:71], v39, s[36:39], s50 offen offset:1024 sc1
s_waitcnt lgkmcnt(0)
s_load_dwordx16 s[8:23], s[48:49], 0 glc
v_lshlrev_b32 v16, 16, v128
v_and_b32 v17, s27, v128
v_lshlrev_b32 v18, 16, v129
v_and_b32 v19, s27, v129
v_lshlrev_b32 v20, 16, v130
v_and_b32 v21, s27, v130
v_lshlrev_b32 v22, 16, v131
v_and_b32 v23, s27, v131
v_lshlrev_b32 v24, 16, v132
v_and_b32 v25, s27, v132
v_lshlrev_b32 v26, 16, v133
v_and_b32 v27, s27, v133
v_lshlrev_b32 v28, 16, v134
v_and_b32 v29, s27, v134
v_lshlrev_b32 v30, 16, v135
v_and_b32 v31, s27, v135
s_mov_b32 s31, 0
s_cmp_lg_u32 s11, s26
s_cbranch_scc1 gE_wait1
gE_go1:
buffer_load_dwordx4 v[72:75], v39, s[36:39], s51 offen offset:0 sc1
buffer_load_dwordx4 v[76:79], v39, s[36:39], s51 offen offset:1024 sc1
s_cmp_lg_u32 s13, s26
s_cbranch_scc1 gE_wait2
gE_go2:
buffer_load_dwordx4 v[80:83], v39, s[36:39], s52 offen offset:0 sc1
buffer_load_dwordx4 v[84:87], v39, s[36:39], s52 offen offset:1024 sc1
v_dot2c_f32_bf16 v16, v136, v35
v_dot2c_f32_bf16 v17, v136, v15
v_dot2c_f32_bf16 v18, v137, v35
v_dot2c_f32_bf16 v19, v137, v15
v_dot2c_f32_bf16 v20, v138, v35
v_dot2c_f32_bf16 v21, v138, v15
v_dot2c_f32_bf16 v22, v139, v35
v_dot2c_f32_bf16 v23, v139, v15
v_dot2c_f32_bf16 v24, v140, v35
v_dot2c_f32_bf16 v25, v140, v15
v_dot2c_f32_bf16 v26, v141, v35
v_dot2c_f32_bf16 v27, v141, v15
v_dot2c_f32_bf16 v28, v142, v35
v_dot2c_f32_bf16 v29, v142, v15
v_dot2c_f32_bf16 v30, v143, v35
v_dot2c_f32_bf16 v31, v143, v15
s_cmp_lg_u32 s15, s26
s_cbranch_scc1 gE_wait3
gE_go3:
buffer_load_dwordx4 v[88:91], v39, s[36:39], s53 offen offset:0 sc1
buffer_load_dwordx4 v[92:95], v39, s[36:39], s53 offen offset:1024 sc1
s_waitcnt vmcnt(7)
v_add3_u32 v32, v32, v64, v65
v_add3_u32 v32, v32, v66, v67
s_waitcnt vmcnt(6)
v_add3_u32 v32, v32, v68, v69
v_add3_u32 v32, v32, v70, v71
v_dot2c_f32_bf16 v16, v64, v35
v_dot2c_f32_bf16 v17, v64, v15
v_dot2c_f32_bf16 v18, v65, v35
v_dot2c_f32_bf16 v19, v65, v15
v_dot2c_f32_bf16 v20, v66, v35
v_dot2c_f32_bf16 v21, v66, v15
v_dot2c_f32_bf16 v22, v67, v35
v_dot2c_f32_bf16 v23, v67, v15
v_dot2c_f32_bf16 v24, v68, v35
v_dot2c_f32_bf16 v25, v68, v15
v_dot2c_f32_bf16 v26, v69, v35
v_dot2c_f32_bf16 v27, v69, v15
v_dot2c_f32_bf16 v28, v70, v35
v_dot2c_f32_bf16 v29, v70, v15
v_dot2c_f32_bf16 v30, v71, v35
v_dot2c_f32_bf16 v31, v71, v15
s_cmp_lg_u32 s17, s26
s_cbranch_scc1 gE_wait4
gE_go4:
buffer_load_dwordx4 v[96:99], v39, s[36:39], s54 offen offset:0 sc1
buffer_load_dwordx4 v[100:103], v39, s[36:39], s54 offen offset:1024 sc1
s_waitcnt vmcnt(7)
v_add3_u32 v32, v32, v72, v73
v_add3_u32 v32, v32, v74, v75
s_waitcnt vmcnt(6)
v_add3_u32 v32, v32, v76, v77
v_add3_u32 v32, v32, v78, v79
v_dot2c_f32_bf16 v16, v72, v35
v_dot2c_f32_bf16 v17, v72, v15
v_dot2c_f32_bf16 v18, v73, v35
v_dot2c_f32_bf16 v19, v73, v15
v_dot2c_f32_bf16 v20, v74, v35
v_dot2c_f32_bf16 v21, v74, v15
v_dot2c_f32_bf16 v22, v75, v35
v_dot2c_f32_bf16 v23, v75, v15
v_dot2c_f32_bf16 v24, v76, v35
v_dot2c_f32_bf16 v25, v76, v15
v_dot2c_f32_bf16 v26, v77, v35
v_dot2c_f32_bf16 v27, v77, v15
v_dot2c_f32_bf16 v28, v78, v35
v_dot2c_f32_bf16 v29, v78, v15
v_dot2c_f32_bf16 v30, v79, v35
v_dot2c_f32_bf16 v31, v79, v15
s_cmp_lg_u32 s19, s26
s_cbranch_scc1 gE_wait5
gE_go5:
buffer_load_dwordx4 v[104:107], v39, s[36:39], s55 offen offset:0 sc1
buffer_load_dwordx4 v[108:111], v39, s[36:39], s55 offen offset:1024 sc1
s_waitcnt vmcnt(7)
v_add3_u32 v32, v32, v80, v81
v_add3_u32 v32, v32, v82, v83
s_waitcnt vmcnt(6)
v_add3_u32 v32, v32, v84, v85
v_add3_u32 v32, v32, v86, v87
v_dot2c_f32_bf16 v16, v80, v35
v_dot2c_f32_bf16 v17, v80, v15
v_dot2c_f32_bf16 v18, v81, v35
v_dot2c_f32_bf16 v19, v81, v15
v_dot2c_f32_bf16 v20, v82, v35
v_dot2c_f32_bf16 v21, v82, v15
v_dot2c_f32_bf16 v22, v83, v35
v_dot2c_f32_bf16 v23, v83, v15
v_dot2c_f32_bf16 v24, v84, v35
v_dot2c_f32_bf16 v25, v84, v15
v_dot2c_f32_bf16 v26, v85, v35
v_dot2c_f32_bf16 v27, v85, v15
v_dot2c_f32_bf16 v28, v86, v35
v_dot2c_f32_bf16 v29, v86, v15
v_dot2c_f32_bf16 v30, v87, v35
v_dot2c_f32_bf16 v31, v87, v15
s_cmp_lg_u32 s21, s26
s_cbranch_scc1 gE_wait6
gE_go6:
buffer_load_dwordx4 v[112:115], v39, s[36:39], s56 offen offset:0 sc1
buffer_load_dwordx4 v[116:119], v39, s[36:39], s56 offen offset:1024 sc1
s_mul_i32 s30, s26, 7
s_sub_u32 s30, s30, s8
s_sub_u32 s30, s30, s10
s_sub_u32 s30, s30, s12
s_sub_u32 s30, s30, s14
s_sub_u32 s30, s30, s16
s_sub_u32 s30, s30, s18
s_sub_u32 s30, s30, s20
s_cmp_lg_u32 s31, 0
s_cbranch_scc1 gE_sum
gE_ownw:
ds_read_b32 v160, v42
s_sub_u32 s63, s63, 1
s_cmp_le_i32 s63, 0
s_waitcnt lgkmcnt(0)
s_cbranch_scc1 gE_redo
v_cmp_eq_u32 vcc, 0, v160
s_cbranch_vccnz gE_ownw
gE_redo:
ds_read_b128 v[160:163], v33 offset:0
ds_read_b128 v[164:167], v33 offset:1024
ds_read_b128 v[168:171], v33 offset:2048
ds_read_b128 v[172:175], v33 offset:3072
s_waitcnt lgkmcnt(0)
v_add_f32 v16, v16, v160
v_add_f32 v17, v17, v161
v_add_f32 v18, v18, v162
v_add_f32 v19, v19, v163
v_add_f32 v20, v20, v164
v_add_f32 v21, v21, v165
v_add_f32 v22, v22, v166
v_add_f32 v23, v23, v167
v_add_f32 v24, v24, v168
v_add_f32 v25, v25, v169
v_add_f32 v26, v26, v170
v_add_f32 v27, v27, v171
v_add_f32 v28, v28, v172
v_add_f32 v29, v29, v173
v_add_f32 v30, v30, v174
v_add_f32 v31, v31, v175
gE_sum:
s_waitcnt vmcnt(7)
v_add3_u32 v32, v32, v88, v89
v_add3_u32 v32, v32, v90, v91
s_waitcnt vmcnt(6)
v_add3_u32 v32, v32, v92, v93
v_add3_u32 v32, v32, v94, v95
v_dot2c_f32_bf16 v16, v88, v35
v_dot2c_f32_bf16 v17, v88, v15
v_dot2c_f32_bf16 v18, v89, v35
v_dot2c_f32_bf16 v19, v89, v15
v_dot2c_f32_bf16 v20, v90, v35
v_dot2c_f32_bf16 v21, v90, v15
v_dot2c_f32_bf16 v22, v91, v35
v_dot2c_f32_bf16 v23, v91, v15
v_dot2c_f32_bf16 v24, v92, v35
v_dot2c_f32_bf16 v25, v92, v15
v_dot2c_f32_bf16 v26, v93, v35
v_dot2c_f32_bf16 v27, v93, v15
v_dot2c_f32_bf16 v28, v94, v35
v_dot2c_f32_bf16 v29, v94, v15
v_dot2c_f32_bf16 v30, v95, v35
v_dot2c_f32_bf16 v31, v95, v15
s_waitcnt vmcnt(5)
v_add3_u32 v32, v32, v96, v97
v_add3_u32 v32, v32, v98, v99
s_waitcnt vmcnt(4)
v_add3_u32 v32, v32, v100, v101
v_add3_u32 v32, v32, v102, v103
v_dot2c_f32_bf16 v16, v96, v35
v_dot2c_f32_bf16 v17, v96, v15
v_dot2c_f32_bf16 v18, v97, v35
v_dot2c_f32_bf16 v19, v97, v15
v_dot2c_f32_bf16 v20, v98, v35
v_dot2c_f32_bf16 v21, v98, v15
v_dot2c_f32_bf16 v22, v99, v35
v_dot2c_f32_bf16 v23, v99, v15
v_dot2c_f32_bf16 v24, v100, v35
v_dot2c_f32_bf16 v25, v100, v15
v_dot2c_f32_bf16 v26, v101, v35
v_dot2c_f32_bf16 v27, v101, v15
v_dot2c_f32_bf16 v28, v102, v35
v_dot2c_f32_bf16 v29, v102, v15
v_dot2c_f32_bf16 v30, v103, v35
v_dot2c_f32_bf16 v31, v103, v15
s_waitcnt vmcnt(3)
v_add3_u32 v32, v32, v104, v105
v_add3_u32 v32, v32, v106, v107
s_waitcnt vmcnt(2)
v_add3_u32 v32, v32, v108, v109
v_add3_u32 v32, v32, v110, v111
v_dot2c_f32_bf16 v16, v104, v35
v_dot2c_f32_bf16 v17, v104, v15
v_dot2c_f32_bf16 v18, v105, v35
v_dot2c_f32_bf16 v19, v105, v15
v_dot2c_f32_bf16 v20, v106, v35
v_dot2c_f32_bf16 v21, v106, v15
v_dot2c_f32_bf16 v22, v107, v35
v_dot2c_f32_bf16 v23, v107, v15
v_dot2c_f32_bf16 v24, v108, v35
v_dot2c_f32_bf16 v25, v108, v15
v_dot2c_f32_bf16 v26, v109, v35
v_dot2c_f32_bf16 v27, v109, v15
v_dot2c_f32_bf16 v28, v110, v35
v_dot2c_f32_bf16 v29, v110, v15
v_dot2c_f32_bf16 v30, v111, v35
v_dot2c_f32_bf16 v31, v111, v15
s_waitcnt vmcnt(0)
v_add3_u32 v32, v32, v112, v113
v_add3_u32 v32, v32, v114, v115
v_add3_u32 v32, v32, v116, v117
v_add3_u32 v32, v32, v118, v119
v_mul_lo_u32 v32, v32, v43
v_dot2c_f32_bf16 v16, v112, v35
v_dot2c_f32_bf16 v17, v112, v15
v_add_u32_dpp v32, v32, v32 row_ror:8 row_mask:0xf bank_mask:0xf
v_dot2c_f32_bf16 v18, v113, v35
v_dot2c_f32_bf16 v19, v113, v15
v_add_u32_dpp v32, v32, v32 row_ror:4 row_mask:0xf bank_mask:0xf
v_dot2c_f32_bf16 v20, v114, v35
v_dot2c_f32_bf16 v21, v114, v15
v_add_u32_dpp v32, v32, v32 row_ror:2 row_mask:0xf bank_mask:0xf
v_dot2c_f32_bf16 v22, v115, v35
v_dot2c_f32_bf16 v23, v115, v15
v_add_u32_dpp v32, v32, v32 row_ror:1 row_mask:0xf bank_mask:0xf
v_dot2c_f32_bf16 v24, v116, v35
v_dot2c_f32_bf16 v25, v116, v15
v_add_u32_dpp v32, v32, v32 row_bcast:15 row_mask:0xa bank_mask:0xf
v_dot2c_f32_bf16 v26, v117, v35
v_dot2c_f32_bf16 v27, v117, v15
v_add_u32_dpp v32, v32, v32 row_bcast:31 row_mask:0xc bank_mask:0xf
v_dot2c_f32_bf16 v28, v118, v35
v_dot2c_f32_bf16 v29, v118, v15
v_readlane_b32 s59, v32, 63
v_dot2c_f32_bf16 v30, v119, v35
v_dot2c_f32_bf16 v31, v119, v15
s_add_u32 s59, s59, s30
s_cmp_lg_u32 s59, 0
s_cbranch_scc1 gE_fail
gE_done:
s_waitcnt lgkmcnt(0)
v_cvt_pk_bf16_f32 v16, v16, v17
v_cvt_pk_bf16_f32 v17, v18, v19
v_cvt_pk_bf16_f32 v18, v20, v21
v_cvt_pk_bf16_f32 v19, v22, v23
ds_write2_b64 v40, v[16:17], v[18:19] offset0:0 offset1:4
v_cvt_pk_bf16_f32 v20, v24, v25
v_cvt_pk_bf16_f32 v21, v26, v27
v_cvt_pk_bf16_f32 v22, v28, v29
v_cvt_pk_bf16_f32 v23, v30, v31
ds_write2_b64 v40, v[20:21], v[22:23] offset0:2 offset1:6
ds_read_b128 v[24:27], v41 offset:0
ds_read_b128 v[28:31], v41 offset:1280
s_waitcnt lgkmcnt(1)
buffer_store_dwordx4 v[24:27], v36, s[44:47], s60 offen
s_waitcnt lgkmcnt(0)
buffer_store_dwordx4 v[28:31], v36, s[44:47], s57 offen
s_lshl_b32 s59, s5, 3
s_add_u32 s59, s59, s4
s_lshl_b32 s59, s59, 3
s_add_u32 s59, s59, s3
s_cmp_lg_u32 s59, 23
s_cbranch_scc1 gE_exit
s_mov_b64 exec, 1
buffer_store_dword v34, v39, s[36:39], 0 offen offset:12 sc1
s_mov_b64 exec, -1
gE_exit:
s_endpgm
gE_fail:
s_sub_u32 s63, s63, 64
s_cmp_le_i32 s63, 0
s_cbranch_scc1 gE_done
s_waitcnt lgkmcnt(0)
s_load_dwordx16 s[8:23], s[48:49], 0 glc
v_mov_b32 v32, 0
s_waitcnt lgkmcnt(0)
s_branch gE_top
gE_idle:
s_cmp_lg_u32 s31, 0
s_cbranch_scc1 gE_idle2
ds_read_b32 v160, v42
s_waitcnt lgkmcnt(0)
v_cmp_eq_u32 vcc, 0, v160
s_cbranch_vccnz gE_idle2
s_mov_b32 s31, 1
ds_read_b128 v[160:163], v33 offset:0
ds_read_b128 v[164:167], v33 offset:1024
ds_read_b128 v[168:171], v33 offset:2048
ds_read_b128 v[172:175], v33 offset:3072
s_waitcnt lgkmcnt(0)
s_load_dwordx16 s[8:23], s[48:49], 0 glc
v_add_f32 v16, v16, v160
v_add_f32 v17, v17, v161
v_add_f32 v18, v18, v162
v_add_f32 v19, v19, v163
v_add_f32 v20, v20, v164
v_add_f32 v21, v21, v165
v_add_f32 v22, v22, v166
v_add_f32 v23, v23, v167
v_add_f32 v24, v24, v168
v_add_f32 v25, v25, v169
v_add_f32 v26, v26, v170
v_add_f32 v27, v27, v171
v_add_f32 v28, v28, v172
v_add_f32 v29, v29, v173
v_add_f32 v30, v30, v174
v_add_f32 v31, v31, v175
s_setpc_b64 s[58:59]
gE_idle2:
s_load_dwordx16 s[8:23], s[48:49], 0 glc
s_setpc_b64 s[58:59]
gE_wait0:
s_waitcnt lgkmcnt(0)
s_cmp_eq_u32 s9, s26
s_cbranch_scc1 gE_go0
s_sub_u32 s63, s63, 1
s_cmp_le_i32 s63, 0
s_cbranch_scc1 gE_go0
s_call_b64 s[58:59], gE_idle
s_branch gE_wait0
gE_wait1:
s_waitcnt lgkmcnt(0)
s_cmp_eq_u32 s11, s26
s_cbranch_scc1 gE_go1
s_sub_u32 s63, s63, 1
s_cmp_le_i32 s63, 0
s_cbranch_scc1 gE_go1
s_call_b64 s[58:59], gE_idle
s_branch gE_wait1
gE_wait2:
s_waitcnt lgkmcnt(0)
s_cmp_eq_u32 s13, s26
s_cbranch_scc1 gE_go2
s_sub_u32 s63, s63, 1
s_cmp_le_i32 s63, 0
s_cbranch_scc1 gE_go2
s_call_b64 s[58:59], gE_idle
s_branch gE_wait2
gE_wait3:
s_waitcnt lgkmcnt(0)
s_cmp_eq_u32 s15, s26
s_cbranch_scc1 gE_go3
s_sub_u32 s63, s63, 1
s_cmp_le_i32 s63, 0
s_cbranch_scc1 gE_go3
s_call_b64 s[58:59], gE_idle
s_branch gE_wait3
gE_wait4:
s_waitcnt lgkmcnt(0)
s_cmp_eq_u32 s17, s26
s_cbranch_scc1 gE_go4
s_sub_u32 s63, s63, 1
s_cmp_le_i32 s63, 0
s_cbranch_scc1 gE_go4
s_call_b64 s[58:59], gE_idle
s_branch gE_wait4
gE_wait5:
s_waitcnt lgkmcnt(0)
s_cmp_eq_u32 s19, s26
s_cbranch_scc1 gE_go5
s_sub_u32 s63, s63, 1
s_cmp_le_i32 s63, 0
s_cbranch_scc1 gE_go5
s_call_b64 s[58:59], gE_idle
s_branch gE_wait5
gE_wait6:
s_waitcnt lgkmcnt(0)
s_cmp_eq_u32 s21, s26
s_cbranch_scc1 gE_go6
s_sub_u32 s63, s63, 1
s_cmp_le_i32 s63, 0
s_cbranch_scc1 gE_go6
s_call_b64 s[58:59], gE_idle
s_branch gE_wait6
role_E_end:
s_endpgm
s_endpgm
s_endpgm
s_endpgm
s_endpgm
s_endpgm
s_endpgm
s_endpgm
s_endpgm
s_endpgm
s_endpgm
s_endpgm
s_endpgm
s_endpgm
s_endpgm
s_endpgm
s_endpgm
s_endpgm
s_endpgm
s_endpgm
s_endpgm
s_endpgm
s_endpgm
s_endpgm
s_endpgm
s_endpgm
s_endpgm
s_endpgm
s_endpgm
s_endpgm
s_endpgm
s_endpgm
s_endpgm
s_endpgm
s_endpgm
s_endpgm
s_endpgm
s_endpgm
s_endpgm
s_endpgm
s_endpgm
s_endpgm
s_endpgm
s_endpgm
s_endpgm
s_endpgm
s_endpgm
s_endpgm
s_endpgm
s_endpgm
s_endpgm
s_endpgm
s_endpgm
s_endpgm
s_endpgm
s_endpgm
s_endpgm
s_endpgm
s_endpgm
s_endpgm
s_endpgm
s_endpgm
s_endpgm
s_endpgm
s_endpgm
s_endpgm
s_endpgm
s_endpgm
s_endpgm
s_endpgm
s_endpgm
s_endpgm
s_endpgm
s_endpgm
s_endpgm
s_endpgm
s_endpgm
s_endpgm
s_endpgm
s_endpgm
s_endpgm
s_endpgm
s_endpgm
s_endpgm
s_endpgm
s_endpgm
s_endpgm
s_endpgm
s_endpgm
s_endpgm
s_endpgm
s_endpgm
s_endpgm
s_endpgm
s_endpgm
s_endpgm
s_endpgm
s_endpgm
s_endpgm
s_endpgm
s_endpgm
s_endpgm
s_endpgm
s_endpgm
s_endpgm
s_endpgm
s_endpgm
s_endpgm
s_endpgm
s_endpgm
s_endpgm
s_endpgm
s_endpgm
s_endpgm
s_endpgm
s_endpgm
s_endpgm
s_endpgm
s_endpgm
s_endpgm
s_endpgm
s_endpgm
s_endpgm
s_endpgm
s_endpgm
s_endpgm
s_endpgm
s_endpgm
s_endpgm
s_endpgm
s_endpgm
s_endpgm
s_endpgm
s_endpgm
s_endpgm
s_endpgm
s_endpgm
s_endpgm
s_endpgm
s_endpgm
s_endpgm
s_endpgm
s_endpgm
s_endpgm
s_endpgm
s_endpgm
s_endpgm
s_endpgm
s_endpgm
s_endpgm
s_endpgm
s_endpgm
s_endpgm
s_endpgm
s_endpgm
s_endpgm
s_endpgm
s_endpgm
s_endpgm
s_endpgm
s_endpgm
s_endpgm
s_endpgm
s_endpgm
s_endpgm
s_endpgm
s_endpgm
s_endpgm
s_endpgm
s_endpgm
s_endpgm
s_endpgm
s_endpgm
s_endpgm
s_endpgm
s_endpgm
s_endpgm
s_endpgm
s_endpgm
s_endpgm
s_endpgm
s_endpgm
s_endpgm
s_endpgm
s_endpgm
s_endpgm
s_endpgm
s_endpgm
s_endpgm
s_endpgm
s_endpgm
s_endpgm
s_endpgm
s_endpgm
s_endpgm
s_endpgm
s_endpgm
s_endpgm
s_endpgm
s_endpgm
s_endpgm
s_endpgm
s_endpgm
s_endpgm
s_endpgm
s_endpgm
s_endpgm
s_endpgm
s_endpgm
s_endpgm
s_endpgm
s_endpgm
s_endpgm
s_endpgm
s_endpgm
s_endpgm
s_endpgm
s_endpgm
s_endpgm
s_endpgm
s_endpgm
s_endpgm
s_endpgm
s_endpgm
s_endpgm
s_endpgm
s_endpgm
s_endpgm
s_endpgm
s_endpgm
s_endpgm
s_endpgm
s_endpgm
s_endpgm
s_endpgm
s_endpgm
s_endpgm
s_endpgm
s_endpgm
s_endpgm
s_endpgm
s_endpgm
s_endpgm
s_endpgm
s_endpgm
s_endpgm
s_endpgm
s_endpgm
s_endpgm
s_endpgm
s_endpgm
s_endpgm
s_endpgm
s_endpgm
s_endpgm
s_endpgm
.section .rodata,"a"
.p2align 6
.amdhsa_kernel parallel_sum__linear_attn_block__dense_activation_squared_relu__prompt_kernel
  .amdhsa_next_free_vgpr 256
  .amdhsa_next_free_sgpr 102
  .amdhsa_accum_offset 256
  .amdhsa_group_segment_fixed_size 0
  .amdhsa_kernarg_size 88
  .amdhsa_user_sgpr_count 2
  .amdhsa_user_sgpr_kernarg_segment_ptr 1
  .amdhsa_system_sgpr_workgroup_id_x 1
.end_amdhsa_kernel
```
